```python
import torch

def _softmax(x, axis=-1):
    return torch.softmax(x, dim=axis)
def _gelu(x):
    return torch.nn.functional.gelu(x, approximate="tanh")
def _silu(x):
    return torch.nn.functional.silu(x)
def _sigmoid(x):
    return torch.sigmoid(x)
def _layernorm(x, axis=-1, eps=1e-5):
    m = x.mean(dim=axis, keepdim=True)
    v = x.var(dim=axis, keepdim=True, unbiased=False)
    return (x - m) / torch.sqrt(v + eps)
def _scatter_add(tgt, idx, src, axis=0):
    return tgt.clone().index_add_(axis, idx, src)
def _segment_sum(src, seg, n):
    out = torch.zeros((n,) + src.shape[1:], dtype=src.dtype)
    return out.index_add_(0, seg, src)
def _pad(x, pw):
    flat = tuple(v for pair in reversed(pw) for v in pair)
    return torch.nn.functional.pad(x, flat)

kernel_name = 'sequential_preLN__softmax_full_mha__dense_activation_silu__prompt'

def setup_inputs():

    _w = (lambda a: (lambda t: t.to(torch.bfloat16) if t.is_floating_point() else t)(torch.as_tensor(a)))
    def _A_setup():
        B, S, D = 1, 2048, 640
        return {
            "x": _w((lambda *s: torch.randn(*s, dtype=torch.bfloat16) * 0.05)(B, S, D)),
            "wqkv": _w((lambda *s: torch.randn(*s, dtype=torch.bfloat16) * 0.05)(D, 3 * D)),
            "wo": _w((lambda *s: torch.randn(*s, dtype=torch.bfloat16) * 0.05)(D, D)),
        }
    _A_in = _A_setup()

    def _B_setup():
        B, S, D, F = 1, 2048, 640, 1728
        return {
            "x": _w((lambda *s: torch.randn(*s, dtype=torch.bfloat16) * 0.05)(B, S, D)),
            "w1": _w((lambda *s: torch.randn(*s, dtype=torch.bfloat16) * 1.6)(D, F) * (D ** -0.5)),
            "w2": _w((lambda *s: torch.randn(*s, dtype=torch.bfloat16) * 0.2)(F, D) * (F ** -0.5)),
        }
    _B_in = _B_setup()

    return {
        "A_x": _A_in["x"],
        "A_wqkv": _A_in["wqkv"],
        "A_wo": _A_in["wo"],
        "B_x": _B_in["x"],
        "B_w1": _B_in["w1"],
        "B_w2": _B_in["w2"],
    }

def reference(A_x, A_wqkv, A_wo, B_x, B_w1, B_w2):
    def _A_ref(x, wqkv, wo):
        B, S, D = x.shape
        H = 32; Dh = D // H
        qkv = (lambda x, *d: x.permute(*d))((x @ wqkv).reshape(B, S, 3, H, Dh), 2, 0, 3, 1, 4)
        q, k, v = qkv[0], qkv[1], qkv[2]
        scale = Dh ** -0.5
        scores = torch.einsum("bhqd,bhkd->bhqk", q, k) * scale
        p = _softmax(scores, axis=-1)
        o = torch.einsum("bhqk,bhkd->bhqd", p, v)
        return (lambda x, *d: x.permute(*d))(o, 0, 2, 1, 3).reshape(B, S, D) @ wo

    def _B_ref(x, w1, w2):
        h = torch.einsum("bsd,df->bsf", x, w1)
        h = _silu(h)
        out = torch.einsum("bsf,fd->bsd", h, w2)
        return out

    x = A_x
    h = x + _A_ref(_layernorm(x, axis=-1), A_wqkv, A_wo)
    h2 = h + _B_ref(_layernorm(h, axis=-1), B_w1, B_w2)
    return h2
```

```asm
; @launch grid=(256,1,1) block=(512,1,1) lds=163840
.amdgcn_target "amdgcn-amd-amdhsa--gfx950"
.text
.p2align 12
.globl sequential_preLN__softmax_full_mha__dense_activation_silu__prompt_kernel
.p2align 8
.type sequential_preLN__softmax_full_mha__dense_activation_silu__prompt_kernel,@function
sequential_preLN__softmax_full_mha__dense_activation_silu__prompt_kernel:
    s_cmp_ge_u32 s2, 256
    s_cbranch_scc1 k_end
    s_load_dwordx16 s[4:19], s[0:1], 0
    s_load_dwordx2 s[20:21], s[0:1], 64
    v_lshrrev_b32 v2, 6, v0
    v_and_b32 v1, 63, v0
    v_readfirstlane_b32 s36, v2
    s_lshr_b32 s53, s2, 3
    s_mul_i32 s53, s53, 3
    s_sub_u32 s54, s36, 1
    s_cmp_lt_u32 s54, 3
    s_cbranch_scc0 k_npf
    s_getpc_b64 s[58:59]
    s_add_u32 s53, s53, s54
    s_lshl_b32 s53, s53, 6
    s_add_u32 s58, s58, s53
    s_addc_u32 s59, s59, 0
    s_load_dword s60, s[58:59], 1024
    s_load_dword s60, s[58:59], 7168
    s_load_dword s60, s[58:59], 13312
k_npf:
    s_mov_b32 s26, 27321088
    s_mov_b32 s27, 0x20000
    s_mov_b32 s31, 0x20000
    s_mov_b32 s35, 0x20000
    s_lshr_b32 s53, s2, 3
    s_bfe_u32 s37, s2, 0x20001
    s_lshl_b32 s37, s37, 2
    s_and_b32 s54, s53, 3
    s_add_u32 s37, s37, s54
    s_and_b32 s38, s2, 1
    s_lshl_b32 s38, s38, 3
    s_lshr_b32 s54, s53, 2
    s_add_u32 s38, s38, s54
    s_mul_i32 s53, s37, 3
    s_mul_i32 s54, s38, 1
    s_add_u32 s53, s53, s54
    s_mul_i32 s54, s53, 205
    s_lshr_b32 s54, s54, 11
    s_mul_i32 s54, s54, 10
    s_sub_u32 s70, s53, s54
    s_cmp_eq_u32 s38, 15
    s_cbranch_scc1 k_spare
    s_cmp_lt_u32 s36, 4
    s_cbranch_scc0 k_load
    s_cmp_eq_u32 s36, 0
    s_cbranch_scc0 k_c_nw
    s_lshl_b32 s72, s37, 4
    s_add_u32 s72, s72, s38
    s_mul_i32 s72, s72, 256
    s_add_u32 s73, s72, 26984448
    s_add_u32 s72, s72, 25804800
    s_mul_i32 s74, s2, 256
    s_add_u32 s74, s74, 25870336
    v_mov_b32 v160, 0
    v_mov_b32 v161, 0
    v_mov_b32 v162, 0
    v_mov_b32 v163, 0
    v_lshlrev_b32 v164, 4, v1
    s_waitcnt lgkmcnt(0)
    s_mov_b32 s24, s20
    s_mov_b32 s25, s21
    s_mov_b64 exec, 0xff
    buffer_store_dwordx4 v[160:163], v164, s[24:27], s73 offen sc1
    buffer_store_dwordx4 v[160:163], v164, s[24:27], s72 offen sc1
    buffer_store_dwordx4 v[160:163], v164, s[24:27], s74 offen sc1
    s_mov_b64 exec, -1
k_c_nw:
    s_branch k_comp
k_load:
    v_lshrrev_b32 v148, 3, v1
    v_mul_u32_u24 v148, 1280, v148
    v_lshrrev_b32 v149, 4, v1
    v_and_b32 v150, 7, v1
    v_xor_b32 v150, v150, v149
    v_lshl_add_u32 v2, v150, 4, v148
    v_xor_b32 v3, 64, v2
    v_add_u32 v3, 9216, v3
    v_add_u32 v4, 18432, v2
    v_add_u32 v5, 18432, v3
    s_cmp_ge_u32 s38, 10
    s_cselect_b32 s53, 10240, 0
    v_add_u32 v3, s53, v3
    v_subrev_u32 v4, s53, v4
    v_mul_u32_u24 v148, 3840, v149
    v_lshlrev_b32 v150, 1, v149
    v_and_b32 v151, 15, v1
    v_xor_b32 v150, v150, v151
    v_lshl_add_u32 v6, v150, 4, v148
    v_add_u32 v7, 14336, v6
    v_xor_b32 v8, 128, v6
    v_add_u32 v9, 43008, v8
    v_add_u32 v8, 28672, v8
    s_sub_u32 s53, s36, 4
    s_lshl_b32 s54, s37, 2
    s_add_u32 s54, s54, s53
    s_mul_i32 s41, s54, 40960
    s_mul_i32 s42, s53, 61440
    s_lshl_b32 s54, s38, 8
    s_add_u32 s42, s42, s54
    s_lshl_b32 s43, s53, 12
    s_mov_b32 s30, 2621440
    s_mov_b32 s34, 2457600
    s_waitcnt lgkmcnt(0)
    s_mov_b32 s28, s4
    s_mov_b32 s29, s5
    s_mov_b32 s32, s6
    s_mov_b32 s33, s7
    s_cmp_le_u32 s70, 0
    s_cselect_b32 s53, 1, 0
    s_lshl_b32 s54, s53, 7
    s_add_u32 s54, s54, s41
    s_add_u32 m0, s43, 0
    s_mul_i32 s53, s53, 245760
    buffer_load_dwordx4 v2, s[28:31], s54 offen offset:0 lds
    buffer_load_dwordx4 v3, s[28:31], s54 offen offset:1024 lds
    buffer_load_dwordx4 v4, s[28:31], s54 offen offset:2048 lds
    buffer_load_dwordx4 v5, s[28:31], s54 offen offset:3072 lds
    s_add_u32 m0, s43, 16384
    s_add_u32 s53, s53, s42
    buffer_load_dwordx4 v6, s[32:35], s53 offen offset:0 lds
    buffer_load_dwordx4 v7, s[32:35], s53 offen offset:1024 lds
    buffer_load_dwordx4 v8, s[32:35], s53 offen offset:2048 lds
    buffer_load_dwordx4 v9, s[32:35], s53 offen offset:3072 lds
    s_mov_b32 s71, 27049984
    s_load_dwordx2 s[22:23], s[20:21], s71
    s_lshl_b32 s71, s2, 7
    s_getpc_b64 s[86:87]
k_pc2_1:
    s_add_u32 s86, s86, k_tab2-k_pc2_1
    s_addc_u32 s87, s87, 0
    s_add_u32 s86, s86, s71
    s_addc_u32 s87, s87, 0
    s_load_dwordx8 s[88:95], s[86:87], 0
    s_mov_b32 s53, s70
    s_lshl_b32 s54, s53, 7
    s_add_u32 s54, s54, s41
    s_add_u32 m0, s43, 32768
    s_mul_i32 s53, s53, 245760
    buffer_load_dwordx4 v2, s[28:31], s54 offen offset:0 lds
    buffer_load_dwordx4 v3, s[28:31], s54 offen offset:1024 lds
    buffer_load_dwordx4 v4, s[28:31], s54 offen offset:2048 lds
    buffer_load_dwordx4 v5, s[28:31], s54 offen offset:3072 lds
    s_add_u32 m0, s43, 49152
    s_add_u32 s53, s53, s42
    buffer_load_dwordx4 v6, s[32:35], s53 offen offset:0 lds
    buffer_load_dwordx4 v7, s[32:35], s53 offen offset:1024 lds
    buffer_load_dwordx4 v8, s[32:35], s53 offen offset:2048 lds
    buffer_load_dwordx4 v9, s[32:35], s53 offen offset:3072 lds
    s_branch k_ldb
k_tab1:
.long 0xc1e1311
.long 0xd1f1812
.long 0x90836463
.long 0x644240c6
.long 0x14160709
.long 0x1517080e
.long 0x64219041
.long 0x40846484
.long 0x4050a1b
.long 0x1d060b1c
.long 0x8422ca5
.long 0x90a00821
.long 0xf1902
.long 0x1101a03
.long 0x8a52c00
.long 0x8000863
.long 0x8110712
.long 0x9160c13
.long 0x9107414a
.long 0x41089149
.long 0x1c0d171e
.long 0x1d0e181f
.long 0x416b658c
.long 0x418c4129
.long 0x1403050a
.long 0x1504060b
.long 0x2ce72d08
.long 0x2d4a08e7
.long 0xf0219
.long 0x1101b1a
.long 0x91662d6b
.long 0x2cc62d29
.long 0x14121705
.long 0x1e131819
.long 0x6631922d
.long 0x92506610
.long 0x1100603
.long 0x2110704
.long 0x41ce65ad
.long 0x41ad4210
.long 0x151a1c0f
.long 0x161b1d00
.long 0x2e52918f
.long 0xa310a52
.long 0xd080a0b
.long 0xe091f0c
.long 0x926e09ef
.long 0x2def2dce
.long 0x90b1806
.long 0xa0c1907
.long 0x43186694
.long 0x42b566b5
.long 0x1d130210
.long 0x1e140311
.long 0x667366d6
.long 0x433942f7
.long 0x170d0e00
.long 0x12080f01
.long 0xad60a73
.long 0x92d79295
.long 0x151a1f04
.long 0x161b1c05
.long 0x93190a94
.long 0x2ef72f18
.long 0xc160b11
.long 0xd171012
.long 0x939b43bd
.long 0x439c43de
.long 0x2040715
.long 0x305081a
.long 0x437b93dd
.long 0x435a675a
.long 0x6181b1d
.long 0x1f191c1e
.long 0xbff2fff
.long 0x93fa2fde
.long 0xe1309
.long 0x10f140a
.long 0x2fbd2f7b
.long 0x2f392f9c
.long 0x3020100
.long 0x7060504
.long 0x0
.long 0x0
.long 0xb0a0908
.long 0xf0e0d0c
.long 0x0
.long 0x0
.long 0x13121110
.long 0x17161514
.long 0x0
.long 0x0
.long 0x1b1a1918
.long 0x1f1e1d1c
.long 0x0
.long 0x0
k_comp:
    s_and_b32 s39, s36, 1
    s_lshr_b32 s40, s36, 1
    s_sub_u32 s53, s38, 5
    s_cmp_lt_u32 s38, 5
    s_cselect_b32 s53, s38, s53
    s_min_u32 s53, s53, 5
    s_lshl_b32 s53, s53, 2
    s_lshl_b32 s54, s39, 1
    s_add_u32 s53, s53, s54
    s_add_u32 s53, s53, s40
    s_lshl_b32 s53, s53, 4
    s_xor_b32 s54, s53, 16
    s_getpc_b64 s[64:65]
k_pc:
    s_sub_u32 s64, s64, k_pc-k_tab1
    s_subb_u32 s65, s65, 0
    s_load_dwordx4 s[44:47], s[64:65], s53
    s_load_dwordx4 s[48:51], s[64:65], s54
    v_and_b32 v148, 15, v1
    v_lshrrev_b32 v149, 4, v1
    v_bfe_u32 v150, v1, 1, 3
    v_xor_b32 v150, v150, v149
    v_lshlrev_b32 v150, 4, v150
    v_lshl_add_u32 v150, v148, 7, v150
    s_lshl_b32 s53, s36, 12
    v_add_u32 v10, s53, v150
    v_xor_b32 v11, 64, v10
    v_xor_b32 v12, 4096, v10
    v_xor_b32 v13, 4096, v11
    v_bfe_u32 v150, v1, 2, 2
    v_lshl_add_u32 v152, v149, 3, v150
    v_lshlrev_b32 v152, 8, v152
    v_and_b32 v150, 28, v1
    v_and_b32 v151, 3, v1
    v_lshlrev_b32 v151, 3, v151
    v_mov_b32 v18, 0x3f803f80
    v_mov_b32 v19, 0x3f803f80
    s_waitcnt lgkmcnt(0)
    s_mov_b32 s24, s20
    s_mov_b32 s25, s21
    s_mov_b64 s[28:29], s[4:5]
    s_mov_b32 s30, 0
    v_lshrrev_b32 v154, v151, s44
    v_and_b32 v154, 31, v154
    v_xor_b32 v154, v154, v150
    v_lshl_add_u32 v14, v154, 3, v152
    v_lshrrev_b32 v154, v151, s45
    v_and_b32 v154, 31, v154
    v_xor_b32 v154, v154, v150
    v_lshl_add_u32 v15, v154, 3, v152
    v_lshrrev_b32 v154, v151, s48
    v_and_b32 v154, 31, v154
    v_xor_b32 v154, v154, v150
    v_lshl_add_u32 v16, v154, 3, v152
    v_lshrrev_b32 v154, v151, s49
    v_and_b32 v154, 31, v154
    v_xor_b32 v154, v154, v150
    v_lshl_add_u32 v17, v154, 3, v152
    s_lshl_b32 s55, s37, 1
    s_add_u32 s55, s55, s40
    s_cmp_ge_u32 s38, 10
    s_cbranch_scc1 k_v
    s_cmp_lt_u32 s38, 5
    s_cselect_b32 s67, 0, 1
    s_cselect_b32 s66, 5242880, 0
    s_lshl_b32 s64, 81920, s67
    s_lshl_b32 s65, 2560, s67
    s_mul_i32 s65, s65, s55
    s_add_u32 s66, s66, s65
    v_lshlrev_b32 v150, 4, v148
    v_add_u32 v150, s66, v150
    v_lshlrev_b32 v151, 4, v149
    v_lshrrev_b64 v[152:153], v151, s[46:47]
    v_and_b32 v153, 31, v152
    v_mad_u32_u24 v153, v153, s64, v150
    v_bfe_u32 v154, v152, 10, 3
    v_lshl_add_u32 v168, v154, 9, v153
    v_cmp_eq_u32 s[56:57], 4, v154
    v_bfe_u32 v153, v152, 5, 5
    v_mad_u32_u24 v153, v153, s64, v150
    v_bfe_u32 v154, v152, 13, 3
    v_lshl_add_u32 v169, v154, 9, v153
    v_lshrrev_b64 v[152:153], v151, s[50:51]
    v_and_b32 v153, 31, v152
    v_mad_u32_u24 v153, v153, s64, v150
    v_bfe_u32 v154, v152, 10, 3
    v_lshl_add_u32 v170, v154, 9, v153
    v_cmp_eq_u32 s[58:59], 4, v154
    v_bfe_u32 v153, v152, 5, 5
    v_mad_u32_u24 v153, v153, s64, v150
    v_bfe_u32 v154, v152, 13, 3
    v_lshl_add_u32 v171, v154, 9, v153
    s_mov_b32 s52, 0
    s_mov_b32 s64, 0xaaaaaaaa
    s_mov_b32 s65, 0xaaaaaaaa
    s_mov_b32 s66, 0xcccccccc
    s_mov_b32 s67, 0xcccccccc
    s_lshl_b32 s53, s36, 7
    s_lshl_b32 s54, s39, 1
    s_add_u32 s54, s54, s40
    s_lshl_b32 s54, s54, 7
    s_mul_i32 s68, s38, 10
    s_add_u32 s68, s68, s70
    s_lshl_b32 s68, s68, 9
    s_add_u32 s68, s68, s54
    s_add_u32 s68, s68, 25722880
    s_cmp_lt_u32 s37, 10
    s_cselect_b32 s68, s68, 0x40000000
    s_mul_i32 s69, s37, 10
    s_add_u32 s69, s69, s70
    s_lshl_b32 s69, s69, 9
    s_add_u32 s69, s69, s53
    s_lshl_b32 s69, s69, 1
    s_add_u32 s69, s69, 25559040
    s_cmp_lt_u32 s38, 10
    s_cselect_b32 s69, s69, 0x40000000
    v_lshlrev_b32 v156, 2, v1
    v_lshlrev_b32 v157, 3, v1
    s_add_u32 s53, s53, 131072
    s_add_u32 s54, s54, 132096
    v_lshlrev_b32 v152, 2, v148
    v_lshlrev_b32 v154, 4, v149
    v_add_u32 v152, s53, v152
    v_xor_b32 v153, 128, v152
    v_add_u32 v154, s54, v154
    v_xor_b32 v155, 128, v154
    s_barrier
    ds_read_b128 v[20:23], v10 offset:0
    ds_read_b64_tr_b16 v[52:53], v14 offset:16384
    ds_read_b64_tr_b16 v[54:55], v14 offset:17408
    ds_read_b128 v[24:27], v10 offset:2048
    ds_read_b128 v[28:31], v12 offset:0
    ds_read_b128 v[32:35], v12 offset:2048
    ds_read_b64_tr_b16 v[56:57], v15 offset:16384
    ds_read_b64_tr_b16 v[58:59], v15 offset:17408
    ds_read_b64_tr_b16 v[60:61], v16 offset:16384
    ds_read_b64_tr_b16 v[62:63], v16 offset:17408
    ds_read_b64_tr_b16 v[64:65], v17 offset:16384
    ds_read_b64_tr_b16 v[66:67], v17 offset:17408
    s_waitcnt lgkmcnt(4)
    v_mfma_f32_16x16x32_bf16 v[84:87], v[52:55], v[20:23], 0
    ds_read_b128 v[36:39], v11 offset:0
    v_mfma_f32_16x16x32_bf16 v[88:91], v[52:55], v[24:27], 0
    ds_read_b64_tr_b16 v[68:69], v14 offset:24576
    v_mfma_f32_16x16x32_bf16 v[92:95], v[52:55], v[28:31], 0
    ds_read_b64_tr_b16 v[70:71], v14 offset:25600
    v_mfma_f32_16x16x32_bf16 v[96:99], v[52:55], v[32:35], 0
    ds_read_b128 v[40:43], v11 offset:2048
    v_mfma_f32_16x16x32_bf16 v[112:115], v[56:59], v[32:35], 0
    ds_read_b128 v[44:47], v13 offset:0
    v_mfma_f32_16x16x32_bf16 v[108:111], v[56:59], v[28:31], 0
    ds_read_b128 v[48:51], v13 offset:2048
    v_mfma_f32_16x16x32_bf16 v[104:107], v[56:59], v[24:27], 0
    ds_read_b64_tr_b16 v[72:73], v15 offset:24576
    v_mfma_f32_16x16x32_bf16 v[100:103], v[56:59], v[20:23], 0
    ds_read_b64_tr_b16 v[74:75], v15 offset:25600
    s_waitcnt lgkmcnt(8)
    v_mfma_f32_16x16x32_bf16 v[116:119], v[60:63], v[20:23], 0
    ds_read_b64_tr_b16 v[76:77], v16 offset:24576
    v_mfma_f32_16x16x32_bf16 v[120:123], v[60:63], v[24:27], 0
    ds_read_b64_tr_b16 v[78:79], v16 offset:25600
    v_mfma_f32_16x16x32_bf16 v[124:127], v[60:63], v[28:31], 0
    ds_read_b64_tr_b16 v[80:81], v17 offset:24576
    v_mfma_f32_16x16x32_bf16 v[128:131], v[60:63], v[32:35], 0
    ds_read_b64_tr_b16 v[82:83], v17 offset:25600
    v_mfma_f32_16x16x32_bf16 v[144:147], v[64:67], v[32:35], 0
    v_mfma_f32_16x16x32_bf16 v[140:143], v[64:67], v[28:31], 0
    v_mfma_f32_16x16x32_bf16 v[136:139], v[64:67], v[24:27], 0
    v_mfma_f32_16x16x32_bf16 v[132:135], v[64:67], v[20:23], 0
    s_waitcnt lgkmcnt(4)
    v_mfma_f32_16x16x32_bf16 v[84:87], v[68:71], v[36:39], v[84:87]
    s_barrier
    ds_read_b128 v[20:23], v10 offset:32768
    v_mfma_f32_16x16x32_bf16 v[88:91], v[68:71], v[40:43], v[88:91]
    ds_read_b64_tr_b16 v[52:53], v14 offset:49152
    v_mfma_f32_16x16x32_bf16 v[92:95], v[68:71], v[44:47], v[92:95]
    ds_read_b64_tr_b16 v[54:55], v14 offset:50176
    v_mfma_f32_16x16x32_bf16 v[96:99], v[68:71], v[48:51], v[96:99]
    ds_read_b128 v[24:27], v10 offset:34816
    v_mfma_f32_16x16x32_bf16 v[112:115], v[72:75], v[48:51], v[112:115]
    ds_read_b128 v[28:31], v12 offset:32768
    v_mfma_f32_16x16x32_bf16 v[108:111], v[72:75], v[44:47], v[108:111]
    ds_read_b128 v[32:35], v12 offset:34816
    v_mfma_f32_16x16x32_bf16 v[104:107], v[72:75], v[40:43], v[104:107]
    ds_read_b64_tr_b16 v[56:57], v15 offset:49152
    v_mfma_f32_16x16x32_bf16 v[100:103], v[72:75], v[36:39], v[100:103]
    ds_read_b64_tr_b16 v[58:59], v15 offset:50176
    s_waitcnt lgkmcnt(8)
    v_mfma_f32_16x16x32_bf16 v[116:119], v[76:79], v[36:39], v[116:119]
    ds_read_b64_tr_b16 v[60:61], v16 offset:49152
    v_mfma_f32_16x16x32_bf16 v[120:123], v[76:79], v[40:43], v[120:123]
    ds_read_b64_tr_b16 v[62:63], v16 offset:50176
    v_mfma_f32_16x16x32_bf16 v[124:127], v[76:79], v[44:47], v[124:127]
    ds_read_b64_tr_b16 v[64:65], v17 offset:49152
    v_mfma_f32_16x16x32_bf16 v[128:131], v[76:79], v[48:51], v[128:131]
    ds_read_b64_tr_b16 v[66:67], v17 offset:50176
    v_mfma_f32_16x16x32_bf16 v[144:147], v[80:83], v[48:51], v[144:147]
    v_mfma_f32_16x16x32_bf16 v[140:143], v[80:83], v[44:47], v[140:143]
    v_mfma_f32_16x16x32_bf16 v[136:139], v[80:83], v[40:43], v[136:139]
    v_mfma_f32_16x16x32_bf16 v[132:135], v[80:83], v[36:39], v[132:135]
    s_waitcnt lgkmcnt(4)
    v_mfma_f32_4x4x4_16b_bf16 v[172:175], v[18:19], v[20:21], 0
    v_mfma_f32_4x4x4_16b_bf16 v[180:183], v[20:21], v[20:21], 0
    v_mfma_f32_4x4x4_16b_bf16 v[188:191], v[18:19], v[52:53], 0
    v_mfma_f32_4x4x4_16b_bf16 v[176:179], v[18:19], v[24:25], 0
    v_mfma_f32_4x4x4_16b_bf16 v[184:187], v[24:25], v[24:25], 0
    v_mfma_f32_4x4x4_16b_bf16 v[192:195], v[18:19], v[56:57], 0
    v_mfma_f32_4x4x4_16b_bf16 v[172:175], v[18:19], v[22:23], v[172:175]
    v_mfma_f32_4x4x4_16b_bf16 v[180:183], v[22:23], v[22:23], v[180:183]
    v_mfma_f32_4x4x4_16b_bf16 v[188:191], v[18:19], v[54:55], v[188:191]
    v_mfma_f32_4x4x4_16b_bf16 v[176:179], v[18:19], v[26:27], v[176:179]
    v_mfma_f32_4x4x4_16b_bf16 v[184:187], v[26:27], v[26:27], v[184:187]
    v_mfma_f32_4x4x4_16b_bf16 v[192:195], v[18:19], v[58:59], v[192:195]
    v_mfma_f32_16x16x32_bf16 v[84:87], v[52:55], v[20:23], v[84:87]
    ds_read_b128 v[36:39], v11 offset:32768
    v_mfma_f32_16x16x32_bf16 v[88:91], v[52:55], v[24:27], v[88:91]
    ds_read_b64_tr_b16 v[68:69], v14 offset:57344
    v_mfma_f32_16x16x32_bf16 v[92:95], v[52:55], v[28:31], v[92:95]
    ds_read_b64_tr_b16 v[70:71], v14 offset:58368
    v_mfma_f32_16x16x32_bf16 v[96:99], v[52:55], v[32:35], v[96:99]
    ds_read_b128 v[40:43], v11 offset:34816
    v_mfma_f32_16x16x32_bf16 v[112:115], v[56:59], v[32:35], v[112:115]
    ds_read_b128 v[44:47], v13 offset:32768
    v_mfma_f32_16x16x32_bf16 v[108:111], v[56:59], v[28:31], v[108:111]
    ds_read_b128 v[48:51], v13 offset:34816
    v_mfma_f32_16x16x32_bf16 v[104:107], v[56:59], v[24:27], v[104:107]
    ds_read_b64_tr_b16 v[72:73], v15 offset:57344
    v_mfma_f32_16x16x32_bf16 v[100:103], v[56:59], v[20:23], v[100:103]
    ds_read_b64_tr_b16 v[74:75], v15 offset:58368
    s_waitcnt lgkmcnt(8)
    v_mfma_f32_16x16x32_bf16 v[116:119], v[60:63], v[20:23], v[116:119]
    ds_read_b64_tr_b16 v[76:77], v16 offset:57344
    v_mfma_f32_16x16x32_bf16 v[120:123], v[60:63], v[24:27], v[120:123]
    ds_read_b64_tr_b16 v[78:79], v16 offset:58368
    v_mfma_f32_16x16x32_bf16 v[124:127], v[60:63], v[28:31], v[124:127]
    ds_read_b64_tr_b16 v[80:81], v17 offset:57344
    v_mfma_f32_16x16x32_bf16 v[128:131], v[60:63], v[32:35], v[128:131]
    ds_read_b64_tr_b16 v[82:83], v17 offset:58368
    v_mfma_f32_16x16x32_bf16 v[144:147], v[64:67], v[32:35], v[144:147]
    v_xor_b32 v10, 0x10000, v10
    v_xor_b32 v11, 0x10000, v11
    v_xor_b32 v12, 0x10000, v12
    v_mfma_f32_16x16x32_bf16 v[140:143], v[64:67], v[28:31], v[140:143]
    s_add_u32 s52, s52, 1
    v_xor_b32 v13, 0x10000, v13
    v_xor_b32 v14, 0x10000, v14
    v_xor_b32 v15, 0x10000, v15
    v_mfma_f32_16x16x32_bf16 v[136:139], v[64:67], v[24:27], v[136:139]
    s_cmp_lt_u32 s52, 5
    v_xor_b32 v16, 0x10000, v16
    v_xor_b32 v17, 0x10000, v17
    v_mfma_f32_16x16x32_bf16 v[132:135], v[64:67], v[20:23], v[132:135]
    s_waitcnt lgkmcnt(4)
    v_mfma_f32_4x4x4_16b_bf16 v[172:175], v[18:19], v[36:37], v[172:175]
    v_mfma_f32_4x4x4_16b_bf16 v[180:183], v[36:37], v[36:37], v[180:183]
    v_mfma_f32_4x4x4_16b_bf16 v[188:191], v[18:19], v[68:69], v[188:191]
    v_mfma_f32_4x4x4_16b_bf16 v[176:179], v[18:19], v[40:41], v[176:179]
    v_mfma_f32_4x4x4_16b_bf16 v[184:187], v[40:41], v[40:41], v[184:187]
    v_mfma_f32_4x4x4_16b_bf16 v[192:195], v[18:19], v[72:73], v[192:195]
    v_mfma_f32_4x4x4_16b_bf16 v[172:175], v[18:19], v[38:39], v[172:175]
    v_mfma_f32_4x4x4_16b_bf16 v[180:183], v[38:39], v[38:39], v[180:183]
    v_mfma_f32_4x4x4_16b_bf16 v[188:191], v[18:19], v[70:71], v[188:191]
    v_mfma_f32_4x4x4_16b_bf16 v[176:179], v[18:19], v[42:43], v[176:179]
    v_mfma_f32_4x4x4_16b_bf16 v[184:187], v[42:43], v[42:43], v[184:187]
    v_mfma_f32_4x4x4_16b_bf16 v[192:195], v[18:19], v[74:75], v[192:195]
    v_mfma_f32_16x16x32_bf16 v[84:87], v[68:71], v[36:39], v[84:87]
    s_nop 3
    v_cndmask_b32 v180, v180, v181, s[64:65]
    v_cndmask_b32 v182, v182, v183, s[64:65]
    v_cndmask_b32 v180, v180, v182, s[66:67]
    v_cndmask_b32 v184, v184, v185, s[64:65]
    v_cndmask_b32 v186, v186, v187, s[64:65]
    v_cndmask_b32 v184, v184, v186, s[66:67]
    s_nop 0
    v_permlane16_swap_b32 v172, v176
    v_permlane16_swap_b32 v188, v192
    v_permlane16_swap_b32 v180, v184
    v_add_f32 v172, v172, v176
    v_add_f32 v188, v188, v192
    v_add_f32 v180, v180, v184
    v_mov_b32 v176, v172
    v_mov_b32 v192, v188
    v_mov_b32 v184, v180
    s_nop 0
    v_permlane32_swap_b32 v172, v176
    v_permlane32_swap_b32 v188, v192
    v_permlane32_swap_b32 v180, v184
    v_add_f32 v172, v172, v176
    v_add_f32 v188, v188, v192
    v_add_f32 v173, v180, v184
    s_mov_b32 exec_hi, 0
    buffer_store_dword v188, v156, s[24:27], s68 offen sc1
    buffer_store_dwordx2 v[172:173], v157, s[24:27], s69 offen sc1
    s_mov_b32 exec_hi, -1
    s_barrier
    ds_read_b128 v[20:23], v10 offset:0
    v_mfma_f32_16x16x32_bf16 v[88:91], v[68:71], v[40:43], v[88:91]
    ds_read_b64_tr_b16 v[52:53], v14 offset:16384
    v_mfma_f32_16x16x32_bf16 v[92:95], v[68:71], v[44:47], v[92:95]
    ds_read_b64_tr_b16 v[54:55], v14 offset:17408
    v_mfma_f32_16x16x32_bf16 v[96:99], v[68:71], v[48:51], v[96:99]
    ds_read_b128 v[24:27], v10 offset:2048
    v_mfma_f32_16x16x32_bf16 v[112:115], v[72:75], v[48:51], v[112:115]
    ds_read_b128 v[28:31], v12 offset:0
    v_mfma_f32_16x16x32_bf16 v[108:111], v[72:75], v[44:47], v[108:111]
    ds_read_b128 v[32:35], v12 offset:2048
    v_mfma_f32_16x16x32_bf16 v[104:107], v[72:75], v[40:43], v[104:107]
    ds_read_b64_tr_b16 v[56:57], v15 offset:16384
    v_mfma_f32_16x16x32_bf16 v[100:103], v[72:75], v[36:39], v[100:103]
    ds_read_b64_tr_b16 v[58:59], v15 offset:17408
    s_waitcnt lgkmcnt(8)
    v_mfma_f32_16x16x32_bf16 v[116:119], v[76:79], v[36:39], v[116:119]
    ds_read_b64_tr_b16 v[60:61], v16 offset:16384
    v_mfma_f32_16x16x32_bf16 v[120:123], v[76:79], v[40:43], v[120:123]
    ds_read_b64_tr_b16 v[62:63], v16 offset:17408
    v_mfma_f32_16x16x32_bf16 v[124:127], v[76:79], v[44:47], v[124:127]
    ds_read_b64_tr_b16 v[64:65], v17 offset:16384
    v_mfma_f32_16x16x32_bf16 v[128:131], v[76:79], v[48:51], v[128:131]
    ds_read_b64_tr_b16 v[66:67], v17 offset:17408
    v_mfma_f32_16x16x32_bf16 v[144:147], v[80:83], v[48:51], v[144:147]
    v_mfma_f32_16x16x32_bf16 v[140:143], v[80:83], v[44:47], v[140:143]
    v_mfma_f32_16x16x32_bf16 v[136:139], v[80:83], v[40:43], v[136:139]
    v_mfma_f32_16x16x32_bf16 v[132:135], v[80:83], v[36:39], v[132:135]
k_loop0:
    s_waitcnt lgkmcnt(4)
    v_mfma_f32_16x16x32_bf16 v[84:87], v[52:55], v[20:23], v[84:87]
    ds_read_b128 v[36:39], v11 offset:0
    v_mfma_f32_16x16x32_bf16 v[88:91], v[52:55], v[24:27], v[88:91]
    ds_read_b64_tr_b16 v[68:69], v14 offset:24576
    v_mfma_f32_16x16x32_bf16 v[92:95], v[52:55], v[28:31], v[92:95]
    ds_read_b64_tr_b16 v[70:71], v14 offset:25600
    v_mfma_f32_16x16x32_bf16 v[96:99], v[52:55], v[32:35], v[96:99]
    ds_read_b128 v[40:43], v11 offset:2048
    v_mfma_f32_16x16x32_bf16 v[112:115], v[56:59], v[32:35], v[112:115]
    ds_read_b128 v[44:47], v13 offset:0
    v_mfma_f32_16x16x32_bf16 v[108:111], v[56:59], v[28:31], v[108:111]
    ds_read_b128 v[48:51], v13 offset:2048
    v_mfma_f32_16x16x32_bf16 v[104:107], v[56:59], v[24:27], v[104:107]
    ds_read_b64_tr_b16 v[72:73], v15 offset:24576
    v_mfma_f32_16x16x32_bf16 v[100:103], v[56:59], v[20:23], v[100:103]
    ds_read_b64_tr_b16 v[74:75], v15 offset:25600
    s_waitcnt lgkmcnt(8)
    v_mfma_f32_16x16x32_bf16 v[116:119], v[60:63], v[20:23], v[116:119]
    ds_read_b64_tr_b16 v[76:77], v16 offset:24576
    v_mfma_f32_16x16x32_bf16 v[120:123], v[60:63], v[24:27], v[120:123]
    ds_read_b64_tr_b16 v[78:79], v16 offset:25600
    v_mfma_f32_16x16x32_bf16 v[124:127], v[60:63], v[28:31], v[124:127]
    ds_read_b64_tr_b16 v[80:81], v17 offset:24576
    v_mfma_f32_16x16x32_bf16 v[128:131], v[60:63], v[32:35], v[128:131]
    ds_read_b64_tr_b16 v[82:83], v17 offset:25600
    v_mfma_f32_16x16x32_bf16 v[144:147], v[64:67], v[32:35], v[144:147]
    v_mfma_f32_16x16x32_bf16 v[140:143], v[64:67], v[28:31], v[140:143]
    v_mfma_f32_16x16x32_bf16 v[136:139], v[64:67], v[24:27], v[136:139]
    v_mfma_f32_16x16x32_bf16 v[132:135], v[64:67], v[20:23], v[132:135]
    s_waitcnt lgkmcnt(4)
    v_mfma_f32_16x16x32_bf16 v[84:87], v[68:71], v[36:39], v[84:87]
    s_waitcnt vmcnt(0)
    s_barrier
    ds_read_b128 v[20:23], v10 offset:32768
    v_mfma_f32_16x16x32_bf16 v[88:91], v[68:71], v[40:43], v[88:91]
    ds_read_b64_tr_b16 v[52:53], v14 offset:49152
    v_mfma_f32_16x16x32_bf16 v[92:95], v[68:71], v[44:47], v[92:95]
    ds_read_b64_tr_b16 v[54:55], v14 offset:50176
    v_mfma_f32_16x16x32_bf16 v[96:99], v[68:71], v[48:51], v[96:99]
    ds_read_b128 v[24:27], v10 offset:34816
    v_mfma_f32_16x16x32_bf16 v[112:115], v[72:75], v[48:51], v[112:115]
    ds_read_b128 v[28:31], v12 offset:32768
    v_mfma_f32_16x16x32_bf16 v[108:111], v[72:75], v[44:47], v[108:111]
    ds_read_b128 v[32:35], v12 offset:34816
    v_mfma_f32_16x16x32_bf16 v[104:107], v[72:75], v[40:43], v[104:107]
    ds_read_b64_tr_b16 v[56:57], v15 offset:49152
    v_mfma_f32_16x16x32_bf16 v[100:103], v[72:75], v[36:39], v[100:103]
    ds_read_b64_tr_b16 v[58:59], v15 offset:50176
    s_waitcnt lgkmcnt(8)
    v_mfma_f32_16x16x32_bf16 v[116:119], v[76:79], v[36:39], v[116:119]
    ds_read_b64_tr_b16 v[60:61], v16 offset:49152
    v_mfma_f32_16x16x32_bf16 v[120:123], v[76:79], v[40:43], v[120:123]
    ds_read_b64_tr_b16 v[62:63], v16 offset:50176
    v_mfma_f32_16x16x32_bf16 v[124:127], v[76:79], v[44:47], v[124:127]
    ds_read_b64_tr_b16 v[64:65], v17 offset:49152
    v_mfma_f32_16x16x32_bf16 v[128:131], v[76:79], v[48:51], v[128:131]
    ds_read_b64_tr_b16 v[66:67], v17 offset:50176
    v_mfma_f32_16x16x32_bf16 v[144:147], v[80:83], v[48:51], v[144:147]
    v_mfma_f32_16x16x32_bf16 v[140:143], v[80:83], v[44:47], v[140:143]
    v_mfma_f32_16x16x32_bf16 v[136:139], v[80:83], v[40:43], v[136:139]
    v_mfma_f32_16x16x32_bf16 v[132:135], v[80:83], v[36:39], v[132:135]
    s_waitcnt lgkmcnt(4)
    v_mfma_f32_16x16x32_bf16 v[84:87], v[52:55], v[20:23], v[84:87]
    ds_read_b128 v[36:39], v11 offset:32768
    v_mfma_f32_16x16x32_bf16 v[88:91], v[52:55], v[24:27], v[88:91]
    ds_read_b64_tr_b16 v[68:69], v14 offset:57344
    v_mfma_f32_16x16x32_bf16 v[92:95], v[52:55], v[28:31], v[92:95]
    ds_read_b64_tr_b16 v[70:71], v14 offset:58368
    v_mfma_f32_16x16x32_bf16 v[96:99], v[52:55], v[32:35], v[96:99]
    ds_read_b128 v[40:43], v11 offset:34816
    v_mfma_f32_16x16x32_bf16 v[112:115], v[56:59], v[32:35], v[112:115]
    ds_read_b128 v[44:47], v13 offset:32768
    v_mfma_f32_16x16x32_bf16 v[108:111], v[56:59], v[28:31], v[108:111]
    ds_read_b128 v[48:51], v13 offset:34816
    v_mfma_f32_16x16x32_bf16 v[104:107], v[56:59], v[24:27], v[104:107]
    ds_read_b64_tr_b16 v[72:73], v15 offset:57344
    v_mfma_f32_16x16x32_bf16 v[100:103], v[56:59], v[20:23], v[100:103]
    ds_read_b64_tr_b16 v[74:75], v15 offset:58368
    s_waitcnt lgkmcnt(8)
    v_mfma_f32_16x16x32_bf16 v[116:119], v[60:63], v[20:23], v[116:119]
    ds_read_b64_tr_b16 v[76:77], v16 offset:57344
    v_mfma_f32_16x16x32_bf16 v[120:123], v[60:63], v[24:27], v[120:123]
    ds_read_b64_tr_b16 v[78:79], v16 offset:58368
    v_mfma_f32_16x16x32_bf16 v[124:127], v[60:63], v[28:31], v[124:127]
    ds_read_b64_tr_b16 v[80:81], v17 offset:57344
    v_mfma_f32_16x16x32_bf16 v[128:131], v[60:63], v[32:35], v[128:131]
    ds_read_b64_tr_b16 v[82:83], v17 offset:58368
    v_mfma_f32_16x16x32_bf16 v[144:147], v[64:67], v[32:35], v[144:147]
    v_xor_b32 v10, 0x10000, v10
    v_xor_b32 v11, 0x10000, v11
    v_xor_b32 v12, 0x10000, v12
    v_mfma_f32_16x16x32_bf16 v[140:143], v[64:67], v[28:31], v[140:143]
    s_add_u32 s52, s52, 1
    v_xor_b32 v13, 0x10000, v13
    v_xor_b32 v14, 0x10000, v14
    v_xor_b32 v15, 0x10000, v15
    v_mfma_f32_16x16x32_bf16 v[136:139], v[64:67], v[24:27], v[136:139]
    s_cmp_lt_u32 s52, 5
    v_xor_b32 v16, 0x10000, v16
    v_xor_b32 v17, 0x10000, v17
    v_mfma_f32_16x16x32_bf16 v[132:135], v[64:67], v[20:23], v[132:135]
    s_waitcnt lgkmcnt(4)
    v_mfma_f32_16x16x32_bf16 v[84:87], v[68:71], v[36:39], v[84:87]
    s_cbranch_scc0 k_last0
    s_barrier
    ds_read_b128 v[20:23], v10 offset:0
    v_mfma_f32_16x16x32_bf16 v[88:91], v[68:71], v[40:43], v[88:91]
    ds_read_b64_tr_b16 v[52:53], v14 offset:16384
    v_mfma_f32_16x16x32_bf16 v[92:95], v[68:71], v[44:47], v[92:95]
    ds_read_b64_tr_b16 v[54:55], v14 offset:17408
    v_mfma_f32_16x16x32_bf16 v[96:99], v[68:71], v[48:51], v[96:99]
    ds_read_b128 v[24:27], v10 offset:2048
    v_mfma_f32_16x16x32_bf16 v[112:115], v[72:75], v[48:51], v[112:115]
    ds_read_b128 v[28:31], v12 offset:0
    v_mfma_f32_16x16x32_bf16 v[108:111], v[72:75], v[44:47], v[108:111]
    ds_read_b128 v[32:35], v12 offset:2048
    v_mfma_f32_16x16x32_bf16 v[104:107], v[72:75], v[40:43], v[104:107]
    ds_read_b64_tr_b16 v[56:57], v15 offset:16384
    v_mfma_f32_16x16x32_bf16 v[100:103], v[72:75], v[36:39], v[100:103]
    ds_read_b64_tr_b16 v[58:59], v15 offset:17408
    s_waitcnt lgkmcnt(8)
    v_mfma_f32_16x16x32_bf16 v[116:119], v[76:79], v[36:39], v[116:119]
    ds_read_b64_tr_b16 v[60:61], v16 offset:16384
    v_mfma_f32_16x16x32_bf16 v[120:123], v[76:79], v[40:43], v[120:123]
    ds_read_b64_tr_b16 v[62:63], v16 offset:17408
    v_mfma_f32_16x16x32_bf16 v[124:127], v[76:79], v[44:47], v[124:127]
    ds_read_b64_tr_b16 v[64:65], v17 offset:16384
    v_mfma_f32_16x16x32_bf16 v[128:131], v[76:79], v[48:51], v[128:131]
    ds_read_b64_tr_b16 v[66:67], v17 offset:17408
    v_mfma_f32_16x16x32_bf16 v[144:147], v[80:83], v[48:51], v[144:147]
    v_mfma_f32_16x16x32_bf16 v[140:143], v[80:83], v[44:47], v[140:143]
    v_mfma_f32_16x16x32_bf16 v[136:139], v[80:83], v[40:43], v[136:139]
    v_mfma_f32_16x16x32_bf16 v[132:135], v[80:83], v[36:39], v[132:135]
    s_branch k_loop0
k_last0:
    v_mfma_f32_16x16x32_bf16 v[88:91], v[68:71], v[40:43], v[88:91]
    v_mfma_f32_16x16x32_bf16 v[92:95], v[68:71], v[44:47], v[92:95]
    v_mfma_f32_16x16x32_bf16 v[96:99], v[68:71], v[48:51], v[96:99]
    v_mfma_f32_16x16x32_bf16 v[112:115], v[72:75], v[48:51], v[112:115]
    v_mfma_f32_16x16x32_bf16 v[108:111], v[72:75], v[44:47], v[108:111]
    v_mfma_f32_16x16x32_bf16 v[104:107], v[72:75], v[40:43], v[104:107]
    v_mfma_f32_16x16x32_bf16 v[100:103], v[72:75], v[36:39], v[100:103]
    s_waitcnt lgkmcnt(0)
    v_mfma_f32_16x16x32_bf16 v[116:119], v[76:79], v[36:39], v[116:119]
    v_mfma_f32_16x16x32_bf16 v[120:123], v[76:79], v[40:43], v[120:123]
    s_barrier
    ds_read2st64_b32 v[52:53], v152 offset0:0 offset1:2
    ds_read2_b32 v[54:55], v152 offset0:16 offset1:144
    ds_read2st64_b32 v[56:57], v153 offset0:0 offset1:2
    ds_read2_b32 v[58:59], v153 offset0:16 offset1:144
    ds_read_b128 v[20:23], v154 offset:0
    ds_read_b128 v[24:27], v154 offset:64
    ds_read_b128 v[28:31], v155 offset:0
    ds_read_b128 v[32:35], v155 offset:64
    v_mfma_f32_16x16x32_bf16 v[124:127], v[76:79], v[44:47], v[124:127]
    v_mfma_f32_16x16x32_bf16 v[128:131], v[76:79], v[48:51], v[128:131]
    v_mfma_f32_16x16x32_bf16 v[144:147], v[80:83], v[48:51], v[144:147]
    v_mfma_f32_16x16x32_bf16 v[140:143], v[80:83], v[44:47], v[140:143]
    v_mfma_f32_16x16x32_bf16 v[136:139], v[80:83], v[40:43], v[136:139]
    v_mfma_f32_16x16x32_bf16 v[132:135], v[80:83], v[36:39], v[132:135]
    s_waitcnt lgkmcnt(0)
    v_pk_fma_f32 v[84:85], v[20:21], v[52:53], v[84:85] op_sel:[0,0,0] op_sel_hi:[1,0,1]
    v_pk_fma_f32 v[86:87], v[22:23], v[52:53], v[86:87] op_sel:[0,0,0] op_sel_hi:[1,0,1]
    v_pk_fma_f32 v[100:101], v[24:25], v[52:53], v[100:101] op_sel:[0,0,0] op_sel_hi:[1,0,1]
    v_pk_fma_f32 v[102:103], v[26:27], v[52:53], v[102:103] op_sel:[0,0,0] op_sel_hi:[1,0,1]
    v_pk_fma_f32 v[92:93], v[20:21], v[56:57], v[92:93] op_sel:[0,0,0] op_sel_hi:[1,0,1]
    v_pk_fma_f32 v[94:95], v[22:23], v[56:57], v[94:95] op_sel:[0,0,0] op_sel_hi:[1,0,1]
    v_pk_fma_f32 v[108:109], v[24:25], v[56:57], v[108:109] op_sel:[0,0,0] op_sel_hi:[1,0,1]
    v_pk_fma_f32 v[110:111], v[26:27], v[56:57], v[110:111] op_sel:[0,0,0] op_sel_hi:[1,0,1]
    v_pk_mul_f32 v[84:85], v[84:85], v[52:53] op_sel:[0,1] op_sel_hi:[1,1]
    v_pk_mul_f32 v[86:87], v[86:87], v[52:53] op_sel:[0,1] op_sel_hi:[1,1]
    v_pk_mul_f32 v[100:101], v[100:101], v[52:53] op_sel:[0,1] op_sel_hi:[1,1]
    v_pk_mul_f32 v[102:103], v[102:103], v[52:53] op_sel:[0,1] op_sel_hi:[1,1]
    v_pk_mul_f32 v[92:93], v[92:93], v[56:57] op_sel:[0,1] op_sel_hi:[1,1]
    v_pk_mul_f32 v[94:95], v[94:95], v[56:57] op_sel:[0,1] op_sel_hi:[1,1]
    v_pk_mul_f32 v[108:109], v[108:109], v[56:57] op_sel:[0,1] op_sel_hi:[1,1]
    v_pk_mul_f32 v[110:111], v[110:111], v[56:57] op_sel:[0,1] op_sel_hi:[1,1]
    v_cvt_pk_bf16_f32 v196, v84, v85
    v_cvt_pk_bf16_f32 v197, v86, v87
    v_cvt_pk_bf16_f32 v198, v100, v101
    v_cvt_pk_bf16_f32 v199, v102, v103
    v_cvt_pk_bf16_f32 v200, v92, v93
    v_cvt_pk_bf16_f32 v201, v94, v95
    v_cvt_pk_bf16_f32 v202, v108, v109
    v_cvt_pk_bf16_f32 v203, v110, v111
    s_mov_b64 exec, s[56:57]
    v_swap_b32 v198, v200
    v_swap_b32 v199, v201
    s_mov_b64 exec, -1
    buffer_store_dwordx4 v[196:199], v168, s[24:27], 0 offen offset:0 sc1
    buffer_store_dwordx4 v[200:203], v169, s[24:27], 0 offen offset:0 sc1
    v_pk_fma_f32 v[88:89], v[20:21], v[54:55], v[88:89] op_sel:[0,0,0] op_sel_hi:[1,0,1]
    v_pk_fma_f32 v[90:91], v[22:23], v[54:55], v[90:91] op_sel:[0,0,0] op_sel_hi:[1,0,1]
    v_pk_fma_f32 v[104:105], v[24:25], v[54:55], v[104:105] op_sel:[0,0,0] op_sel_hi:[1,0,1]
    v_pk_fma_f32 v[106:107], v[26:27], v[54:55], v[106:107] op_sel:[0,0,0] op_sel_hi:[1,0,1]
    v_pk_fma_f32 v[96:97], v[20:21], v[58:59], v[96:97] op_sel:[0,0,0] op_sel_hi:[1,0,1]
    v_pk_fma_f32 v[98:99], v[22:23], v[58:59], v[98:99] op_sel:[0,0,0] op_sel_hi:[1,0,1]
    v_pk_fma_f32 v[112:113], v[24:25], v[58:59], v[112:113] op_sel:[0,0,0] op_sel_hi:[1,0,1]
    v_pk_fma_f32 v[114:115], v[26:27], v[58:59], v[114:115] op_sel:[0,0,0] op_sel_hi:[1,0,1]
    v_pk_mul_f32 v[88:89], v[88:89], v[54:55] op_sel:[0,1] op_sel_hi:[1,1]
    v_pk_mul_f32 v[90:91], v[90:91], v[54:55] op_sel:[0,1] op_sel_hi:[1,1]
    v_pk_mul_f32 v[104:105], v[104:105], v[54:55] op_sel:[0,1] op_sel_hi:[1,1]
    v_pk_mul_f32 v[106:107], v[106:107], v[54:55] op_sel:[0,1] op_sel_hi:[1,1]
    v_pk_mul_f32 v[96:97], v[96:97], v[58:59] op_sel:[0,1] op_sel_hi:[1,1]
    v_pk_mul_f32 v[98:99], v[98:99], v[58:59] op_sel:[0,1] op_sel_hi:[1,1]
    v_pk_mul_f32 v[112:113], v[112:113], v[58:59] op_sel:[0,1] op_sel_hi:[1,1]
    v_pk_mul_f32 v[114:115], v[114:115], v[58:59] op_sel:[0,1] op_sel_hi:[1,1]
    v_cvt_pk_bf16_f32 v204, v88, v89
    v_cvt_pk_bf16_f32 v205, v90, v91
    v_cvt_pk_bf16_f32 v206, v104, v105
    v_cvt_pk_bf16_f32 v207, v106, v107
    v_cvt_pk_bf16_f32 v208, v96, v97
    v_cvt_pk_bf16_f32 v209, v98, v99
    v_cvt_pk_bf16_f32 v210, v112, v113
    v_cvt_pk_bf16_f32 v211, v114, v115
    s_mov_b64 exec, s[56:57]
    v_swap_b32 v206, v208
    v_swap_b32 v207, v209
    s_mov_b64 exec, -1
    buffer_store_dwordx4 v[204:207], v168, s[24:27], 0 offen offset:256 sc1
    buffer_store_dwordx4 v[208:211], v169, s[24:27], 0 offen offset:256 sc1
    v_pk_fma_f32 v[116:117], v[28:29], v[52:53], v[116:117] op_sel:[0,0,0] op_sel_hi:[1,0,1]
    v_pk_fma_f32 v[118:119], v[30:31], v[52:53], v[118:119] op_sel:[0,0,0] op_sel_hi:[1,0,1]
    v_pk_fma_f32 v[132:133], v[32:33], v[52:53], v[132:133] op_sel:[0,0,0] op_sel_hi:[1,0,1]
    v_pk_fma_f32 v[134:135], v[34:35], v[52:53], v[134:135] op_sel:[0,0,0] op_sel_hi:[1,0,1]
    v_pk_fma_f32 v[124:125], v[28:29], v[56:57], v[124:125] op_sel:[0,0,0] op_sel_hi:[1,0,1]
    v_pk_fma_f32 v[126:127], v[30:31], v[56:57], v[126:127] op_sel:[0,0,0] op_sel_hi:[1,0,1]
    v_pk_fma_f32 v[140:141], v[32:33], v[56:57], v[140:141] op_sel:[0,0,0] op_sel_hi:[1,0,1]
    v_pk_fma_f32 v[142:143], v[34:35], v[56:57], v[142:143] op_sel:[0,0,0] op_sel_hi:[1,0,1]
    v_pk_mul_f32 v[116:117], v[116:117], v[52:53] op_sel:[0,1] op_sel_hi:[1,1]
    v_pk_mul_f32 v[118:119], v[118:119], v[52:53] op_sel:[0,1] op_sel_hi:[1,1]
    v_pk_mul_f32 v[132:133], v[132:133], v[52:53] op_sel:[0,1] op_sel_hi:[1,1]
    v_pk_mul_f32 v[134:135], v[134:135], v[52:53] op_sel:[0,1] op_sel_hi:[1,1]
    v_pk_mul_f32 v[124:125], v[124:125], v[56:57] op_sel:[0,1] op_sel_hi:[1,1]
    v_pk_mul_f32 v[126:127], v[126:127], v[56:57] op_sel:[0,1] op_sel_hi:[1,1]
    v_pk_mul_f32 v[140:141], v[140:141], v[56:57] op_sel:[0,1] op_sel_hi:[1,1]
    v_pk_mul_f32 v[142:143], v[142:143], v[56:57] op_sel:[0,1] op_sel_hi:[1,1]
    v_cvt_pk_bf16_f32 v212, v116, v117
    v_cvt_pk_bf16_f32 v213, v118, v119
    v_cvt_pk_bf16_f32 v214, v132, v133
    v_cvt_pk_bf16_f32 v215, v134, v135
    v_cvt_pk_bf16_f32 v216, v124, v125
    v_cvt_pk_bf16_f32 v217, v126, v127
    v_cvt_pk_bf16_f32 v218, v140, v141
    v_cvt_pk_bf16_f32 v219, v142, v143
    s_mov_b64 exec, s[58:59]
    v_swap_b32 v214, v216
    v_swap_b32 v215, v217
    s_mov_b64 exec, -1
    buffer_store_dwordx4 v[212:215], v170, s[24:27], 0 offen offset:0 sc1
    buffer_store_dwordx4 v[216:219], v171, s[24:27], 0 offen offset:0 sc1
    v_pk_fma_f32 v[120:121], v[28:29], v[54:55], v[120:121] op_sel:[0,0,0] op_sel_hi:[1,0,1]
    v_pk_fma_f32 v[122:123], v[30:31], v[54:55], v[122:123] op_sel:[0,0,0] op_sel_hi:[1,0,1]
    v_pk_fma_f32 v[136:137], v[32:33], v[54:55], v[136:137] op_sel:[0,0,0] op_sel_hi:[1,0,1]
    v_pk_fma_f32 v[138:139], v[34:35], v[54:55], v[138:139] op_sel:[0,0,0] op_sel_hi:[1,0,1]
    v_pk_fma_f32 v[128:129], v[28:29], v[58:59], v[128:129] op_sel:[0,0,0] op_sel_hi:[1,0,1]
    v_pk_fma_f32 v[130:131], v[30:31], v[58:59], v[130:131] op_sel:[0,0,0] op_sel_hi:[1,0,1]
    v_pk_fma_f32 v[144:145], v[32:33], v[58:59], v[144:145] op_sel:[0,0,0] op_sel_hi:[1,0,1]
    v_pk_fma_f32 v[146:147], v[34:35], v[58:59], v[146:147] op_sel:[0,0,0] op_sel_hi:[1,0,1]
    v_pk_mul_f32 v[120:121], v[120:121], v[54:55] op_sel:[0,1] op_sel_hi:[1,1]
    v_pk_mul_f32 v[122:123], v[122:123], v[54:55] op_sel:[0,1] op_sel_hi:[1,1]
    v_pk_mul_f32 v[136:137], v[136:137], v[54:55] op_sel:[0,1] op_sel_hi:[1,1]
    v_pk_mul_f32 v[138:139], v[138:139], v[54:55] op_sel:[0,1] op_sel_hi:[1,1]
    v_pk_mul_f32 v[128:129], v[128:129], v[58:59] op_sel:[0,1] op_sel_hi:[1,1]
    v_pk_mul_f32 v[130:131], v[130:131], v[58:59] op_sel:[0,1] op_sel_hi:[1,1]
    v_pk_mul_f32 v[144:145], v[144:145], v[58:59] op_sel:[0,1] op_sel_hi:[1,1]
    v_pk_mul_f32 v[146:147], v[146:147], v[58:59] op_sel:[0,1] op_sel_hi:[1,1]
    v_cvt_pk_bf16_f32 v220, v120, v121
    v_cvt_pk_bf16_f32 v221, v122, v123
    v_cvt_pk_bf16_f32 v222, v136, v137
    v_cvt_pk_bf16_f32 v223, v138, v139
    v_cvt_pk_bf16_f32 v224, v128, v129
    v_cvt_pk_bf16_f32 v225, v130, v131
    v_cvt_pk_bf16_f32 v226, v144, v145
    v_cvt_pk_bf16_f32 v227, v146, v147
    s_mov_b64 exec, s[58:59]
    v_swap_b32 v222, v224
    v_swap_b32 v223, v225
    s_mov_b64 exec, -1
    buffer_store_dwordx4 v[220:223], v170, s[24:27], 0 offen offset:256 sc1
    buffer_store_dwordx4 v[224:227], v171, s[24:27], 0 offen offset:256 sc1
    s_mov_b32 s71, 27049984
    s_load_dwordx2 s[22:23], s[20:21], s71
    s_lshl_b32 s71, s2, 7
    s_getpc_b64 s[86:87]
k_pc2_2:
    s_add_u32 s86, s86, k_tab2-k_pc2_2
    s_addc_u32 s87, s87, 0
    s_add_u32 s86, s86, s71
    s_addc_u32 s87, s87, 0
    s_load_dwordx8 s[88:95], s[86:87], 0
    s_branch k_p2
k_v:
    s_mul_i32 s65, s55, 5120
    s_add_u32 s65, s65, 2560
    s_mul_i32 s56, s39, 1280
    s_add_u32 s56, s56, s65
    s_xor_b32 s57, s39, 1
    s_mul_i32 s57, s57, 1280
    s_add_u32 s57, s57, s65
    s_sub_u32 s64, s38, 10
    s_lshl_b32 s64, s64, 2
    s_lshl_b32 s65, s39, 1
    s_add_u32 s64, s64, s65
    s_add_u32 s64, s64, s40
    s_lshl_b32 s64, s64, 5
    s_mov_b32 s68, 163520
    v_mul_u32_u24 v150, 320, v149
    s_xor_b32 s65, s64, 0
    v_add_u32 v151, s65, v148
    v_mul_u32_u24 v152, 3277, v151
    v_lshrrev_b32 v152, 16, v152
    v_mad_u32_u24 v152, v152, s68, v150
    v_lshl_add_u32 v168, v151, 4, v152
    s_xor_b32 s65, s64, 16
    v_add_u32 v151, s65, v148
    v_mul_u32_u24 v152, 3277, v151
    v_lshrrev_b32 v152, 16, v152
    v_mad_u32_u24 v152, v152, s68, v150
    v_lshl_add_u32 v169, v151, 4, v152
    s_xor_b32 s65, s64, 32
    v_add_u32 v151, s65, v148
    v_mul_u32_u24 v152, 3277, v151
    v_lshrrev_b32 v152, 16, v152
    v_mad_u32_u24 v152, v152, s68, v150
    v_lshl_add_u32 v170, v151, 4, v152
    s_xor_b32 s65, s64, 48
    v_add_u32 v151, s65, v148
    v_mul_u32_u24 v152, 3277, v151
    v_lshrrev_b32 v152, 16, v152
    v_mad_u32_u24 v152, v152, s68, v150
    v_lshl_add_u32 v171, v151, 4, v152
    s_mov_b32 s52, 0
    s_mov_b32 s64, 0xaaaaaaaa
    s_mov_b32 s65, 0xaaaaaaaa
    s_mov_b32 s66, 0xcccccccc
    s_mov_b32 s67, 0xcccccccc
    s_lshl_b32 s53, s36, 7
    s_lshl_b32 s54, s39, 1
    s_add_u32 s54, s54, s40
    s_lshl_b32 s54, s54, 7
    s_mul_i32 s68, s38, 10
    s_add_u32 s68, s68, s70
    s_lshl_b32 s68, s68, 9
    s_add_u32 s68, s68, s54
    s_add_u32 s68, s68, 25722880
    s_cmp_lt_u32 s37, 10
    s_cselect_b32 s68, s68, 0x40000000
    s_mul_i32 s69, s37, 10
    s_add_u32 s69, s69, s70
    s_lshl_b32 s69, s69, 9
    s_add_u32 s69, s69, s53
    s_lshl_b32 s69, s69, 1
    s_add_u32 s69, s69, 25559040
    s_cmp_lt_u32 s38, 10
    s_cselect_b32 s69, s69, 0x40000000
    v_lshlrev_b32 v156, 2, v1
    v_lshlrev_b32 v157, 3, v1
    s_add_u32 s53, s53, 131072
    s_add_u32 s54, s54, 132096
    v_lshrrev_b32 v152, 5, v1
    v_lshlrev_b32 v152, 6, v152
    v_and_b32 v153, 16, v1
    v_add_u32 v152, v152, v153
    v_lshlrev_b32 v154, 2, v148
    v_add_u32 v152, s53, v152
    v_xor_b32 v153, 128, v152
    v_add_u32 v154, s54, v154
    v_xor_b32 v155, 128, v154
    s_barrier
    ds_read_b128 v[20:23], v10 offset:0
    ds_read_b64_tr_b16 v[52:53], v14 offset:16384
    ds_read_b64_tr_b16 v[54:55], v14 offset:17408
    ds_read_b128 v[24:27], v10 offset:2048
    ds_read_b128 v[28:31], v12 offset:0
    ds_read_b128 v[32:35], v12 offset:2048
    ds_read_b64_tr_b16 v[56:57], v15 offset:16384
    ds_read_b64_tr_b16 v[58:59], v15 offset:17408
    ds_read_b64_tr_b16 v[60:61], v16 offset:16384
    ds_read_b64_tr_b16 v[62:63], v16 offset:17408
    ds_read_b64_tr_b16 v[64:65], v17 offset:16384
    ds_read_b64_tr_b16 v[66:67], v17 offset:17408
    s_waitcnt lgkmcnt(4)
    v_mfma_f32_16x16x32_bf16 v[84:87], v[20:23], v[52:55], 0
    ds_read_b128 v[36:39], v11 offset:0
    v_mfma_f32_16x16x32_bf16 v[88:91], v[24:27], v[52:55], 0
    ds_read_b64_tr_b16 v[68:69], v14 offset:24576
    v_mfma_f32_16x16x32_bf16 v[92:95], v[28:31], v[52:55], 0
    ds_read_b64_tr_b16 v[70:71], v14 offset:25600
    v_mfma_f32_16x16x32_bf16 v[96:99], v[32:35], v[52:55], 0
    ds_read_b128 v[40:43], v11 offset:2048
    v_mfma_f32_16x16x32_bf16 v[112:115], v[32:35], v[56:59], 0
    ds_read_b128 v[44:47], v13 offset:0
    v_mfma_f32_16x16x32_bf16 v[108:111], v[28:31], v[56:59], 0
    ds_read_b128 v[48:51], v13 offset:2048
    v_mfma_f32_16x16x32_bf16 v[104:107], v[24:27], v[56:59], 0
    ds_read_b64_tr_b16 v[72:73], v15 offset:24576
    v_mfma_f32_16x16x32_bf16 v[100:103], v[20:23], v[56:59], 0
    ds_read_b64_tr_b16 v[74:75], v15 offset:25600
    s_waitcnt lgkmcnt(8)
    v_mfma_f32_16x16x32_bf16 v[116:119], v[20:23], v[60:63], 0
    ds_read_b64_tr_b16 v[76:77], v16 offset:24576
    v_mfma_f32_16x16x32_bf16 v[120:123], v[24:27], v[60:63], 0
    ds_read_b64_tr_b16 v[78:79], v16 offset:25600
    v_mfma_f32_16x16x32_bf16 v[124:127], v[28:31], v[60:63], 0
    ds_read_b64_tr_b16 v[80:81], v17 offset:24576
    v_mfma_f32_16x16x32_bf16 v[128:131], v[32:35], v[60:63], 0
    ds_read_b64_tr_b16 v[82:83], v17 offset:25600
    v_mfma_f32_16x16x32_bf16 v[144:147], v[32:35], v[64:67], 0
    v_mfma_f32_16x16x32_bf16 v[140:143], v[28:31], v[64:67], 0
    v_mfma_f32_16x16x32_bf16 v[136:139], v[24:27], v[64:67], 0
    v_mfma_f32_16x16x32_bf16 v[132:135], v[20:23], v[64:67], 0
    s_waitcnt lgkmcnt(4)
    v_mfma_f32_16x16x32_bf16 v[84:87], v[36:39], v[68:71], v[84:87]
    s_barrier
    ds_read_b128 v[20:23], v10 offset:32768
    v_mfma_f32_16x16x32_bf16 v[88:91], v[40:43], v[68:71], v[88:91]
    ds_read_b64_tr_b16 v[52:53], v14 offset:49152
    v_mfma_f32_16x16x32_bf16 v[92:95], v[44:47], v[68:71], v[92:95]
    ds_read_b64_tr_b16 v[54:55], v14 offset:50176
    v_mfma_f32_16x16x32_bf16 v[96:99], v[48:51], v[68:71], v[96:99]
    ds_read_b128 v[24:27], v10 offset:34816
    v_mfma_f32_16x16x32_bf16 v[112:115], v[48:51], v[72:75], v[112:115]
    ds_read_b128 v[28:31], v12 offset:32768
    v_mfma_f32_16x16x32_bf16 v[108:111], v[44:47], v[72:75], v[108:111]
    ds_read_b128 v[32:35], v12 offset:34816
    v_mfma_f32_16x16x32_bf16 v[104:107], v[40:43], v[72:75], v[104:107]
    ds_read_b64_tr_b16 v[56:57], v15 offset:49152
    v_mfma_f32_16x16x32_bf16 v[100:103], v[36:39], v[72:75], v[100:103]
    ds_read_b64_tr_b16 v[58:59], v15 offset:50176
    s_waitcnt lgkmcnt(8)
    v_mfma_f32_16x16x32_bf16 v[116:119], v[36:39], v[76:79], v[116:119]
    ds_read_b64_tr_b16 v[60:61], v16 offset:49152
    v_mfma_f32_16x16x32_bf16 v[120:123], v[40:43], v[76:79], v[120:123]
    ds_read_b64_tr_b16 v[62:63], v16 offset:50176
    v_mfma_f32_16x16x32_bf16 v[124:127], v[44:47], v[76:79], v[124:127]
    ds_read_b64_tr_b16 v[64:65], v17 offset:49152
    v_mfma_f32_16x16x32_bf16 v[128:131], v[48:51], v[76:79], v[128:131]
    ds_read_b64_tr_b16 v[66:67], v17 offset:50176
    v_mfma_f32_16x16x32_bf16 v[144:147], v[48:51], v[80:83], v[144:147]
    v_mfma_f32_16x16x32_bf16 v[140:143], v[44:47], v[80:83], v[140:143]
    v_mfma_f32_16x16x32_bf16 v[136:139], v[40:43], v[80:83], v[136:139]
    v_mfma_f32_16x16x32_bf16 v[132:135], v[36:39], v[80:83], v[132:135]
    s_waitcnt lgkmcnt(4)
    v_mfma_f32_4x4x4_16b_bf16 v[172:175], v[18:19], v[20:21], 0
    v_mfma_f32_4x4x4_16b_bf16 v[180:183], v[20:21], v[20:21], 0
    v_mfma_f32_4x4x4_16b_bf16 v[188:191], v[18:19], v[52:53], 0
    v_mfma_f32_4x4x4_16b_bf16 v[176:179], v[18:19], v[24:25], 0
    v_mfma_f32_4x4x4_16b_bf16 v[184:187], v[24:25], v[24:25], 0
    v_mfma_f32_4x4x4_16b_bf16 v[192:195], v[18:19], v[56:57], 0
    v_mfma_f32_4x4x4_16b_bf16 v[172:175], v[18:19], v[22:23], v[172:175]
    v_mfma_f32_4x4x4_16b_bf16 v[180:183], v[22:23], v[22:23], v[180:183]
    v_mfma_f32_4x4x4_16b_bf16 v[188:191], v[18:19], v[54:55], v[188:191]
    v_mfma_f32_4x4x4_16b_bf16 v[176:179], v[18:19], v[26:27], v[176:179]
    v_mfma_f32_4x4x4_16b_bf16 v[184:187], v[26:27], v[26:27], v[184:187]
    v_mfma_f32_4x4x4_16b_bf16 v[192:195], v[18:19], v[58:59], v[192:195]
    v_mfma_f32_16x16x32_bf16 v[84:87], v[20:23], v[52:55], v[84:87]
    ds_read_b128 v[36:39], v11 offset:32768
    v_mfma_f32_16x16x32_bf16 v[88:91], v[24:27], v[52:55], v[88:91]
    ds_read_b64_tr_b16 v[68:69], v14 offset:57344
    v_mfma_f32_16x16x32_bf16 v[92:95], v[28:31], v[52:55], v[92:95]
    ds_read_b64_tr_b16 v[70:71], v14 offset:58368
    v_mfma_f32_16x16x32_bf16 v[96:99], v[32:35], v[52:55], v[96:99]
    ds_read_b128 v[40:43], v11 offset:34816
    v_mfma_f32_16x16x32_bf16 v[112:115], v[32:35], v[56:59], v[112:115]
    ds_read_b128 v[44:47], v13 offset:32768
    v_mfma_f32_16x16x32_bf16 v[108:111], v[28:31], v[56:59], v[108:111]
    ds_read_b128 v[48:51], v13 offset:34816
    v_mfma_f32_16x16x32_bf16 v[104:107], v[24:27], v[56:59], v[104:107]
    ds_read_b64_tr_b16 v[72:73], v15 offset:57344
    v_mfma_f32_16x16x32_bf16 v[100:103], v[20:23], v[56:59], v[100:103]
    ds_read_b64_tr_b16 v[74:75], v15 offset:58368
    s_waitcnt lgkmcnt(8)
    v_mfma_f32_16x16x32_bf16 v[116:119], v[20:23], v[60:63], v[116:119]
    ds_read_b64_tr_b16 v[76:77], v16 offset:57344
    v_mfma_f32_16x16x32_bf16 v[120:123], v[24:27], v[60:63], v[120:123]
    ds_read_b64_tr_b16 v[78:79], v16 offset:58368
    v_mfma_f32_16x16x32_bf16 v[124:127], v[28:31], v[60:63], v[124:127]
    ds_read_b64_tr_b16 v[80:81], v17 offset:57344
    v_mfma_f32_16x16x32_bf16 v[128:131], v[32:35], v[60:63], v[128:131]
    ds_read_b64_tr_b16 v[82:83], v17 offset:58368
    v_mfma_f32_16x16x32_bf16 v[144:147], v[32:35], v[64:67], v[144:147]
    v_xor_b32 v10, 0x10000, v10
    v_xor_b32 v11, 0x10000, v11
    v_xor_b32 v12, 0x10000, v12
    v_mfma_f32_16x16x32_bf16 v[140:143], v[28:31], v[64:67], v[140:143]
    s_add_u32 s52, s52, 1
    v_xor_b32 v13, 0x10000, v13
    v_xor_b32 v14, 0x10000, v14
    v_xor_b32 v15, 0x10000, v15
    v_mfma_f32_16x16x32_bf16 v[136:139], v[24:27], v[64:67], v[136:139]
    s_cmp_lt_u32 s52, 5
    v_xor_b32 v16, 0x10000, v16
    v_xor_b32 v17, 0x10000, v17
    v_mfma_f32_16x16x32_bf16 v[132:135], v[20:23], v[64:67], v[132:135]
    s_waitcnt lgkmcnt(4)
    v_mfma_f32_4x4x4_16b_bf16 v[172:175], v[18:19], v[36:37], v[172:175]
    v_mfma_f32_4x4x4_16b_bf16 v[180:183], v[36:37], v[36:37], v[180:183]
    v_mfma_f32_4x4x4_16b_bf16 v[188:191], v[18:19], v[68:69], v[188:191]
    v_mfma_f32_4x4x4_16b_bf16 v[176:179], v[18:19], v[40:41], v[176:179]
    v_mfma_f32_4x4x4_16b_bf16 v[184:187], v[40:41], v[40:41], v[184:187]
    v_mfma_f32_4x4x4_16b_bf16 v[192:195], v[18:19], v[72:73], v[192:195]
    v_mfma_f32_4x4x4_16b_bf16 v[172:175], v[18:19], v[38:39], v[172:175]
    v_mfma_f32_4x4x4_16b_bf16 v[180:183], v[38:39], v[38:39], v[180:183]
    v_mfma_f32_4x4x4_16b_bf16 v[188:191], v[18:19], v[70:71], v[188:191]
    v_mfma_f32_4x4x4_16b_bf16 v[176:179], v[18:19], v[42:43], v[176:179]
    v_mfma_f32_4x4x4_16b_bf16 v[184:187], v[42:43], v[42:43], v[184:187]
    v_mfma_f32_4x4x4_16b_bf16 v[192:195], v[18:19], v[74:75], v[192:195]
    v_mfma_f32_16x16x32_bf16 v[84:87], v[36:39], v[68:71], v[84:87]
    s_nop 3
    v_cndmask_b32 v180, v180, v181, s[64:65]
    v_cndmask_b32 v182, v182, v183, s[64:65]
    v_cndmask_b32 v180, v180, v182, s[66:67]
    v_cndmask_b32 v184, v184, v185, s[64:65]
    v_cndmask_b32 v186, v186, v187, s[64:65]
    v_cndmask_b32 v184, v184, v186, s[66:67]
    s_nop 0
    v_permlane16_swap_b32 v172, v176
    v_permlane16_swap_b32 v188, v192
    v_permlane16_swap_b32 v180, v184
    v_add_f32 v172, v172, v176
    v_add_f32 v188, v188, v192
    v_add_f32 v180, v180, v184
    v_mov_b32 v176, v172
    v_mov_b32 v192, v188
    v_mov_b32 v184, v180
    s_nop 0
    v_permlane32_swap_b32 v172, v176
    v_permlane32_swap_b32 v188, v192
    v_permlane32_swap_b32 v180, v184
    v_add_f32 v172, v172, v176
    v_add_f32 v188, v188, v192
    v_add_f32 v173, v180, v184
    s_mov_b32 exec_hi, 0
    buffer_store_dword v188, v156, s[24:27], s68 offen sc1
    buffer_store_dwordx2 v[172:173], v157, s[24:27], s69 offen sc1
    s_mov_b32 exec_hi, -1
    s_barrier
    ds_read_b128 v[20:23], v10 offset:0
    v_mfma_f32_16x16x32_bf16 v[88:91], v[40:43], v[68:71], v[88:91]
    ds_read_b64_tr_b16 v[52:53], v14 offset:16384
    v_mfma_f32_16x16x32_bf16 v[92:95], v[44:47], v[68:71], v[92:95]
    ds_read_b64_tr_b16 v[54:55], v14 offset:17408
    v_mfma_f32_16x16x32_bf16 v[96:99], v[48:51], v[68:71], v[96:99]
    ds_read_b128 v[24:27], v10 offset:2048
    v_mfma_f32_16x16x32_bf16 v[112:115], v[48:51], v[72:75], v[112:115]
    ds_read_b128 v[28:31], v12 offset:0
    v_mfma_f32_16x16x32_bf16 v[108:111], v[44:47], v[72:75], v[108:111]
    ds_read_b128 v[32:35], v12 offset:2048
    v_mfma_f32_16x16x32_bf16 v[104:107], v[40:43], v[72:75], v[104:107]
    ds_read_b64_tr_b16 v[56:57], v15 offset:16384
    v_mfma_f32_16x16x32_bf16 v[100:103], v[36:39], v[72:75], v[100:103]
    ds_read_b64_tr_b16 v[58:59], v15 offset:17408
    s_waitcnt lgkmcnt(8)
    v_mfma_f32_16x16x32_bf16 v[116:119], v[36:39], v[76:79], v[116:119]
    ds_read_b64_tr_b16 v[60:61], v16 offset:16384
    v_mfma_f32_16x16x32_bf16 v[120:123], v[40:43], v[76:79], v[120:123]
    ds_read_b64_tr_b16 v[62:63], v16 offset:17408
    v_mfma_f32_16x16x32_bf16 v[124:127], v[44:47], v[76:79], v[124:127]
    ds_read_b64_tr_b16 v[64:65], v17 offset:16384
    v_mfma_f32_16x16x32_bf16 v[128:131], v[48:51], v[76:79], v[128:131]
    ds_read_b64_tr_b16 v[66:67], v17 offset:17408
    v_mfma_f32_16x16x32_bf16 v[144:147], v[48:51], v[80:83], v[144:147]
    v_mfma_f32_16x16x32_bf16 v[140:143], v[44:47], v[80:83], v[140:143]
    v_mfma_f32_16x16x32_bf16 v[136:139], v[40:43], v[80:83], v[136:139]
    v_mfma_f32_16x16x32_bf16 v[132:135], v[36:39], v[80:83], v[132:135]
k_loop1:
    s_waitcnt lgkmcnt(4)
    v_mfma_f32_16x16x32_bf16 v[84:87], v[20:23], v[52:55], v[84:87]
    ds_read_b128 v[36:39], v11 offset:0
    v_mfma_f32_16x16x32_bf16 v[88:91], v[24:27], v[52:55], v[88:91]
    ds_read_b64_tr_b16 v[68:69], v14 offset:24576
    v_mfma_f32_16x16x32_bf16 v[92:95], v[28:31], v[52:55], v[92:95]
    ds_read_b64_tr_b16 v[70:71], v14 offset:25600
    v_mfma_f32_16x16x32_bf16 v[96:99], v[32:35], v[52:55], v[96:99]
    ds_read_b128 v[40:43], v11 offset:2048
    v_mfma_f32_16x16x32_bf16 v[112:115], v[32:35], v[56:59], v[112:115]
    ds_read_b128 v[44:47], v13 offset:0
    v_mfma_f32_16x16x32_bf16 v[108:111], v[28:31], v[56:59], v[108:111]
    ds_read_b128 v[48:51], v13 offset:2048
    v_mfma_f32_16x16x32_bf16 v[104:107], v[24:27], v[56:59], v[104:107]
    ds_read_b64_tr_b16 v[72:73], v15 offset:24576
    v_mfma_f32_16x16x32_bf16 v[100:103], v[20:23], v[56:59], v[100:103]
    ds_read_b64_tr_b16 v[74:75], v15 offset:25600
    s_waitcnt lgkmcnt(8)
    v_mfma_f32_16x16x32_bf16 v[116:119], v[20:23], v[60:63], v[116:119]
    ds_read_b64_tr_b16 v[76:77], v16 offset:24576
    v_mfma_f32_16x16x32_bf16 v[120:123], v[24:27], v[60:63], v[120:123]
    ds_read_b64_tr_b16 v[78:79], v16 offset:25600
    v_mfma_f32_16x16x32_bf16 v[124:127], v[28:31], v[60:63], v[124:127]
    ds_read_b64_tr_b16 v[80:81], v17 offset:24576
    v_mfma_f32_16x16x32_bf16 v[128:131], v[32:35], v[60:63], v[128:131]
    ds_read_b64_tr_b16 v[82:83], v17 offset:25600
    v_mfma_f32_16x16x32_bf16 v[144:147], v[32:35], v[64:67], v[144:147]
    v_mfma_f32_16x16x32_bf16 v[140:143], v[28:31], v[64:67], v[140:143]
    v_mfma_f32_16x16x32_bf16 v[136:139], v[24:27], v[64:67], v[136:139]
    v_mfma_f32_16x16x32_bf16 v[132:135], v[20:23], v[64:67], v[132:135]
    s_waitcnt lgkmcnt(4)
    v_mfma_f32_16x16x32_bf16 v[84:87], v[36:39], v[68:71], v[84:87]
    s_waitcnt vmcnt(0)
    s_barrier
    ds_read_b128 v[20:23], v10 offset:32768
    v_mfma_f32_16x16x32_bf16 v[88:91], v[40:43], v[68:71], v[88:91]
    ds_read_b64_tr_b16 v[52:53], v14 offset:49152
    v_mfma_f32_16x16x32_bf16 v[92:95], v[44:47], v[68:71], v[92:95]
    ds_read_b64_tr_b16 v[54:55], v14 offset:50176
    v_mfma_f32_16x16x32_bf16 v[96:99], v[48:51], v[68:71], v[96:99]
    ds_read_b128 v[24:27], v10 offset:34816
    v_mfma_f32_16x16x32_bf16 v[112:115], v[48:51], v[72:75], v[112:115]
    ds_read_b128 v[28:31], v12 offset:32768
    v_mfma_f32_16x16x32_bf16 v[108:111], v[44:47], v[72:75], v[108:111]
    ds_read_b128 v[32:35], v12 offset:34816
    v_mfma_f32_16x16x32_bf16 v[104:107], v[40:43], v[72:75], v[104:107]
    ds_read_b64_tr_b16 v[56:57], v15 offset:49152
    v_mfma_f32_16x16x32_bf16 v[100:103], v[36:39], v[72:75], v[100:103]
    ds_read_b64_tr_b16 v[58:59], v15 offset:50176
    s_waitcnt lgkmcnt(8)
    v_mfma_f32_16x16x32_bf16 v[116:119], v[36:39], v[76:79], v[116:119]
    ds_read_b64_tr_b16 v[60:61], v16 offset:49152
    v_mfma_f32_16x16x32_bf16 v[120:123], v[40:43], v[76:79], v[120:123]
    ds_read_b64_tr_b16 v[62:63], v16 offset:50176
    v_mfma_f32_16x16x32_bf16 v[124:127], v[44:47], v[76:79], v[124:127]
    ds_read_b64_tr_b16 v[64:65], v17 offset:49152
    v_mfma_f32_16x16x32_bf16 v[128:131], v[48:51], v[76:79], v[128:131]
    ds_read_b64_tr_b16 v[66:67], v17 offset:50176
    v_mfma_f32_16x16x32_bf16 v[144:147], v[48:51], v[80:83], v[144:147]
    v_mfma_f32_16x16x32_bf16 v[140:143], v[44:47], v[80:83], v[140:143]
    v_mfma_f32_16x16x32_bf16 v[136:139], v[40:43], v[80:83], v[136:139]
    v_mfma_f32_16x16x32_bf16 v[132:135], v[36:39], v[80:83], v[132:135]
    s_waitcnt lgkmcnt(4)
    v_mfma_f32_16x16x32_bf16 v[84:87], v[20:23], v[52:55], v[84:87]
    ds_read_b128 v[36:39], v11 offset:32768
    v_mfma_f32_16x16x32_bf16 v[88:91], v[24:27], v[52:55], v[88:91]
    ds_read_b64_tr_b16 v[68:69], v14 offset:57344
    v_mfma_f32_16x16x32_bf16 v[92:95], v[28:31], v[52:55], v[92:95]
    ds_read_b64_tr_b16 v[70:71], v14 offset:58368
    v_mfma_f32_16x16x32_bf16 v[96:99], v[32:35], v[52:55], v[96:99]
    ds_read_b128 v[40:43], v11 offset:34816
    v_mfma_f32_16x16x32_bf16 v[112:115], v[32:35], v[56:59], v[112:115]
    ds_read_b128 v[44:47], v13 offset:32768
    v_mfma_f32_16x16x32_bf16 v[108:111], v[28:31], v[56:59], v[108:111]
    ds_read_b128 v[48:51], v13 offset:34816
    v_mfma_f32_16x16x32_bf16 v[104:107], v[24:27], v[56:59], v[104:107]
    ds_read_b64_tr_b16 v[72:73], v15 offset:57344
    v_mfma_f32_16x16x32_bf16 v[100:103], v[20:23], v[56:59], v[100:103]
    ds_read_b64_tr_b16 v[74:75], v15 offset:58368
    s_waitcnt lgkmcnt(8)
    v_mfma_f32_16x16x32_bf16 v[116:119], v[20:23], v[60:63], v[116:119]
    ds_read_b64_tr_b16 v[76:77], v16 offset:57344
    v_mfma_f32_16x16x32_bf16 v[120:123], v[24:27], v[60:63], v[120:123]
    ds_read_b64_tr_b16 v[78:79], v16 offset:58368
    v_mfma_f32_16x16x32_bf16 v[124:127], v[28:31], v[60:63], v[124:127]
    ds_read_b64_tr_b16 v[80:81], v17 offset:57344
    v_mfma_f32_16x16x32_bf16 v[128:131], v[32:35], v[60:63], v[128:131]
    ds_read_b64_tr_b16 v[82:83], v17 offset:58368
    v_mfma_f32_16x16x32_bf16 v[144:147], v[32:35], v[64:67], v[144:147]
    v_xor_b32 v10, 0x10000, v10
    v_xor_b32 v11, 0x10000, v11
    v_xor_b32 v12, 0x10000, v12
    v_mfma_f32_16x16x32_bf16 v[140:143], v[28:31], v[64:67], v[140:143]
    s_add_u32 s52, s52, 1
    v_xor_b32 v13, 0x10000, v13
    v_xor_b32 v14, 0x10000, v14
    v_xor_b32 v15, 0x10000, v15
    v_mfma_f32_16x16x32_bf16 v[136:139], v[24:27], v[64:67], v[136:139]
    s_cmp_lt_u32 s52, 5
    v_xor_b32 v16, 0x10000, v16
    v_xor_b32 v17, 0x10000, v17
    v_mfma_f32_16x16x32_bf16 v[132:135], v[20:23], v[64:67], v[132:135]
    s_waitcnt lgkmcnt(4)
    v_mfma_f32_16x16x32_bf16 v[84:87], v[36:39], v[68:71], v[84:87]
    s_cbranch_scc0 k_last1
    s_barrier
    ds_read_b128 v[20:23], v10 offset:0
    v_mfma_f32_16x16x32_bf16 v[88:91], v[40:43], v[68:71], v[88:91]
    ds_read_b64_tr_b16 v[52:53], v14 offset:16384
    v_mfma_f32_16x16x32_bf16 v[92:95], v[44:47], v[68:71], v[92:95]
    ds_read_b64_tr_b16 v[54:55], v14 offset:17408
    v_mfma_f32_16x16x32_bf16 v[96:99], v[48:51], v[68:71], v[96:99]
    ds_read_b128 v[24:27], v10 offset:2048
    v_mfma_f32_16x16x32_bf16 v[112:115], v[48:51], v[72:75], v[112:115]
    ds_read_b128 v[28:31], v12 offset:0
    v_mfma_f32_16x16x32_bf16 v[108:111], v[44:47], v[72:75], v[108:111]
    ds_read_b128 v[32:35], v12 offset:2048
    v_mfma_f32_16x16x32_bf16 v[104:107], v[40:43], v[72:75], v[104:107]
    ds_read_b64_tr_b16 v[56:57], v15 offset:16384
    v_mfma_f32_16x16x32_bf16 v[100:103], v[36:39], v[72:75], v[100:103]
    ds_read_b64_tr_b16 v[58:59], v15 offset:17408
    s_waitcnt lgkmcnt(8)
    v_mfma_f32_16x16x32_bf16 v[116:119], v[36:39], v[76:79], v[116:119]
    ds_read_b64_tr_b16 v[60:61], v16 offset:16384
    v_mfma_f32_16x16x32_bf16 v[120:123], v[40:43], v[76:79], v[120:123]
    ds_read_b64_tr_b16 v[62:63], v16 offset:17408
    v_mfma_f32_16x16x32_bf16 v[124:127], v[44:47], v[76:79], v[124:127]
    ds_read_b64_tr_b16 v[64:65], v17 offset:16384
    v_mfma_f32_16x16x32_bf16 v[128:131], v[48:51], v[76:79], v[128:131]
    ds_read_b64_tr_b16 v[66:67], v17 offset:17408
    v_mfma_f32_16x16x32_bf16 v[144:147], v[48:51], v[80:83], v[144:147]
    v_mfma_f32_16x16x32_bf16 v[140:143], v[44:47], v[80:83], v[140:143]
    v_mfma_f32_16x16x32_bf16 v[136:139], v[40:43], v[80:83], v[136:139]
    v_mfma_f32_16x16x32_bf16 v[132:135], v[36:39], v[80:83], v[132:135]
    s_branch k_loop1
k_last1:
    v_mfma_f32_16x16x32_bf16 v[88:91], v[40:43], v[68:71], v[88:91]
    v_mfma_f32_16x16x32_bf16 v[92:95], v[44:47], v[68:71], v[92:95]
    v_mfma_f32_16x16x32_bf16 v[96:99], v[48:51], v[68:71], v[96:99]
    v_mfma_f32_16x16x32_bf16 v[112:115], v[48:51], v[72:75], v[112:115]
    v_mfma_f32_16x16x32_bf16 v[108:111], v[44:47], v[72:75], v[108:111]
    v_mfma_f32_16x16x32_bf16 v[104:107], v[40:43], v[72:75], v[104:107]
    v_mfma_f32_16x16x32_bf16 v[100:103], v[36:39], v[72:75], v[100:103]
    s_waitcnt lgkmcnt(0)
    v_mfma_f32_16x16x32_bf16 v[116:119], v[36:39], v[76:79], v[116:119]
    v_mfma_f32_16x16x32_bf16 v[120:123], v[40:43], v[76:79], v[120:123]
    s_barrier
    ds_read2_b32 v[228:229], v154 offset0:0 offset1:16
    ds_read2_b32 v[230:231], v155 offset0:0 offset1:16
    ds_read_b128 v[20:23], v152 offset:0
    ds_read_b128 v[52:55], v152 offset:512
    ds_read_b128 v[24:27], v152 offset:32
    ds_read_b128 v[56:59], v152 offset:544
    ds_read_b128 v[28:31], v153 offset:0
    ds_read_b128 v[60:63], v153 offset:512
    ds_read_b128 v[32:35], v153 offset:32
    ds_read_b128 v[64:67], v153 offset:544
    v_mfma_f32_16x16x32_bf16 v[124:127], v[44:47], v[76:79], v[124:127]
    v_mfma_f32_16x16x32_bf16 v[128:131], v[48:51], v[76:79], v[128:131]
    v_mfma_f32_16x16x32_bf16 v[144:147], v[48:51], v[80:83], v[144:147]
    v_mfma_f32_16x16x32_bf16 v[140:143], v[44:47], v[80:83], v[140:143]
    v_mfma_f32_16x16x32_bf16 v[136:139], v[40:43], v[80:83], v[136:139]
    v_mfma_f32_16x16x32_bf16 v[132:135], v[36:39], v[80:83], v[132:135]
    s_waitcnt lgkmcnt(0)
    v_pk_fma_f32 v[84:85], v[20:21], v[228:229], v[84:85] op_sel:[0,0,0] op_sel_hi:[1,0,1]
    v_pk_fma_f32 v[86:87], v[22:23], v[228:229], v[86:87] op_sel:[0,0,0] op_sel_hi:[1,0,1]
    v_pk_fma_f32 v[88:89], v[24:25], v[228:229], v[88:89] op_sel:[0,0,0] op_sel_hi:[1,0,1]
    v_pk_fma_f32 v[90:91], v[26:27], v[228:229], v[90:91] op_sel:[0,0,0] op_sel_hi:[1,0,1]
    v_pk_mul_f32 v[84:85], v[84:85], v[52:53]
    v_pk_mul_f32 v[86:87], v[86:87], v[54:55]
    v_pk_mul_f32 v[88:89], v[88:89], v[56:57]
    v_pk_mul_f32 v[90:91], v[90:91], v[58:59]
    v_cvt_pk_bf16_f32 v196, v84, v85
    v_cvt_pk_bf16_f32 v197, v86, v87
    v_cvt_pk_bf16_f32 v198, v88, v89
    v_cvt_pk_bf16_f32 v199, v90, v91
    buffer_store_dwordx4 v[196:199], v168, s[24:27], s56 offen sc1
    v_pk_fma_f32 v[92:93], v[28:29], v[228:229], v[92:93] op_sel:[0,0,0] op_sel_hi:[1,0,1]
    v_pk_fma_f32 v[94:95], v[30:31], v[228:229], v[94:95] op_sel:[0,0,0] op_sel_hi:[1,0,1]
    v_pk_fma_f32 v[96:97], v[32:33], v[228:229], v[96:97] op_sel:[0,0,0] op_sel_hi:[1,0,1]
    v_pk_fma_f32 v[98:99], v[34:35], v[228:229], v[98:99] op_sel:[0,0,0] op_sel_hi:[1,0,1]
    v_pk_mul_f32 v[92:93], v[92:93], v[60:61]
    v_pk_mul_f32 v[94:95], v[94:95], v[62:63]
    v_pk_mul_f32 v[96:97], v[96:97], v[64:65]
    v_pk_mul_f32 v[98:99], v[98:99], v[66:67]
    v_cvt_pk_bf16_f32 v200, v92, v93
    v_cvt_pk_bf16_f32 v201, v94, v95
    v_cvt_pk_bf16_f32 v202, v96, v97
    v_cvt_pk_bf16_f32 v203, v98, v99
    buffer_store_dwordx4 v[200:203], v168, s[24:27], s57 offen sc1
    v_pk_fma_f32 v[100:101], v[20:21], v[228:229], v[100:101] op_sel:[0,1,0] op_sel_hi:[1,1,1]
    v_pk_fma_f32 v[102:103], v[22:23], v[228:229], v[102:103] op_sel:[0,1,0] op_sel_hi:[1,1,1]
    v_pk_fma_f32 v[104:105], v[24:25], v[228:229], v[104:105] op_sel:[0,1,0] op_sel_hi:[1,1,1]
    v_pk_fma_f32 v[106:107], v[26:27], v[228:229], v[106:107] op_sel:[0,1,0] op_sel_hi:[1,1,1]
    v_pk_mul_f32 v[100:101], v[100:101], v[52:53]
    v_pk_mul_f32 v[102:103], v[102:103], v[54:55]
    v_pk_mul_f32 v[104:105], v[104:105], v[56:57]
    v_pk_mul_f32 v[106:107], v[106:107], v[58:59]
    v_cvt_pk_bf16_f32 v204, v100, v101
    v_cvt_pk_bf16_f32 v205, v102, v103
    v_cvt_pk_bf16_f32 v206, v104, v105
    v_cvt_pk_bf16_f32 v207, v106, v107
    buffer_store_dwordx4 v[204:207], v169, s[24:27], s56 offen sc1
    v_pk_fma_f32 v[108:109], v[28:29], v[228:229], v[108:109] op_sel:[0,1,0] op_sel_hi:[1,1,1]
    v_pk_fma_f32 v[110:111], v[30:31], v[228:229], v[110:111] op_sel:[0,1,0] op_sel_hi:[1,1,1]
    v_pk_fma_f32 v[112:113], v[32:33], v[228:229], v[112:113] op_sel:[0,1,0] op_sel_hi:[1,1,1]
    v_pk_fma_f32 v[114:115], v[34:35], v[228:229], v[114:115] op_sel:[0,1,0] op_sel_hi:[1,1,1]
    v_pk_mul_f32 v[108:109], v[108:109], v[60:61]
    v_pk_mul_f32 v[110:111], v[110:111], v[62:63]
    v_pk_mul_f32 v[112:113], v[112:113], v[64:65]
    v_pk_mul_f32 v[114:115], v[114:115], v[66:67]
    v_cvt_pk_bf16_f32 v208, v108, v109
    v_cvt_pk_bf16_f32 v209, v110, v111
    v_cvt_pk_bf16_f32 v210, v112, v113
    v_cvt_pk_bf16_f32 v211, v114, v115
    buffer_store_dwordx4 v[208:211], v169, s[24:27], s57 offen sc1
    v_pk_fma_f32 v[116:117], v[20:21], v[230:231], v[116:117] op_sel:[0,0,0] op_sel_hi:[1,0,1]
    v_pk_fma_f32 v[118:119], v[22:23], v[230:231], v[118:119] op_sel:[0,0,0] op_sel_hi:[1,0,1]
    v_pk_fma_f32 v[120:121], v[24:25], v[230:231], v[120:121] op_sel:[0,0,0] op_sel_hi:[1,0,1]
    v_pk_fma_f32 v[122:123], v[26:27], v[230:231], v[122:123] op_sel:[0,0,0] op_sel_hi:[1,0,1]
    v_pk_mul_f32 v[116:117], v[116:117], v[52:53]
    v_pk_mul_f32 v[118:119], v[118:119], v[54:55]
    v_pk_mul_f32 v[120:121], v[120:121], v[56:57]
    v_pk_mul_f32 v[122:123], v[122:123], v[58:59]
    v_cvt_pk_bf16_f32 v212, v116, v117
    v_cvt_pk_bf16_f32 v213, v118, v119
    v_cvt_pk_bf16_f32 v214, v120, v121
    v_cvt_pk_bf16_f32 v215, v122, v123
    buffer_store_dwordx4 v[212:215], v170, s[24:27], s56 offen sc1
    v_pk_fma_f32 v[124:125], v[28:29], v[230:231], v[124:125] op_sel:[0,0,0] op_sel_hi:[1,0,1]
    v_pk_fma_f32 v[126:127], v[30:31], v[230:231], v[126:127] op_sel:[0,0,0] op_sel_hi:[1,0,1]
    v_pk_fma_f32 v[128:129], v[32:33], v[230:231], v[128:129] op_sel:[0,0,0] op_sel_hi:[1,0,1]
    v_pk_fma_f32 v[130:131], v[34:35], v[230:231], v[130:131] op_sel:[0,0,0] op_sel_hi:[1,0,1]
    v_pk_mul_f32 v[124:125], v[124:125], v[60:61]
    v_pk_mul_f32 v[126:127], v[126:127], v[62:63]
    v_pk_mul_f32 v[128:129], v[128:129], v[64:65]
    v_pk_mul_f32 v[130:131], v[130:131], v[66:67]
    v_cvt_pk_bf16_f32 v216, v124, v125
    v_cvt_pk_bf16_f32 v217, v126, v127
    v_cvt_pk_bf16_f32 v218, v128, v129
    v_cvt_pk_bf16_f32 v219, v130, v131
    buffer_store_dwordx4 v[216:219], v170, s[24:27], s57 offen sc1
    v_pk_fma_f32 v[132:133], v[20:21], v[230:231], v[132:133] op_sel:[0,1,0] op_sel_hi:[1,1,1]
    v_pk_fma_f32 v[134:135], v[22:23], v[230:231], v[134:135] op_sel:[0,1,0] op_sel_hi:[1,1,1]
    v_pk_fma_f32 v[136:137], v[24:25], v[230:231], v[136:137] op_sel:[0,1,0] op_sel_hi:[1,1,1]
    v_pk_fma_f32 v[138:139], v[26:27], v[230:231], v[138:139] op_sel:[0,1,0] op_sel_hi:[1,1,1]
    v_pk_mul_f32 v[132:133], v[132:133], v[52:53]
    v_pk_mul_f32 v[134:135], v[134:135], v[54:55]
    v_pk_mul_f32 v[136:137], v[136:137], v[56:57]
    v_pk_mul_f32 v[138:139], v[138:139], v[58:59]
    v_cvt_pk_bf16_f32 v220, v132, v133
    v_cvt_pk_bf16_f32 v221, v134, v135
    v_cvt_pk_bf16_f32 v222, v136, v137
    v_cvt_pk_bf16_f32 v223, v138, v139
    buffer_store_dwordx4 v[220:223], v171, s[24:27], s56 offen sc1
    v_pk_fma_f32 v[140:141], v[28:29], v[230:231], v[140:141] op_sel:[0,1,0] op_sel_hi:[1,1,1]
    v_pk_fma_f32 v[142:143], v[30:31], v[230:231], v[142:143] op_sel:[0,1,0] op_sel_hi:[1,1,1]
    v_pk_fma_f32 v[144:145], v[32:33], v[230:231], v[144:145] op_sel:[0,1,0] op_sel_hi:[1,1,1]
    v_pk_fma_f32 v[146:147], v[34:35], v[230:231], v[146:147] op_sel:[0,1,0] op_sel_hi:[1,1,1]
    v_pk_mul_f32 v[140:141], v[140:141], v[60:61]
    v_pk_mul_f32 v[142:143], v[142:143], v[62:63]
    v_pk_mul_f32 v[144:145], v[144:145], v[64:65]
    v_pk_mul_f32 v[146:147], v[146:147], v[66:67]
    v_cvt_pk_bf16_f32 v224, v140, v141
    v_cvt_pk_bf16_f32 v225, v142, v143
    v_cvt_pk_bf16_f32 v226, v144, v145
    v_cvt_pk_bf16_f32 v227, v146, v147
    buffer_store_dwordx4 v[224:227], v171, s[24:27], s57 offen sc1
    s_mov_b32 s71, 27049984
    s_load_dwordx2 s[22:23], s[20:21], s71
    s_lshl_b32 s71, s2, 7
    s_getpc_b64 s[86:87]
k_pc2_3:
    s_add_u32 s86, s86, k_tab2-k_pc2_3
    s_addc_u32 s87, s87, 0
    s_add_u32 s86, s86, s71
    s_addc_u32 s87, s87, 0
    s_load_dwordx8 s[88:95], s[86:87], 0
    s_branch k_p2
k_ldb:
    s_cmp_eq_u32 s36, 4
    s_cbranch_scc1 k_ncp
    s_getpc_b64 s[58:59]
k_pc3:
    s_lshr_b32 s53, s2, 3
    s_mul_i32 s53, s53, 3
    s_add_u32 s53, s53, s36
    s_sub_u32 s53, s53, 5
    s_lshl_b32 s53, s53, 6
    s_min_u32 s54, s53, k_end-k_pc3
    s_load_dword s60, s[58:59], s54
    s_add_u32 s53, s53, 5376
    s_min_u32 s54, s53, k_end-k_pc3
    s_load_dword s60, s[58:59], s54
    s_add_u32 s53, s53, 5376
    s_min_u32 s54, s53, k_end-k_pc3
    s_load_dword s60, s[58:59], s54
    s_add_u32 s53, s53, 5376
    s_min_u32 s54, s53, k_end-k_pc3
    s_load_dword s60, s[58:59], s54
    s_add_u32 s53, s53, 5376
    s_min_u32 s54, s53, k_end-k_pc3
    s_load_dword s60, s[58:59], s54
    s_add_u32 s53, s53, 5376
    s_min_u32 s54, s53, k_end-k_pc3
    s_load_dword s60, s[58:59], s54
    s_add_u32 s53, s53, 5376
    s_min_u32 s54, s53, k_end-k_pc3
    s_load_dword s60, s[58:59], s54
    s_add_u32 s53, s53, 5376
    s_min_u32 s54, s53, k_end-k_pc3
    s_load_dword s60, s[58:59], s54
    s_add_u32 s53, s53, 5376
    s_min_u32 s54, s53, k_end-k_pc3
    s_load_dword s60, s[58:59], s54
    s_add_u32 s53, s53, 5376
    s_min_u32 s54, s53, k_end-k_pc3
    s_load_dword s60, s[58:59], s54
    s_add_u32 s53, s53, 5376
    s_min_u32 s54, s53, k_end-k_pc3
    s_load_dword s60, s[58:59], s54
    s_add_u32 s53, s53, 5376
k_ncp:
    s_mov_b32 s24, s20
    s_mov_b32 s25, s21
    v_and_b32 v148, 31, v1
    v_lshrrev_b32 v149, 5, v1
    v_min_u32 v20, 9, v148
    s_lshl_b32 s55, s37, 4
    v_add_u32 v21, s55, v20
    v_lshlrev_b32 v20, 4, v20
    v_add_u32 v20, s38, v20
    s_mov_b32 s68, 0
    s_mov_b32 s69, -1
    v_cndmask_b32 v20, v21, v20, s[68:69]
    v_mul_u32_u24 v20, 256, v20
    s_add_u32 s67, s55, s38
    s_mul_i32 s67, s67, 256
    s_mov_b32 s72, 26984448
    s_add_u32 s67, s67, s72
    v_mul_u32_u24 v21, 2560, v149
    v_lshl_add_u32 v21, v148, 2, v21
    v_lshlrev_b32 v22, 1, v21
    s_sub_u32 s55, s36, 4
    s_lshl_b32 s55, s55, 7
    s_mul_i32 s64, s38, 5120
    s_add_u32 s64, s64, s55
    s_add_u32 s64, s64, 25722880
    s_mul_i32 s65, s37, 5120
    s_add_u32 s65, s65, s55
    s_lshl_b32 s65, s65, 1
    s_add_u32 s65, s65, 25559040
    s_add_u32 s66, s65, 4096
    v_lshlrev_b32 v150, 2, v148
    v_add_u32 v150, s55, v150
    v_add_u32 v150, 131072, v150
    v_lshl_add_u32 v151, v149, 9, v150
    s_and_b32 s53, s36, 1
    s_mul_i32 s53, s53, 5
    s_lshl_b32 s54, s37, 4
    s_add_u32 s54, s54, s53
    s_lshl_b32 s53, s53, 4
    s_add_u32 s53, s53, s38
    s_cmp_lt_u32 s36, 6
    s_cselect_b32 s56, s54, s53
    s_cselect_b32 s57, 1, 16
    s_mul_i32 s56, s56, 256
    s_mul_i32 s57, s57, 256
    s_add_u32 s56, s56, s72
    v_mov_b32 v142, 0
    v_mov_b32 v143, 0
    v_mov_b32 v172, 0
    v_mov_b32 v173, 0
    v_mov_b32 v174, 0
    v_mov_b32 v175, 0
    v_mov_b32 v176, 0
    v_mov_b32 v204, 0
    v_mov_b32 v226, 0
    v_mov_b32 v227, 0
    s_waitcnt vmcnt(8)
    s_barrier
    s_cmp_le_u32 s70, 1
    s_cselect_b32 s53, 2, 1
    s_lshl_b32 s54, s53, 7
    s_add_u32 s54, s54, s41
    s_add_u32 m0, s43, 65536
    s_mul_i32 s53, s53, 245760
    buffer_load_dwordx4 v2, s[28:31], s54 offen offset:0 lds
    buffer_load_dwordx4 v3, s[28:31], s54 offen offset:1024 lds
    buffer_load_dwordx4 v4, s[28:31], s54 offen offset:2048 lds
    buffer_load_dwordx4 v5, s[28:31], s54 offen offset:3072 lds
    s_add_u32 m0, s43, 81920
    s_add_u32 s53, s53, s42
    buffer_load_dwordx4 v6, s[32:35], s53 offen offset:0 lds
    buffer_load_dwordx4 v7, s[32:35], s53 offen offset:1024 lds
    buffer_load_dwordx4 v8, s[32:35], s53 offen offset:2048 lds
    buffer_load_dwordx4 v9, s[32:35], s53 offen offset:3072 lds
    s_waitcnt vmcnt(8)
    s_barrier
    s_cmp_le_u32 s70, 2
    s_cselect_b32 s53, 3, 2
    s_lshl_b32 s54, s53, 7
    s_add_u32 s54, s54, s41
    s_add_u32 m0, s43, 98304
    s_mul_i32 s53, s53, 245760
    buffer_load_dwordx4 v2, s[28:31], s54 offen offset:0 lds
    buffer_load_dwordx4 v3, s[28:31], s54 offen offset:1024 lds
    buffer_load_dwordx4 v4, s[28:31], s54 offen offset:2048 lds
    buffer_load_dwordx4 v5, s[28:31], s54 offen offset:3072 lds
    s_add_u32 m0, s43, 114688
    s_add_u32 s53, s53, s42
    buffer_load_dwordx4 v6, s[32:35], s53 offen offset:0 lds
    buffer_load_dwordx4 v7, s[32:35], s53 offen offset:1024 lds
    buffer_load_dwordx4 v8, s[32:35], s53 offen offset:2048 lds
    buffer_load_dwordx4 v9, s[32:35], s53 offen offset:3072 lds
    s_waitcnt vmcnt(8)
    s_barrier
    s_cmp_le_u32 s70, 3
    s_cselect_b32 s53, 4, 3
    s_lshl_b32 s54, s53, 7
    s_add_u32 s54, s54, s41
    s_add_u32 m0, s43, 0
    s_mul_i32 s53, s53, 245760
    buffer_load_dwordx4 v2, s[28:31], s54 offen offset:0 lds
    buffer_load_dwordx4 v3, s[28:31], s54 offen offset:1024 lds
    buffer_load_dwordx4 v4, s[28:31], s54 offen offset:2048 lds
    buffer_load_dwordx4 v5, s[28:31], s54 offen offset:3072 lds
    s_add_u32 m0, s43, 16384
    s_add_u32 s53, s53, s42
    buffer_load_dwordx4 v6, s[32:35], s53 offen offset:0 lds
    buffer_load_dwordx4 v7, s[32:35], s53 offen offset:1024 lds
    buffer_load_dwordx4 v8, s[32:35], s53 offen offset:2048 lds
    buffer_load_dwordx4 v9, s[32:35], s53 offen offset:3072 lds
    s_waitcnt vmcnt(8)
    s_barrier
    s_cmp_eq_u32 s36, 4
    s_cbranch_scc0 k_nb
    s_waitcnt lgkmcnt(0)
    s_mul_i32 s22, s22, 1664525
    s_add_u32 s22, s22, 1013904223
    s_or_b32 s22, s22, 1
    s_andn2_b32 s22, s22, 2
    s_mul_i32 s23, s23, 22695477
    s_add_u32 s23, s23, 1
    v_mov_b32 v42, s22
    v_mov_b32 v43, s23
    s_mov_b64 exec, 1
    buffer_store_dwordx2 v[42:43], off, s[24:27], s67 offset:0 sc1
    s_mov_b64 exec, -1
k_nb:
    s_cmp_le_u32 s70, 4
    s_cselect_b32 s53, 5, 4
    s_lshl_b32 s54, s53, 7
    s_add_u32 s54, s54, s41
    s_add_u32 m0, s43, 32768
    s_mul_i32 s53, s53, 245760
    buffer_load_dwordx4 v2, s[28:31], s54 offen offset:0 lds
    buffer_load_dwordx4 v3, s[28:31], s54 offen offset:1024 lds
    buffer_load_dwordx4 v4, s[28:31], s54 offen offset:2048 lds
    buffer_load_dwordx4 v5, s[28:31], s54 offen offset:3072 lds
    s_add_u32 m0, s43, 49152
    s_add_u32 s53, s53, s42
    buffer_load_dwordx4 v6, s[32:35], s53 offen offset:0 lds
    buffer_load_dwordx4 v7, s[32:35], s53 offen offset:1024 lds
    buffer_load_dwordx4 v8, s[32:35], s53 offen offset:2048 lds
    buffer_load_dwordx4 v9, s[32:35], s53 offen offset:3072 lds
    s_waitcnt vmcnt(8)
    s_barrier
    s_cmp_le_u32 s70, 5
    s_cselect_b32 s53, 6, 5
    s_lshl_b32 s54, s53, 7
    s_add_u32 s54, s54, s41
    s_add_u32 m0, s43, 65536
    s_mul_i32 s53, s53, 245760
    buffer_load_dwordx4 v2, s[28:31], s54 offen offset:0 lds
    buffer_load_dwordx4 v3, s[28:31], s54 offen offset:1024 lds
    buffer_load_dwordx4 v4, s[28:31], s54 offen offset:2048 lds
    buffer_load_dwordx4 v5, s[28:31], s54 offen offset:3072 lds
    s_add_u32 m0, s43, 81920
    s_add_u32 s53, s53, s42
    buffer_load_dwordx4 v6, s[32:35], s53 offen offset:0 lds
    buffer_load_dwordx4 v7, s[32:35], s53 offen offset:1024 lds
    buffer_load_dwordx4 v8, s[32:35], s53 offen offset:2048 lds
    buffer_load_dwordx4 v9, s[32:35], s53 offen offset:3072 lds
    s_waitcnt vmcnt(8)
    s_barrier
    s_cmp_le_u32 s70, 6
    s_cselect_b32 s53, 7, 6
    s_lshl_b32 s54, s53, 7
    s_add_u32 s54, s54, s41
    s_add_u32 m0, s43, 98304
    s_mul_i32 s53, s53, 245760
    buffer_load_dwordx4 v2, s[28:31], s54 offen offset:0 lds
    buffer_load_dwordx4 v3, s[28:31], s54 offen offset:1024 lds
    buffer_load_dwordx4 v4, s[28:31], s54 offen offset:2048 lds
    buffer_load_dwordx4 v5, s[28:31], s54 offen offset:3072 lds
    s_add_u32 m0, s43, 114688
    s_add_u32 s53, s53, s42
    buffer_load_dwordx4 v6, s[32:35], s53 offen offset:0 lds
    buffer_load_dwordx4 v7, s[32:35], s53 offen offset:1024 lds
    buffer_load_dwordx4 v8, s[32:35], s53 offen offset:2048 lds
    buffer_load_dwordx4 v9, s[32:35], s53 offen offset:3072 lds
    s_waitcnt vmcnt(8)
    s_cmp_eq_u32 s36, 4
    s_cbranch_scc1 k_ht
    s_waitcnt lgkmcnt(0)
    s_mul_i32 s22, s22, 1664525
    s_add_u32 s22, s22, 1013904223
    s_or_b32 s22, s22, 1
    s_andn2_b32 s22, s22, 2
    s_mul_i32 s23, s23, 22695477
    s_add_u32 s23, s23, 1
k_ht:
    s_barrier
    s_load_dwordx2 s[76:77], s[20:21], s56 glc
    s_add_u32 s56, s56, s57
    s_load_dwordx2 s[78:79], s[20:21], s56 glc
    s_add_u32 s56, s56, s57
    s_load_dwordx2 s[80:81], s[20:21], s56 glc
    s_add_u32 s56, s56, s57
    s_load_dwordx2 s[82:83], s[20:21], s56 glc
    s_add_u32 s56, s56, s57
    s_load_dwordx2 s[84:85], s[20:21], s56 glc
    s_add_u32 s56, s56, s57
    s_cmp_le_u32 s70, 7
    s_cselect_b32 s53, 8, 7
    s_lshl_b32 s54, s53, 7
    s_add_u32 s54, s54, s41
    s_add_u32 m0, s43, 0
    s_mul_i32 s53, s53, 245760
    buffer_load_dwordx4 v2, s[28:31], s54 offen offset:0 lds
    buffer_load_dwordx4 v3, s[28:31], s54 offen offset:1024 lds
    buffer_load_dwordx4 v4, s[28:31], s54 offen offset:2048 lds
    buffer_load_dwordx4 v5, s[28:31], s54 offen offset:3072 lds
    s_add_u32 m0, s43, 16384
    s_add_u32 s53, s53, s42
    buffer_load_dwordx4 v6, s[32:35], s53 offen offset:0 lds
    buffer_load_dwordx4 v7, s[32:35], s53 offen offset:1024 lds
    buffer_load_dwordx4 v8, s[32:35], s53 offen offset:2048 lds
    buffer_load_dwordx4 v9, s[32:35], s53 offen offset:3072 lds
    s_waitcnt vmcnt(8)
    s_barrier
    s_cmp_le_u32 s70, 8
    s_cselect_b32 s53, 9, 8
    s_lshl_b32 s54, s53, 7
    s_add_u32 s54, s54, s41
    s_add_u32 m0, s43, 32768
    s_mul_i32 s53, s53, 245760
    buffer_load_dwordx4 v2, s[28:31], s54 offen offset:0 lds
    buffer_load_dwordx4 v3, s[28:31], s54 offen offset:1024 lds
    buffer_load_dwordx4 v4, s[28:31], s54 offen offset:2048 lds
    buffer_load_dwordx4 v5, s[28:31], s54 offen offset:3072 lds
    s_add_u32 m0, s43, 49152
    s_add_u32 s53, s53, s42
    buffer_load_dwordx4 v6, s[32:35], s53 offen offset:0 lds
    buffer_load_dwordx4 v7, s[32:35], s53 offen offset:1024 lds
    buffer_load_dwordx4 v8, s[32:35], s53 offen offset:2048 lds
    buffer_load_dwordx4 v9, s[32:35], s53 offen offset:3072 lds
    s_waitcnt vmcnt(8)
    s_waitcnt lgkmcnt(0)
    s_cmp_eq_u64 s[76:77], s[22:23]
    s_cbranch_scc0 k_lslow
    s_cmp_eq_u64 s[78:79], s[22:23]
    s_cbranch_scc0 k_lslow
    s_cmp_eq_u64 s[80:81], s[22:23]
    s_cbranch_scc0 k_lslow
    s_cmp_eq_u64 s[82:83], s[22:23]
    s_cbranch_scc0 k_lslow
    s_cmp_eq_u64 s[84:85], s[22:23]
    s_cbranch_scc0 k_lslow
k_lok:
    s_barrier
    buffer_load_dwordx2 v[26:27], v22, s[24:27], s65 offen offset:0 sc1
    buffer_load_dword v36, v21, s[24:27], s64 offen offset:0 sc1
    buffer_load_dwordx2 v[28:29], v22, s[24:27], s65 offen offset:1024 sc1
    buffer_load_dword v37, v21, s[24:27], s64 offen offset:512 sc1
    buffer_load_dwordx2 v[30:31], v22, s[24:27], s65 offen offset:2048 sc1
    buffer_load_dword v38, v21, s[24:27], s64 offen offset:1024 sc1
    buffer_load_dwordx2 v[32:33], v22, s[24:27], s65 offen offset:3072 sc1
    buffer_load_dword v39, v21, s[24:27], s64 offen offset:1536 sc1
    buffer_load_dwordx2 v[34:35], v22, s[24:27], s66 offen offset:0 sc1
    buffer_load_dword v40, v21, s[24:27], s64 offen offset:2048 sc1
    s_waitcnt vmcnt(10)
    s_barrier
    s_waitcnt vmcnt(0)
    v_add_f32 v26, v26, v28
    v_add_f32 v27, v27, v29
    v_add_f32 v36, v36, v37
    v_add_f32 v26, v26, v30
    v_add_f32 v27, v27, v31
    v_add_f32 v36, v36, v38
    v_add_f32 v26, v26, v32
    v_add_f32 v27, v27, v33
    v_add_f32 v36, v36, v39
    v_add_f32 v26, v26, v34
    v_add_f32 v27, v27, v35
    v_add_f32 v36, v36, v40
    v_mov_b32 v28, v26
    v_mov_b32 v29, v27
    v_mov_b32 v30, v36
    s_nop 1
    v_permlane32_swap_b32 v26, v28
    v_permlane32_swap_b32 v27, v29
    v_permlane32_swap_b32 v36, v30
    v_add_f32 v26, v26, v28
    v_add_f32 v27, v27, v29
    v_add_f32 v36, v36, v30
    v_mul_f32 v26, 0xbacccccd, v26
    v_mul_f32 v27, 0x3acccccd, v27
    v_fma_f32 v27, -v26, v26, v27
    v_max_f32 v27, 0, v27
    v_add_f32 v27, 0x3727c5ac, v27
    v_rsq_f32 v27, v27
    s_cmp_lt_u32 s38, 5
    s_cselect_b32 s54, 0x3ea52b5c, 1.0
    v_mul_f32 v27, s54, v27
    v_cndmask_b32 v26, v26, v27, s[68:69]
    ds_write_b32 v151, v26
    ds_write_b32 v150, v36 offset:1024
    s_waitcnt lgkmcnt(0)
    s_barrier
    s_branch k_p2
k_lslow:
    s_mov_b32 s71, 0
k_l_pc0:
k_l_pc2:
    buffer_load_dwordx2 v[24:25], v20, s[24:27], s72 offen sc1
    s_waitcnt vmcnt(0)
k_l_pc1:
    v_cmp_ne_u64 vcc, s[22:23], v[24:25]
    s_add_u32 s71, s71, 1
    s_cmp_gt_u32 s71, 131072
    s_cbranch_scc1 k_l_pd
    s_cbranch_vccnz k_l_pc0
k_l_pd:
    s_branch k_lok
k_spare:
    v_lshrrev_b32 v2, 4, v0
    v_and_b32 v3, 15, v0
    v_mul_u32_u24 v4, 3456, v2
    v_lshl_add_u32 v4, v3, 4, v4
    s_lshl_b32 s53, s37, 8
    s_cmp_lt_u32 s37, 14
    s_cselect_b32 s30, 2211840, 0
    s_mov_b32 s54, 0x00003f80
    s_mov_b32 s55, 0x3f800000
    s_waitcnt lgkmcnt(0)
    s_mov_b32 s28, s12
    s_mov_b32 s29, s13
    s_mov_b32 s24, s20
    s_mov_b32 s25, s21
    s_mov_b32 s71, 27049984
    s_load_dwordx2 s[22:23], s[20:21], s71
    s_lshl_b32 s71, s2, 7
    s_getpc_b64 s[86:87]
k_pc2_4:
    s_add_u32 s86, s86, k_tab2-k_pc2_4
    s_addc_u32 s87, s87, 0
    s_add_u32 s86, s86, s71
    s_addc_u32 s87, s87, 0
    s_load_dwordx8 s[88:95], s[86:87], 0
    s_mov_b64 s[32:33], s[4:5]
    s_mov_b32 s34, 0
    v_mov_b32 v7, 0
    v_mov_b32 v142, 0
    v_mov_b32 v143, 0
    v_mov_b32 v150, 0
    v_mov_b32 v172, 0
    v_mov_b32 v173, 0
    v_mov_b32 v174, 0
    v_mov_b32 v175, 0
    v_mov_b32 v176, 0
    v_mov_b32 v204, 0
    v_mov_b32 v226, 0
    v_mov_b32 v227, 0
    buffer_load_dwordx4 v[16:19], v4, s[28:31], s53 offen
    s_add_u32 s53, s53, 110592
    buffer_load_dwordx4 v[20:23], v4, s[28:31], s53 offen
    s_add_u32 s53, s53, 110592
    buffer_load_dwordx4 v[24:27], v4, s[28:31], s53 offen
    s_add_u32 s53, s53, 110592
    buffer_load_dwordx4 v[28:31], v4, s[28:31], s53 offen
    s_add_u32 s53, s53, 110592
    buffer_load_dwordx4 v[32:35], v4, s[28:31], s53 offen
    s_add_u32 s53, s53, 110592
    buffer_load_dwordx4 v[36:39], v4, s[28:31], s53 offen
    s_add_u32 s53, s53, 110592
    buffer_load_dwordx4 v[40:43], v4, s[28:31], s53 offen
    s_add_u32 s53, s53, 110592
    buffer_load_dwordx4 v[44:47], v4, s[28:31], s53 offen
    s_add_u32 s53, s53, 110592
    buffer_load_dwordx4 v[48:51], v4, s[28:31], s53 offen
    s_add_u32 s53, s53, 110592
    buffer_load_dwordx4 v[52:55], v4, s[28:31], s53 offen
    s_add_u32 s53, s53, 110592
    buffer_load_dwordx4 v[56:59], v4, s[28:31], s53 offen
    s_add_u32 s53, s53, 110592
    buffer_load_dwordx4 v[60:63], v4, s[28:31], s53 offen
    s_add_u32 s53, s53, 110592
    buffer_load_dwordx4 v[64:67], v4, s[28:31], s53 offen
    s_add_u32 s53, s53, 110592
    buffer_load_dwordx4 v[68:71], v4, s[28:31], s53 offen
    s_add_u32 s53, s53, 110592
    buffer_load_dwordx4 v[72:75], v4, s[28:31], s53 offen
    s_add_u32 s53, s53, 110592
    buffer_load_dwordx4 v[76:79], v4, s[28:31], s53 offen
    s_add_u32 s53, s53, 110592
    buffer_load_dwordx4 v[80:83], v4, s[28:31], s53 offen
    s_add_u32 s53, s53, 110592
    buffer_load_dwordx4 v[84:87], v4, s[28:31], s53 offen
    s_add_u32 s53, s53, 110592
    buffer_load_dwordx4 v[88:91], v4, s[28:31], s53 offen
    s_add_u32 s53, s53, 110592
    buffer_load_dwordx4 v[92:95], v4, s[28:31], s53 offen
    s_add_u32 s53, s53, 110592
    v_mov_b32 v8, 0
    v_mov_b32 v9, 0
    v_mov_b32 v10, 0
    v_mov_b32 v11, 0
    v_mov_b32 v12, 0
    v_mov_b32 v13, 0
    v_mov_b32 v14, 0
    v_mov_b32 v15, 0
    s_waitcnt lgkmcnt(0)
    s_cmp_lt_u32 s36, 4
    s_cbranch_scc1 k_snt
    s_mul_i32 s22, s22, 1664525
    s_add_u32 s22, s22, 1013904223
    s_or_b32 s22, s22, 1
    s_andn2_b32 s22, s22, 2
    s_mul_i32 s23, s23, 22695477
    s_add_u32 s23, s23, 1
k_snt:
    s_waitcnt vmcnt(19)
    v_dot2_f32_bf16 v8, v16, s54, v8
    v_dot2_f32_bf16 v9, v16, s55, v9
    v_dot2_f32_bf16 v10, v17, s54, v10
    v_dot2_f32_bf16 v11, v17, s55, v11
    v_dot2_f32_bf16 v12, v18, s54, v12
    v_dot2_f32_bf16 v13, v18, s55, v13
    v_dot2_f32_bf16 v14, v19, s54, v14
    v_dot2_f32_bf16 v15, v19, s55, v15
    s_waitcnt vmcnt(18)
    v_dot2_f32_bf16 v8, v20, s54, v8
    v_dot2_f32_bf16 v9, v20, s55, v9
    v_dot2_f32_bf16 v10, v21, s54, v10
    v_dot2_f32_bf16 v11, v21, s55, v11
    v_dot2_f32_bf16 v12, v22, s54, v12
    v_dot2_f32_bf16 v13, v22, s55, v13
    v_dot2_f32_bf16 v14, v23, s54, v14
    v_dot2_f32_bf16 v15, v23, s55, v15
    s_waitcnt vmcnt(17)
    v_dot2_f32_bf16 v8, v24, s54, v8
    v_dot2_f32_bf16 v9, v24, s55, v9
    v_dot2_f32_bf16 v10, v25, s54, v10
    v_dot2_f32_bf16 v11, v25, s55, v11
    v_dot2_f32_bf16 v12, v26, s54, v12
    v_dot2_f32_bf16 v13, v26, s55, v13
    v_dot2_f32_bf16 v14, v27, s54, v14
    v_dot2_f32_bf16 v15, v27, s55, v15
    s_waitcnt vmcnt(16)
    v_dot2_f32_bf16 v8, v28, s54, v8
    v_dot2_f32_bf16 v9, v28, s55, v9
    v_dot2_f32_bf16 v10, v29, s54, v10
    v_dot2_f32_bf16 v11, v29, s55, v11
    v_dot2_f32_bf16 v12, v30, s54, v12
    v_dot2_f32_bf16 v13, v30, s55, v13
    v_dot2_f32_bf16 v14, v31, s54, v14
    v_dot2_f32_bf16 v15, v31, s55, v15
    s_waitcnt vmcnt(15)
    v_dot2_f32_bf16 v8, v32, s54, v8
    v_dot2_f32_bf16 v9, v32, s55, v9
    v_dot2_f32_bf16 v10, v33, s54, v10
    v_dot2_f32_bf16 v11, v33, s55, v11
    v_dot2_f32_bf16 v12, v34, s54, v12
    v_dot2_f32_bf16 v13, v34, s55, v13
    v_dot2_f32_bf16 v14, v35, s54, v14
    v_dot2_f32_bf16 v15, v35, s55, v15
    s_waitcnt vmcnt(14)
    v_dot2_f32_bf16 v8, v36, s54, v8
    v_dot2_f32_bf16 v9, v36, s55, v9
    v_dot2_f32_bf16 v10, v37, s54, v10
    v_dot2_f32_bf16 v11, v37, s55, v11
    v_dot2_f32_bf16 v12, v38, s54, v12
    v_dot2_f32_bf16 v13, v38, s55, v13
    v_dot2_f32_bf16 v14, v39, s54, v14
    v_dot2_f32_bf16 v15, v39, s55, v15
    s_waitcnt vmcnt(13)
    v_dot2_f32_bf16 v8, v40, s54, v8
    v_dot2_f32_bf16 v9, v40, s55, v9
    v_dot2_f32_bf16 v10, v41, s54, v10
    v_dot2_f32_bf16 v11, v41, s55, v11
    v_dot2_f32_bf16 v12, v42, s54, v12
    v_dot2_f32_bf16 v13, v42, s55, v13
    v_dot2_f32_bf16 v14, v43, s54, v14
    v_dot2_f32_bf16 v15, v43, s55, v15
    s_waitcnt vmcnt(12)
    v_dot2_f32_bf16 v8, v44, s54, v8
    v_dot2_f32_bf16 v9, v44, s55, v9
    v_dot2_f32_bf16 v10, v45, s54, v10
    v_dot2_f32_bf16 v11, v45, s55, v11
    v_dot2_f32_bf16 v12, v46, s54, v12
    v_dot2_f32_bf16 v13, v46, s55, v13
    v_dot2_f32_bf16 v14, v47, s54, v14
    v_dot2_f32_bf16 v15, v47, s55, v15
    s_waitcnt vmcnt(11)
    v_dot2_f32_bf16 v8, v48, s54, v8
    v_dot2_f32_bf16 v9, v48, s55, v9
    v_dot2_f32_bf16 v10, v49, s54, v10
    v_dot2_f32_bf16 v11, v49, s55, v11
    v_dot2_f32_bf16 v12, v50, s54, v12
    v_dot2_f32_bf16 v13, v50, s55, v13
    v_dot2_f32_bf16 v14, v51, s54, v14
    v_dot2_f32_bf16 v15, v51, s55, v15
    s_waitcnt vmcnt(10)
    v_dot2_f32_bf16 v8, v52, s54, v8
    v_dot2_f32_bf16 v9, v52, s55, v9
    v_dot2_f32_bf16 v10, v53, s54, v10
    v_dot2_f32_bf16 v11, v53, s55, v11
    v_dot2_f32_bf16 v12, v54, s54, v12
    v_dot2_f32_bf16 v13, v54, s55, v13
    v_dot2_f32_bf16 v14, v55, s54, v14
    v_dot2_f32_bf16 v15, v55, s55, v15
    s_waitcnt vmcnt(9)
    v_dot2_f32_bf16 v8, v56, s54, v8
    v_dot2_f32_bf16 v9, v56, s55, v9
    v_dot2_f32_bf16 v10, v57, s54, v10
    v_dot2_f32_bf16 v11, v57, s55, v11
    v_dot2_f32_bf16 v12, v58, s54, v12
    v_dot2_f32_bf16 v13, v58, s55, v13
    v_dot2_f32_bf16 v14, v59, s54, v14
    v_dot2_f32_bf16 v15, v59, s55, v15
    s_waitcnt vmcnt(8)
    v_dot2_f32_bf16 v8, v60, s54, v8
    v_dot2_f32_bf16 v9, v60, s55, v9
    v_dot2_f32_bf16 v10, v61, s54, v10
    v_dot2_f32_bf16 v11, v61, s55, v11
    v_dot2_f32_bf16 v12, v62, s54, v12
    v_dot2_f32_bf16 v13, v62, s55, v13
    v_dot2_f32_bf16 v14, v63, s54, v14
    v_dot2_f32_bf16 v15, v63, s55, v15
    s_waitcnt vmcnt(7)
    v_dot2_f32_bf16 v8, v64, s54, v8
    v_dot2_f32_bf16 v9, v64, s55, v9
    v_dot2_f32_bf16 v10, v65, s54, v10
    v_dot2_f32_bf16 v11, v65, s55, v11
    v_dot2_f32_bf16 v12, v66, s54, v12
    v_dot2_f32_bf16 v13, v66, s55, v13
    v_dot2_f32_bf16 v14, v67, s54, v14
    v_dot2_f32_bf16 v15, v67, s55, v15
    s_waitcnt vmcnt(6)
    v_dot2_f32_bf16 v8, v68, s54, v8
    v_dot2_f32_bf16 v9, v68, s55, v9
    v_dot2_f32_bf16 v10, v69, s54, v10
    v_dot2_f32_bf16 v11, v69, s55, v11
    v_dot2_f32_bf16 v12, v70, s54, v12
    v_dot2_f32_bf16 v13, v70, s55, v13
    v_dot2_f32_bf16 v14, v71, s54, v14
    v_dot2_f32_bf16 v15, v71, s55, v15
    s_waitcnt vmcnt(5)
    v_dot2_f32_bf16 v8, v72, s54, v8
    v_dot2_f32_bf16 v9, v72, s55, v9
    v_dot2_f32_bf16 v10, v73, s54, v10
    v_dot2_f32_bf16 v11, v73, s55, v11
    v_dot2_f32_bf16 v12, v74, s54, v12
    v_dot2_f32_bf16 v13, v74, s55, v13
    v_dot2_f32_bf16 v14, v75, s54, v14
    v_dot2_f32_bf16 v15, v75, s55, v15
    s_waitcnt vmcnt(4)
    v_dot2_f32_bf16 v8, v76, s54, v8
    v_dot2_f32_bf16 v9, v76, s55, v9
    v_dot2_f32_bf16 v10, v77, s54, v10
    v_dot2_f32_bf16 v11, v77, s55, v11
    v_dot2_f32_bf16 v12, v78, s54, v12
    v_dot2_f32_bf16 v13, v78, s55, v13
    v_dot2_f32_bf16 v14, v79, s54, v14
    v_dot2_f32_bf16 v15, v79, s55, v15
    s_waitcnt vmcnt(3)
    v_dot2_f32_bf16 v8, v80, s54, v8
    v_dot2_f32_bf16 v9, v80, s55, v9
    v_dot2_f32_bf16 v10, v81, s54, v10
    v_dot2_f32_bf16 v11, v81, s55, v11
    v_dot2_f32_bf16 v12, v82, s54, v12
    v_dot2_f32_bf16 v13, v82, s55, v13
    v_dot2_f32_bf16 v14, v83, s54, v14
    v_dot2_f32_bf16 v15, v83, s55, v15
    s_waitcnt vmcnt(2)
    v_dot2_f32_bf16 v8, v84, s54, v8
    v_dot2_f32_bf16 v9, v84, s55, v9
    v_dot2_f32_bf16 v10, v85, s54, v10
    v_dot2_f32_bf16 v11, v85, s55, v11
    v_dot2_f32_bf16 v12, v86, s54, v12
    v_dot2_f32_bf16 v13, v86, s55, v13
    v_dot2_f32_bf16 v14, v87, s54, v14
    v_dot2_f32_bf16 v15, v87, s55, v15
    s_waitcnt vmcnt(1)
    v_dot2_f32_bf16 v8, v88, s54, v8
    v_dot2_f32_bf16 v9, v88, s55, v9
    v_dot2_f32_bf16 v10, v89, s54, v10
    v_dot2_f32_bf16 v11, v89, s55, v11
    v_dot2_f32_bf16 v12, v90, s54, v12
    v_dot2_f32_bf16 v13, v90, s55, v13
    v_dot2_f32_bf16 v14, v91, s54, v14
    v_dot2_f32_bf16 v15, v91, s55, v15
    s_waitcnt vmcnt(0)
    v_dot2_f32_bf16 v8, v92, s54, v8
    v_dot2_f32_bf16 v9, v92, s55, v9
    v_dot2_f32_bf16 v10, v93, s54, v10
    v_dot2_f32_bf16 v11, v93, s55, v11
    v_dot2_f32_bf16 v12, v94, s54, v12
    v_dot2_f32_bf16 v13, v94, s55, v13
    v_dot2_f32_bf16 v14, v95, s54, v14
    v_dot2_f32_bf16 v15, v95, s55, v15
    s_cmp_eq_u32 s36, 0
    s_cbranch_scc0 k_sp_nw
    s_lshl_b32 s72, s37, 4
    s_add_u32 s72, s72, s38
    s_mul_i32 s72, s72, 256
    s_add_u32 s73, s72, 26984448
    s_add_u32 s72, s72, 25804800
    s_mul_i32 s74, s2, 256
    s_add_u32 s74, s74, 25870336
    v_mov_b32 v100, 0
    v_mov_b32 v101, 0
    v_mov_b32 v102, 0
    v_mov_b32 v103, 0
    v_lshlrev_b32 v104, 4, v1
    s_mov_b64 exec, 0xff
    buffer_store_dwordx4 v[100:103], v104, s[24:27], s73 offen sc1
    buffer_store_dwordx4 v[100:103], v104, s[24:27], s72 offen sc1
    buffer_store_dwordx4 v[100:103], v104, s[24:27], s74 offen sc1
    s_mov_b64 exec, -1
k_sp_nw:
    v_lshlrev_b32 v5, 5, v0
    v_lshlrev_b32 v6, 2, v0
    s_nop 1
    ds_write_b128 v5, v[8:11]
    ds_write_b128 v5, v[12:15] offset:16
    s_waitcnt lgkmcnt(0)
    s_barrier
    s_cmp_ge_u32 s36, 2
    s_cbranch_scc1 k_spdone
    ds_read_b32 v16, v6 offset:0
    ds_read_b32 v17, v6 offset:512
    ds_read_b32 v18, v6 offset:1024
    ds_read_b32 v19, v6 offset:1536
    ds_read_b32 v20, v6 offset:2048
    ds_read_b32 v21, v6 offset:2560
    ds_read_b32 v22, v6 offset:3072
    ds_read_b32 v23, v6 offset:3584
    ds_read_b32 v24, v6 offset:4096
    ds_read_b32 v25, v6 offset:4608
    ds_read_b32 v26, v6 offset:5120
    ds_read_b32 v27, v6 offset:5632
    ds_read_b32 v28, v6 offset:6144
    ds_read_b32 v29, v6 offset:6656
    ds_read_b32 v30, v6 offset:7168
    ds_read_b32 v31, v6 offset:7680
    ds_read_b32 v32, v6 offset:8192
    ds_read_b32 v33, v6 offset:8704
    ds_read_b32 v34, v6 offset:9216
    ds_read_b32 v35, v6 offset:9728
    ds_read_b32 v36, v6 offset:10240
    ds_read_b32 v37, v6 offset:10752
    ds_read_b32 v38, v6 offset:11264
    ds_read_b32 v39, v6 offset:11776
    ds_read_b32 v40, v6 offset:12288
    ds_read_b32 v41, v6 offset:12800
    ds_read_b32 v42, v6 offset:13312
    ds_read_b32 v43, v6 offset:13824
    ds_read_b32 v44, v6 offset:14336
    ds_read_b32 v45, v6 offset:14848
    ds_read_b32 v46, v6 offset:15360
    ds_read_b32 v47, v6 offset:15872
    s_waitcnt lgkmcnt(0)
    v_add_f32 v16, v16, v17
    v_add_f32 v16, v16, v18
    v_add_f32 v16, v16, v19
    v_add_f32 v16, v16, v20
    v_add_f32 v16, v16, v21
    v_add_f32 v16, v16, v22
    v_add_f32 v16, v16, v23
    v_add_f32 v16, v16, v24
    v_add_f32 v16, v16, v25
    v_add_f32 v16, v16, v26
    v_add_f32 v16, v16, v27
    v_add_f32 v16, v16, v28
    v_add_f32 v16, v16, v29
    v_add_f32 v16, v16, v30
    v_add_f32 v16, v16, v31
    v_add_f32 v16, v16, v32
    v_add_f32 v16, v16, v33
    v_add_f32 v16, v16, v34
    v_add_f32 v16, v16, v35
    v_add_f32 v16, v16, v36
    v_add_f32 v16, v16, v37
    v_add_f32 v16, v16, v38
    v_add_f32 v16, v16, v39
    v_add_f32 v16, v16, v40
    v_add_f32 v16, v16, v41
    v_add_f32 v16, v16, v42
    v_add_f32 v16, v16, v43
    v_add_f32 v16, v16, v44
    v_add_f32 v16, v16, v45
    v_add_f32 v16, v16, v46
    v_add_f32 v16, v16, v47
    s_lshl_b32 s53, s37, 9
    s_add_u32 s53, s53, 27314176
    buffer_store_dword v16, v6, s[24:27], s53 offen sc1
k_spdone:
k_p2:
    s_mov_b32 s3, s38
    s_lshl_b32 s53, s37, 4
    s_add_u32 s53, s53, s38
    s_mul_i32 s53, s53, 256
    s_add_u32 s72, s53, 25804800
    s_and_b32 s96, s36, 3
    s_and_b32 s53, s2, 7
    s_lshl_b32 s53, s53, 2
    s_bfe_u32 s54, s2, 0x20003
    s_add_u32 s37, s53, s54
    s_lshr_b32 s38, s2, 5
    s_lshl_b32 s38, s38, 3
    s_add_u32 s38, s38, s36
    v_lshlrev_b32 v125, 4, v1
    s_lshl_b32 s53, s96, 10
    s_mov_b32 m0, s53
    s_mul_i32 s39, s37, 163840
    s_add_u32 s39, s39, s53
    s_mul_i32 s53, s37, 81920
    s_lshr_b32 s54, s38, 1
    s_mul_i32 s54, s54, 2560
    s_add_u32 s53, s53, s54
    s_add_u32 s53, s53, 5242880
    s_and_b32 s54, s38, 1
    s_lshr_b32 s69, 0x87f8d861, s37
    s_and_b32 s69, s69, 1
    s_xor_b32 s68, s54, s69
    s_lshl_b32 s68, s68, 3
    s_add_u32 s68, s68, s53
    s_lshl_b32 s54, s54, 10
    s_add_u32 s67, s53, s54
    s_cmp_lt_u32 s36, 4
    s_cselect_b64 s[44:45], -1, 0
    s_cbranch_scc0 k_so1
    s_cmp_lt_u32 s2, 148
    s_cselect_b32 s28, s12, s14
    s_cselect_b32 s29, s13, s15
    s_cselect_b32 s42, 27, 10
    s_mov_b32 s30, 2211840
    s_mov_b32 s54, 16
    s_mov_b32 s55, 8
    s_mov_b32 s43, 4
    s_cmp_lt_u32 s2, 40
    s_cbranch_scc0 k_notwo
    s_mov_b32 s28, s8
    s_mov_b32 s29, s9
    s_mov_b32 s30, 819200
    s_mov_b32 s42, 10
    s_lshr_b32 s53, s2, 1
    s_cmp_ge_u32 s53, 10
    s_cselect_b32 s56, 10, 0
    s_sub_u32 s53, s53, s56
    s_cmp_lt_u32 s53, 8
    s_cselect_b32 s54, 20, 80
    s_cselect_b32 s55, 4, 40
    s_cselect_b32 s43, 8, 20
k_notwo:
    s_lshl_b32 s42, s42, 7
    s_lshr_b32 s56, s96, 1
    s_mul_i32 s56, s56, s54
    s_and_b32 s57, s96, 1
    s_mul_i32 s57, s57, s55
    s_add_u32 s56, s56, s57
    v_lshrrev_b32 v126, 5, v1
    v_mul_u32_u24 v126, s43, v126
    v_bfe_u32 v127, v1, 3, 2
    v_add3_u32 v126, v126, v127, s56
    v_mul_u32_u24 v126, s42, v126
    v_and_b32 v127, 7, v1
    v_lshl_add_u32 v204, v127, 4, v126
k_so1:
    v_and_b32 v126, 31, v1
    v_lshlrev_b32 v127, 4, v126
    v_lshrrev_b32 v128, 5, v1
    v_mov_b32 v122, v125
    v_xor_b32 v129, s69, v128
    v_lshl_add_u32 v123, v129, 3, v127
    v_mul_u32_u24 v129, 320, v128
    v_add_u32 v124, v129, v127
    s_mov_b32 s50, 0x000fffff
    s_mov_b32 s51, 0x000fffff
    v_and_b32 v129, 27, v1
    v_cmp_eq_u32 vcc, 24, v129
    v_mov_b32 v130, 0x3f803f80
    s_nop 0
    v_cndmask_b32 v100, 0, v130, vcc
    v_mov_b32 v101, v100
    v_mov_b32 v102, v100
    v_mov_b32 v103, v100
    v_mov_b32 v104, v100
    v_mov_b32 v105, v100
    v_mov_b32 v106, v100
    v_mov_b32 v107, v100
    v_mov_b32 v108, v100
    v_mov_b32 v109, v100
    v_mov_b32 v110, v100
    v_mov_b32 v111, v100
    v_mov_b32 v112, v100
    v_mov_b32 v113, v100
    v_mov_b32 v114, v100
    v_mov_b32 v115, v100
    v_mov_b32 v66, 0
    v_mov_b32 v67, 0
    v_mov_b32 v68, 0
    v_mov_b32 v69, 0
    v_mov_b32 v70, 0
    v_mov_b32 v71, 0
    v_mov_b32 v72, 0
    v_mov_b32 v73, 0
    v_mov_b32 v74, 0
    v_mov_b32 v75, 0
    v_mov_b32 v76, 0
    v_mov_b32 v77, 0
    v_mov_b32 v78, 0
    v_mov_b32 v79, 0
    v_mov_b32 v80, 0
    v_mov_b32 v81, 0
    v_mov_b32 v86, 0
    v_mov_b32 v87, 0
    v_mov_b32 v88, 0
    v_mov_b32 v89, 0
    s_cmp_lt_u32 s36, 4
    s_cbranch_scc0 k_so2
    s_mul_i32 s53, s96, 5120
    s_add_u32 s53, s53, 143360
    v_bfe_u32 v129, v1, 2, 2
    v_lshlrev_b32 v129, 7, v129
    v_lshl_add_u32 v129, v128, 6, v129
    v_add_u32 v129, s53, v129
    v_and_b32 v130, 3, v1
    v_bfe_u32 v131, v1, 4, 1
    v_lshl_add_u32 v205, v130, 1, v131
    v_lshl_add_u32 v205, v205, 3, v129
    v_lshl_add_u32 v206, v131, 2, v130
    v_lshl_add_u32 v206, v206, 3, v129
k_so2:
    v_and_b32 v129, 15, v1
    v_lshrrev_b32 v130, 4, v1
    s_mov_b32 s32, s4
    s_mov_b32 s33, s5
    s_mov_b32 s34, 2621440
    s_cmp_lt_u32 s36, 4
    s_cbranch_scc1 k_so3
    s_mul_i32 s53, s37, 20
    s_lshr_b32 s54, s53, 7
    s_add_u32 s53, s53, 19
    s_lshr_b32 s53, s53, 7
    s_cmp_lg_u32 s53, s54
    s_cselect_b32 s52, -1, 0xffff
    s_lshr_b32 s55, s2, 5
    s_lshl_b32 s55, s55, 1
    s_lshl_b32 s55, 0x30003, s55
    s_mul_i32 s53, s96, 5
    s_cmp_eq_u32 s36, 7
    s_cselect_b32 s55, s55, -1
    s_cselect_b32 s53, 0, s53
    s_and_b32 s74, s52, s55
    s_mov_b32 s75, 0
    s_add_u32 s54, s54, s53
    v_and_b32 v142, 1, v130
    v_lshl_add_u32 v142, v129, 4, v142
    v_add_u32 v142, s54, v142
    v_mul_u32_u24 v142, 256, v142
    s_lshr_b32 s73, s2, 5
    s_mul_i32 s73, s73, 0
    s_add_u32 s73, s73, 25804800
    v_lshlrev_b32 v143, 7, v1
    v_mul_u32_u24 v150, 256, v1
k_so3:
    s_waitcnt vmcnt(0)
    s_barrier
    s_cmp_lt_u32 s36, 5
    s_cbranch_scc0 k_p2y
    s_cmp_eq_u32 s36, 4
    s_cbranch_scc0 k_p2o
    v_mov_b32 v144, s22
    v_mov_b32 v145, s23
    s_mov_b64 exec, 1
    buffer_store_dwordx2 v[144:145], off, s[24:27], s72 offset:0 sc1
    s_mov_b64 exec, -1
    s_cmp_eq_u32 s3, 14
    s_cbranch_scc0 k_p2y
    s_mov_b64 exec, 1
    buffer_store_dwordx2 v[144:145], off, s[24:27], s72 offset:128 sc1
    s_mov_b64 exec, -1
    s_branch k_p2y
k_p2o:
    v_lshrrev_b32 v253, 4, v1
    v_lshlrev_b32 v253, 2, v253
    global_load_dword v248, v253, s[86:87] offset:32
    global_load_dword v249, v253, s[86:87] offset:48
    global_load_dword v250, v253, s[86:87] offset:64
    global_load_dword v251, v253, s[86:87] offset:80
    global_load_dword v252, v253, s[86:87] offset:96
    s_waitcnt lgkmcnt(0)
    s_mul_i32 s22, s22, 1664525
    s_add_u32 s22, s22, 1013904223
    s_or_b32 s22, s22, 1
    s_andn2_b32 s22, s22, 2
    s_mul_i32 s23, s23, 22695477
    s_add_u32 s23, s23, 1
k_p2y:
    s_lshr_b32 s53, s2, 3
    s_bfe_u32 s60, s2, 0x20001
    s_lshl_b32 s60, s60, 3
    s_and_b32 s54, s53, 7
    s_add_u32 s60, s60, s54
    s_and_b32 s61, s2, 1
    s_lshl_b32 s61, s61, 2
    s_lshr_b32 s54, s53, 3
    s_add_u32 s61, s61, s54
    s_and_b32 s62, s36, 1
    s_bfe_u32 s63, s36, 0x10001
    s_lshl_b32 s64, s60, 1
    s_add_u32 s64, s64, s62
    s_lshl_b32 s53, s64, 1
    s_add_u32 s53, s53, s63
    s_lshl_b32 s83, s53, 3
    s_add_u32 s83, s83, s61
    s_mul_i32 s83, s83, 256
    s_add_u32 s83, s83, 26460160
    s_mul_i32 s53, s53, 20480
    s_lshr_b32 s54, s61, 1
    s_mul_i32 s54, s54, 5120
    s_add_u32 s53, s53, s54
    s_and_b32 s54, s61, 1
    s_mul_i32 s65, s54, 3072
    s_add_u32 s65, s65, s53
    s_lshl_b32 s66, s54, 9
    s_add_u32 s66, s66, s53
    s_add_u32 s66, s66, 2048
    s_lshl_b32 s85, s61, 1
    s_add_u32 s85, s85, s63
    s_mul_i32 s85, s85, 27
    s_add_u32 s85, s85, s62
    s_mul_i32 s85, s85, 5120
    s_add_u32 s85, s85, 23347200
    s_lshl_b32 s82, s38, 5
    s_add_u32 s82, s82, s37
    s_mul_i32 s82, s82, 256
    s_add_u32 s82, s82, 25935872
    s_bfe_u32 s77, s2, 0x20001
    s_lshl_b32 s77, s77, 2
    s_bfe_u32 s54, s2, 0x20003
    s_add_u32 s77, s77, s54
    s_lshl_b32 s77, s77, 2
    s_add_u32 s77, s77, s96
    s_lshr_b32 s54, s2, 5
    s_and_b32 s55, s2, 1
    s_lshl_b32 s76, s55, 3
    s_add_u32 s76, s76, s54
    s_lshl_b32 s84, s77, 4
    s_add_u32 s84, s84, s76
    s_mul_i32 s84, s84, 256
    s_add_u32 s84, s84, 26722304
    s_lshr_b32 s56, s54, 1
    s_mul_i32 s56, s56, 7
    s_and_b32 s57, s54, 1
    s_lshl_b32 s80, s57, 2
    s_add_u32 s80, s80, s56
    s_add_u32 s81, s56, 3
    s_lshl_b32 s81, s81, 1
    s_add_u32 s81, s81, s57
    s_mul_i32 s79, s54, 7
    s_mul_i32 s56, s54, 3
    s_add_u32 s56, s56, 3
    s_lshl_b32 s57, s56, 1
    s_cmp_lt_u32 s54, 6
    s_cselect_b32 s78, 7, 6
    s_cselect_b32 s79, s79, s57
    s_cselect_b32 s80, s80, s56
    s_mul_i32 s55, s55, 27
    s_add_u32 s80, s80, s55
    s_lshl_b32 s55, s55, 1
    s_add_u32 s79, s79, s55
    s_add_u32 s81, s81, s55
    s_mul_i32 s53, s77, 110592
    s_add_u32 s53, s53, 13107200
    s_lshl_b32 s55, s55, 9
    s_add_u32 s53, s53, s55
    s_lshl_b32 s93, s54, 10
    s_add_u32 s93, s93, s53
    s_lshl_b32 s94, s54, 9
    s_add_u32 s94, s94, s53
    s_add_u32 s94, s94, 24576
    s_cmp_lt_u32 s36, 4
    s_cbranch_scc0 k_so4
    s_lshl_b32 s53, s64, 1
    s_add_u32 s53, s53, s63
    s_mul_i32 s53, s53, 20480
    s_sub_u32 s42, s65, s53
    s_lshr_b32 s42, s42, 4
    s_add_u32 s42, s42, s53
    s_sub_u32 s43, s66, s53
    s_lshr_b32 s43, s43, 4
    s_add_u32 s43, s43, s53
    v_mul_u32_u24 v226, 1280, v129
    v_lshl_add_u32 v226, v130, 3, v226
    v_lshl_add_u32 v227, v130, 3, v226
k_so4:
    s_lshr_b32 s53, s2, 3
    s_lshl_b32 s53, s53, 3
    s_add_u32 s53, s53, s36
    s_and_b32 s54, s53, 31
    s_mul_i32 s54, s54, 34
    s_min_u32 s54, s54, 1046
    s_lshl_b32 s54, s54, 7
    s_lshr_b32 s53, s53, 5
    s_and_b32 s55, s2, 1
    s_lshl_b32 s55, s55, 3
    s_add_u32 s53, s53, s55
    s_mul_i32 s53, s53, 138240
    s_add_u32 s53, s53, s54
    s_add_u32 s69, s53, 23347200
    s_lshr_b32 s53, s37, 4
    s_mul_i32 s53, s53, 10240
    s_mul_i32 s54, s38, 40960
    s_add_u32 s53, s53, s54
    s_add_u32 s53, s53, 7864320
    s_and_b32 s54, s37, 15
    s_lshl_b32 s41, s54, 7
    s_add_u32 s41, s41, s53
    s_add_u32 s41, s41, 8192
    s_lshl_b32 s54, s54, 9
    s_add_u32 s40, s53, s54
    s_mov_b32 s48, 0x7b800000
    s_mov_b32 s70, 0x76800000
    s_mov_b32 s49, 0x21800000
    s_mul_i32 s46, s79, 20
    s_add_u32 s46, s46, s96
    s_and_b32 s53, s44, 40
    s_add_u32 s46, s46, s53
    s_lshl_b32 s46, s46, 10
    s_add_u32 s46, s46, 21135360
    s_mov_b32 s47, 4096
    s_cmp_lt_u32 s36, 4
    s_cbranch_scc0 k_so5
    v_lshlrev_b32 v131, 4, v129
    s_waitcnt vmcnt(0)
    v_and_b32 v126, 1, v248
    v_cmp_eq_u32 s[54:55], 1, v126
    v_sub_u32 v172, v248, v126
    v_add_u32 v172, v172, v131
    v_cndmask_b32 v177, v205, v206, s[54:55]
    v_and_b32 v126, 1, v249
    v_cmp_eq_u32 s[54:55], 1, v126
    v_sub_u32 v173, v249, v126
    v_add_u32 v173, v173, v131
    v_cndmask_b32 v178, v205, v206, s[54:55]
    v_and_b32 v126, 1, v250
    v_cmp_eq_u32 s[54:55], 1, v126
    v_sub_u32 v174, v250, v126
    v_add_u32 v174, v174, v131
    v_cndmask_b32 v179, v205, v206, s[54:55]
    v_and_b32 v126, 1, v251
    v_cmp_eq_u32 s[54:55], 1, v126
    v_sub_u32 v175, v251, v126
    v_add_u32 v175, v175, v131
    v_cndmask_b32 v180, v205, v206, s[54:55]
    v_and_b32 v126, 1, v252
    v_cmp_eq_u32 s[54:55], 1, v126
    v_sub_u32 v176, v252, v126
    v_add_u32 v176, v176, v131
    v_cndmask_b32 v181, v205, v206, s[54:55]
k_so5:
    v_mov_b32 v220, 0
    v_mov_b32 v221, 0
    v_mov_b32 v222, 0
    v_mov_b32 v223, 0
    v_lshlrev_b32 v224, 4, v1
    v_min_u32 v254, 33, v1
    v_lshlrev_b32 v254, 7, v254
    v_and_b32 v126, 1, v130
    v_mul_u32_u24 v126, 20480, v126
    v_lshl_add_u32 v253, v129, 3, v126
    v_lshl_add_u32 v126, v129, 4, v126
    v_lshl_add_u32 v252, v128, 8, v126
    v_mov_b32 v128, -1
    v_mov_b32 v129, -1
    v_mov_b32 v130, -1
    v_mov_b32 v131, -1
    v_lshlrev_b32 v126, 3, v1
    s_lshr_b32 s53, s36, 2
    s_mul_i32 s54, s53, 55296
    s_add_u32 s52, s93, s54
    s_add_u32 s97, s94, s54
    s_cmp_eq_u32 s78, 7
    s_cselect_b32 s97, s97, 0x40000000
    s_lshl_b32 s53, s53, 10
    s_add_u32 s86, s65, s53
    s_add_u32 s86, s86, 10485760
    s_add_u32 s87, s66, 10485760
    s_sub_u32 s54, s83, 26460160
    s_lshr_b32 s54, s54, 1
    s_add_u32 s54, s54, 20185088
    s_cmp_lt_u32 s36, 4
    s_cselect_b32 s87, s87, s54
    s_or_b32 s0, s44, 0xffff
    s_mov_b32 s1, s44
    s_cmp_lt_u32 s36, 5
    s_cbranch_scc1 k_w1
    s_cmp_eq_u32 s3, 15
    s_cbranch_scc0 k_w2
    s_sub_u32 s53, s72, 128
    s_mov_b32 s71, 0
    s_mov_b64 exec, 1
k_f1s_p0:
    buffer_load_dwordx2 v[146:147], v150, s[24:27], s53 offen sc1
k_f1s_p2:
    s_add_u32 s71, s71, 1
    s_cmp_gt_u32 s71, 131072
    s_waitcnt vmcnt(0)
k_f1s_p3:
    v_cmpx_ne_u64 vcc, s[22:23], v[146:147]
    s_cbranch_scc1 k_f1s_p1
    s_cbranch_execnz k_f1s_p0
k_f1s_p1:
    s_mov_b64 exec, -1
    s_nop 3
k_w2:
    s_mov_b32 s71, 0
    s_mov_b64 exec, s[74:75]
k_f1_p0:
    buffer_load_dwordx2 v[146:147], v142, s[24:27], s73 offen sc1
k_f1_p2:
    s_add_u32 s71, s71, 1
    s_cmp_gt_u32 s71, 131072
    s_waitcnt vmcnt(0)
k_f1_p3:
    v_cmpx_ne_u64 vcc, s[22:23], v[146:147]
    s_cbranch_scc1 k_f1_p1
    s_cbranch_execnz k_f1_p0
k_f1_p1:
    s_mov_b64 exec, -1
    s_nop 3
k_w1:
    s_mov_b64 exec, 0
    s_cmp_eq_u32 s36, 0
    s_cbranch_scc1 k_pad0
    s_cmp_eq_u32 s36, 1
    s_cbranch_scc1 k_pad1
    s_cmp_eq_u32 s36, 2
    s_cbranch_scc1 k_pad2
    s_cmp_eq_u32 s36, 3
    s_cbranch_scc1 k_pad3
k_walked3_0:
    s_mov_b64 exec, -1
k_pad0:
    s_cbranch_execz k_walked3_0
    s_mov_b64 vcc, s[44:45]
    s_barrier
    s_cbranch_vccnz k_g1
    buffer_load_dwordx4 v125, s[24:27], s39 offen sc1 lds
    s_add_u32 m0, m0, 4096
    s_add_u32 s39, s39, 4096
    buffer_load_dwordx4 v125, s[24:27], s39 offen sc1 lds
    s_add_u32 m0, m0, 4096
    s_add_u32 s39, s39, 4096
    buffer_load_dwordx4 v125, s[24:27], s39 offen sc1 lds
    s_add_u32 m0, m0, 4096
    s_add_u32 s39, s39, 4096
    buffer_load_dwordx4 v125, s[24:27], s39 offen sc1 lds
    s_add_u32 m0, m0, 4096
    s_add_u32 s39, s39, 4096
    buffer_load_dwordx4 v125, s[24:27], s39 offen sc1 lds
    s_add_u32 m0, m0, 4096
    s_add_u32 s39, s39, 4096
    buffer_load_dwordx4 v125, s[24:27], s39 offen sc1 lds
    s_add_u32 m0, m0, 4096
    s_add_u32 s39, s39, 4096
    buffer_load_dwordx4 v125, s[24:27], s39 offen sc1 lds
    s_add_u32 m0, m0, 4096
    s_add_u32 s39, s39, 4096
    buffer_load_dwordx4 v125, s[24:27], s39 offen sc1 lds
    s_add_u32 m0, m0, 4096
    s_add_u32 s39, s39, 4096
    buffer_load_dwordx4 v125, s[24:27], s39 offen sc1 lds
    s_add_u32 m0, m0, 4096
    s_add_u32 s39, s39, 4096
    buffer_load_dwordx4 v125, s[24:27], s39 offen sc1 lds
    s_add_u32 m0, m0, 4096
    s_add_u32 s39, s39, 4096
    s_waitcnt vmcnt(6)
    s_barrier
    buffer_load_dwordx4 v[116:119], v125, s[24:27], s67 offen sc1
    buffer_load_dwordx2 v[120:121], v127, s[24:27], s68 offen offset:2048 sc1
    buffer_load_dwordx4 v125, s[24:27], s39 offen sc1 lds
    s_add_u32 m0, m0, 4096
    s_add_u32 s39, s39, 4096
    buffer_load_dwordx4 v125, s[24:27], s39 offen sc1 lds
    s_add_u32 m0, m0, 4096
    s_add_u32 s39, s39, 4096
    buffer_load_dwordx4 v125, s[24:27], s39 offen sc1 lds
    s_add_u32 m0, m0, 4096
    s_add_u32 s39, s39, 4096
    buffer_load_dwordx4 v125, s[24:27], s39 offen sc1 lds
    s_add_u32 m0, m0, 4096
    s_add_u32 s39, s39, 4096
    buffer_load_dwordx4 v125, s[24:27], s39 offen sc1 lds
    s_add_u32 m0, m0, 4096
    s_add_u32 s39, s39, 4096
    buffer_load_dwordx4 v125, s[24:27], s39 offen sc1 lds
    s_add_u32 m0, m0, 4096
    s_add_u32 s39, s39, 4096
    s_waitcnt vmcnt(10)
    s_barrier
    buffer_load_dwordx4 v125, s[24:27], s39 offen sc1 lds
    s_add_u32 m0, m0, 4096
    s_add_u32 s39, s39, 4096
    buffer_load_dwordx4 v125, s[24:27], s39 offen sc1 lds
    s_add_u32 m0, m0, 4096
    s_add_u32 s39, s39, 4096
    buffer_load_dwordx4 v125, s[24:27], s39 offen sc1 lds
    s_add_u32 m0, m0, 4096
    s_add_u32 s39, s39, 4096
    buffer_load_dwordx4 v125, s[24:27], s39 offen sc1 lds
    s_add_u32 m0, m0, 4096
    s_add_u32 s39, s39, 4096
    buffer_load_dwordx4 v125, s[24:27], s39 offen sc1 lds
    s_add_u32 m0, m0, 4096
    s_add_u32 s39, s39, 4096
    buffer_load_dwordx4 v125, s[24:27], s39 offen sc1 lds
    s_add_u32 m0, m0, 4096
    s_add_u32 s39, s39, 4096
    buffer_load_dwordx4 v125, s[24:27], s39 offen sc1 lds
    s_add_u32 m0, m0, 4096
    s_add_u32 s39, s39, 4096
    buffer_load_dwordx4 v125, s[24:27], s39 offen sc1 lds
    s_add_u32 m0, m0, 4096
    s_add_u32 s39, s39, 4096
    buffer_load_dwordx4 v125, s[24:27], s39 offen sc1 lds
    s_add_u32 m0, m0, 4096
    s_add_u32 s39, s39, 4096
    buffer_load_dwordx4 v125, s[24:27], s39 offen sc1 lds
    s_add_u32 m0, m0, 4096
    s_add_u32 s39, s39, 4096
    buffer_load_dwordx4 v125, s[24:27], s39 offen sc1 lds
    s_add_u32 m0, m0, 4096
    s_add_u32 s39, s39, 4096
    buffer_load_dwordx4 v125, s[24:27], s39 offen sc1 lds
    s_add_u32 m0, m0, 4096
    s_add_u32 s39, s39, 4096
    buffer_load_dwordx4 v125, s[24:27], s39 offen sc1 lds
    s_add_u32 m0, m0, 4096
    s_add_u32 s39, s39, 4096
    buffer_load_dwordx4 v125, s[24:27], s39 offen sc1 lds
    s_add_u32 m0, m0, 4096
    s_add_u32 s39, s39, 4096
    buffer_load_dwordx4 v125, s[24:27], s39 offen sc1 lds
    s_add_u32 m0, m0, 4096
    s_add_u32 s39, s39, 4096
    buffer_load_dwordx4 v125, s[24:27], s39 offen sc1 lds
    s_add_u32 m0, m0, 4096
    s_add_u32 s39, s39, 4096
    buffer_load_dwordx4 v125, s[24:27], s39 offen sc1 lds
    s_add_u32 m0, m0, 4096
    s_add_u32 s39, s39, 4096
    buffer_load_dwordx4 v125, s[24:27], s39 offen sc1 lds
    s_add_u32 m0, m0, 4096
    s_add_u32 s39, s39, 4096
    buffer_load_dwordx4 v125, s[24:27], s39 offen sc1 lds
    s_add_u32 m0, m0, 4096
    s_add_u32 s39, s39, 4096
    s_waitcnt vmcnt(19)
    s_barrier
k_g1:
    s_cbranch_vccz k_g2
    buffer_load_dwordx4 v[116:119], v125, s[24:27], s67 offen sc1
    buffer_load_dwordx2 v[120:121], v127, s[24:27], s68 offen offset:2048 sc1
    s_mov_b64 exec, 0
    s_cmp_eq_u32 s36, 0
    s_cbranch_scc1 k_pad4
    s_cmp_eq_u32 s36, 1
    s_cbranch_scc1 k_pad5
    s_cmp_eq_u32 s36, 2
    s_cbranch_scc1 k_pad6
    s_cmp_eq_u32 s36, 3
    s_cbranch_scc1 k_pad7
k_walked2_0:
    s_mov_b64 exec, -1
    s_waitcnt vmcnt(0)
    s_barrier
k_g2:
    ds_read_b64 v[98:99], v123 offset:2048
    ds_read_b128 v[90:93], v122 offset:0
    ds_read_b128 v[94:97], v122 offset:1024
    s_setprio 3
    s_waitcnt lgkmcnt(2)
    v_mfma_f32_32x32x4_2b_bf16 v[2:33], v[98:99], v[120:121], 0
    ds_read_b64 v[98:99], v123 offset:7168
    s_mov_b64 exec, s[50:51]
    ds_read_b128 v[100:103], v124 offset:2560
    s_mov_b64 exec, -1
    s_nop 13
    s_waitcnt lgkmcnt(2)
    v_mfma_f32_32x32x16_bf16 v[2:17], v[90:93], v[116:119], v[2:17]
    ds_read_b128 v[90:93], v122 offset:5120
    s_mov_b64 exec, s[50:51]
    ds_read_b128 v[104:107], v124 offset:3200
    s_mov_b64 exec, -1
    v_mfma_f32_32x32x16_bf16 v[18:33], v[94:97], v[116:119], v[18:33]
    ds_read_b128 v[94:97], v122 offset:6144
    s_mov_b64 exec, s[50:51]
    ds_read_b128 v[108:111], v124 offset:3840
    s_mov_b64 exec, -1
    s_nop 3
    s_waitcnt lgkmcnt(2)
    v_mfma_f32_32x32x4_2b_bf16 v[34:65], v[98:99], v[120:121], 0
    ds_read_b64 v[98:99], v123 offset:12288
    v_exp_f32 v2, v2
    v_exp_f32 v3, v3
    v_exp_f32 v4, v4
    v_cvt_pk_bf16_f32 v82, v2, v3
    v_exp_f32 v5, v5
    v_exp_f32 v6, v6
    v_cvt_pk_bf16_f32 v83, v4, v5
    v_exp_f32 v7, v7
    v_exp_f32 v8, v8
    v_cvt_pk_bf16_f32 v84, v6, v7
    v_exp_f32 v9, v9
    v_exp_f32 v10, v10
    v_mfma_f32_32x32x16_bf16 v[66:81], v[112:115], v[86:89], v[66:81]
    v_cvt_pk_bf16_f32 v85, v8, v9
    v_exp_f32 v11, v11
    v_exp_f32 v12, v12
    v_cvt_pk_bf16_f32 v86, v10, v11
    v_exp_f32 v13, v13
    v_mfma_f32_32x32x16_bf16 v[66:81], v[100:103], v[82:85], v[66:81]
    s_mov_b64 exec, s[50:51]
    ds_read_b128 v[112:115], v124 offset:4480
    ds_read_b128 v[100:103], v124 offset:7680
    s_mov_b64 exec, -1
    v_exp_f32 v14, v14
    v_cvt_pk_bf16_f32 v87, v12, v13
    v_exp_f32 v15, v15
    v_exp_f32 v16, v16
    v_cvt_pk_bf16_f32 v88, v14, v15
    v_exp_f32 v17, v17
    v_mfma_f32_32x32x16_bf16 v[34:49], v[90:93], v[116:119], v[34:49]
    s_waitcnt lgkmcnt(3)
    ds_read_b128 v[90:93], v122 offset:10240
    v_exp_f32 v18, v18
    v_cvt_pk_bf16_f32 v89, v16, v17
    v_exp_f32 v19, v19
    v_exp_f32 v20, v20
    v_cvt_pk_bf16_f32 v82, v18, v19
    v_exp_f32 v21, v21
    v_mfma_f32_32x32x16_bf16 v[66:81], v[104:107], v[86:89], v[66:81]
    v_exp_f32 v22, v22
    v_cvt_pk_bf16_f32 v83, v20, v21
    v_exp_f32 v23, v23
    v_exp_f32 v24, v24
    v_cvt_pk_bf16_f32 v84, v22, v23
    v_exp_f32 v25, v25
    v_mfma_f32_32x32x16_bf16 v[50:65], v[94:97], v[116:119], v[50:65]
    s_waitcnt lgkmcnt(0)
    ds_read_b128 v[94:97], v122 offset:11264
    v_exp_f32 v26, v26
    v_cvt_pk_bf16_f32 v85, v24, v25
    v_exp_f32 v27, v27
    v_exp_f32 v28, v28
    v_cvt_pk_bf16_f32 v86, v26, v27
    v_exp_f32 v29, v29
    v_mfma_f32_32x32x16_bf16 v[66:81], v[108:111], v[82:85], v[66:81]
    s_mov_b64 exec, s[50:51]
    ds_read_b128 v[104:107], v124 offset:8320
    ds_read_b128 v[108:111], v124 offset:8960
    s_mov_b64 exec, -1
    v_exp_f32 v30, v30
    v_cvt_pk_bf16_f32 v87, v28, v29
    v_exp_f32 v31, v31
    v_exp_f32 v32, v32
    v_exp_f32 v33, v33
    v_cvt_pk_bf16_f32 v88, v30, v31
    v_cvt_pk_bf16_f32 v89, v32, v33
    s_cbranch_vccz k_g3
    s_barrier
k_g3:
    v_mfma_f32_32x32x4_2b_bf16 v[2:33], v[98:99], v[120:121], 0
    ds_read_b64 v[98:99], v123 offset:17408
    v_exp_f32 v34, v34
    v_exp_f32 v35, v35
    v_exp_f32 v36, v36
    v_cvt_pk_bf16_f32 v82, v34, v35
    v_exp_f32 v37, v37
    v_exp_f32 v38, v38
    v_cvt_pk_bf16_f32 v83, v36, v37
    v_exp_f32 v39, v39
    v_exp_f32 v40, v40
    v_cvt_pk_bf16_f32 v84, v38, v39
    v_exp_f32 v41, v41
    v_exp_f32 v42, v42
    v_mfma_f32_32x32x16_bf16 v[66:81], v[112:115], v[86:89], v[66:81]
    v_cvt_pk_bf16_f32 v85, v40, v41
    v_exp_f32 v43, v43
    v_exp_f32 v44, v44
    v_cvt_pk_bf16_f32 v86, v42, v43
    v_exp_f32 v45, v45
    v_mfma_f32_32x32x16_bf16 v[66:81], v[100:103], v[82:85], v[66:81]
    s_mov_b64 exec, s[50:51]
    ds_read_b128 v[112:115], v124 offset:9600
    ds_read_b128 v[100:103], v124 offset:12800
    s_mov_b64 exec, -1
    v_exp_f32 v46, v46
    v_cvt_pk_bf16_f32 v87, v44, v45
    v_exp_f32 v47, v47
    v_exp_f32 v48, v48
    v_cvt_pk_bf16_f32 v88, v46, v47
    v_exp_f32 v49, v49
    v_mfma_f32_32x32x16_bf16 v[2:17], v[90:93], v[116:119], v[2:17]
    s_waitcnt lgkmcnt(3)
    ds_read_b128 v[90:93], v122 offset:15360
    v_exp_f32 v50, v50
    v_cvt_pk_bf16_f32 v89, v48, v49
    v_exp_f32 v51, v51
    v_exp_f32 v52, v52
    v_cvt_pk_bf16_f32 v82, v50, v51
    v_exp_f32 v53, v53
    v_mfma_f32_32x32x16_bf16 v[66:81], v[104:107], v[86:89], v[66:81]
    v_exp_f32 v54, v54
    v_cvt_pk_bf16_f32 v83, v52, v53
    v_exp_f32 v55, v55
    v_exp_f32 v56, v56
    v_cvt_pk_bf16_f32 v84, v54, v55
    v_exp_f32 v57, v57
    v_mfma_f32_32x32x16_bf16 v[18:33], v[94:97], v[116:119], v[18:33]
    s_waitcnt lgkmcnt(0)
    ds_read_b128 v[94:97], v122 offset:16384
    v_exp_f32 v58, v58
    v_cvt_pk_bf16_f32 v85, v56, v57
    v_exp_f32 v59, v59
    v_exp_f32 v60, v60
    v_cvt_pk_bf16_f32 v86, v58, v59
    v_exp_f32 v61, v61
    v_mfma_f32_32x32x16_bf16 v[66:81], v[108:111], v[82:85], v[66:81]
    s_mov_b64 exec, s[50:51]
    ds_read_b128 v[104:107], v124 offset:13440
    ds_read_b128 v[108:111], v124 offset:14080
    s_mov_b64 exec, -1
    v_exp_f32 v62, v62
    v_cvt_pk_bf16_f32 v87, v60, v61
    v_exp_f32 v63, v63
    v_exp_f32 v64, v64
    v_exp_f32 v65, v65
    v_cvt_pk_bf16_f32 v88, v62, v63
    v_cvt_pk_bf16_f32 v89, v64, v65
    v_mfma_f32_32x32x4_2b_bf16 v[34:65], v[98:99], v[120:121], 0
    ds_read_b64 v[98:99], v123 offset:22528
    v_exp_f32 v2, v2
    v_exp_f32 v3, v3
    v_exp_f32 v4, v4
    v_cvt_pk_bf16_f32 v82, v2, v3
    v_exp_f32 v5, v5
    v_exp_f32 v6, v6
    v_cvt_pk_bf16_f32 v83, v4, v5
    v_exp_f32 v7, v7
    v_exp_f32 v8, v8
    v_cvt_pk_bf16_f32 v84, v6, v7
    v_exp_f32 v9, v9
    v_exp_f32 v10, v10
    v_mfma_f32_32x32x16_bf16 v[66:81], v[112:115], v[86:89], v[66:81]
    v_cvt_pk_bf16_f32 v85, v8, v9
    v_exp_f32 v11, v11
    v_exp_f32 v12, v12
    v_cvt_pk_bf16_f32 v86, v10, v11
    v_exp_f32 v13, v13
    v_mfma_f32_32x32x16_bf16 v[66:81], v[100:103], v[82:85], v[66:81]
    s_mov_b64 exec, s[50:51]
    ds_read_b128 v[112:115], v124 offset:14720
    ds_read_b128 v[100:103], v124 offset:17920
    s_mov_b64 exec, -1
    v_exp_f32 v14, v14
    v_cvt_pk_bf16_f32 v87, v12, v13
    v_exp_f32 v15, v15
    v_exp_f32 v16, v16
    v_cvt_pk_bf16_f32 v88, v14, v15
    v_exp_f32 v17, v17
    v_mfma_f32_32x32x16_bf16 v[34:49], v[90:93], v[116:119], v[34:49]
    s_waitcnt lgkmcnt(3)
    ds_read_b128 v[90:93], v122 offset:20480
    v_exp_f32 v18, v18
    v_cvt_pk_bf16_f32 v89, v16, v17
    v_exp_f32 v19, v19
    v_exp_f32 v20, v20
    v_cvt_pk_bf16_f32 v82, v18, v19
    v_exp_f32 v21, v21
    v_mfma_f32_32x32x16_bf16 v[66:81], v[104:107], v[86:89], v[66:81]
    v_exp_f32 v22, v22
    v_cvt_pk_bf16_f32 v83, v20, v21
    v_exp_f32 v23, v23
    v_exp_f32 v24, v24
    v_cvt_pk_bf16_f32 v84, v22, v23
    v_exp_f32 v25, v25
    v_mfma_f32_32x32x16_bf16 v[50:65], v[94:97], v[116:119], v[50:65]
    s_waitcnt lgkmcnt(0)
    ds_read_b128 v[94:97], v122 offset:21504
    v_exp_f32 v26, v26
    v_cvt_pk_bf16_f32 v85, v24, v25
    v_exp_f32 v27, v27
    v_exp_f32 v28, v28
    v_cvt_pk_bf16_f32 v86, v26, v27
    v_exp_f32 v29, v29
    v_mfma_f32_32x32x16_bf16 v[66:81], v[108:111], v[82:85], v[66:81]
    s_mov_b64 exec, s[50:51]
    ds_read_b128 v[104:107], v124 offset:18560
    ds_read_b128 v[108:111], v124 offset:19200
    s_mov_b64 exec, -1
    v_exp_f32 v30, v30
    v_cvt_pk_bf16_f32 v87, v28, v29
    v_exp_f32 v31, v31
    v_exp_f32 v32, v32
    v_exp_f32 v33, v33
    v_cvt_pk_bf16_f32 v88, v30, v31
    v_cvt_pk_bf16_f32 v89, v32, v33
    v_mfma_f32_32x32x4_2b_bf16 v[2:33], v[98:99], v[120:121], 0
    ds_read_b64 v[98:99], v123 offset:27648
    v_exp_f32 v34, v34
    v_exp_f32 v35, v35
    v_exp_f32 v36, v36
    v_cvt_pk_bf16_f32 v82, v34, v35
    v_exp_f32 v37, v37
    v_exp_f32 v38, v38
    v_cvt_pk_bf16_f32 v83, v36, v37
    v_exp_f32 v39, v39
    v_exp_f32 v40, v40
    v_cvt_pk_bf16_f32 v84, v38, v39
    v_exp_f32 v41, v41
    v_exp_f32 v42, v42
    v_mfma_f32_32x32x16_bf16 v[66:81], v[112:115], v[86:89], v[66:81]
    v_cvt_pk_bf16_f32 v85, v40, v41
    v_exp_f32 v43, v43
    v_exp_f32 v44, v44
    v_cvt_pk_bf16_f32 v86, v42, v43
    v_exp_f32 v45, v45
    v_mfma_f32_32x32x16_bf16 v[66:81], v[100:103], v[82:85], v[66:81]
    s_mov_b64 exec, s[50:51]
    ds_read_b128 v[112:115], v124 offset:19840
    ds_read_b128 v[100:103], v124 offset:23040
    s_mov_b64 exec, -1
    v_exp_f32 v46, v46
    v_cvt_pk_bf16_f32 v87, v44, v45
    v_exp_f32 v47, v47
    v_exp_f32 v48, v48
    v_cvt_pk_bf16_f32 v88, v46, v47
    v_exp_f32 v49, v49
    v_mfma_f32_32x32x16_bf16 v[2:17], v[90:93], v[116:119], v[2:17]
    s_waitcnt lgkmcnt(3)
    ds_read_b128 v[90:93], v122 offset:25600
    v_exp_f32 v50, v50
    v_cvt_pk_bf16_f32 v89, v48, v49
    v_exp_f32 v51, v51
    v_exp_f32 v52, v52
    v_cvt_pk_bf16_f32 v82, v50, v51
    v_exp_f32 v53, v53
    v_mfma_f32_32x32x16_bf16 v[66:81], v[104:107], v[86:89], v[66:81]
    v_exp_f32 v54, v54
    v_cvt_pk_bf16_f32 v83, v52, v53
    v_exp_f32 v55, v55
    v_exp_f32 v56, v56
    v_cvt_pk_bf16_f32 v84, v54, v55
    v_exp_f32 v57, v57
    v_mfma_f32_32x32x16_bf16 v[18:33], v[94:97], v[116:119], v[18:33]
    s_waitcnt lgkmcnt(0)
    ds_read_b128 v[94:97], v122 offset:26624
    v_exp_f32 v58, v58
    v_cvt_pk_bf16_f32 v85, v56, v57
    v_exp_f32 v59, v59
    v_exp_f32 v60, v60
    v_cvt_pk_bf16_f32 v86, v58, v59
    v_exp_f32 v61, v61
    v_mfma_f32_32x32x16_bf16 v[66:81], v[108:111], v[82:85], v[66:81]
    s_mov_b64 exec, s[50:51]
    ds_read_b128 v[104:107], v124 offset:23680
    ds_read_b128 v[108:111], v124 offset:24320
    s_mov_b64 exec, -1
    v_exp_f32 v62, v62
    v_cvt_pk_bf16_f32 v87, v60, v61
    v_exp_f32 v63, v63
    v_exp_f32 v64, v64
    v_exp_f32 v65, v65
    v_cvt_pk_bf16_f32 v88, v62, v63
    v_cvt_pk_bf16_f32 v89, v64, v65
    s_cbranch_vccz k_g4
    s_barrier
k_g4:
    s_cbranch_vccz k_g5
    s_mul_i32 s53, s96, 5120
    s_add_u32 m0, s53, 143360
    s_nop 0
    buffer_load_dwordx4 v204, s[28:31], s88 offen lds
    s_add_u32 m0, m0, 1024
    s_nop 0
    buffer_load_dwordx4 v204, s[28:31], s89 offen lds
    s_add_u32 m0, m0, 1024
    s_nop 0
    buffer_load_dwordx4 v204, s[28:31], s90 offen lds
    s_add_u32 m0, m0, 1024
    s_nop 0
    buffer_load_dwordx4 v204, s[28:31], s91 offen lds
    s_add_u32 m0, m0, 1024
    s_nop 0
    buffer_load_dwordx4 v204, s[28:31], s92 offen lds
    s_add_u32 m0, m0, 1024
    s_nop 0
k_g5:
    v_mfma_f32_32x32x4_2b_bf16 v[34:65], v[98:99], v[120:121], 0
    ds_read_b64 v[98:99], v123 offset:32768
    v_exp_f32 v2, v2
    v_exp_f32 v3, v3
    v_exp_f32 v4, v4
    v_cvt_pk_bf16_f32 v82, v2, v3
    v_exp_f32 v5, v5
    v_exp_f32 v6, v6
    v_cvt_pk_bf16_f32 v83, v4, v5
    v_exp_f32 v7, v7
    v_exp_f32 v8, v8
    v_cvt_pk_bf16_f32 v84, v6, v7
    v_exp_f32 v9, v9
    v_exp_f32 v10, v10
    v_mfma_f32_32x32x16_bf16 v[66:81], v[112:115], v[86:89], v[66:81]
    v_cvt_pk_bf16_f32 v85, v8, v9
    v_exp_f32 v11, v11
    v_exp_f32 v12, v12
    v_cvt_pk_bf16_f32 v86, v10, v11
    v_exp_f32 v13, v13
    v_mfma_f32_32x32x16_bf16 v[66:81], v[100:103], v[82:85], v[66:81]
    s_mov_b64 exec, s[50:51]
    ds_read_b128 v[112:115], v124 offset:24960
    ds_read_b128 v[100:103], v124 offset:28160
    s_mov_b64 exec, -1
    v_exp_f32 v14, v14
    v_cvt_pk_bf16_f32 v87, v12, v13
    v_exp_f32 v15, v15
    v_exp_f32 v16, v16
    v_cvt_pk_bf16_f32 v88, v14, v15
    v_exp_f32 v17, v17
    v_mfma_f32_32x32x16_bf16 v[34:49], v[90:93], v[116:119], v[34:49]
    s_waitcnt lgkmcnt(3)
    ds_read_b128 v[90:93], v122 offset:30720
    v_exp_f32 v18, v18
    v_cvt_pk_bf16_f32 v89, v16, v17
    v_exp_f32 v19, v19
    v_exp_f32 v20, v20
    v_cvt_pk_bf16_f32 v82, v18, v19
    v_exp_f32 v21, v21
    v_mfma_f32_32x32x16_bf16 v[66:81], v[104:107], v[86:89], v[66:81]
    v_exp_f32 v22, v22
    v_cvt_pk_bf16_f32 v83, v20, v21
    v_exp_f32 v23, v23
    v_exp_f32 v24, v24
    v_cvt_pk_bf16_f32 v84, v22, v23
    v_exp_f32 v25, v25
    v_mfma_f32_32x32x16_bf16 v[50:65], v[94:97], v[116:119], v[50:65]
    s_waitcnt lgkmcnt(0)
    ds_read_b128 v[94:97], v122 offset:31744
    v_exp_f32 v26, v26
    v_cvt_pk_bf16_f32 v85, v24, v25
    v_exp_f32 v27, v27
    v_exp_f32 v28, v28
    v_cvt_pk_bf16_f32 v86, v26, v27
    v_exp_f32 v29, v29
    v_mfma_f32_32x32x16_bf16 v[66:81], v[108:111], v[82:85], v[66:81]
    s_mov_b64 exec, s[50:51]
    ds_read_b128 v[104:107], v124 offset:28800
    ds_read_b128 v[108:111], v124 offset:29440
    s_mov_b64 exec, -1
    v_exp_f32 v30, v30
    v_cvt_pk_bf16_f32 v87, v28, v29
    v_exp_f32 v31, v31
    v_exp_f32 v32, v32
    v_exp_f32 v33, v33
    v_cvt_pk_bf16_f32 v88, v30, v31
    v_cvt_pk_bf16_f32 v89, v32, v33
    s_cbranch_vccnz k_g6
    s_mov_b64 exec, 0xffff
    buffer_store_dwordx4 v[220:223], v224, s[24:27], s82 offen sc1
    s_mov_b64 exec, -1
k_g6:
    v_mfma_f32_32x32x4_2b_bf16 v[2:33], v[98:99], v[120:121], 0
    ds_read_b64 v[98:99], v123 offset:37888
    v_exp_f32 v34, v34
    v_exp_f32 v35, v35
    v_exp_f32 v36, v36
    v_cvt_pk_bf16_f32 v82, v34, v35
    v_exp_f32 v37, v37
    v_exp_f32 v38, v38
    v_cvt_pk_bf16_f32 v83, v36, v37
    v_exp_f32 v39, v39
    v_exp_f32 v40, v40
    v_cvt_pk_bf16_f32 v84, v38, v39
    v_exp_f32 v41, v41
    v_exp_f32 v42, v42
    v_mfma_f32_32x32x16_bf16 v[66:81], v[112:115], v[86:89], v[66:81]
    v_cvt_pk_bf16_f32 v85, v40, v41
    v_exp_f32 v43, v43
    v_exp_f32 v44, v44
    v_cvt_pk_bf16_f32 v86, v42, v43
    v_exp_f32 v45, v45
    v_mfma_f32_32x32x16_bf16 v[66:81], v[100:103], v[82:85], v[66:81]
    s_mov_b64 exec, s[50:51]
    ds_read_b128 v[112:115], v124 offset:30080
    ds_read_b128 v[100:103], v124 offset:33280
    s_mov_b64 exec, -1
    v_exp_f32 v46, v46
    v_cvt_pk_bf16_f32 v87, v44, v45
    v_exp_f32 v47, v47
    v_exp_f32 v48, v48
    v_cvt_pk_bf16_f32 v88, v46, v47
    v_exp_f32 v49, v49
    v_mfma_f32_32x32x16_bf16 v[2:17], v[90:93], v[116:119], v[2:17]
    s_waitcnt lgkmcnt(3)
    ds_read_b128 v[90:93], v122 offset:35840
    v_exp_f32 v50, v50
    v_cvt_pk_bf16_f32 v89, v48, v49
    v_exp_f32 v51, v51
    v_exp_f32 v52, v52
    v_cvt_pk_bf16_f32 v82, v50, v51
    v_exp_f32 v53, v53
    v_mfma_f32_32x32x16_bf16 v[66:81], v[104:107], v[86:89], v[66:81]
    v_exp_f32 v54, v54
    v_cvt_pk_bf16_f32 v83, v52, v53
    v_exp_f32 v55, v55
    v_exp_f32 v56, v56
    v_cvt_pk_bf16_f32 v84, v54, v55
    v_exp_f32 v57, v57
    v_mfma_f32_32x32x16_bf16 v[18:33], v[94:97], v[116:119], v[18:33]
    s_waitcnt lgkmcnt(0)
    ds_read_b128 v[94:97], v122 offset:36864
    v_exp_f32 v58, v58
    v_cvt_pk_bf16_f32 v85, v56, v57
    v_exp_f32 v59, v59
    v_exp_f32 v60, v60
    v_cvt_pk_bf16_f32 v86, v58, v59
    v_exp_f32 v61, v61
    v_mfma_f32_32x32x16_bf16 v[66:81], v[108:111], v[82:85], v[66:81]
k_pad1:
    s_cbranch_execz k_walked3_0
    s_mov_b64 exec, s[50:51]
    ds_read_b128 v[104:107], v124 offset:33920
    ds_read_b128 v[108:111], v124 offset:34560
    s_mov_b64 exec, -1
    v_exp_f32 v62, v62
    v_cvt_pk_bf16_f32 v87, v60, v61
    v_exp_f32 v63, v63
    v_exp_f32 v64, v64
    v_exp_f32 v65, v65
    v_cvt_pk_bf16_f32 v88, v62, v63
    v_cvt_pk_bf16_f32 v89, v64, v65
    s_cbranch_vccz k_g7
    s_waitcnt vmcnt(0)
    ds_read_b64_tr_b16 v[152:153], v177 offset:0
    ds_read_b64_tr_b16 v[154:155], v177 offset:512
    ds_read_b64_tr_b16 v[156:157], v178 offset:1024
    ds_read_b64_tr_b16 v[158:159], v178 offset:1536
    ds_read_b64_tr_b16 v[160:161], v179 offset:2048
    ds_read_b64_tr_b16 v[162:163], v179 offset:2560
    ds_read_b64_tr_b16 v[164:165], v180 offset:3072
    ds_read_b64_tr_b16 v[166:167], v180 offset:3584
    ds_read_b64_tr_b16 v[168:169], v181 offset:4096
    ds_read_b64_tr_b16 v[170:171], v181 offset:4608
k_g7:
    s_setprio 2
    v_mfma_f32_32x32x4_2b_bf16 v[34:65], v[98:99], v[120:121], 0
    ds_read_b64 v[98:99], v123 offset:43008
    v_exp_f32 v2, v2
    v_exp_f32 v3, v3
    v_exp_f32 v4, v4
    v_cvt_pk_bf16_f32 v82, v2, v3
    v_exp_f32 v5, v5
    v_exp_f32 v6, v6
    v_cvt_pk_bf16_f32 v83, v4, v5
    v_exp_f32 v7, v7
    v_exp_f32 v8, v8
    v_cvt_pk_bf16_f32 v84, v6, v7
    v_exp_f32 v9, v9
    v_exp_f32 v10, v10
    v_mfma_f32_32x32x16_bf16 v[66:81], v[112:115], v[86:89], v[66:81]
    v_cvt_pk_bf16_f32 v85, v8, v9
    v_exp_f32 v11, v11
    v_exp_f32 v12, v12
    v_cvt_pk_bf16_f32 v86, v10, v11
    v_exp_f32 v13, v13
    v_mfma_f32_32x32x16_bf16 v[66:81], v[100:103], v[82:85], v[66:81]
    s_mov_b64 exec, s[50:51]
    ds_read_b128 v[112:115], v124 offset:35200
    ds_read_b128 v[100:103], v124 offset:38400
    s_mov_b64 exec, -1
    v_exp_f32 v14, v14
    v_cvt_pk_bf16_f32 v87, v12, v13
    v_exp_f32 v15, v15
    v_exp_f32 v16, v16
    v_cvt_pk_bf16_f32 v88, v14, v15
    v_exp_f32 v17, v17
    v_mfma_f32_32x32x16_bf16 v[34:49], v[90:93], v[116:119], v[34:49]
    s_waitcnt lgkmcnt(3)
    ds_read_b128 v[90:93], v122 offset:40960
    v_exp_f32 v18, v18
    v_cvt_pk_bf16_f32 v89, v16, v17
    v_exp_f32 v19, v19
    v_exp_f32 v20, v20
    v_cvt_pk_bf16_f32 v82, v18, v19
    v_exp_f32 v21, v21
    v_mfma_f32_32x32x16_bf16 v[66:81], v[104:107], v[86:89], v[66:81]
    v_exp_f32 v22, v22
    v_cvt_pk_bf16_f32 v83, v20, v21
    v_exp_f32 v23, v23
    v_exp_f32 v24, v24
    v_cvt_pk_bf16_f32 v84, v22, v23
    v_exp_f32 v25, v25
    v_mfma_f32_32x32x16_bf16 v[50:65], v[94:97], v[116:119], v[50:65]
    s_waitcnt lgkmcnt(0)
    ds_read_b128 v[94:97], v122 offset:41984
    v_exp_f32 v26, v26
    v_cvt_pk_bf16_f32 v85, v24, v25
    v_exp_f32 v27, v27
    v_exp_f32 v28, v28
    v_cvt_pk_bf16_f32 v86, v26, v27
    v_exp_f32 v29, v29
    v_mfma_f32_32x32x16_bf16 v[66:81], v[108:111], v[82:85], v[66:81]
    s_mov_b64 exec, s[50:51]
    ds_read_b128 v[104:107], v124 offset:39040
    ds_read_b128 v[108:111], v124 offset:39680
    s_mov_b64 exec, -1
    v_exp_f32 v30, v30
    v_cvt_pk_bf16_f32 v87, v28, v29
    v_exp_f32 v31, v31
    v_exp_f32 v32, v32
    v_exp_f32 v33, v33
    v_cvt_pk_bf16_f32 v88, v30, v31
    v_cvt_pk_bf16_f32 v89, v32, v33
    s_cbranch_vccz k_g8
    s_lshl_b32 s53, s96, 8
    buffer_store_dwordx4 v[152:155], v172, s[24:27], s53 offen sc1
    buffer_store_dwordx4 v[156:159], v173, s[24:27], s53 offen sc1
    buffer_store_dwordx4 v[160:163], v174, s[24:27], s53 offen sc1
    buffer_store_dwordx4 v[164:167], v175, s[24:27], s53 offen sc1
    buffer_store_dwordx4 v[168:171], v176, s[24:27], s53 offen sc1
    s_mov_b64 exec, 0xffff
    buffer_store_dwordx4 v[220:223], v224, s[24:27], s82 offen sc1
    buffer_store_dwordx4 v[220:223], v224, s[24:27], s83 offen sc1
    buffer_store_dwordx4 v[220:223], v224, s[24:27], s84 offen sc1
    s_mov_b64 exec, -1
k_g8:
    v_mfma_f32_32x32x4_2b_bf16 v[2:33], v[98:99], v[120:121], 0
    ds_read_b64 v[98:99], v123 offset:48128
    v_exp_f32 v34, v34
    v_exp_f32 v35, v35
    v_exp_f32 v36, v36
    v_cvt_pk_bf16_f32 v82, v34, v35
    v_exp_f32 v37, v37
    v_exp_f32 v38, v38
    v_cvt_pk_bf16_f32 v83, v36, v37
    v_exp_f32 v39, v39
    v_exp_f32 v40, v40
    v_cvt_pk_bf16_f32 v84, v38, v39
    v_exp_f32 v41, v41
    v_exp_f32 v42, v42
    v_mfma_f32_32x32x16_bf16 v[66:81], v[112:115], v[86:89], v[66:81]
    v_cvt_pk_bf16_f32 v85, v40, v41
    v_exp_f32 v43, v43
    v_exp_f32 v44, v44
    v_cvt_pk_bf16_f32 v86, v42, v43
    v_exp_f32 v45, v45
    v_mfma_f32_32x32x16_bf16 v[66:81], v[100:103], v[82:85], v[66:81]
    s_mov_b64 exec, s[50:51]
    ds_read_b128 v[112:115], v124 offset:40320
    ds_read_b128 v[100:103], v124 offset:43520
    s_mov_b64 exec, -1
    v_exp_f32 v46, v46
    v_cvt_pk_bf16_f32 v87, v44, v45
    v_exp_f32 v47, v47
    v_exp_f32 v48, v48
    v_cvt_pk_bf16_f32 v88, v46, v47
    v_exp_f32 v49, v49
    v_mfma_f32_32x32x16_bf16 v[2:17], v[90:93], v[116:119], v[2:17]
    s_waitcnt lgkmcnt(3)
    ds_read_b128 v[90:93], v122 offset:46080
    v_exp_f32 v50, v50
    v_cvt_pk_bf16_f32 v89, v48, v49
    v_exp_f32 v51, v51
    v_exp_f32 v52, v52
    v_cvt_pk_bf16_f32 v82, v50, v51
    v_exp_f32 v53, v53
    v_mfma_f32_32x32x16_bf16 v[66:81], v[104:107], v[86:89], v[66:81]
    v_exp_f32 v54, v54
    v_cvt_pk_bf16_f32 v83, v52, v53
    v_exp_f32 v55, v55
    v_exp_f32 v56, v56
    v_cvt_pk_bf16_f32 v84, v54, v55
    v_exp_f32 v57, v57
    v_mfma_f32_32x32x16_bf16 v[18:33], v[94:97], v[116:119], v[18:33]
    s_waitcnt lgkmcnt(0)
    ds_read_b128 v[94:97], v122 offset:47104
    v_exp_f32 v58, v58
    v_cvt_pk_bf16_f32 v85, v56, v57
    v_exp_f32 v59, v59
    v_exp_f32 v60, v60
    v_cvt_pk_bf16_f32 v86, v58, v59
    v_exp_f32 v61, v61
    v_mfma_f32_32x32x16_bf16 v[66:81], v[108:111], v[82:85], v[66:81]
    s_mov_b64 exec, s[50:51]
    ds_read_b128 v[104:107], v124 offset:44160
    ds_read_b128 v[108:111], v124 offset:44800
    s_mov_b64 exec, -1
    v_exp_f32 v62, v62
    v_cvt_pk_bf16_f32 v87, v60, v61
    v_exp_f32 v63, v63
    v_exp_f32 v64, v64
    v_exp_f32 v65, v65
    v_cvt_pk_bf16_f32 v88, v62, v63
    v_cvt_pk_bf16_f32 v89, v64, v65
    v_mfma_f32_32x32x4_2b_bf16 v[34:65], v[98:99], v[120:121], 0
    ds_read_b64 v[98:99], v123 offset:53248
    v_exp_f32 v2, v2
    v_exp_f32 v3, v3
    v_exp_f32 v4, v4
    v_cvt_pk_bf16_f32 v82, v2, v3
    v_exp_f32 v5, v5
    v_exp_f32 v6, v6
    v_cvt_pk_bf16_f32 v83, v4, v5
    v_exp_f32 v7, v7
    v_exp_f32 v8, v8
    v_cvt_pk_bf16_f32 v84, v6, v7
    v_exp_f32 v9, v9
    v_exp_f32 v10, v10
    s_setprio 1
    v_mfma_f32_32x32x16_bf16 v[66:81], v[112:115], v[86:89], v[66:81]
    v_cvt_pk_bf16_f32 v85, v8, v9
    v_exp_f32 v11, v11
    v_exp_f32 v12, v12
    v_cvt_pk_bf16_f32 v86, v10, v11
    v_exp_f32 v13, v13
    v_mfma_f32_32x32x16_bf16 v[66:81], v[100:103], v[82:85], v[66:81]
    s_mov_b64 exec, s[50:51]
    ds_read_b128 v[112:115], v124 offset:45440
    ds_read_b128 v[100:103], v124 offset:48640
    s_mov_b64 exec, -1
    v_exp_f32 v14, v14
    v_cvt_pk_bf16_f32 v87, v12, v13
    v_exp_f32 v15, v15
    v_exp_f32 v16, v16
    v_cvt_pk_bf16_f32 v88, v14, v15
    v_exp_f32 v17, v17
    v_mfma_f32_32x32x16_bf16 v[34:49], v[90:93], v[116:119], v[34:49]
    s_waitcnt lgkmcnt(3)
    ds_read_b128 v[90:93], v122 offset:51200
    v_exp_f32 v18, v18
    v_cvt_pk_bf16_f32 v89, v16, v17
    v_exp_f32 v19, v19
    v_exp_f32 v20, v20
    v_cvt_pk_bf16_f32 v82, v18, v19
    v_exp_f32 v21, v21
    v_mfma_f32_32x32x16_bf16 v[66:81], v[104:107], v[86:89], v[66:81]
    v_exp_f32 v22, v22
    v_cvt_pk_bf16_f32 v83, v20, v21
    v_exp_f32 v23, v23
    v_exp_f32 v24, v24
    v_cvt_pk_bf16_f32 v84, v22, v23
    v_exp_f32 v25, v25
    v_mfma_f32_32x32x16_bf16 v[50:65], v[94:97], v[116:119], v[50:65]
    s_waitcnt lgkmcnt(0)
    ds_read_b128 v[94:97], v122 offset:52224
    v_exp_f32 v26, v26
    v_cvt_pk_bf16_f32 v85, v24, v25
    v_exp_f32 v27, v27
    v_exp_f32 v28, v28
    v_cvt_pk_bf16_f32 v86, v26, v27
    v_exp_f32 v29, v29
    v_mfma_f32_32x32x16_bf16 v[66:81], v[108:111], v[82:85], v[66:81]
    s_mov_b64 exec, s[50:51]
    ds_read_b128 v[104:107], v124 offset:49280
    ds_read_b128 v[108:111], v124 offset:49920
    s_mov_b64 exec, -1
    v_exp_f32 v30, v30
    v_cvt_pk_bf16_f32 v87, v28, v29
    v_exp_f32 v31, v31
    v_exp_f32 v32, v32
    v_exp_f32 v33, v33
    v_cvt_pk_bf16_f32 v88, v30, v31
    v_cvt_pk_bf16_f32 v89, v32, v33
    v_mfma_f32_32x32x4_2b_bf16 v[2:33], v[98:99], v[120:121], 0
    ds_read_b64 v[98:99], v123 offset:58368
    v_exp_f32 v34, v34
    v_exp_f32 v35, v35
    v_exp_f32 v36, v36
    v_cvt_pk_bf16_f32 v82, v34, v35
    v_exp_f32 v37, v37
    v_exp_f32 v38, v38
    v_cvt_pk_bf16_f32 v83, v36, v37
    v_exp_f32 v39, v39
    v_exp_f32 v40, v40
    v_cvt_pk_bf16_f32 v84, v38, v39
    v_exp_f32 v41, v41
    v_exp_f32 v42, v42
    v_mfma_f32_32x32x16_bf16 v[66:81], v[112:115], v[86:89], v[66:81]
    v_cvt_pk_bf16_f32 v85, v40, v41
    v_exp_f32 v43, v43
    v_exp_f32 v44, v44
    v_cvt_pk_bf16_f32 v86, v42, v43
    v_exp_f32 v45, v45
    v_mfma_f32_32x32x16_bf16 v[66:81], v[100:103], v[82:85], v[66:81]
    s_mov_b64 exec, s[50:51]
    ds_read_b128 v[112:115], v124 offset:50560
    ds_read_b128 v[100:103], v124 offset:53760
    s_mov_b64 exec, -1
    v_exp_f32 v46, v46
    v_cvt_pk_bf16_f32 v87, v44, v45
    v_exp_f32 v47, v47
    v_exp_f32 v48, v48
    v_cvt_pk_bf16_f32 v88, v46, v47
    v_exp_f32 v49, v49
    v_mfma_f32_32x32x16_bf16 v[2:17], v[90:93], v[116:119], v[2:17]
    s_waitcnt lgkmcnt(3)
    ds_read_b128 v[90:93], v122 offset:56320
    v_exp_f32 v50, v50
    s_setprio 0
    v_cvt_pk_bf16_f32 v89, v48, v49
    v_exp_f32 v51, v51
    v_exp_f32 v52, v52
    v_cvt_pk_bf16_f32 v82, v50, v51
    v_exp_f32 v53, v53
    v_mfma_f32_32x32x16_bf16 v[66:81], v[104:107], v[86:89], v[66:81]
    v_exp_f32 v54, v54
    v_cvt_pk_bf16_f32 v83, v52, v53
    v_exp_f32 v55, v55
    v_exp_f32 v56, v56
    v_cvt_pk_bf16_f32 v84, v54, v55
    v_exp_f32 v57, v57
    v_mfma_f32_32x32x16_bf16 v[18:33], v[94:97], v[116:119], v[18:33]
    s_waitcnt lgkmcnt(0)
    ds_read_b128 v[94:97], v122 offset:57344
    v_exp_f32 v58, v58
    v_cvt_pk_bf16_f32 v85, v56, v57
    v_exp_f32 v59, v59
    v_exp_f32 v60, v60
    v_cvt_pk_bf16_f32 v86, v58, v59
    v_exp_f32 v61, v61
    v_mfma_f32_32x32x16_bf16 v[66:81], v[108:111], v[82:85], v[66:81]
    s_mov_b64 exec, s[50:51]
    ds_read_b128 v[104:107], v124 offset:54400
    ds_read_b128 v[108:111], v124 offset:55040
    s_mov_b64 exec, -1
    v_exp_f32 v62, v62
    v_cvt_pk_bf16_f32 v87, v60, v61
    v_exp_f32 v63, v63
    v_exp_f32 v64, v64
    v_exp_f32 v65, v65
    v_cvt_pk_bf16_f32 v88, v62, v63
    v_cvt_pk_bf16_f32 v89, v64, v65
    s_waitcnt vmcnt(0)
    s_barrier
    s_setprio 3
    v_add_u32 v122, 51200, v122
    v_add_u32 v123, 51200, v123
    v_add_u32 v124, 51200, v124
    s_cmp_eq_u32 s36, 0
    s_cbranch_scc0 k_g9
    s_mul_i32 s54, s2, 256
    s_add_u32 s54, s54, 25870336
    v_mov_b32 v146, s22
    v_mov_b32 v147, s23
    s_mov_b64 exec, 1
    buffer_store_dwordx2 v[146:147], off, s[24:27], s54 offset:0 sc1
    s_mov_b64 exec, -1
k_g9:
    s_cbranch_vccnz k_g10
    buffer_load_dwordx4 v125, s[24:27], s39 offen sc1 lds
    s_add_u32 m0, m0, 4096
    s_add_u32 s39, s39, 4096
    buffer_load_dwordx4 v125, s[24:27], s39 offen sc1 lds
    s_add_u32 m0, m0, 4096
    s_add_u32 s39, s39, 4096
    buffer_load_dwordx4 v125, s[24:27], s39 offen sc1 lds
    s_add_u32 m0, m0, 4096
    s_add_u32 s39, s39, 4096
    buffer_load_dwordx4 v125, s[24:27], s39 offen sc1 lds
    s_add_u32 m0, m0, 4096
    s_add_u32 s39, s39, 4096
    buffer_load_dwordx4 v125, s[24:27], s39 offen sc1 lds
    s_add_u32 m0, m0, 4096
    s_add_u32 s39, s39, 4096
k_g10:
    v_mfma_f32_32x32x4_2b_bf16 v[34:65], v[98:99], v[120:121], 0
    ds_read_b64 v[98:99], v123 offset:12288
    v_exp_f32 v2, v2
    v_exp_f32 v3, v3
    v_exp_f32 v4, v4
    v_cvt_pk_bf16_f32 v82, v2, v3
    v_exp_f32 v5, v5
    v_exp_f32 v6, v6
    v_cvt_pk_bf16_f32 v83, v4, v5
    v_exp_f32 v7, v7
    v_exp_f32 v8, v8
    v_cvt_pk_bf16_f32 v84, v6, v7
    v_exp_f32 v9, v9
    v_exp_f32 v10, v10
    v_mfma_f32_32x32x16_bf16 v[66:81], v[112:115], v[86:89], v[66:81]
    v_cvt_pk_bf16_f32 v85, v8, v9
    v_exp_f32 v11, v11
    v_exp_f32 v12, v12
    v_cvt_pk_bf16_f32 v86, v10, v11
    v_exp_f32 v13, v13
    v_mfma_f32_32x32x16_bf16 v[66:81], v[100:103], v[82:85], v[66:81]
    s_mov_b64 exec, s[50:51]
    ds_read_b128 v[112:115], v124 offset:4480
    ds_read_b128 v[100:103], v124 offset:7680
    s_mov_b64 exec, -1
    v_exp_f32 v14, v14
    v_cvt_pk_bf16_f32 v87, v12, v13
    v_exp_f32 v15, v15
    v_exp_f32 v16, v16
    v_cvt_pk_bf16_f32 v88, v14, v15
    v_exp_f32 v17, v17
    v_mfma_f32_32x32x16_bf16 v[34:49], v[90:93], v[116:119], v[34:49]
    s_waitcnt lgkmcnt(3)
    ds_read_b128 v[90:93], v122 offset:10240
    v_exp_f32 v18, v18
    v_cvt_pk_bf16_f32 v89, v16, v17
    v_exp_f32 v19, v19
    v_exp_f32 v20, v20
    v_cvt_pk_bf16_f32 v82, v18, v19
    v_exp_f32 v21, v21
    v_mfma_f32_32x32x16_bf16 v[66:81], v[104:107], v[86:89], v[66:81]
    v_exp_f32 v22, v22
    v_cvt_pk_bf16_f32 v83, v20, v21
    v_exp_f32 v23, v23
    v_exp_f32 v24, v24
    v_cvt_pk_bf16_f32 v84, v22, v23
    v_exp_f32 v25, v25
    v_mfma_f32_32x32x16_bf16 v[50:65], v[94:97], v[116:119], v[50:65]
    s_waitcnt lgkmcnt(0)
    ds_read_b128 v[94:97], v122 offset:11264
    v_exp_f32 v26, v26
    v_cvt_pk_bf16_f32 v85, v24, v25
    v_exp_f32 v27, v27
    v_exp_f32 v28, v28
    v_cvt_pk_bf16_f32 v86, v26, v27
    v_exp_f32 v29, v29
    v_mfma_f32_32x32x16_bf16 v[66:81], v[108:111], v[82:85], v[66:81]
    s_mov_b64 exec, s[50:51]
    ds_read_b128 v[104:107], v124 offset:8320
    ds_read_b128 v[108:111], v124 offset:8960
    s_mov_b64 exec, -1
    v_exp_f32 v30, v30
    v_cvt_pk_bf16_f32 v87, v28, v29
    v_exp_f32 v31, v31
    v_exp_f32 v32, v32
    v_exp_f32 v33, v33
    v_cvt_pk_bf16_f32 v88, v30, v31
    v_cvt_pk_bf16_f32 v89, v32, v33
    v_mfma_f32_32x32x4_2b_bf16 v[2:33], v[98:99], v[120:121], 0
    ds_read_b64 v[98:99], v123 offset:17408
    buffer_store_dwordx4 v[128:131], v252, s[24:27], s40 offen offset:0 sc1
    v_exp_f32 v34, v34
    v_exp_f32 v35, v35
    v_exp_f32 v36, v36
    v_cvt_pk_bf16_f32 v82, v34, v35
    v_exp_f32 v37, v37
    v_exp_f32 v38, v38
    v_cvt_pk_bf16_f32 v83, v36, v37
    v_exp_f32 v39, v39
    v_exp_f32 v40, v40
    v_cvt_pk_bf16_f32 v84, v38, v39
    v_exp_f32 v41, v41
    v_exp_f32 v42, v42
    v_mfma_f32_32x32x16_bf16 v[66:81], v[112:115], v[86:89], v[66:81]
    v_cvt_pk_bf16_f32 v85, v40, v41
    v_exp_f32 v43, v43
    v_exp_f32 v44, v44
    v_cvt_pk_bf16_f32 v86, v42, v43
    v_exp_f32 v45, v45
    v_mfma_f32_32x32x16_bf16 v[66:81], v[100:103], v[82:85], v[66:81]
    s_mov_b64 exec, s[50:51]
    ds_read_b128 v[112:115], v124 offset:9600
    ds_read_b128 v[100:103], v124 offset:12800
    s_mov_b64 exec, -1
    v_exp_f32 v46, v46
    v_cvt_pk_bf16_f32 v87, v44, v45
    v_exp_f32 v47, v47
    v_exp_f32 v48, v48
    v_cvt_pk_bf16_f32 v88, v46, v47
    v_exp_f32 v49, v49
    v_mfma_f32_32x32x16_bf16 v[2:17], v[90:93], v[116:119], v[2:17]
    s_waitcnt lgkmcnt(3)
    ds_read_b128 v[90:93], v122 offset:15360
    v_exp_f32 v50, v50
    v_cvt_pk_bf16_f32 v89, v48, v49
    v_exp_f32 v51, v51
    v_exp_f32 v52, v52
    v_cvt_pk_bf16_f32 v82, v50, v51
    v_exp_f32 v53, v53
    v_mfma_f32_32x32x16_bf16 v[66:81], v[104:107], v[86:89], v[66:81]
    v_exp_f32 v54, v54
    v_cvt_pk_bf16_f32 v83, v52, v53
    v_exp_f32 v55, v55
    v_exp_f32 v56, v56
    v_cvt_pk_bf16_f32 v84, v54, v55
    v_exp_f32 v57, v57
    v_mfma_f32_32x32x16_bf16 v[18:33], v[94:97], v[116:119], v[18:33]
    s_waitcnt lgkmcnt(0)
    ds_read_b128 v[94:97], v122 offset:16384
    v_exp_f32 v58, v58
    v_cvt_pk_bf16_f32 v85, v56, v57
    v_exp_f32 v59, v59
    v_exp_f32 v60, v60
    v_cvt_pk_bf16_f32 v86, v58, v59
    v_exp_f32 v61, v61
    v_mfma_f32_32x32x16_bf16 v[66:81], v[108:111], v[82:85], v[66:81]
    s_mov_b64 exec, s[50:51]
    ds_read_b128 v[104:107], v124 offset:13440
    ds_read_b128 v[108:111], v124 offset:14080
    s_mov_b64 exec, -1
    v_exp_f32 v62, v62
    v_cvt_pk_bf16_f32 v87, v60, v61
    v_exp_f32 v63, v63
    v_exp_f32 v64, v64
    v_exp_f32 v65, v65
    v_cvt_pk_bf16_f32 v88, v62, v63
    v_cvt_pk_bf16_f32 v89, v64, v65
    s_cbranch_vccz k_g11
    buffer_load_dwordx4 v[132:135], v227, s[32:35], s42 offen
    buffer_load_dwordx4 v[136:139], v227, s[32:35], s42 offen offset:64
    buffer_load_dwordx2 v[140:141], v226, s[32:35], s43 offen
k_g11:
    s_cmp_eq_u32 s36, 4
    s_cbranch_scc0 k_g12
    s_mov_b32 s56, 25870336
    s_mov_b32 s57, 25886720
    s_mov_b32 s58, 25903104
    s_mov_b32 s59, 25919488
    buffer_load_dwordx2 v[212:213], v150, s[24:27], s56 offen sc1
    buffer_load_dwordx2 v[214:215], v150, s[24:27], s57 offen sc1
    buffer_load_dwordx2 v[216:217], v150, s[24:27], s58 offen sc1
    buffer_load_dwordx2 v[218:219], v150, s[24:27], s59 offen sc1
k_g12:
    v_mfma_f32_32x32x4_2b_bf16 v[34:65], v[98:99], v[120:121], 0
    ds_read_b64 v[98:99], v123 offset:22528
    s_mov_b32 exec_hi, 0
    buffer_store_dwordx2 v[128:129], v253, s[24:27], s41 offen sc1
    s_mov_b32 exec_hi, -1
    v_exp_f32 v2, v2
    v_exp_f32 v3, v3
    v_exp_f32 v4, v4
    v_cvt_pk_bf16_f32 v82, v2, v3
    v_exp_f32 v5, v5
    v_exp_f32 v6, v6
    v_cvt_pk_bf16_f32 v83, v4, v5
    v_exp_f32 v7, v7
    v_exp_f32 v8, v8
    v_cvt_pk_bf16_f32 v84, v6, v7
    v_exp_f32 v9, v9
    v_exp_f32 v10, v10
    v_mfma_f32_32x32x16_bf16 v[66:81], v[112:115], v[86:89], v[66:81]
    v_cvt_pk_bf16_f32 v85, v8, v9
    v_exp_f32 v11, v11
    v_exp_f32 v12, v12
    v_cvt_pk_bf16_f32 v86, v10, v11
    v_exp_f32 v13, v13
    v_mfma_f32_32x32x16_bf16 v[66:81], v[100:103], v[82:85], v[66:81]
    s_mov_b64 exec, s[50:51]
    ds_read_b128 v[112:115], v124 offset:14720
    ds_read_b128 v[100:103], v124 offset:17920
    s_mov_b64 exec, -1
    v_exp_f32 v14, v14
    v_cvt_pk_bf16_f32 v87, v12, v13
    v_exp_f32 v15, v15
    v_exp_f32 v16, v16
    v_cvt_pk_bf16_f32 v88, v14, v15
    v_exp_f32 v17, v17
    v_mfma_f32_32x32x16_bf16 v[34:49], v[90:93], v[116:119], v[34:49]
    s_waitcnt lgkmcnt(3)
    ds_read_b128 v[90:93], v122 offset:20480
    v_exp_f32 v18, v18
    v_cvt_pk_bf16_f32 v89, v16, v17
    v_exp_f32 v19, v19
    v_exp_f32 v20, v20
    v_cvt_pk_bf16_f32 v82, v18, v19
    v_exp_f32 v21, v21
    v_mfma_f32_32x32x16_bf16 v[66:81], v[104:107], v[86:89], v[66:81]
    v_exp_f32 v22, v22
    v_cvt_pk_bf16_f32 v83, v20, v21
    v_exp_f32 v23, v23
    v_exp_f32 v24, v24
    v_cvt_pk_bf16_f32 v84, v22, v23
    v_exp_f32 v25, v25
    v_mfma_f32_32x32x16_bf16 v[50:65], v[94:97], v[116:119], v[50:65]
    s_waitcnt lgkmcnt(0)
    ds_read_b128 v[94:97], v122 offset:21504
    v_exp_f32 v26, v26
    v_cvt_pk_bf16_f32 v85, v24, v25
    v_exp_f32 v27, v27
    v_exp_f32 v28, v28
    v_cvt_pk_bf16_f32 v86, v26, v27
    v_exp_f32 v29, v29
    v_mfma_f32_32x32x16_bf16 v[66:81], v[108:111], v[82:85], v[66:81]
    s_mov_b64 exec, s[50:51]
    ds_read_b128 v[104:107], v124 offset:18560
    ds_read_b128 v[108:111], v124 offset:19200
    s_mov_b64 exec, -1
    v_exp_f32 v30, v30
    v_cvt_pk_bf16_f32 v87, v28, v29
    v_exp_f32 v31, v31
    v_exp_f32 v32, v32
    v_exp_f32 v33, v33
    v_cvt_pk_bf16_f32 v88, v30, v31
    v_cvt_pk_bf16_f32 v89, v32, v33
    v_mfma_f32_32x32x4_2b_bf16 v[2:33], v[98:99], v[120:121], 0
    ds_read_b64 v[98:99], v123 offset:27648
    buffer_store_dwordx4 v[128:131], v125, s[24:27], s86 offen offset:0 sc1
    v_exp_f32 v34, v34
    v_exp_f32 v35, v35
    v_exp_f32 v36, v36
    v_cvt_pk_bf16_f32 v82, v34, v35
    v_exp_f32 v37, v37
    v_exp_f32 v38, v38
    v_cvt_pk_bf16_f32 v83, v36, v37
    v_exp_f32 v39, v39
    v_exp_f32 v40, v40
    v_cvt_pk_bf16_f32 v84, v38, v39
    v_exp_f32 v41, v41
    v_exp_f32 v42, v42
    v_mfma_f32_32x32x16_bf16 v[66:81], v[112:115], v[86:89], v[66:81]
    v_cvt_pk_bf16_f32 v85, v40, v41
    v_exp_f32 v43, v43
    v_exp_f32 v44, v44
    v_cvt_pk_bf16_f32 v86, v42, v43
    v_exp_f32 v45, v45
    v_mfma_f32_32x32x16_bf16 v[66:81], v[100:103], v[82:85], v[66:81]
    s_mov_b64 exec, s[50:51]
    ds_read_b128 v[112:115], v124 offset:19840
    ds_read_b128 v[100:103], v124 offset:23040
    s_mov_b64 exec, -1
    v_exp_f32 v46, v46
    v_cvt_pk_bf16_f32 v87, v44, v45
    v_exp_f32 v47, v47
    v_exp_f32 v48, v48
    v_cvt_pk_bf16_f32 v88, v46, v47
    v_exp_f32 v49, v49
    v_mfma_f32_32x32x16_bf16 v[2:17], v[90:93], v[116:119], v[2:17]
    s_waitcnt lgkmcnt(3)
    ds_read_b128 v[90:93], v122 offset:25600
    v_exp_f32 v50, v50
    v_cvt_pk_bf16_f32 v89, v48, v49
    v_exp_f32 v51, v51
    v_exp_f32 v52, v52
    v_cvt_pk_bf16_f32 v82, v50, v51
    v_exp_f32 v53, v53
    v_mfma_f32_32x32x16_bf16 v[66:81], v[104:107], v[86:89], v[66:81]
    v_exp_f32 v54, v54
    v_cvt_pk_bf16_f32 v83, v52, v53
    v_exp_f32 v55, v55
    v_exp_f32 v56, v56
    v_cvt_pk_bf16_f32 v84, v54, v55
    v_exp_f32 v57, v57
    v_mfma_f32_32x32x16_bf16 v[18:33], v[94:97], v[116:119], v[18:33]
    s_waitcnt lgkmcnt(0)
    ds_read_b128 v[94:97], v122 offset:26624
    v_exp_f32 v58, v58
    v_cvt_pk_bf16_f32 v85, v56, v57
    v_exp_f32 v59, v59
    v_exp_f32 v60, v60
    v_cvt_pk_bf16_f32 v86, v58, v59
    v_exp_f32 v61, v61
    v_mfma_f32_32x32x16_bf16 v[66:81], v[108:111], v[82:85], v[66:81]
    s_mov_b64 exec, s[50:51]
    ds_read_b128 v[104:107], v124 offset:23680
    ds_read_b128 v[108:111], v124 offset:24320
    s_mov_b64 exec, -1
    v_exp_f32 v62, v62
    v_cvt_pk_bf16_f32 v87, v60, v61
    v_exp_f32 v63, v63
    v_exp_f32 v64, v64
    v_exp_f32 v65, v65
    v_cvt_pk_bf16_f32 v88, v62, v63
    v_cvt_pk_bf16_f32 v89, v64, v65
    v_mfma_f32_32x32x4_2b_bf16 v[34:65], v[98:99], v[120:121], 0
    ds_read_b64 v[98:99], v123 offset:32768
    s_mov_b64 exec, s[0:1]
    buffer_store_dwordx2 v[128:129], v126, s[24:27], s87 offen sc1
    s_mov_b64 exec, -1
    v_exp_f32 v2, v2
    v_exp_f32 v3, v3
    v_exp_f32 v4, v4
    v_cvt_pk_bf16_f32 v82, v2, v3
    v_exp_f32 v5, v5
    v_exp_f32 v6, v6
    v_cvt_pk_bf16_f32 v83, v4, v5
    v_exp_f32 v7, v7
    v_exp_f32 v8, v8
    v_cvt_pk_bf16_f32 v84, v6, v7
    v_exp_f32 v9, v9
    v_exp_f32 v10, v10
    v_mfma_f32_32x32x16_bf16 v[66:81], v[112:115], v[86:89], v[66:81]
    v_cvt_pk_bf16_f32 v85, v8, v9
    v_exp_f32 v11, v11
    v_exp_f32 v12, v12
    v_cvt_pk_bf16_f32 v86, v10, v11
    v_exp_f32 v13, v13
    v_mfma_f32_32x32x16_bf16 v[66:81], v[100:103], v[82:85], v[66:81]
    s_mov_b64 exec, s[50:51]
    ds_read_b128 v[112:115], v124 offset:24960
    ds_read_b128 v[100:103], v124 offset:28160
    s_mov_b64 exec, -1
    v_exp_f32 v14, v14
    v_cvt_pk_bf16_f32 v87, v12, v13
    v_exp_f32 v15, v15
    v_exp_f32 v16, v16
    v_cvt_pk_bf16_f32 v88, v14, v15
    v_exp_f32 v17, v17
    v_mfma_f32_32x32x16_bf16 v[34:49], v[90:93], v[116:119], v[34:49]
    s_waitcnt lgkmcnt(3)
    ds_read_b128 v[90:93], v122 offset:30720
    v_exp_f32 v18, v18
    v_cvt_pk_bf16_f32 v89, v16, v17
    v_exp_f32 v19, v19
    v_exp_f32 v20, v20
    v_cvt_pk_bf16_f32 v82, v18, v19
    v_exp_f32 v21, v21
    v_mfma_f32_32x32x16_bf16 v[66:81], v[104:107], v[86:89], v[66:81]
    v_exp_f32 v22, v22
    v_cvt_pk_bf16_f32 v83, v20, v21
    v_exp_f32 v23, v23
    v_exp_f32 v24, v24
    v_cvt_pk_bf16_f32 v84, v22, v23
    v_exp_f32 v25, v25
    v_mfma_f32_32x32x16_bf16 v[50:65], v[94:97], v[116:119], v[50:65]
    s_waitcnt lgkmcnt(0)
    ds_read_b128 v[94:97], v122 offset:31744
    v_exp_f32 v26, v26
    v_cvt_pk_bf16_f32 v85, v24, v25
    v_exp_f32 v27, v27
    v_exp_f32 v28, v28
    v_cvt_pk_bf16_f32 v86, v26, v27
    v_exp_f32 v29, v29
    v_mfma_f32_32x32x16_bf16 v[66:81], v[108:111], v[82:85], v[66:81]
k_pad2:
    s_cbranch_execz k_walked3_0
    s_mov_b64 exec, s[50:51]
    ds_read_b128 v[104:107], v124 offset:28800
    ds_read_b128 v[108:111], v124 offset:29440
    s_mov_b64 exec, -1
    v_exp_f32 v30, v30
    v_cvt_pk_bf16_f32 v87, v28, v29
    v_exp_f32 v31, v31
    v_exp_f32 v32, v32
    v_exp_f32 v33, v33
    v_cvt_pk_bf16_f32 v88, v30, v31
    v_cvt_pk_bf16_f32 v89, v32, v33
    s_setprio 2
    v_mfma_f32_32x32x4_2b_bf16 v[2:33], v[98:99], v[120:121], 0
    ds_read_b64 v[98:99], v123 offset:37888
    buffer_store_dwordx4 v[128:131], v125, s[24:27], s52 offen offset:0 sc1
    v_exp_f32 v34, v34
    v_exp_f32 v35, v35
    v_exp_f32 v36, v36
    v_cvt_pk_bf16_f32 v82, v34, v35
    v_exp_f32 v37, v37
    v_exp_f32 v38, v38
    v_cvt_pk_bf16_f32 v83, v36, v37
    v_exp_f32 v39, v39
    v_exp_f32 v40, v40
    v_cvt_pk_bf16_f32 v84, v38, v39
    v_exp_f32 v41, v41
    v_exp_f32 v42, v42
    v_mfma_f32_32x32x16_bf16 v[66:81], v[112:115], v[86:89], v[66:81]
    v_cvt_pk_bf16_f32 v85, v40, v41
    v_exp_f32 v43, v43
    v_exp_f32 v44, v44
    v_cvt_pk_bf16_f32 v86, v42, v43
    v_exp_f32 v45, v45
    v_mfma_f32_32x32x16_bf16 v[66:81], v[100:103], v[82:85], v[66:81]
    s_mov_b64 exec, s[50:51]
    ds_read_b128 v[112:115], v124 offset:30080
    ds_read_b128 v[100:103], v124 offset:33280
    s_mov_b64 exec, -1
    v_exp_f32 v46, v46
    v_cvt_pk_bf16_f32 v87, v44, v45
    v_exp_f32 v47, v47
    v_exp_f32 v48, v48
    v_cvt_pk_bf16_f32 v88, v46, v47
    v_exp_f32 v49, v49
    v_mfma_f32_32x32x16_bf16 v[2:17], v[90:93], v[116:119], v[2:17]
    s_waitcnt lgkmcnt(3)
    ds_read_b128 v[90:93], v122 offset:35840
    v_exp_f32 v50, v50
    v_cvt_pk_bf16_f32 v89, v48, v49
    v_exp_f32 v51, v51
    v_exp_f32 v52, v52
    v_cvt_pk_bf16_f32 v82, v50, v51
    v_exp_f32 v53, v53
    v_mfma_f32_32x32x16_bf16 v[66:81], v[104:107], v[86:89], v[66:81]
    v_exp_f32 v54, v54
    v_cvt_pk_bf16_f32 v83, v52, v53
    v_exp_f32 v55, v55
    v_exp_f32 v56, v56
    v_cvt_pk_bf16_f32 v84, v54, v55
    v_exp_f32 v57, v57
    v_mfma_f32_32x32x16_bf16 v[18:33], v[94:97], v[116:119], v[18:33]
    s_waitcnt lgkmcnt(0)
    ds_read_b128 v[94:97], v122 offset:36864
    v_exp_f32 v58, v58
    v_cvt_pk_bf16_f32 v85, v56, v57
    v_exp_f32 v59, v59
    v_exp_f32 v60, v60
    v_cvt_pk_bf16_f32 v86, v58, v59
    v_exp_f32 v61, v61
    v_mfma_f32_32x32x16_bf16 v[66:81], v[108:111], v[82:85], v[66:81]
    s_mov_b64 exec, s[50:51]
    ds_read_b128 v[104:107], v124 offset:33920
    ds_read_b128 v[108:111], v124 offset:34560
    s_mov_b64 exec, -1
    v_exp_f32 v62, v62
    v_cvt_pk_bf16_f32 v87, v60, v61
    v_exp_f32 v63, v63
    v_exp_f32 v64, v64
    v_exp_f32 v65, v65
    v_cvt_pk_bf16_f32 v88, v62, v63
    v_cvt_pk_bf16_f32 v89, v64, v65
    v_mfma_f32_32x32x4_2b_bf16 v[34:65], v[98:99], v[120:121], 0
    ds_read_b64 v[98:99], v123 offset:43008
    s_add_u32 s52, s52, 8192
    buffer_store_dwordx4 v[128:131], v125, s[24:27], s52 offen offset:0 sc1
    v_exp_f32 v2, v2
    v_exp_f32 v3, v3
    v_exp_f32 v4, v4
    v_cvt_pk_bf16_f32 v82, v2, v3
    v_exp_f32 v5, v5
    v_exp_f32 v6, v6
    v_cvt_pk_bf16_f32 v83, v4, v5
    v_exp_f32 v7, v7
    v_exp_f32 v8, v8
    v_cvt_pk_bf16_f32 v84, v6, v7
    v_exp_f32 v9, v9
    v_exp_f32 v10, v10
    v_mfma_f32_32x32x16_bf16 v[66:81], v[112:115], v[86:89], v[66:81]
    v_cvt_pk_bf16_f32 v85, v8, v9
    v_exp_f32 v11, v11
    v_exp_f32 v12, v12
    v_cvt_pk_bf16_f32 v86, v10, v11
    v_exp_f32 v13, v13
    v_mfma_f32_32x32x16_bf16 v[66:81], v[100:103], v[82:85], v[66:81]
    s_mov_b64 exec, s[50:51]
    ds_read_b128 v[112:115], v124 offset:35200
    ds_read_b128 v[100:103], v124 offset:38400
    s_mov_b64 exec, -1
    v_exp_f32 v14, v14
    v_cvt_pk_bf16_f32 v87, v12, v13
    v_exp_f32 v15, v15
    v_exp_f32 v16, v16
    v_cvt_pk_bf16_f32 v88, v14, v15
    v_exp_f32 v17, v17
    v_mfma_f32_32x32x16_bf16 v[34:49], v[90:93], v[116:119], v[34:49]
    s_waitcnt lgkmcnt(3)
    ds_read_b128 v[90:93], v122 offset:40960
    v_exp_f32 v18, v18
    v_cvt_pk_bf16_f32 v89, v16, v17
    v_exp_f32 v19, v19
    v_exp_f32 v20, v20
    v_cvt_pk_bf16_f32 v82, v18, v19
    v_exp_f32 v21, v21
    v_mfma_f32_32x32x16_bf16 v[66:81], v[104:107], v[86:89], v[66:81]
    v_exp_f32 v22, v22
    v_cvt_pk_bf16_f32 v83, v20, v21
    v_exp_f32 v23, v23
    v_exp_f32 v24, v24
    v_cvt_pk_bf16_f32 v84, v22, v23
    v_exp_f32 v25, v25
    v_mfma_f32_32x32x16_bf16 v[50:65], v[94:97], v[116:119], v[50:65]
    s_waitcnt lgkmcnt(0)
    ds_read_b128 v[94:97], v122 offset:41984
    v_exp_f32 v26, v26
    v_cvt_pk_bf16_f32 v85, v24, v25
    v_exp_f32 v27, v27
    v_exp_f32 v28, v28
    v_cvt_pk_bf16_f32 v86, v26, v27
    v_exp_f32 v29, v29
    v_mfma_f32_32x32x16_bf16 v[66:81], v[108:111], v[82:85], v[66:81]
    s_mov_b64 exec, s[50:51]
    ds_read_b128 v[104:107], v124 offset:39040
    ds_read_b128 v[108:111], v124 offset:39680
    s_mov_b64 exec, -1
    v_exp_f32 v30, v30
    v_cvt_pk_bf16_f32 v87, v28, v29
    v_exp_f32 v31, v31
    v_exp_f32 v32, v32
    v_exp_f32 v33, v33
    v_cvt_pk_bf16_f32 v88, v30, v31
    v_cvt_pk_bf16_f32 v89, v32, v33
    v_mfma_f32_32x32x4_2b_bf16 v[2:33], v[98:99], v[120:121], 0
    ds_read_b64 v[98:99], v123 offset:48128
    s_add_u32 s52, s52, 8192
    buffer_store_dwordx4 v[128:131], v125, s[24:27], s52 offen offset:0 sc1
    v_exp_f32 v34, v34
    v_exp_f32 v35, v35
    v_exp_f32 v36, v36
    v_cvt_pk_bf16_f32 v82, v34, v35
    v_exp_f32 v37, v37
    v_exp_f32 v38, v38
    v_cvt_pk_bf16_f32 v83, v36, v37
    v_exp_f32 v39, v39
    v_exp_f32 v40, v40
    v_cvt_pk_bf16_f32 v84, v38, v39
    v_exp_f32 v41, v41
    v_exp_f32 v42, v42
    v_mfma_f32_32x32x16_bf16 v[66:81], v[112:115], v[86:89], v[66:81]
    v_cvt_pk_bf16_f32 v85, v40, v41
    v_exp_f32 v43, v43
    v_exp_f32 v44, v44
    v_cvt_pk_bf16_f32 v86, v42, v43
    v_exp_f32 v45, v45
    v_mfma_f32_32x32x16_bf16 v[66:81], v[100:103], v[82:85], v[66:81]
    s_mov_b64 exec, s[50:51]
    ds_read_b128 v[112:115], v124 offset:40320
    ds_read_b128 v[100:103], v124 offset:43520
    s_mov_b64 exec, -1
    v_exp_f32 v46, v46
    v_cvt_pk_bf16_f32 v87, v44, v45
    v_exp_f32 v47, v47
    v_exp_f32 v48, v48
    v_cvt_pk_bf16_f32 v88, v46, v47
    v_exp_f32 v49, v49
    v_mfma_f32_32x32x16_bf16 v[2:17], v[90:93], v[116:119], v[2:17]
    s_waitcnt lgkmcnt(3)
    ds_read_b128 v[90:93], v122 offset:46080
    v_exp_f32 v50, v50
    v_cvt_pk_bf16_f32 v89, v48, v49
    v_exp_f32 v51, v51
    v_exp_f32 v52, v52
    v_cvt_pk_bf16_f32 v82, v50, v51
    v_exp_f32 v53, v53
    v_mfma_f32_32x32x16_bf16 v[66:81], v[104:107], v[86:89], v[66:81]
    v_exp_f32 v54, v54
    v_cvt_pk_bf16_f32 v83, v52, v53
    v_exp_f32 v55, v55
    v_exp_f32 v56, v56
    v_cvt_pk_bf16_f32 v84, v54, v55
    v_exp_f32 v57, v57
    v_mfma_f32_32x32x16_bf16 v[18:33], v[94:97], v[116:119], v[18:33]
    s_waitcnt lgkmcnt(0)
    ds_read_b128 v[94:97], v122 offset:47104
    v_exp_f32 v58, v58
    v_cvt_pk_bf16_f32 v85, v56, v57
    v_exp_f32 v59, v59
    v_exp_f32 v60, v60
    v_cvt_pk_bf16_f32 v86, v58, v59
    v_exp_f32 v61, v61
    v_mfma_f32_32x32x16_bf16 v[66:81], v[108:111], v[82:85], v[66:81]
    s_mov_b64 exec, s[50:51]
    ds_read_b128 v[104:107], v124 offset:44160
    ds_read_b128 v[108:111], v124 offset:44800
    s_mov_b64 exec, -1
    v_exp_f32 v62, v62
    v_cvt_pk_bf16_f32 v87, v60, v61
    v_exp_f32 v63, v63
    v_exp_f32 v64, v64
    v_exp_f32 v65, v65
    v_cvt_pk_bf16_f32 v88, v62, v63
    v_cvt_pk_bf16_f32 v89, v64, v65
    s_cmp_eq_u32 s36, 4
    s_cbranch_scc0 k_g13
    s_waitcnt vmcnt(6)
    s_mov_b32 s71, 0
    s_branch k_fp_pc1
k_fp_pc0:
k_fp_pc2:
    buffer_load_dwordx2 v[212:213], v150, s[24:27], s56 offen sc1
    buffer_load_dwordx2 v[214:215], v150, s[24:27], s57 offen sc1
    buffer_load_dwordx2 v[216:217], v150, s[24:27], s58 offen sc1
    buffer_load_dwordx2 v[218:219], v150, s[24:27], s59 offen sc1
    s_waitcnt vmcnt(0)
k_fp_pc1:
    v_cmp_ne_u64 vcc, s[22:23], v[212:213]
    v_cmp_ne_u64 s[74:75], s[22:23], v[214:215]
    s_nop 1
    s_or_b64 vcc, vcc, s[74:75]
    v_cmp_ne_u64 s[74:75], s[22:23], v[216:217]
    s_nop 1
    s_or_b64 vcc, vcc, s[74:75]
    v_cmp_ne_u64 s[74:75], s[22:23], v[218:219]
    s_nop 1
    s_or_b64 vcc, vcc, s[74:75]
    s_add_u32 s71, s71, 1
    s_cmp_gt_u32 s71, 131072
    s_cbranch_scc1 k_fp_pd
    s_cbranch_vccnz k_fp_pc0
k_fp_pd:
    s_mov_b64 vcc, 0
    s_cmp_eq_u32 s2, 0
    s_cbranch_scc0 k_ne
    s_mov_b32 s54, 27049984
    v_mov_b32 v146, s22
    v_mov_b32 v147, s23
    s_mov_b64 exec, 1
    buffer_store_dwordx2 v[146:147], off, s[24:27], s54 offset:0 sc1
    s_mov_b64 exec, -1
k_ne:
k_g13:
    s_setprio 1
    v_mfma_f32_32x32x4_2b_bf16 v[34:65], v[98:99], v[120:121], 0
    ds_read_b64 v[98:99], v123 offset:53248
    buffer_store_dwordx2 v[128:129], v126, s[24:27], s97 offen sc1
    v_exp_f32 v2, v2
    v_exp_f32 v3, v3
    v_exp_f32 v4, v4
    v_cvt_pk_bf16_f32 v82, v2, v3
    v_exp_f32 v5, v5
    v_exp_f32 v6, v6
    v_cvt_pk_bf16_f32 v83, v4, v5
    v_exp_f32 v7, v7
    v_exp_f32 v8, v8
    v_cvt_pk_bf16_f32 v84, v6, v7
    v_exp_f32 v9, v9
    v_exp_f32 v10, v10
    v_mfma_f32_32x32x16_bf16 v[66:81], v[112:115], v[86:89], v[66:81]
    v_cvt_pk_bf16_f32 v85, v8, v9
    v_exp_f32 v11, v11
    v_exp_f32 v12, v12
    v_cvt_pk_bf16_f32 v86, v10, v11
    v_exp_f32 v13, v13
    v_mfma_f32_32x32x16_bf16 v[66:81], v[100:103], v[82:85], v[66:81]
    s_mov_b64 exec, s[50:51]
    ds_read_b128 v[112:115], v124 offset:45440
    ds_read_b128 v[100:103], v124 offset:48640
    s_mov_b64 exec, -1
    v_exp_f32 v14, v14
    v_cvt_pk_bf16_f32 v87, v12, v13
    v_exp_f32 v15, v15
    v_exp_f32 v16, v16
    v_cvt_pk_bf16_f32 v88, v14, v15
    v_exp_f32 v17, v17
    v_mfma_f32_32x32x16_bf16 v[34:49], v[90:93], v[116:119], v[34:49]
    s_waitcnt lgkmcnt(3)
    ds_read_b128 v[90:93], v122 offset:51200
    v_exp_f32 v18, v18
    v_cvt_pk_bf16_f32 v89, v16, v17
    v_exp_f32 v19, v19
    v_exp_f32 v20, v20
    v_cvt_pk_bf16_f32 v82, v18, v19
    v_exp_f32 v21, v21
    v_mfma_f32_32x32x16_bf16 v[66:81], v[104:107], v[86:89], v[66:81]
    v_exp_f32 v22, v22
    v_cvt_pk_bf16_f32 v83, v20, v21
    v_exp_f32 v23, v23
    v_exp_f32 v24, v24
    v_cvt_pk_bf16_f32 v84, v22, v23
    v_exp_f32 v25, v25
    v_mfma_f32_32x32x16_bf16 v[50:65], v[94:97], v[116:119], v[50:65]
    s_waitcnt lgkmcnt(0)
    ds_read_b128 v[94:97], v122 offset:52224
    v_exp_f32 v26, v26
    v_cvt_pk_bf16_f32 v85, v24, v25
    v_exp_f32 v27, v27
    v_exp_f32 v28, v28
    v_cvt_pk_bf16_f32 v86, v26, v27
    v_exp_f32 v29, v29
    v_mfma_f32_32x32x16_bf16 v[66:81], v[108:111], v[82:85], v[66:81]
    s_mov_b64 exec, s[50:51]
    ds_read_b128 v[104:107], v124 offset:49280
    ds_read_b128 v[108:111], v124 offset:49920
    s_mov_b64 exec, -1
    v_exp_f32 v30, v30
    v_cvt_pk_bf16_f32 v87, v28, v29
    v_exp_f32 v31, v31
    v_exp_f32 v32, v32
    v_exp_f32 v33, v33
    v_cvt_pk_bf16_f32 v88, v30, v31
    v_cvt_pk_bf16_f32 v89, v32, v33
    v_mfma_f32_32x32x4_2b_bf16 v[2:33], v[98:99], v[120:121], 0
    ds_read_b64 v[98:99], v123 offset:58368
    v_exp_f32 v34, v34
    v_exp_f32 v35, v35
    v_exp_f32 v36, v36
    v_cvt_pk_bf16_f32 v82, v34, v35
    v_exp_f32 v37, v37
    v_exp_f32 v38, v38
    v_cvt_pk_bf16_f32 v83, v36, v37
    v_exp_f32 v39, v39
    v_exp_f32 v40, v40
    v_cvt_pk_bf16_f32 v84, v38, v39
    v_exp_f32 v41, v41
    v_exp_f32 v42, v42
    v_mfma_f32_32x32x16_bf16 v[66:81], v[112:115], v[86:89], v[66:81]
    v_cvt_pk_bf16_f32 v85, v40, v41
    v_exp_f32 v43, v43
    v_exp_f32 v44, v44
    v_cvt_pk_bf16_f32 v86, v42, v43
    v_exp_f32 v45, v45
    v_mfma_f32_32x32x16_bf16 v[66:81], v[100:103], v[82:85], v[66:81]
    s_mov_b64 exec, s[50:51]
    ds_read_b128 v[112:115], v124 offset:50560
    ds_read_b128 v[100:103], v124 offset:53760
    s_mov_b64 exec, -1
    v_exp_f32 v46, v46
    v_cvt_pk_bf16_f32 v87, v44, v45
    v_exp_f32 v47, v47
    v_exp_f32 v48, v48
    v_cvt_pk_bf16_f32 v88, v46, v47
    v_exp_f32 v49, v49
    v_mfma_f32_32x32x16_bf16 v[2:17], v[90:93], v[116:119], v[2:17]
    s_waitcnt lgkmcnt(3)
    ds_read_b128 v[90:93], v122 offset:56320
    v_exp_f32 v50, v50
    s_setprio 0
    v_cvt_pk_bf16_f32 v89, v48, v49
    v_exp_f32 v51, v51
    v_exp_f32 v52, v52
    v_cvt_pk_bf16_f32 v82, v50, v51
    v_exp_f32 v53, v53
    v_mfma_f32_32x32x16_bf16 v[66:81], v[104:107], v[86:89], v[66:81]
    v_exp_f32 v54, v54
    v_cvt_pk_bf16_f32 v83, v52, v53
    v_exp_f32 v55, v55
    v_exp_f32 v56, v56
    v_cvt_pk_bf16_f32 v84, v54, v55
    v_exp_f32 v57, v57
    v_mfma_f32_32x32x16_bf16 v[18:33], v[94:97], v[116:119], v[18:33]
    s_waitcnt lgkmcnt(0)
    ds_read_b128 v[94:97], v122 offset:57344
    v_exp_f32 v58, v58
    v_cvt_pk_bf16_f32 v85, v56, v57
    v_exp_f32 v59, v59
    v_exp_f32 v60, v60
    v_cvt_pk_bf16_f32 v86, v58, v59
    v_exp_f32 v61, v61
    v_mfma_f32_32x32x16_bf16 v[66:81], v[108:111], v[82:85], v[66:81]
    s_mov_b64 exec, s[50:51]
    ds_read_b128 v[104:107], v124 offset:54400
    ds_read_b128 v[108:111], v124 offset:55040
    s_mov_b64 exec, -1
    v_exp_f32 v62, v62
    v_cvt_pk_bf16_f32 v87, v60, v61
    v_exp_f32 v63, v63
    v_exp_f32 v64, v64
    v_exp_f32 v65, v65
    v_cvt_pk_bf16_f32 v88, v62, v63
    v_cvt_pk_bf16_f32 v89, v64, v65
    s_waitcnt vmcnt(8)
    s_barrier
    s_setprio 3
    s_lshl_b32 s53, s36, 10
    s_mov_b32 m0, s53
    s_mul_i32 s39, s61, 102400
    s_add_u32 s39, s39, s53
    s_add_u32 s39, s39, 20316160
    v_mfma_f32_32x32x4_2b_bf16 v[34:65], v[98:99], v[120:121], 0
    ds_read_b64 v[98:99], v123 offset:63488
    buffer_load_dwordx4 v[152:155], v125, s[24:27], s46 offen sc1
    s_add_u32 s46, s46, s47
    v_exp_f32 v2, v2
    v_exp_f32 v3, v3
    v_exp_f32 v4, v4
    v_cvt_pk_bf16_f32 v82, v2, v3
    v_exp_f32 v5, v5
    v_exp_f32 v6, v6
    v_cvt_pk_bf16_f32 v83, v4, v5
    v_exp_f32 v7, v7
    v_exp_f32 v8, v8
    v_cvt_pk_bf16_f32 v84, v6, v7
    v_exp_f32 v9, v9
    v_exp_f32 v10, v10
    v_mfma_f32_32x32x16_bf16 v[66:81], v[112:115], v[86:89], v[66:81]
    buffer_load_dwordx4 v125, s[24:27], s39 offen sc1 lds
    s_add_u32 m0, m0, 8192
    s_add_u32 s39, s39, 8192
    v_cvt_pk_bf16_f32 v85, v8, v9
    v_exp_f32 v11, v11
    v_exp_f32 v12, v12
    v_cvt_pk_bf16_f32 v86, v10, v11
    v_exp_f32 v13, v13
    v_mfma_f32_32x32x16_bf16 v[66:81], v[100:103], v[82:85], v[66:81]
    s_mov_b64 exec, s[50:51]
    ds_read_b128 v[112:115], v124 offset:55680
    ds_read_b128 v[100:103], v124 offset:58880
    s_mov_b64 exec, -1
    buffer_load_dwordx4 v[156:159], v125, s[24:27], s46 offen sc1
    s_add_u32 s46, s46, s47
    v_exp_f32 v14, v14
    v_cvt_pk_bf16_f32 v87, v12, v13
    v_exp_f32 v15, v15
    v_exp_f32 v16, v16
    v_cvt_pk_bf16_f32 v88, v14, v15
    v_exp_f32 v17, v17
    v_mfma_f32_32x32x16_bf16 v[34:49], v[90:93], v[116:119], v[34:49]
    s_waitcnt lgkmcnt(3)
    ds_read_b128 v[90:93], v122 offset:61440
    buffer_load_dwordx4 v[160:163], v125, s[24:27], s46 offen sc1
    s_add_u32 s46, s46, s47
    v_exp_f32 v18, v18
    v_cvt_pk_bf16_f32 v89, v16, v17
    v_exp_f32 v19, v19
    v_exp_f32 v20, v20
    v_cvt_pk_bf16_f32 v82, v18, v19
    v_exp_f32 v21, v21
    v_mfma_f32_32x32x16_bf16 v[66:81], v[104:107], v[86:89], v[66:81]
    v_exp_f32 v22, v22
    v_cvt_pk_bf16_f32 v83, v20, v21
    v_exp_f32 v23, v23
    v_exp_f32 v24, v24
    v_cvt_pk_bf16_f32 v84, v22, v23
    v_exp_f32 v25, v25
    v_mfma_f32_32x32x16_bf16 v[50:65], v[94:97], v[116:119], v[50:65]
    s_waitcnt lgkmcnt(0)
    ds_read_b128 v[94:97], v122 offset:62464
    v_exp_f32 v26, v26
    v_cvt_pk_bf16_f32 v85, v24, v25
    v_exp_f32 v27, v27
    v_exp_f32 v28, v28
    v_cvt_pk_bf16_f32 v86, v26, v27
    v_exp_f32 v29, v29
    v_mfma_f32_32x32x16_bf16 v[66:81], v[108:111], v[82:85], v[66:81]
    s_mov_b64 exec, s[50:51]
    ds_read_b128 v[104:107], v124 offset:59520
    ds_read_b128 v[108:111], v124 offset:60160
    s_mov_b64 exec, -1
    v_exp_f32 v30, v30
    v_cvt_pk_bf16_f32 v87, v28, v29
    v_exp_f32 v31, v31
    v_exp_f32 v32, v32
    v_exp_f32 v33, v33
    v_cvt_pk_bf16_f32 v88, v30, v31
    v_cvt_pk_bf16_f32 v89, v32, v33
    v_add_u32 v122, 56320, v122
    v_add_u32 v123, 56320, v123
    v_add_u32 v124, 56320, v124
    v_mfma_f32_32x32x4_2b_bf16 v[2:33], v[98:99], v[120:121], 0
    ds_read_b64 v[98:99], v123 offset:12288
    buffer_load_dwordx4 v125, s[24:27], s39 offen sc1 lds
    s_add_u32 m0, m0, 8192
    s_add_u32 s39, s39, 8192
    v_exp_f32 v34, v34
    v_exp_f32 v35, v35
    v_exp_f32 v36, v36
    v_cvt_pk_bf16_f32 v82, v34, v35
    v_exp_f32 v37, v37
    v_exp_f32 v38, v38
    v_cvt_pk_bf16_f32 v83, v36, v37
    v_exp_f32 v39, v39
    v_exp_f32 v40, v40
    v_cvt_pk_bf16_f32 v84, v38, v39
    v_exp_f32 v41, v41
    v_exp_f32 v42, v42
    v_mfma_f32_32x32x16_bf16 v[66:81], v[112:115], v[86:89], v[66:81]
    buffer_load_dwordx4 v[164:167], v125, s[24:27], s46 offen sc1
    s_add_u32 s46, s46, s47
    v_cvt_pk_bf16_f32 v85, v40, v41
    v_exp_f32 v43, v43
    v_exp_f32 v44, v44
    v_cvt_pk_bf16_f32 v86, v42, v43
    v_exp_f32 v45, v45
    v_mfma_f32_32x32x16_bf16 v[66:81], v[100:103], v[82:85], v[66:81]
    s_mov_b64 exec, s[50:51]
    ds_read_b128 v[112:115], v124 offset:4480
    ds_read_b128 v[100:103], v124 offset:7680
    s_mov_b64 exec, -1
    buffer_load_dwordx4 v[168:171], v125, s[24:27], s46 offen sc1
    s_add_u32 s46, s46, s47
    v_exp_f32 v46, v46
    v_cvt_pk_bf16_f32 v87, v44, v45
    v_exp_f32 v47, v47
    v_exp_f32 v48, v48
    v_cvt_pk_bf16_f32 v88, v46, v47
    v_exp_f32 v49, v49
    v_mfma_f32_32x32x16_bf16 v[2:17], v[90:93], v[116:119], v[2:17]
    s_waitcnt lgkmcnt(3)
    ds_read_b128 v[90:93], v122 offset:10240
    buffer_load_dwordx4 v125, s[24:27], s39 offen sc1 lds
    s_add_u32 m0, m0, 8192
    s_add_u32 s39, s39, 8192
    v_exp_f32 v50, v50
    v_cvt_pk_bf16_f32 v89, v48, v49
    v_exp_f32 v51, v51
    v_exp_f32 v52, v52
    v_cvt_pk_bf16_f32 v82, v50, v51
    v_exp_f32 v53, v53
    v_mfma_f32_32x32x16_bf16 v[66:81], v[104:107], v[86:89], v[66:81]
    v_exp_f32 v54, v54
    v_cvt_pk_bf16_f32 v83, v52, v53
    v_exp_f32 v55, v55
    v_exp_f32 v56, v56
    v_cvt_pk_bf16_f32 v84, v54, v55
    v_exp_f32 v57, v57
    v_mfma_f32_32x32x16_bf16 v[18:33], v[94:97], v[116:119], v[18:33]
    s_waitcnt lgkmcnt(0)
    ds_read_b128 v[94:97], v122 offset:11264
    v_exp_f32 v58, v58
    v_cvt_pk_bf16_f32 v85, v56, v57
    v_exp_f32 v59, v59
    v_exp_f32 v60, v60
    v_cvt_pk_bf16_f32 v86, v58, v59
    v_exp_f32 v61, v61
    v_mfma_f32_32x32x16_bf16 v[66:81], v[108:111], v[82:85], v[66:81]
    s_mov_b64 exec, s[50:51]
    ds_read_b128 v[104:107], v124 offset:8320
    ds_read_b128 v[108:111], v124 offset:8960
    s_mov_b64 exec, -1
    v_exp_f32 v62, v62
    v_cvt_pk_bf16_f32 v87, v60, v61
    v_exp_f32 v63, v63
    v_exp_f32 v64, v64
    v_exp_f32 v65, v65
    v_cvt_pk_bf16_f32 v88, v62, v63
    v_cvt_pk_bf16_f32 v89, v64, v65
    v_mfma_f32_32x32x4_2b_bf16 v[34:65], v[98:99], v[120:121], 0
    ds_read_b64 v[98:99], v123 offset:17408
    buffer_load_dwordx4 v[172:175], v125, s[24:27], s46 offen sc1
    s_add_u32 s46, s46, s47
    v_exp_f32 v2, v2
    v_exp_f32 v3, v3
    v_exp_f32 v4, v4
    v_cvt_pk_bf16_f32 v82, v2, v3
    v_exp_f32 v5, v5
    v_exp_f32 v6, v6
    v_cvt_pk_bf16_f32 v83, v4, v5
    v_exp_f32 v7, v7
    v_exp_f32 v8, v8
    v_cvt_pk_bf16_f32 v84, v6, v7
    v_exp_f32 v9, v9
    v_exp_f32 v10, v10
    v_mfma_f32_32x32x16_bf16 v[66:81], v[112:115], v[86:89], v[66:81]
    buffer_load_dwordx4 v[176:179], v125, s[24:27], s46 offen sc1
    s_add_u32 s46, s46, s47
    v_cvt_pk_bf16_f32 v85, v8, v9
    v_exp_f32 v11, v11
    v_exp_f32 v12, v12
    v_cvt_pk_bf16_f32 v86, v10, v11
    v_exp_f32 v13, v13
    v_mfma_f32_32x32x16_bf16 v[66:81], v[100:103], v[82:85], v[66:81]
    s_mov_b64 exec, s[50:51]
    ds_read_b128 v[112:115], v124 offset:9600
    ds_read_b128 v[100:103], v124 offset:12800
    s_mov_b64 exec, -1
    buffer_load_dwordx4 v125, s[24:27], s39 offen sc1 lds
    s_add_u32 m0, m0, 8192
    s_add_u32 s39, s39, 8192
    v_exp_f32 v14, v14
    v_cvt_pk_bf16_f32 v87, v12, v13
    v_exp_f32 v15, v15
    v_exp_f32 v16, v16
    v_cvt_pk_bf16_f32 v88, v14, v15
    v_exp_f32 v17, v17
    v_mfma_f32_32x32x16_bf16 v[34:49], v[90:93], v[116:119], v[34:49]
    s_waitcnt lgkmcnt(3)
    ds_read_b128 v[90:93], v122 offset:15360
    buffer_load_dwordx4 v[180:183], v125, s[24:27], s46 offen sc1
    s_add_u32 s46, s46, s47
    v_exp_f32 v18, v18
    v_cvt_pk_bf16_f32 v89, v16, v17
    v_exp_f32 v19, v19
    v_exp_f32 v20, v20
    v_cvt_pk_bf16_f32 v82, v18, v19
    v_exp_f32 v21, v21
    v_mfma_f32_32x32x16_bf16 v[66:81], v[104:107], v[86:89], v[66:81]
    v_exp_f32 v22, v22
    v_cvt_pk_bf16_f32 v83, v20, v21
    v_exp_f32 v23, v23
    v_exp_f32 v24, v24
    v_cvt_pk_bf16_f32 v84, v22, v23
    v_exp_f32 v25, v25
    v_mfma_f32_32x32x16_bf16 v[50:65], v[94:97], v[116:119], v[50:65]
    s_waitcnt lgkmcnt(0)
    ds_read_b128 v[94:97], v122 offset:16384
    v_exp_f32 v26, v26
    v_cvt_pk_bf16_f32 v85, v24, v25
    v_exp_f32 v27, v27
    v_exp_f32 v28, v28
    v_cvt_pk_bf16_f32 v86, v26, v27
    v_exp_f32 v29, v29
    v_mfma_f32_32x32x16_bf16 v[66:81], v[108:111], v[82:85], v[66:81]
    s_mov_b64 exec, s[50:51]
    ds_read_b128 v[104:107], v124 offset:13440
    ds_read_b128 v[108:111], v124 offset:14080
    s_mov_b64 exec, -1
    v_exp_f32 v30, v30
    v_cvt_pk_bf16_f32 v87, v28, v29
    v_exp_f32 v31, v31
    v_exp_f32 v32, v32
    v_exp_f32 v33, v33
    v_cvt_pk_bf16_f32 v88, v30, v31
    v_cvt_pk_bf16_f32 v89, v32, v33
    v_mfma_f32_32x32x4_2b_bf16 v[2:33], v[98:99], v[120:121], 0
    ds_read_b64 v[98:99], v123 offset:22528
    buffer_load_dwordx4 v[184:187], v125, s[24:27], s46 offen sc1
    s_add_u32 s46, s46, s47
    v_exp_f32 v34, v34
    v_exp_f32 v35, v35
    v_exp_f32 v36, v36
    v_cvt_pk_bf16_f32 v82, v34, v35
    v_exp_f32 v37, v37
    v_exp_f32 v38, v38
    v_cvt_pk_bf16_f32 v83, v36, v37
    v_exp_f32 v39, v39
    v_exp_f32 v40, v40
    v_cvt_pk_bf16_f32 v84, v38, v39
    v_exp_f32 v41, v41
    v_exp_f32 v42, v42
    v_mfma_f32_32x32x16_bf16 v[66:81], v[112:115], v[86:89], v[66:81]
    buffer_load_dwordx4 v125, s[24:27], s39 offen sc1 lds
    s_add_u32 m0, m0, 8192
    s_add_u32 s39, s39, 8192
    v_cvt_pk_bf16_f32 v85, v40, v41
    v_exp_f32 v43, v43
    v_exp_f32 v44, v44
    v_cvt_pk_bf16_f32 v86, v42, v43
    v_exp_f32 v45, v45
    v_mfma_f32_32x32x16_bf16 v[66:81], v[100:103], v[82:85], v[66:81]
    s_mov_b64 exec, s[50:51]
    ds_read_b128 v[112:115], v124 offset:14720
    ds_read_b128 v[100:103], v124 offset:17920
    s_mov_b64 exec, -1
    buffer_load_dwordx4 v[188:191], v125, s[24:27], s46 offen sc1
    s_add_u32 s46, s46, s47
    v_exp_f32 v46, v46
    v_cvt_pk_bf16_f32 v87, v44, v45
    v_exp_f32 v47, v47
    v_exp_f32 v48, v48
    v_cvt_pk_bf16_f32 v88, v46, v47
    v_exp_f32 v49, v49
    v_mfma_f32_32x32x16_bf16 v[2:17], v[90:93], v[116:119], v[2:17]
    s_waitcnt lgkmcnt(3)
    ds_read_b128 v[90:93], v122 offset:20480
    s_add_u32 s53, s85, 0
    s_cmp_lt_u32 s36, 4
    s_cselect_b32 s46, s46, s53
    s_cselect_b32 s47, s47, 1024
    buffer_load_dwordx4 v[192:195], v125, s[24:27], s46 offen sc1
    s_add_u32 s46, s46, s47
    v_exp_f32 v50, v50
    v_cvt_pk_bf16_f32 v89, v48, v49
    v_exp_f32 v51, v51
    v_exp_f32 v52, v52
    v_cvt_pk_bf16_f32 v82, v50, v51
    v_exp_f32 v53, v53
    v_mfma_f32_32x32x16_bf16 v[66:81], v[104:107], v[86:89], v[66:81]
    v_exp_f32 v54, v54
    v_cvt_pk_bf16_f32 v83, v52, v53
    v_exp_f32 v55, v55
    v_exp_f32 v56, v56
    v_cvt_pk_bf16_f32 v84, v54, v55
    v_exp_f32 v57, v57
    v_mfma_f32_32x32x16_bf16 v[18:33], v[94:97], v[116:119], v[18:33]
    s_waitcnt lgkmcnt(0)
    ds_read_b128 v[94:97], v122 offset:21504
    v_exp_f32 v58, v58
    v_cvt_pk_bf16_f32 v85, v56, v57
    v_exp_f32 v59, v59
    v_exp_f32 v60, v60
    v_cvt_pk_bf16_f32 v86, v58, v59
    v_exp_f32 v61, v61
    v_mfma_f32_32x32x16_bf16 v[66:81], v[108:111], v[82:85], v[66:81]
k_pad3:
    s_cbranch_execz k_walked3_0
    s_mov_b64 exec, s[50:51]
    ds_read_b128 v[104:107], v124 offset:18560
    ds_read_b128 v[108:111], v124 offset:19200
    s_mov_b64 exec, -1
    v_exp_f32 v62, v62
    v_cvt_pk_bf16_f32 v87, v60, v61
    v_exp_f32 v63, v63
    v_exp_f32 v64, v64
    v_exp_f32 v65, v65
    v_cvt_pk_bf16_f32 v88, v62, v63
    v_cvt_pk_bf16_f32 v89, v64, v65
    s_setprio 2
    v_mfma_f32_32x32x4_2b_bf16 v[34:65], v[98:99], v[120:121], 0
    ds_read_b64 v[98:99], v123 offset:27648
    buffer_load_dwordx4 v125, s[24:27], s39 offen sc1 lds
    s_add_u32 m0, m0, 8192
    s_add_u32 s39, s39, 8192
    v_exp_f32 v2, v2
    v_exp_f32 v3, v3
    v_exp_f32 v4, v4
    v_cvt_pk_bf16_f32 v82, v2, v3
    v_exp_f32 v5, v5
    v_exp_f32 v6, v6
    v_cvt_pk_bf16_f32 v83, v4, v5
    v_exp_f32 v7, v7
    v_exp_f32 v8, v8
    v_cvt_pk_bf16_f32 v84, v6, v7
    v_exp_f32 v9, v9
    v_exp_f32 v10, v10
    v_mfma_f32_32x32x16_bf16 v[66:81], v[112:115], v[86:89], v[66:81]
    buffer_load_dwordx4 v[196:199], v125, s[24:27], s46 offen sc1
    s_add_u32 s46, s46, s47
    v_cvt_pk_bf16_f32 v85, v8, v9
    v_exp_f32 v11, v11
    v_exp_f32 v12, v12
    v_cvt_pk_bf16_f32 v86, v10, v11
    v_exp_f32 v13, v13
    v_mfma_f32_32x32x16_bf16 v[66:81], v[100:103], v[82:85], v[66:81]
    s_mov_b64 exec, s[50:51]
    ds_read_b128 v[112:115], v124 offset:19840
    ds_read_b128 v[100:103], v124 offset:23040
    s_mov_b64 exec, -1
    buffer_load_dwordx4 v[200:203], v125, s[24:27], s46 offen sc1
    s_add_u32 s46, s46, s47
    v_exp_f32 v14, v14
    v_cvt_pk_bf16_f32 v87, v12, v13
    v_exp_f32 v15, v15
    v_exp_f32 v16, v16
    v_cvt_pk_bf16_f32 v88, v14, v15
    v_exp_f32 v17, v17
    v_mfma_f32_32x32x16_bf16 v[34:49], v[90:93], v[116:119], v[34:49]
    s_waitcnt lgkmcnt(3)
    ds_read_b128 v[90:93], v122 offset:25600
    buffer_load_dwordx4 v125, s[24:27], s39 offen sc1 lds
    s_add_u32 m0, m0, 8192
    s_add_u32 s39, s39, 8192
    v_exp_f32 v18, v18
    v_cvt_pk_bf16_f32 v89, v16, v17
    v_exp_f32 v19, v19
    v_exp_f32 v20, v20
    v_cvt_pk_bf16_f32 v82, v18, v19
    v_exp_f32 v21, v21
    v_mfma_f32_32x32x16_bf16 v[66:81], v[104:107], v[86:89], v[66:81]
    v_exp_f32 v22, v22
    v_cvt_pk_bf16_f32 v83, v20, v21
    v_exp_f32 v23, v23
    v_exp_f32 v24, v24
    v_cvt_pk_bf16_f32 v84, v22, v23
    v_exp_f32 v25, v25
    v_mfma_f32_32x32x16_bf16 v[50:65], v[94:97], v[116:119], v[50:65]
    s_waitcnt lgkmcnt(0)
    ds_read_b128 v[94:97], v122 offset:26624
    v_exp_f32 v26, v26
    v_cvt_pk_bf16_f32 v85, v24, v25
    v_exp_f32 v27, v27
    v_exp_f32 v28, v28
    v_cvt_pk_bf16_f32 v86, v26, v27
    v_exp_f32 v29, v29
    v_mfma_f32_32x32x16_bf16 v[66:81], v[108:111], v[82:85], v[66:81]
    s_mov_b64 exec, s[50:51]
    ds_read_b128 v[104:107], v124 offset:23680
    ds_read_b128 v[108:111], v124 offset:24320
    s_mov_b64 exec, -1
    v_exp_f32 v30, v30
    v_cvt_pk_bf16_f32 v87, v28, v29
    v_exp_f32 v31, v31
    v_exp_f32 v32, v32
    v_exp_f32 v33, v33
    v_cvt_pk_bf16_f32 v88, v30, v31
    v_cvt_pk_bf16_f32 v89, v32, v33
    v_mfma_f32_32x32x4_2b_bf16 v[2:33], v[98:99], v[120:121], 0
    ds_read_b64 v[98:99], v123 offset:32768
    buffer_load_dwordx4 v[204:207], v125, s[24:27], s46 offen sc1
    s_add_u32 s46, s46, s47
    v_exp_f32 v34, v34
    v_exp_f32 v35, v35
    v_exp_f32 v36, v36
    v_cvt_pk_bf16_f32 v82, v34, v35
    v_exp_f32 v37, v37
    v_exp_f32 v38, v38
    v_cvt_pk_bf16_f32 v83, v36, v37
    v_exp_f32 v39, v39
    v_exp_f32 v40, v40
    v_cvt_pk_bf16_f32 v84, v38, v39
    v_exp_f32 v41, v41
    v_exp_f32 v42, v42
    v_mfma_f32_32x32x16_bf16 v[66:81], v[112:115], v[86:89], v[66:81]
    buffer_load_dwordx4 v[208:211], v125, s[24:27], s46 offen sc1
    s_add_u32 s46, s46, s47
    v_cvt_pk_bf16_f32 v85, v40, v41
    v_exp_f32 v43, v43
    v_exp_f32 v44, v44
    v_cvt_pk_bf16_f32 v86, v42, v43
    v_exp_f32 v45, v45
    v_mfma_f32_32x32x16_bf16 v[66:81], v[100:103], v[82:85], v[66:81]
    s_mov_b64 exec, s[50:51]
    ds_read_b128 v[112:115], v124 offset:24960
    ds_read_b128 v[100:103], v124 offset:28160
    s_mov_b64 exec, -1
    buffer_load_dwordx4 v125, s[24:27], s39 offen sc1 lds
    s_add_u32 m0, m0, 8192
    s_add_u32 s39, s39, 8192
    v_exp_f32 v46, v46
    v_cvt_pk_bf16_f32 v87, v44, v45
    v_exp_f32 v47, v47
    v_exp_f32 v48, v48
    v_cvt_pk_bf16_f32 v88, v46, v47
    v_exp_f32 v49, v49
    v_mfma_f32_32x32x16_bf16 v[2:17], v[90:93], v[116:119], v[2:17]
    s_waitcnt lgkmcnt(3)
    ds_read_b128 v[90:93], v122 offset:30720
    s_add_u32 s53, s85, 112640
    s_cmp_lt_u32 s36, 4
    s_cselect_b32 s46, s46, s53
    s_cselect_b32 s47, s47, 1024
    buffer_load_dwordx4 v[212:215], v125, s[24:27], s46 offen sc1
    s_add_u32 s46, s46, s47
    v_exp_f32 v50, v50
    v_cvt_pk_bf16_f32 v89, v48, v49
    v_exp_f32 v51, v51
    v_exp_f32 v52, v52
    v_cvt_pk_bf16_f32 v82, v50, v51
    v_exp_f32 v53, v53
    v_mfma_f32_32x32x16_bf16 v[66:81], v[104:107], v[86:89], v[66:81]
    v_exp_f32 v54, v54
    v_cvt_pk_bf16_f32 v83, v52, v53
    v_exp_f32 v55, v55
    v_exp_f32 v56, v56
    v_cvt_pk_bf16_f32 v84, v54, v55
    v_exp_f32 v57, v57
    v_mfma_f32_32x32x16_bf16 v[18:33], v[94:97], v[116:119], v[18:33]
    s_waitcnt lgkmcnt(0)
    ds_read_b128 v[94:97], v122 offset:31744
    v_exp_f32 v58, v58
    v_cvt_pk_bf16_f32 v85, v56, v57
    v_exp_f32 v59, v59
    v_exp_f32 v60, v60
    v_cvt_pk_bf16_f32 v86, v58, v59
    v_exp_f32 v61, v61
    v_mfma_f32_32x32x16_bf16 v[66:81], v[108:111], v[82:85], v[66:81]
    s_mov_b64 exec, s[50:51]
    ds_read_b128 v[104:107], v124 offset:28800
    ds_read_b128 v[108:111], v124 offset:29440
    s_mov_b64 exec, -1
    v_exp_f32 v62, v62
    v_cvt_pk_bf16_f32 v87, v60, v61
    v_exp_f32 v63, v63
    v_exp_f32 v64, v64
    v_exp_f32 v65, v65
    v_cvt_pk_bf16_f32 v88, v62, v63
    v_cvt_pk_bf16_f32 v89, v64, v65
    v_mfma_f32_32x32x4_2b_bf16 v[34:65], v[98:99], v[120:121], 0
    ds_read_b64 v[98:99], v123 offset:37888
    buffer_load_dwordx4 v[216:219], v125, s[24:27], s46 offen sc1
    s_add_u32 s46, s46, s47
    v_exp_f32 v2, v2
    v_exp_f32 v3, v3
    v_exp_f32 v4, v4
    v_cvt_pk_bf16_f32 v82, v2, v3
    v_exp_f32 v5, v5
    v_exp_f32 v6, v6
    v_cvt_pk_bf16_f32 v83, v4, v5
    v_exp_f32 v7, v7
    v_exp_f32 v8, v8
    v_cvt_pk_bf16_f32 v84, v6, v7
    v_exp_f32 v9, v9
    v_exp_f32 v10, v10
    v_mfma_f32_32x32x16_bf16 v[66:81], v[112:115], v[86:89], v[66:81]
    buffer_load_dwordx4 v125, s[24:27], s39 offen sc1 lds
    s_add_u32 m0, m0, 8192
    s_add_u32 s39, s39, 8192
    v_cvt_pk_bf16_f32 v85, v8, v9
    v_exp_f32 v11, v11
    v_exp_f32 v12, v12
    v_cvt_pk_bf16_f32 v86, v10, v11
    v_exp_f32 v13, v13
    v_mfma_f32_32x32x16_bf16 v[66:81], v[100:103], v[82:85], v[66:81]
    s_mov_b64 exec, s[50:51]
    ds_read_b128 v[112:115], v124 offset:30080
    ds_read_b128 v[100:103], v124 offset:33280
    s_mov_b64 exec, -1
    buffer_load_dwordx4 v[220:223], v125, s[24:27], s46 offen sc1
    s_add_u32 s46, s46, s47
    v_exp_f32 v14, v14
    v_cvt_pk_bf16_f32 v87, v12, v13
    v_exp_f32 v15, v15
    v_exp_f32 v16, v16
    v_cvt_pk_bf16_f32 v88, v14, v15
    v_exp_f32 v17, v17
    v_mfma_f32_32x32x16_bf16 v[34:49], v[90:93], v[116:119], v[34:49]
    s_waitcnt lgkmcnt(3)
    ds_read_b128 v[90:93], v122 offset:35840
    buffer_load_dwordx4 v[224:227], v125, s[24:27], s46 offen sc1
    s_add_u32 s46, s46, s47
    v_exp_f32 v18, v18
    v_cvt_pk_bf16_f32 v89, v16, v17
    v_exp_f32 v19, v19
    v_exp_f32 v20, v20
    v_cvt_pk_bf16_f32 v82, v18, v19
    v_exp_f32 v21, v21
    v_mfma_f32_32x32x16_bf16 v[66:81], v[104:107], v[86:89], v[66:81]
    v_exp_f32 v22, v22
    v_cvt_pk_bf16_f32 v83, v20, v21
    v_exp_f32 v23, v23
    v_exp_f32 v24, v24
    v_cvt_pk_bf16_f32 v84, v22, v23
    v_exp_f32 v25, v25
    v_mfma_f32_32x32x16_bf16 v[50:65], v[94:97], v[116:119], v[50:65]
    s_waitcnt lgkmcnt(0)
    ds_read_b128 v[94:97], v122 offset:36864
    v_exp_f32 v26, v26
    v_cvt_pk_bf16_f32 v85, v24, v25
    v_exp_f32 v27, v27
    v_exp_f32 v28, v28
    v_cvt_pk_bf16_f32 v86, v26, v27
    v_exp_f32 v29, v29
    v_mfma_f32_32x32x16_bf16 v[66:81], v[108:111], v[82:85], v[66:81]
    s_mov_b64 exec, s[50:51]
    ds_read_b128 v[104:107], v124 offset:33920
    ds_read_b128 v[108:111], v124 offset:34560
    s_mov_b64 exec, -1
    v_exp_f32 v30, v30
    v_cvt_pk_bf16_f32 v87, v28, v29
    v_exp_f32 v31, v31
    v_exp_f32 v32, v32
    v_exp_f32 v33, v33
    v_cvt_pk_bf16_f32 v88, v30, v31
    v_cvt_pk_bf16_f32 v89, v32, v33
    v_mfma_f32_32x32x4_2b_bf16 v[2:33], v[98:99], v[120:121], 0
    ds_read_b64 v[98:99], v123 offset:43008
    buffer_load_dwordx4 v125, s[24:27], s39 offen sc1 lds
    s_add_u32 m0, m0, 8192
    s_add_u32 s39, s39, 8192
    v_exp_f32 v34, v34
    v_exp_f32 v35, v35
    v_exp_f32 v36, v36
    v_cvt_pk_bf16_f32 v82, v34, v35
    v_exp_f32 v37, v37
    v_exp_f32 v38, v38
    v_cvt_pk_bf16_f32 v83, v36, v37
    v_exp_f32 v39, v39
    v_exp_f32 v40, v40
    v_cvt_pk_bf16_f32 v84, v38, v39
    v_exp_f32 v41, v41
    v_exp_f32 v42, v42
    v_mfma_f32_32x32x16_bf16 v[66:81], v[112:115], v[86:89], v[66:81]
    buffer_load_dwordx4 v[228:231], v125, s[24:27], s46 offen sc1
    s_add_u32 s46, s46, s47
    v_cvt_pk_bf16_f32 v85, v40, v41
    v_exp_f32 v43, v43
    v_exp_f32 v44, v44
    v_cvt_pk_bf16_f32 v86, v42, v43
    v_exp_f32 v45, v45
    v_mfma_f32_32x32x16_bf16 v[66:81], v[100:103], v[82:85], v[66:81]
    s_mov_b64 exec, s[50:51]
    ds_read_b128 v[112:115], v124 offset:35200
    ds_read_b128 v[100:103], v124 offset:38400
    s_mov_b64 exec, -1
    s_add_u32 s53, s85, 122880
    s_cmp_lt_u32 s36, 4
    s_cselect_b32 s46, s46, s53
    s_cselect_b32 s47, s47, 1024
    buffer_load_dwordx4 v[232:235], v125, s[24:27], s46 offen sc1
    s_add_u32 s46, s46, s47
    v_exp_f32 v46, v46
    v_cvt_pk_bf16_f32 v87, v44, v45
    v_exp_f32 v47, v47
    v_exp_f32 v48, v48
    v_cvt_pk_bf16_f32 v88, v46, v47
    v_exp_f32 v49, v49
    v_mfma_f32_32x32x16_bf16 v[2:17], v[90:93], v[116:119], v[2:17]
    s_waitcnt lgkmcnt(3)
    ds_read_b128 v[90:93], v122 offset:40960
    buffer_load_dwordx4 v125, s[24:27], s39 offen sc1 lds
    s_add_u32 m0, m0, 8192
    s_add_u32 s39, s39, 8192
    v_exp_f32 v50, v50
    v_cvt_pk_bf16_f32 v89, v48, v49
    v_exp_f32 v51, v51
    v_exp_f32 v52, v52
    v_cvt_pk_bf16_f32 v82, v50, v51
    v_exp_f32 v53, v53
    v_mfma_f32_32x32x16_bf16 v[66:81], v[104:107], v[86:89], v[66:81]
    v_exp_f32 v54, v54
    v_cvt_pk_bf16_f32 v83, v52, v53
    v_exp_f32 v55, v55
    v_exp_f32 v56, v56
    v_cvt_pk_bf16_f32 v84, v54, v55
    v_exp_f32 v57, v57
    v_mfma_f32_32x32x16_bf16 v[18:33], v[94:97], v[116:119], v[18:33]
    s_waitcnt lgkmcnt(0)
    ds_read_b128 v[94:97], v122 offset:41984
    v_exp_f32 v58, v58
    v_cvt_pk_bf16_f32 v85, v56, v57
    v_exp_f32 v59, v59
    v_exp_f32 v60, v60
    v_cvt_pk_bf16_f32 v86, v58, v59
    v_exp_f32 v61, v61
    v_mfma_f32_32x32x16_bf16 v[66:81], v[108:111], v[82:85], v[66:81]
    s_mov_b64 exec, s[50:51]
    ds_read_b128 v[104:107], v124 offset:39040
    ds_read_b128 v[108:111], v124 offset:39680
    s_mov_b64 exec, -1
    v_exp_f32 v62, v62
    v_cvt_pk_bf16_f32 v87, v60, v61
    v_exp_f32 v63, v63
    v_exp_f32 v64, v64
    v_exp_f32 v65, v65
    v_cvt_pk_bf16_f32 v88, v62, v63
    v_cvt_pk_bf16_f32 v89, v64, v65
    s_setprio 1
    v_mfma_f32_32x32x4_2b_bf16 v[34:65], v[98:99], v[120:121], 0
    ds_read_b64 v[98:99], v123 offset:48128
    buffer_load_dwordx4 v[236:239], v125, s[24:27], s46 offen sc1
    s_add_u32 s46, s46, s47
    v_exp_f32 v2, v2
    v_exp_f32 v3, v3
    v_exp_f32 v4, v4
    v_cvt_pk_bf16_f32 v82, v2, v3
    v_exp_f32 v5, v5
    v_exp_f32 v6, v6
    v_cvt_pk_bf16_f32 v83, v4, v5
    v_exp_f32 v7, v7
    v_exp_f32 v8, v8
    v_cvt_pk_bf16_f32 v84, v6, v7
    v_exp_f32 v9, v9
    v_exp_f32 v10, v10
    v_mfma_f32_32x32x16_bf16 v[66:81], v[112:115], v[86:89], v[66:81]
    buffer_load_dwordx4 v[240:243], v125, s[24:27], s46 offen sc1
    s_add_u32 s46, s46, s47
    v_cvt_pk_bf16_f32 v85, v8, v9
    v_exp_f32 v11, v11
    v_exp_f32 v12, v12
    v_cvt_pk_bf16_f32 v86, v10, v11
    v_exp_f32 v13, v13
    v_mfma_f32_32x32x16_bf16 v[66:81], v[100:103], v[82:85], v[66:81]
    s_mov_b64 exec, s[50:51]
    ds_read_b128 v[112:115], v124 offset:40320
    ds_read_b128 v[100:103], v124 offset:43520
    s_mov_b64 exec, -1
    buffer_load_dwordx4 v125, s[24:27], s39 offen sc1 lds
    s_add_u32 m0, m0, 8192
    s_add_u32 s39, s39, 8192
    v_exp_f32 v14, v14
    v_cvt_pk_bf16_f32 v87, v12, v13
    v_exp_f32 v15, v15
    v_exp_f32 v16, v16
    v_cvt_pk_bf16_f32 v88, v14, v15
    v_exp_f32 v17, v17
    v_mfma_f32_32x32x16_bf16 v[34:49], v[90:93], v[116:119], v[34:49]
    s_waitcnt lgkmcnt(3)
    ds_read_b128 v[90:93], v122 offset:46080
    buffer_load_dwordx4 v[244:247], v125, s[24:27], s46 offen sc1
    s_add_u32 s46, s46, s47
    v_exp_f32 v18, v18
    v_cvt_pk_bf16_f32 v89, v16, v17
    v_exp_f32 v19, v19
    v_exp_f32 v20, v20
    v_cvt_pk_bf16_f32 v82, v18, v19
    v_exp_f32 v21, v21
    v_mfma_f32_32x32x16_bf16 v[66:81], v[104:107], v[86:89], v[66:81]
    v_exp_f32 v22, v22
    v_cvt_pk_bf16_f32 v83, v20, v21
    v_exp_f32 v23, v23
    v_exp_f32 v24, v24
    v_cvt_pk_bf16_f32 v84, v22, v23
    v_exp_f32 v25, v25
    v_mfma_f32_32x32x16_bf16 v[50:65], v[94:97], v[116:119], v[50:65]
    s_waitcnt lgkmcnt(0)
    ds_read_b128 v[94:97], v122 offset:47104
    v_exp_f32 v26, v26
    v_cvt_pk_bf16_f32 v85, v24, v25
    v_exp_f32 v27, v27
    v_exp_f32 v28, v28
    v_cvt_pk_bf16_f32 v86, v26, v27
    v_exp_f32 v29, v29
    v_mfma_f32_32x32x16_bf16 v[66:81], v[108:111], v[82:85], v[66:81]
    s_mov_b64 exec, s[50:51]
    ds_read_b128 v[104:107], v124 offset:44160
    ds_read_b128 v[108:111], v124 offset:44800
    s_mov_b64 exec, -1
    v_exp_f32 v30, v30
    v_cvt_pk_bf16_f32 v87, v28, v29
    v_exp_f32 v31, v31
    v_exp_f32 v32, v32
    v_exp_f32 v33, v33
    v_cvt_pk_bf16_f32 v88, v30, v31
    v_cvt_pk_bf16_f32 v89, v32, v33
    s_cbranch_vccz k_g14
    buffer_load_dwordx4 v125, s[24:27], s39 offen sc1 lds
    s_add_u32 m0, m0, 8192
    s_add_u32 s39, s39, 8192
k_g14:
    v_mfma_f32_32x32x4_2b_bf16 v[2:33], v[98:99], v[120:121], 0
    ds_read_b64 v[98:99], v123 offset:53248
    buffer_load_dwordx4 v[248:251], v125, s[24:27], s46 offen sc1
    s_add_u32 s46, s46, s47
    v_exp_f32 v34, v34
    v_exp_f32 v35, v35
    v_exp_f32 v36, v36
    v_cvt_pk_bf16_f32 v82, v34, v35
    v_exp_f32 v37, v37
    v_exp_f32 v38, v38
    v_cvt_pk_bf16_f32 v83, v36, v37
    v_exp_f32 v39, v39
    v_exp_f32 v40, v40
    v_cvt_pk_bf16_f32 v84, v38, v39
    v_exp_f32 v41, v41
    v_exp_f32 v42, v42
    v_mfma_f32_32x32x16_bf16 v[66:81], v[112:115], v[86:89], v[66:81]
    buffer_load_dword v148, v254, s[24:27], s69 offen sc1
    v_cvt_pk_bf16_f32 v85, v40, v41
    v_exp_f32 v43, v43
    v_exp_f32 v44, v44
    v_cvt_pk_bf16_f32 v86, v42, v43
    v_exp_f32 v45, v45
    v_mfma_f32_32x32x16_bf16 v[66:81], v[100:103], v[82:85], v[66:81]
    s_mov_b64 exec, s[50:51]
    ds_read_b128 v[112:115], v124 offset:45440
    ds_read_b128 v[100:103], v124 offset:48640
    s_mov_b64 exec, -1
    v_exp_f32 v46, v46
    v_cvt_pk_bf16_f32 v87, v44, v45
    v_exp_f32 v47, v47
    v_exp_f32 v48, v48
    v_cvt_pk_bf16_f32 v88, v46, v47
    v_exp_f32 v49, v49
    v_mfma_f32_32x32x16_bf16 v[2:17], v[90:93], v[116:119], v[2:17]
    s_waitcnt lgkmcnt(3)
    ds_read_b128 v[90:93], v122 offset:51200
    v_exp_f32 v50, v50
    v_cvt_pk_bf16_f32 v89, v48, v49
    v_exp_f32 v51, v51
    v_exp_f32 v52, v52
    v_cvt_pk_bf16_f32 v82, v50, v51
    v_exp_f32 v53, v53
    v_mfma_f32_32x32x16_bf16 v[66:81], v[104:107], v[86:89], v[66:81]
    v_exp_f32 v54, v54
    v_cvt_pk_bf16_f32 v83, v52, v53
    v_exp_f32 v55, v55
    v_exp_f32 v56, v56
    v_cvt_pk_bf16_f32 v84, v54, v55
    v_exp_f32 v57, v57
    v_mfma_f32_32x32x16_bf16 v[18:33], v[94:97], v[116:119], v[18:33]
    s_waitcnt lgkmcnt(0)
    ds_read_b128 v[94:97], v122 offset:52224
    v_exp_f32 v58, v58
    v_cvt_pk_bf16_f32 v85, v56, v57
    v_exp_f32 v59, v59
    v_exp_f32 v60, v60
    v_cvt_pk_bf16_f32 v86, v58, v59
    v_exp_f32 v61, v61
    v_mfma_f32_32x32x16_bf16 v[66:81], v[108:111], v[82:85], v[66:81]
    s_mov_b64 exec, s[50:51]
    ds_read_b128 v[104:107], v124 offset:49280
    ds_read_b128 v[108:111], v124 offset:49920
    s_mov_b64 exec, -1
    v_exp_f32 v62, v62
    v_cvt_pk_bf16_f32 v87, v60, v61
    v_exp_f32 v63, v63
    v_exp_f32 v64, v64
    v_exp_f32 v65, v65
    v_cvt_pk_bf16_f32 v88, v62, v63
    v_cvt_pk_bf16_f32 v89, v64, v65
    v_mfma_f32_32x32x4_2b_bf16 v[34:65], v[98:99], v[120:121], 0
    v_exp_f32 v2, v2
    v_exp_f32 v3, v3
    v_exp_f32 v4, v4
    v_cvt_pk_bf16_f32 v82, v2, v3
    v_exp_f32 v5, v5
    v_exp_f32 v6, v6
    v_cvt_pk_bf16_f32 v83, v4, v5
    v_exp_f32 v7, v7
    v_exp_f32 v8, v8
    v_cvt_pk_bf16_f32 v84, v6, v7
    v_exp_f32 v9, v9
    v_exp_f32 v10, v10
    v_mfma_f32_32x32x16_bf16 v[66:81], v[112:115], v[86:89], v[66:81]
    v_cvt_pk_bf16_f32 v85, v8, v9
    v_exp_f32 v11, v11
    v_exp_f32 v12, v12
    v_cvt_pk_bf16_f32 v86, v10, v11
    v_exp_f32 v13, v13
    v_mfma_f32_32x32x16_bf16 v[66:81], v[100:103], v[82:85], v[66:81]
    s_mov_b64 exec, s[50:51]
    ds_read_b128 v[112:115], v124 offset:50560
    ds_read_b128 v[100:103], v124 offset:53760
    s_mov_b64 exec, -1
    v_exp_f32 v14, v14
    v_cvt_pk_bf16_f32 v87, v12, v13
    v_exp_f32 v15, v15
    v_exp_f32 v16, v16
    v_cvt_pk_bf16_f32 v88, v14, v15
    v_exp_f32 v17, v17
    v_mfma_f32_32x32x16_bf16 v[34:49], v[90:93], v[116:119], v[34:49]
    s_waitcnt lgkmcnt(2)
    v_exp_f32 v18, v18
    v_cvt_pk_bf16_f32 v89, v16, v17
    v_exp_f32 v19, v19
    v_exp_f32 v20, v20
    v_cvt_pk_bf16_f32 v82, v18, v19
    v_exp_f32 v21, v21
    v_mfma_f32_32x32x16_bf16 v[66:81], v[104:107], v[86:89], v[66:81]
    v_exp_f32 v22, v22
    v_cvt_pk_bf16_f32 v83, v20, v21
    v_exp_f32 v23, v23
    v_exp_f32 v24, v24
    v_cvt_pk_bf16_f32 v84, v22, v23
    v_exp_f32 v25, v25
    v_mfma_f32_32x32x16_bf16 v[50:65], v[94:97], v[116:119], v[50:65]
    s_waitcnt lgkmcnt(0)
    v_exp_f32 v26, v26
    v_cvt_pk_bf16_f32 v85, v24, v25
    v_exp_f32 v27, v27
    v_exp_f32 v28, v28
    v_cvt_pk_bf16_f32 v86, v26, v27
    v_exp_f32 v29, v29
    v_mfma_f32_32x32x16_bf16 v[66:81], v[108:111], v[82:85], v[66:81]
    s_mov_b64 exec, s[50:51]
    ds_read_b128 v[104:107], v124 offset:54400
    ds_read_b128 v[108:111], v124 offset:55040
    s_mov_b64 exec, -1
    v_exp_f32 v30, v30
    v_cvt_pk_bf16_f32 v87, v28, v29
    v_exp_f32 v31, v31
    v_exp_f32 v32, v32
    v_exp_f32 v33, v33
    v_cvt_pk_bf16_f32 v88, v30, v31
    v_cvt_pk_bf16_f32 v89, v32, v33
    s_setprio 0
    v_exp_f32 v34, v34
    v_exp_f32 v35, v35
    v_exp_f32 v36, v36
    v_cvt_pk_bf16_f32 v82, v34, v35
    v_exp_f32 v37, v37
    v_exp_f32 v38, v38
    v_cvt_pk_bf16_f32 v83, v36, v37
    v_exp_f32 v39, v39
    v_exp_f32 v40, v40
    v_cvt_pk_bf16_f32 v84, v38, v39
    v_exp_f32 v41, v41
    v_exp_f32 v42, v42
    v_mfma_f32_32x32x16_bf16 v[66:81], v[112:115], v[86:89], v[66:81]
    s_mov_b64 exec, s[50:51]
    ds_read_b128 v[112:115], v124 offset:55680
    s_mov_b64 exec, -1
    v_cvt_pk_bf16_f32 v85, v40, v41
    v_exp_f32 v43, v43
    v_exp_f32 v44, v44
    v_cvt_pk_bf16_f32 v86, v42, v43
    v_exp_f32 v45, v45
    v_mfma_f32_32x32x16_bf16 v[66:81], v[100:103], v[82:85], v[66:81]
    s_waitcnt lgkmcnt(1)
    v_exp_f32 v46, v46
    v_cvt_pk_bf16_f32 v87, v44, v45
    v_exp_f32 v47, v47
    v_exp_f32 v48, v48
    v_cvt_pk_bf16_f32 v88, v46, v47
    v_exp_f32 v49, v49
    v_exp_f32 v50, v50
    v_cvt_pk_bf16_f32 v89, v48, v49
    v_exp_f32 v51, v51
    v_exp_f32 v52, v52
    v_cvt_pk_bf16_f32 v82, v50, v51
    v_exp_f32 v53, v53
    v_mfma_f32_32x32x16_bf16 v[66:81], v[104:107], v[86:89], v[66:81]
    v_exp_f32 v54, v54
    v_cvt_pk_bf16_f32 v83, v52, v53
    v_exp_f32 v55, v55
    v_exp_f32 v56, v56
    v_cvt_pk_bf16_f32 v84, v54, v55
    v_exp_f32 v57, v57
    v_exp_f32 v58, v58
    v_cvt_pk_bf16_f32 v85, v56, v57
    v_exp_f32 v59, v59
    v_exp_f32 v60, v60
    v_cvt_pk_bf16_f32 v86, v58, v59
    v_exp_f32 v61, v61
    v_mfma_f32_32x32x16_bf16 v[66:81], v[108:111], v[82:85], v[66:81]
    v_exp_f32 v62, v62
    v_cvt_pk_bf16_f32 v87, v60, v61
    v_exp_f32 v63, v63
    v_exp_f32 v64, v64
    v_exp_f32 v65, v65
    v_cvt_pk_bf16_f32 v88, v62, v63
    v_cvt_pk_bf16_f32 v89, v64, v65
    s_waitcnt vmcnt(0) lgkmcnt(0)
    s_nop 0
    v_mfma_f32_32x32x16_bf16 v[66:81], v[112:115], v[86:89], v[66:81]
    v_mov_b32 v254, 1
    v_lshlrev_b32 v149, 8, v1
    s_and_b32 s72, s82, 0xfffff000
    s_mov_b64 exec, 3
    buffer_atomic_add v254, v149, s[24:27], s72 offen sc1
    s_mov_b64 exec, -1
    v_mov_b32 v150, s22
    v_mov_b32 v151, s23
    s_nop 3
    v_add_f32 v126, abs(v66), abs(v67)
    v_add_f32 v127, abs(v68), abs(v69)
    v_add_f32 v126, abs(v70), v126
    v_add_f32 v127, abs(v71), v127
    v_add_f32 v126, abs(v72), v126
    v_add_f32 v127, abs(v73), v127
    v_add_f32 v126, abs(v74), v126
    v_add_f32 v127, abs(v75), v127
    v_add_f32 v126, abs(v76), v126
    v_add_f32 v127, abs(v77), v127
    v_add_f32 v126, v126, v127
    v_cmp_gt_f32 s[54:55], s48, v126
    v_cmp_gt_f32 s[56:57], s70, v78
    v_cmp_lt_f32 s[58:59], s49, v78
    v_rcp_f32 v126, v78
    s_and_b64 s[54:55], s[54:55], s[56:57]
    s_and_b64 s[54:55], s[54:55], s[58:59]
    s_cmp_eq_u64 s[54:55], -1
    s_cbranch_scc0 k_slow
k_out:
    v_pk_mul_f32 v[66:67], v[66:67], v[126:127] op_sel:[0,0] op_sel_hi:[1,0]
    v_pk_mul_f32 v[68:69], v[68:69], v[126:127] op_sel:[0,0] op_sel_hi:[1,0]
    v_pk_mul_f32 v[70:71], v[70:71], v[126:127] op_sel:[0,0] op_sel_hi:[1,0]
    v_pk_mul_f32 v[72:73], v[72:73], v[126:127] op_sel:[0,0] op_sel_hi:[1,0]
    v_pk_mul_f32 v[74:75], v[74:75], v[126:127] op_sel:[0,0] op_sel_hi:[1,0]
    v_pk_mul_f32 v[76:77], v[76:77], v[126:127] op_sel:[0,0] op_sel_hi:[1,0]
    v_cvt_pk_bf16_f32 v82, v66, v67
    v_cvt_pk_bf16_f32 v83, v68, v69
    v_cvt_pk_bf16_f32 v84, v70, v71
    v_cvt_pk_bf16_f32 v85, v72, v73
    v_cvt_pk_bf16_f32 v86, v74, v75
    v_cvt_pk_bf16_f32 v87, v76, v77
    buffer_store_dwordx4 v[82:85], v252, s[24:27], s40 offen sc1
    s_mov_b32 exec_hi, 0
    buffer_store_dwordx2 v[86:87], v253, s[24:27], s41 offen sc1
    s_mov_b32 exec_hi, -1
    v_lshlrev_b32 v2, 4, v1
    v_lshlrev_b32 v4, 3, v1
    v_and_b32 v8, 15, v1
    v_lshrrev_b32 v9, 4, v1
    v_lshlrev_b32 v10, 3, v8
    v_lshl_add_u32 v3, v9, 8, v10
    v_mul_u32_u24 v10, 256, v8
    s_cmp_ge_u32 s36, 4
    s_cbranch_scc1 k_ld
    s_mul_i32 s53, s63, 51200
    v_add_u32 v5, s53, v2
    s_lshl_b32 s53, s64, 1
    s_add_u32 s53, s53, s63
    s_mul_i32 s54, s63, 10240
    s_add_u32 s54, s54, 7864320
    s_mul_i32 s37, s53, 20480
    s_add_u32 s37, s37, s54
    s_xor_b32 s55, s53, 1
    s_mul_i32 s38, s55, 20480
    s_add_u32 s38, s38, s54
    s_mul_i32 s73, s53, 4096
    s_add_u32 s73, s73, 25935872
    s_barrier
    v_lshlrev_b32 v36, 16, v132
    v_and_b32 v37, 0xffff0000, v132
    v_lshlrev_b32 v38, 16, v133
    v_and_b32 v39, 0xffff0000, v133
    v_mov_b32 v40, 0
    v_mov_b32 v41, 0
    v_mov_b32 v42, 0
    v_mov_b32 v43, 0
    v_lshlrev_b32 v44, 16, v134
    v_and_b32 v45, 0xffff0000, v134
    v_lshlrev_b32 v46, 16, v135
    v_and_b32 v47, 0xffff0000, v135
    v_mov_b32 v48, 0
    v_mov_b32 v49, 0
    v_mov_b32 v50, 0
    v_mov_b32 v51, 0
    v_lshlrev_b32 v52, 16, v136
    v_and_b32 v53, 0xffff0000, v136
    v_lshlrev_b32 v54, 16, v137
    v_and_b32 v55, 0xffff0000, v137
    v_mov_b32 v56, 0
    v_mov_b32 v57, 0
    v_mov_b32 v58, 0
    v_mov_b32 v59, 0
    v_lshlrev_b32 v60, 16, v138
    v_and_b32 v61, 0xffff0000, v138
    v_lshlrev_b32 v62, 16, v139
    v_and_b32 v63, 0xffff0000, v139
    v_mov_b32 v64, 0
    v_mov_b32 v65, 0
k_pad4:
    s_cbranch_execz k_pad8
    v_mov_b32 v66, 0
    v_mov_b32 v67, 0
    v_lshlrev_b32 v68, 16, v140
    v_and_b32 v69, 0xffff0000, v140
    v_lshlrev_b32 v70, 16, v141
    v_and_b32 v71, 0xffff0000, v141
    v_mov_b32 v72, 0
    v_mov_b32 v73, 0
    v_mov_b32 v74, 0
    v_mov_b32 v75, 0
    s_mul_i32 s53, s36, 5120
    s_add_u32 s53, s53, 102400
    v_add_u32 v12, s53, v2
    s_xor_b32 s54, s36, 2
    s_mul_i32 s54, s54, 5120
    s_add_u32 s54, s54, 102400
    v_add_u32 v13, s54, v2
    s_add_u32 s54, s65, 10485760
    s_add_u32 s55, s66, 10485760
    s_lshl_b32 s53, s64, 1
    s_add_u32 s53, s53, s63
    s_lshl_b32 s53, s53, 3
    s_add_u32 s53, s53, s61
    s_lshl_b32 s56, s53, 7
    s_add_u32 s56, s56, 20185088
    s_mov_b32 s57, 0x3f803f80
    ds_read_b128 v[16:19], v5 offset:0
    ds_read_b128 v[20:23], v5 offset:1024
    ds_read_b128 v[24:27], v5 offset:2048
    ds_read_b128 v[28:31], v5 offset:3072
    ds_read_b128 v[32:35], v5 offset:4096
    s_and_b32 s74, s61, 1
    s_mul_i32 s74, s74, 256
    s_add_u32 s74, s74, s73
    s_mov_b32 s71, 0
k_f2_c0:
    v_mov_b32 v252, 0
    s_mov_b64 exec, 1
    buffer_atomic_add v252, off, s[24:27], s74 sc0 sc1
    s_mov_b64 exec, -1
    s_waitcnt vmcnt(0)
k_f2_c1:
    v_readfirstlane_b32 s53, v252
    s_add_u32 s71, s71, 1
    s_cmp_gt_u32 s71, 131072
    s_cbranch_scc1 k_f2_c2
    s_cmp_lt_u32 s53, 16
    s_cbranch_scc1 k_f2_c0
k_f2_c2:
    buffer_load_dwordx4 v[76:79], v2, s[24:27], s37 offen offset:0 sc1
    buffer_load_dwordx4 v[80:83], v2, s[24:27], s38 offen offset:0 sc1
    buffer_load_dwordx4 v[84:87], v2, s[24:27], s37 offen offset:1024 sc1
    buffer_load_dwordx4 v[88:91], v2, s[24:27], s38 offen offset:1024 sc1
    buffer_load_dwordx4 v[92:95], v2, s[24:27], s37 offen offset:2048 sc1
    buffer_load_dwordx4 v[96:99], v2, s[24:27], s38 offen offset:2048 sc1
    buffer_load_dwordx4 v[100:103], v2, s[24:27], s37 offen offset:3072 sc1
    buffer_load_dwordx4 v[104:107], v2, s[24:27], s38 offen offset:3072 sc1
    s_add_u32 s37, s37, 4096
    buffer_load_dwordx4 v[108:111], v2, s[24:27], s37 offen offset:0 sc1
    s_add_u32 s38, s38, 4096
    buffer_load_dwordx4 v[112:115], v2, s[24:27], s38 offen offset:0 sc1
    buffer_load_dwordx4 v[116:119], v2, s[24:27], s37 offen offset:1024 sc1
    buffer_load_dwordx4 v[120:123], v2, s[24:27], s38 offen offset:1024 sc1
    s_waitcnt vmcnt(10) lgkmcnt(4)
    v_mfma_f32_16x16x32_bf16 v[36:39], v[16:19], v[76:79], v[36:39]
    buffer_load_dwordx4 v[124:127], v2, s[24:27], s37 offen offset:2048 sc1
    v_mfma_f32_16x16x32_bf16 v[40:43], v[16:19], v[80:83], v[40:43]
    ds_read_b128 v[16:19], v5 offset:5120
    s_waitcnt lgkmcnt(4)
    v_mfma_f32_16x16x32_bf16 v[44:47], v[20:23], v[76:79], v[44:47]
    buffer_load_dwordx4 v[128:131], v2, s[24:27], s38 offen offset:2048 sc1
    v_mfma_f32_16x16x32_bf16 v[48:51], v[20:23], v[80:83], v[48:51]
    ds_read_b128 v[20:23], v5 offset:6144
    s_waitcnt lgkmcnt(4)
    v_mfma_f32_16x16x32_bf16 v[52:55], v[24:27], v[76:79], v[52:55]
    s_mov_b64 exec, 1
    buffer_store_dwordx2 v[150:151], off, s[24:27], s82 offset:128 sc1
    s_mov_b64 exec, -1
    v_mfma_f32_16x16x32_bf16 v[56:59], v[24:27], v[80:83], v[56:59]
    ds_read_b128 v[24:27], v5 offset:7168
    s_waitcnt lgkmcnt(4)
    v_mfma_f32_16x16x32_bf16 v[60:63], v[28:31], v[76:79], v[60:63]
    v_mfma_f32_16x16x32_bf16 v[64:67], v[28:31], v[80:83], v[64:67]
    ds_read_b128 v[28:31], v5 offset:8192
    s_waitcnt lgkmcnt(4)
    v_mfma_f32_16x16x32_bf16 v[68:71], v[32:35], v[76:79], v[68:71]
    v_mfma_f32_16x16x32_bf16 v[72:75], v[32:35], v[80:83], v[72:75]
    ds_read_b128 v[32:35], v5 offset:9216
    s_waitcnt vmcnt(11) lgkmcnt(4)
    v_mfma_f32_16x16x32_bf16 v[36:39], v[16:19], v[84:87], v[36:39]
    buffer_load_dwordx4 v[76:79], v2, s[24:27], s37 offen offset:3072 sc1
    v_mfma_f32_16x16x32_bf16 v[40:43], v[16:19], v[88:91], v[40:43]
    ds_read_b128 v[16:19], v5 offset:10240
    s_waitcnt lgkmcnt(4)
    v_mfma_f32_16x16x32_bf16 v[44:47], v[20:23], v[84:87], v[44:47]
    buffer_load_dwordx4 v[80:83], v2, s[24:27], s38 offen offset:3072 sc1
    v_mfma_f32_16x16x32_bf16 v[48:51], v[20:23], v[88:91], v[48:51]
    ds_read_b128 v[20:23], v5 offset:11264
    s_waitcnt lgkmcnt(4)
    v_mfma_f32_16x16x32_bf16 v[52:55], v[24:27], v[84:87], v[52:55]
    v_mfma_f32_16x16x32_bf16 v[56:59], v[24:27], v[88:91], v[56:59]
    ds_read_b128 v[24:27], v5 offset:12288
    s_waitcnt lgkmcnt(4)
    v_mfma_f32_16x16x32_bf16 v[60:63], v[28:31], v[84:87], v[60:63]
    v_mfma_f32_16x16x32_bf16 v[64:67], v[28:31], v[88:91], v[64:67]
    ds_read_b128 v[28:31], v5 offset:13312
    s_waitcnt lgkmcnt(4)
    v_mfma_f32_16x16x32_bf16 v[68:71], v[32:35], v[84:87], v[68:71]
    v_mfma_f32_16x16x32_bf16 v[72:75], v[32:35], v[88:91], v[72:75]
    ds_read_b128 v[32:35], v5 offset:14336
    s_waitcnt vmcnt(11) lgkmcnt(4)
    v_mfma_f32_16x16x32_bf16 v[36:39], v[16:19], v[92:95], v[36:39]
    s_add_u32 s37, s37, 4096
    buffer_load_dwordx2 v[84:85], v3, s[24:27], s37 offen offset:0 sc1
    v_mfma_f32_16x16x32_bf16 v[40:43], v[16:19], v[96:99], v[40:43]
    ds_read_b128 v[16:19], v5 offset:15360
    s_waitcnt lgkmcnt(4)
    v_mfma_f32_16x16x32_bf16 v[44:47], v[20:23], v[92:95], v[44:47]
    buffer_load_dwordx2 v[86:87], v3, s[24:27], s37 offen offset:128 sc1
    v_mfma_f32_16x16x32_bf16 v[48:51], v[20:23], v[96:99], v[48:51]
    ds_read_b128 v[20:23], v5 offset:16384
    s_waitcnt lgkmcnt(4)
    v_mfma_f32_16x16x32_bf16 v[52:55], v[24:27], v[92:95], v[52:55]
    s_add_u32 s38, s38, 4096
    buffer_load_dwordx2 v[88:89], v3, s[24:27], s38 offen offset:0 sc1
    v_mfma_f32_16x16x32_bf16 v[56:59], v[24:27], v[96:99], v[56:59]
    ds_read_b128 v[24:27], v5 offset:17408
    s_waitcnt lgkmcnt(4)
    v_mfma_f32_16x16x32_bf16 v[60:63], v[28:31], v[92:95], v[60:63]
    buffer_load_dwordx2 v[90:91], v3, s[24:27], s38 offen offset:128 sc1
    v_mfma_f32_16x16x32_bf16 v[64:67], v[28:31], v[96:99], v[64:67]
    ds_read_b128 v[28:31], v5 offset:18432
    s_waitcnt lgkmcnt(4)
    v_mfma_f32_16x16x32_bf16 v[68:71], v[32:35], v[92:95], v[68:71]
    v_mfma_f32_16x16x32_bf16 v[72:75], v[32:35], v[96:99], v[72:75]
    ds_read_b128 v[32:35], v5 offset:19456
    s_waitcnt vmcnt(13) lgkmcnt(4)
    v_mfma_f32_16x16x32_bf16 v[36:39], v[16:19], v[100:103], v[36:39]
    buffer_load_dwordx2 v[92:93], v3, s[24:27], s37 offen offset:1024 sc1
    v_mfma_f32_16x16x32_bf16 v[40:43], v[16:19], v[104:107], v[40:43]
    ds_read_b128 v[16:19], v5 offset:20480
    s_waitcnt lgkmcnt(4)
    v_mfma_f32_16x16x32_bf16 v[44:47], v[20:23], v[100:103], v[44:47]
    buffer_load_dwordx2 v[94:95], v3, s[24:27], s37 offen offset:1152 sc1
    v_mfma_f32_16x16x32_bf16 v[48:51], v[20:23], v[104:107], v[48:51]
    ds_read_b128 v[20:23], v5 offset:21504
    s_waitcnt lgkmcnt(4)
    v_mfma_f32_16x16x32_bf16 v[52:55], v[24:27], v[100:103], v[52:55]
    buffer_load_dwordx2 v[96:97], v3, s[24:27], s38 offen offset:1024 sc1
    v_mfma_f32_16x16x32_bf16 v[56:59], v[24:27], v[104:107], v[56:59]
    ds_read_b128 v[24:27], v5 offset:22528
    s_waitcnt lgkmcnt(4)
    v_mfma_f32_16x16x32_bf16 v[60:63], v[28:31], v[100:103], v[60:63]
    buffer_load_dwordx2 v[98:99], v3, s[24:27], s38 offen offset:1152 sc1
    v_mfma_f32_16x16x32_bf16 v[64:67], v[28:31], v[104:107], v[64:67]
    ds_read_b128 v[28:31], v5 offset:23552
    s_waitcnt lgkmcnt(4)
    v_mfma_f32_16x16x32_bf16 v[68:71], v[32:35], v[100:103], v[68:71]
    v_mfma_f32_16x16x32_bf16 v[72:75], v[32:35], v[104:107], v[72:75]
    ds_read_b128 v[32:35], v5 offset:24576
    s_waitcnt vmcnt(15) lgkmcnt(4)
    v_mfma_f32_16x16x32_bf16 v[36:39], v[16:19], v[108:111], v[36:39]
    s_barrier
    v_mfma_f32_16x16x32_bf16 v[40:43], v[16:19], v[112:115], v[40:43]
    ds_read_b128 v[16:19], v5 offset:25600
    s_waitcnt lgkmcnt(4)
    v_mfma_f32_16x16x32_bf16 v[44:47], v[20:23], v[108:111], v[44:47]
    v_mfma_f32_16x16x32_bf16 v[48:51], v[20:23], v[112:115], v[48:51]
    ds_read_b128 v[20:23], v5 offset:26624
    s_waitcnt lgkmcnt(4)
    v_mfma_f32_16x16x32_bf16 v[52:55], v[24:27], v[108:111], v[52:55]
    v_mfma_f32_16x16x32_bf16 v[56:59], v[24:27], v[112:115], v[56:59]
    ds_read_b128 v[24:27], v5 offset:27648
    s_waitcnt lgkmcnt(4)
    v_mfma_f32_16x16x32_bf16 v[60:63], v[28:31], v[108:111], v[60:63]
    v_mfma_f32_16x16x32_bf16 v[64:67], v[28:31], v[112:115], v[64:67]
    ds_read_b128 v[28:31], v5 offset:28672
    s_waitcnt lgkmcnt(4)
    v_mfma_f32_16x16x32_bf16 v[68:71], v[32:35], v[108:111], v[68:71]
    v_mfma_f32_16x16x32_bf16 v[72:75], v[32:35], v[112:115], v[72:75]
    ds_read_b128 v[32:35], v5 offset:29696
    s_waitcnt vmcnt(13) lgkmcnt(4)
    v_mfma_f32_16x16x32_bf16 v[36:39], v[16:19], v[116:119], v[36:39]
    v_mfma_f32_16x16x32_bf16 v[40:43], v[16:19], v[120:123], v[40:43]
    ds_read_b128 v[16:19], v5 offset:30720
    s_waitcnt lgkmcnt(4)
    v_mfma_f32_16x16x32_bf16 v[44:47], v[20:23], v[116:119], v[44:47]
    v_mfma_f32_16x16x32_bf16 v[48:51], v[20:23], v[120:123], v[48:51]
    ds_read_b128 v[20:23], v5 offset:31744
    s_waitcnt lgkmcnt(4)
    v_mfma_f32_16x16x32_bf16 v[52:55], v[24:27], v[116:119], v[52:55]
    v_mfma_f32_16x16x32_bf16 v[56:59], v[24:27], v[120:123], v[56:59]
    ds_read_b128 v[24:27], v5 offset:32768
    s_waitcnt lgkmcnt(4)
    v_mfma_f32_16x16x32_bf16 v[60:63], v[28:31], v[116:119], v[60:63]
    v_mfma_f32_16x16x32_bf16 v[64:67], v[28:31], v[120:123], v[64:67]
    ds_read_b128 v[28:31], v5 offset:33792
    s_waitcnt lgkmcnt(4)
    v_mfma_f32_16x16x32_bf16 v[68:71], v[32:35], v[116:119], v[68:71]
    v_mfma_f32_16x16x32_bf16 v[72:75], v[32:35], v[120:123], v[72:75]
    ds_read_b128 v[32:35], v5 offset:34816
    s_waitcnt vmcnt(10) lgkmcnt(4)
    v_mfma_f32_16x16x32_bf16 v[36:39], v[16:19], v[124:127], v[36:39]
    v_mfma_f32_16x16x32_bf16 v[40:43], v[16:19], v[128:131], v[40:43]
    ds_read_b128 v[16:19], v5 offset:35840
    s_waitcnt lgkmcnt(4)
    v_mfma_f32_16x16x32_bf16 v[44:47], v[20:23], v[124:127], v[44:47]
    v_mfma_f32_16x16x32_bf16 v[48:51], v[20:23], v[128:131], v[48:51]
    ds_read_b128 v[20:23], v5 offset:36864
    s_waitcnt lgkmcnt(4)
    v_mfma_f32_16x16x32_bf16 v[52:55], v[24:27], v[124:127], v[52:55]
    v_mfma_f32_16x16x32_bf16 v[56:59], v[24:27], v[128:131], v[56:59]
    ds_read_b128 v[24:27], v5 offset:37888
    s_waitcnt lgkmcnt(4)
    v_mfma_f32_16x16x32_bf16 v[60:63], v[28:31], v[124:127], v[60:63]
    v_mfma_f32_16x16x32_bf16 v[64:67], v[28:31], v[128:131], v[64:67]
    ds_read_b128 v[28:31], v5 offset:38912
    s_waitcnt lgkmcnt(4)
    v_mfma_f32_16x16x32_bf16 v[68:71], v[32:35], v[124:127], v[68:71]
    v_mfma_f32_16x16x32_bf16 v[72:75], v[32:35], v[128:131], v[72:75]
    ds_read_b128 v[32:35], v5 offset:39936
    s_waitcnt vmcnt(8) lgkmcnt(4)
    v_mfma_f32_16x16x32_bf16 v[36:39], v[16:19], v[76:79], v[36:39]
    v_mfma_f32_16x16x32_bf16 v[40:43], v[16:19], v[80:83], v[40:43]
    ds_read_b128 v[16:19], v5 offset:40960
    s_waitcnt lgkmcnt(4)
    v_mfma_f32_16x16x32_bf16 v[44:47], v[20:23], v[76:79], v[44:47]
    v_mfma_f32_16x16x32_bf16 v[48:51], v[20:23], v[80:83], v[48:51]
    ds_read_b128 v[20:23], v5 offset:41984
    s_waitcnt lgkmcnt(4)
    v_mfma_f32_16x16x32_bf16 v[52:55], v[24:27], v[76:79], v[52:55]
    v_mfma_f32_16x16x32_bf16 v[56:59], v[24:27], v[80:83], v[56:59]
    ds_read_b128 v[24:27], v5 offset:43008
    s_waitcnt lgkmcnt(4)
    v_mfma_f32_16x16x32_bf16 v[60:63], v[28:31], v[76:79], v[60:63]
    v_mfma_f32_16x16x32_bf16 v[64:67], v[28:31], v[80:83], v[64:67]
    ds_read_b128 v[28:31], v5 offset:44032
    s_waitcnt lgkmcnt(4)
    v_mfma_f32_16x16x32_bf16 v[68:71], v[32:35], v[76:79], v[68:71]
    v_mfma_f32_16x16x32_bf16 v[72:75], v[32:35], v[80:83], v[72:75]
    ds_read_b128 v[32:35], v5 offset:45056
    s_waitcnt vmcnt(4) lgkmcnt(4)
    v_mfma_f32_16x16x32_bf16 v[36:39], v[16:19], v[84:87], v[36:39]
    v_mfma_f32_16x16x32_bf16 v[40:43], v[16:19], v[88:91], v[40:43]
    ds_read_b128 v[16:19], v5 offset:46080
    s_waitcnt lgkmcnt(4)
    v_mfma_f32_16x16x32_bf16 v[44:47], v[20:23], v[84:87], v[44:47]
    v_mfma_f32_16x16x32_bf16 v[48:51], v[20:23], v[88:91], v[48:51]
    ds_read_b128 v[20:23], v5 offset:47104
    s_waitcnt lgkmcnt(4)
    v_mfma_f32_16x16x32_bf16 v[52:55], v[24:27], v[84:87], v[52:55]
    v_mfma_f32_16x16x32_bf16 v[56:59], v[24:27], v[88:91], v[56:59]
    ds_read_b128 v[24:27], v5 offset:48128
    s_waitcnt lgkmcnt(4)
    v_mfma_f32_16x16x32_bf16 v[60:63], v[28:31], v[84:87], v[60:63]
    v_mfma_f32_16x16x32_bf16 v[64:67], v[28:31], v[88:91], v[64:67]
    ds_read_b128 v[28:31], v5 offset:49152
    s_waitcnt lgkmcnt(4)
    v_mfma_f32_16x16x32_bf16 v[68:71], v[32:35], v[84:87], v[68:71]
    v_mfma_f32_16x16x32_bf16 v[72:75], v[32:35], v[88:91], v[72:75]
    ds_read_b128 v[32:35], v5 offset:50176
    s_waitcnt vmcnt(0) lgkmcnt(4)
    v_mfma_f32_16x16x32_bf16 v[36:39], v[16:19], v[92:95], v[36:39]
    v_mfma_f32_16x16x32_bf16 v[40:43], v[16:19], v[96:99], v[40:43]
    s_waitcnt lgkmcnt(3)
    v_mfma_f32_16x16x32_bf16 v[44:47], v[20:23], v[92:95], v[44:47]
    v_mfma_f32_16x16x32_bf16 v[48:51], v[20:23], v[96:99], v[48:51]
    s_waitcnt lgkmcnt(2)
    v_mfma_f32_16x16x32_bf16 v[52:55], v[24:27], v[92:95], v[52:55]
    v_mfma_f32_16x16x32_bf16 v[56:59], v[24:27], v[96:99], v[56:59]
    s_waitcnt lgkmcnt(1)
    v_mfma_f32_16x16x32_bf16 v[60:63], v[28:31], v[92:95], v[60:63]
    v_mfma_f32_16x16x32_bf16 v[64:67], v[28:31], v[96:99], v[64:67]
    v_cmp_u_f32 vcc, v36, v40
    s_nop 0
    s_cbranch_vccnz k_r3
    s_nop 1
    ds_write_b128 v12, v[40:43] offset:0
    s_waitcnt lgkmcnt(0)
    v_mfma_f32_16x16x32_bf16 v[68:71], v[32:35], v[92:95], v[68:71]
    v_mfma_f32_16x16x32_bf16 v[72:75], v[32:35], v[96:99], v[72:75]
    s_nop 1
    ds_write_b128 v12, v[48:51] offset:1024
    s_nop 1
    ds_write_b128 v12, v[56:59] offset:2048
    s_nop 1
    ds_write_b128 v12, v[64:67] offset:3072
    s_nop 2
    s_nop 1
    ds_write_b128 v12, v[72:75] offset:4096
k_r3_ret:
    v_mov_b32 v14, 0
    v_mov_b32 v15, 0
    s_waitcnt lgkmcnt(0)
    s_barrier
    ds_read_b128 v[40:43], v13 offset:0
    ds_read_b128 v[48:51], v13 offset:1024
    ds_read_b128 v[56:59], v13 offset:2048
    ds_read_b128 v[64:67], v13 offset:3072
    ds_read_b128 v[72:75], v13 offset:4096
    s_and_b32 s72, s83, 0xfffff000
    s_mov_b64 exec, 3
    buffer_atomic_add v254, v10, s[24:27], s72 offen sc1
    s_mov_b64 exec, -1
    s_waitcnt lgkmcnt(4)
    v_pk_add_f32 v[36:37], v[36:37], v[40:41]
    v_pk_add_f32 v[38:39], v[38:39], v[42:43]
    v_cvt_pk_bf16_f32 v132, v36, v37
    v_cvt_pk_bf16_f32 v133, v38, v39
    s_waitcnt lgkmcnt(3)
    v_pk_add_f32 v[44:45], v[44:45], v[48:49]
    v_pk_add_f32 v[46:47], v[46:47], v[50:51]
    v_cvt_pk_bf16_f32 v134, v44, v45
    v_cvt_pk_bf16_f32 v135, v46, v47
    buffer_store_dwordx4 v[132:135], v2, s[24:27], s54 offen sc1
    s_waitcnt lgkmcnt(2)
    v_pk_add_f32 v[52:53], v[52:53], v[56:57]
    v_pk_add_f32 v[54:55], v[54:55], v[58:59]
    v_cvt_pk_bf16_f32 v136, v52, v53
    v_cvt_pk_bf16_f32 v137, v54, v55
    s_waitcnt lgkmcnt(1)
    v_pk_add_f32 v[60:61], v[60:61], v[64:65]
    v_pk_add_f32 v[62:63], v[62:63], v[66:67]
    v_cvt_pk_bf16_f32 v138, v60, v61
    v_cvt_pk_bf16_f32 v139, v62, v63
    buffer_store_dwordx4 v[136:139], v2, s[24:27], s54 offen offset:1024 sc1
    s_waitcnt lgkmcnt(0)
    v_pk_add_f32 v[68:69], v[68:69], v[72:73]
    v_pk_add_f32 v[70:71], v[70:71], v[74:75]
    v_cvt_pk_bf16_f32 v140, v68, v69
    v_cvt_pk_bf16_f32 v141, v70, v71
    buffer_store_dwordx2 v[140:141], v4, s[24:27], s55 offen sc1
    v_dot2_f32_bf16 v14, v132, s57, v14
    v_dot2_f32_bf16 v15, v132, v132, v15
    v_dot2_f32_bf16 v14, v133, s57, v14
    v_dot2_f32_bf16 v15, v133, v133, v15
    v_dot2_f32_bf16 v14, v134, s57, v14
    v_dot2_f32_bf16 v15, v134, v134, v15
    v_dot2_f32_bf16 v14, v135, s57, v14
    v_dot2_f32_bf16 v15, v135, v135, v15
    v_dot2_f32_bf16 v14, v136, s57, v14
    v_dot2_f32_bf16 v15, v136, v136, v15
    v_dot2_f32_bf16 v14, v137, s57, v14
    v_dot2_f32_bf16 v15, v137, v137, v15
    v_dot2_f32_bf16 v14, v138, s57, v14
    v_dot2_f32_bf16 v15, v138, v138, v15
    v_dot2_f32_bf16 v14, v139, s57, v14
    v_dot2_f32_bf16 v15, v139, v139, v15
    v_dot2_f32_bf16 v14, v140, s57, v14
    v_dot2_f32_bf16 v15, v140, v140, v15
    v_dot2_f32_bf16 v14, v141, s57, v14
    v_dot2_f32_bf16 v15, v141, v141, v15
    s_nop 2
    v_mov_b32 v12, v14
    v_mov_b32 v13, v15
    s_nop 1
    v_permlane32_swap_b32 v14, v12
    v_permlane32_swap_b32 v15, v13
    v_add_f32 v14, v14, v12
    v_add_f32 v15, v15, v13
    v_mov_b32 v12, v14
    v_mov_b32 v13, v15
    s_nop 1
    v_permlane16_swap_b32 v14, v12
    v_permlane16_swap_b32 v15, v13
    v_add_f32 v14, v14, v12
    v_add_f32 v15, v15, v13
    s_mov_b64 exec, 0xffff
    buffer_store_dwordx2 v[14:15], v4, s[24:27], s56 offen sc1
    s_mov_b64 exec, -1
    s_barrier
    s_mul_i32 s37, s77, 40960
    s_add_u32 s37, s37, 10485760
    s_add_u32 s38, s37, 20480
    s_lshl_b32 s58, s77, 11
    s_add_u32 s58, s58, 20185088
    v_mov_b32 v5, v2
    v_add_u32 v6, 0x10000, v5
    v_add_u32 v7, 0x20000, v5
    v_lshlrev_b32 v12, 5, v9
    v_lshlrev_b32 v13, 4, v9
    s_lshl_b32 s54, s80, 7
    s_add_u32 s54, s54, 27314176
    s_lshl_b32 s55, s81, 6
    s_add_u32 s55, s55, 27314176
    s_mul_i32 s73, s77, 4096
    s_add_u32 s73, s73, 26460160
    s_lshl_b32 s53, s36, 10
    v_add_u32 v14, s53, v2
    v_add_u32 v15, 0x10000, v14
    s_cmp_eq_u32 s78, 6
    s_cbranch_scc1 k_six
    ds_read_b128 v[16:19], v6 offset:57344
    ds_read_b128 v[20:23], v6 offset:58368
    ds_read_b128 v[24:27], v6 offset:59392
    ds_read_b128 v[28:31], v6 offset:60416
    ds_read_b128 v[32:35], v6 offset:61440
    ds_read_b128 v[36:39], v6 offset:62464
    ds_read_b128 v[40:43], v6 offset:63488
    s_and_b32 s74, s76, 1
    s_mul_i32 s74, s74, 256
    s_add_u32 s74, s74, s73
    s_mov_b32 s71, 0
    v_mov_b32 v252, 0
    s_mov_b64 exec, 1
    buffer_atomic_add v252, off, s[24:27], s74 sc0 sc1
    s_mov_b64 exec, -1
    ds_write_b128 v14, v[152:155] offset:0
    ds_write_b128 v14, v[156:159] offset:4096
    ds_write_b128 v14, v[160:163] offset:8192
    ds_write_b128 v14, v[164:167] offset:12288
    ds_write_b128 v14, v[168:171] offset:16384
    ds_write_b128 v14, v[172:175] offset:20480
    ds_write_b128 v14, v[176:179] offset:24576
    ds_write_b128 v14, v[180:183] offset:28672
    ds_write_b128 v14, v[184:187] offset:32768
    ds_write_b128 v14, v[188:191] offset:36864
    ds_write_b128 v14, v[192:195] offset:40960
    ds_write_b128 v14, v[196:199] offset:45056
    ds_write_b128 v14, v[200:203] offset:49152
    ds_write_b128 v14, v[204:207] offset:53248
    ds_write_b128 v14, v[208:211] offset:57344
    ds_write_b128 v14, v[212:215] offset:61440
    s_waitcnt vmcnt(0)
    s_branch k_f3_7_c1
k_f3_7_c0:
    v_mov_b32 v252, 0
    s_mov_b64 exec, 1
    buffer_atomic_add v252, off, s[24:27], s74 sc0 sc1
    s_mov_b64 exec, -1
    s_waitcnt vmcnt(0)
k_f3_7_c1:
    v_readfirstlane_b32 s53, v252
    s_add_u32 s71, s71, 1
    s_cmp_gt_u32 s71, 131072
    s_cbranch_scc1 k_f3_7_c2
    s_cmp_lt_u32 s53, 16
    s_cbranch_scc1 k_f3_7_c0
k_f3_7_c2:
    s_waitcnt lgkmcnt(0)
    buffer_load_dwordx4 v[152:155], v2, s[24:27], s37 offen offset:0 sc1
    buffer_load_dwordx4 v[156:159], v2, s[24:27], s38 offen offset:0 sc1
    buffer_load_dwordx4 v[160:163], v2, s[24:27], s37 offen offset:1024 sc1
    buffer_load_dwordx4 v[164:167], v2, s[24:27], s38 offen offset:1024 sc1
    buffer_load_dwordx2 v[168:169], v3, s[24:27], s37 offen offset:2048 sc1
    buffer_load_dwordx2 v[170:171], v3, s[24:27], s37 offen offset:2176 sc1
    buffer_load_dwordx2 v[172:173], v3, s[24:27], s38 offen offset:2048 sc1
    buffer_load_dwordx2 v[174:175], v3, s[24:27], s38 offen offset:2176 sc1
    buffer_load_dwordx4 v[176:179], v2, s[24:27], s37 offen offset:3072 sc1
    buffer_load_dwordx4 v[180:183], v2, s[24:27], s38 offen offset:3072 sc1
    ds_write_b128 v15, v[216:219] offset:0
    ds_write_b128 v15, v[220:223] offset:4096
    ds_write_b128 v15, v[224:227] offset:8192
    ds_write_b128 v15, v[228:231] offset:12288
    ds_write_b128 v15, v[232:235] offset:16384
    ds_write_b128 v15, v[236:239] offset:20480
    ds_write_b128 v15, v[240:243] offset:24576
    ds_write_b128 v15, v[244:247] offset:28672
    ds_write_b128 v15, v[248:251] offset:32768
    s_waitcnt lgkmcnt(0)
    s_add_u32 s37, s37, 4096
    buffer_load_dwordx4 v[184:187], v2, s[24:27], s37 offen offset:0 sc1
    s_add_u32 s38, s38, 4096
    buffer_load_dwordx4 v[188:191], v2, s[24:27], s38 offen offset:0 sc1
    buffer_load_dwordx4 v[192:195], v2, s[24:27], s37 offen offset:1024 sc1
    buffer_load_dwordx4 v[196:199], v2, s[24:27], s38 offen offset:1024 sc1
    s_waitcnt vmcnt(12) lgkmcnt(6)
    v_mfma_f32_16x16x32_bf16 v[44:47], v[16:19], v[152:155], 0
    buffer_load_dwordx4 v[200:203], v2, s[24:27], s37 offen offset:2048 sc1
    v_mfma_f32_16x16x32_bf16 v[48:51], v[16:19], v[156:159], 0
    ds_read_b128 v[16:19], v6 offset:64512
    s_waitcnt lgkmcnt(6)
    v_mfma_f32_16x16x32_bf16 v[52:55], v[20:23], v[152:155], 0
    buffer_load_dwordx4 v[204:207], v2, s[24:27], s38 offen offset:2048 sc1
    v_mfma_f32_16x16x32_bf16 v[56:59], v[20:23], v[156:159], 0
    ds_read_b128 v[20:23], v7 offset:0
    s_waitcnt lgkmcnt(6)
    v_mfma_f32_16x16x32_bf16 v[60:63], v[24:27], v[152:155], 0
    buffer_load_dwordx2 v[142:143], v3, s[24:27], s58 offen offset:0 sc1
    v_mfma_f32_16x16x32_bf16 v[64:67], v[24:27], v[156:159], 0
    ds_read_b128 v[24:27], v7 offset:1024
    s_waitcnt lgkmcnt(6)
    v_mfma_f32_16x16x32_bf16 v[68:71], v[28:31], v[152:155], 0
    buffer_load_dwordx2 v[144:145], v3, s[24:27], s58 offen offset:128 sc1
    v_mfma_f32_16x16x32_bf16 v[72:75], v[28:31], v[156:159], 0
    ds_read_b128 v[28:31], v7 offset:2048
    s_waitcnt lgkmcnt(6)
    v_mfma_f32_16x16x32_bf16 v[76:79], v[32:35], v[152:155], 0
    buffer_load_dwordx2 v[146:147], v3, s[24:27], s58 offen offset:1024 sc1
    v_mfma_f32_16x16x32_bf16 v[80:83], v[32:35], v[156:159], 0
    ds_read_b128 v[32:35], v7 offset:3072
    s_waitcnt lgkmcnt(6)
    v_mfma_f32_16x16x32_bf16 v[84:87], v[36:39], v[152:155], 0
    buffer_load_dwordx2 v[148:149], v3, s[24:27], s58 offen offset:1152 sc1
    v_mfma_f32_16x16x32_bf16 v[88:91], v[36:39], v[156:159], 0
    ds_read_b128 v[36:39], v7 offset:4096
    s_waitcnt lgkmcnt(6)
    v_mfma_f32_16x16x32_bf16 v[92:95], v[40:43], v[152:155], 0
    buffer_load_dwordx4 v[100:103], v12, s[24:27], s54 offen offset:0 sc1
    v_mfma_f32_16x16x32_bf16 v[96:99], v[40:43], v[156:159], 0
    ds_read_b128 v[40:43], v7 offset:5120
    s_waitcnt vmcnt(17) lgkmcnt(6)
    v_mfma_f32_16x16x32_bf16 v[44:47], v[16:19], v[160:163], v[44:47]
    buffer_load_dwordx2 v[152:153], v3, s[24:27], s37 offen offset:3072 sc1
    v_mfma_f32_16x16x32_bf16 v[48:51], v[16:19], v[164:167], v[48:51]
    ds_read_b128 v[16:19], v7 offset:6144
    s_waitcnt lgkmcnt(6)
    v_mfma_f32_16x16x32_bf16 v[52:55], v[20:23], v[160:163], v[52:55]
    buffer_load_dwordx2 v[154:155], v3, s[24:27], s37 offen offset:3200 sc1
    v_mfma_f32_16x16x32_bf16 v[56:59], v[20:23], v[164:167], v[56:59]
    ds_read_b128 v[20:23], v7 offset:7168
    s_waitcnt lgkmcnt(6)
    v_mfma_f32_16x16x32_bf16 v[60:63], v[24:27], v[160:163], v[60:63]
    buffer_load_dwordx2 v[156:157], v3, s[24:27], s38 offen offset:3072 sc1
    v_mfma_f32_16x16x32_bf16 v[64:67], v[24:27], v[164:167], v[64:67]
    ds_read_b128 v[24:27], v7 offset:8192
    s_waitcnt lgkmcnt(6)
    v_mfma_f32_16x16x32_bf16 v[68:71], v[28:31], v[160:163], v[68:71]
    buffer_load_dwordx2 v[158:159], v3, s[24:27], s38 offen offset:3200 sc1
    v_mfma_f32_16x16x32_bf16 v[72:75], v[28:31], v[164:167], v[72:75]
    ds_read_b128 v[28:31], v7 offset:9216
    s_waitcnt lgkmcnt(6)
    v_mfma_f32_16x16x32_bf16 v[76:79], v[32:35], v[160:163], v[76:79]
    buffer_load_dwordx4 v[104:107], v12, s[24:27], s54 offen offset:16 sc1
    v_mfma_f32_16x16x32_bf16 v[80:83], v[32:35], v[164:167], v[80:83]
    ds_read_b128 v[32:35], v7 offset:10240
    s_waitcnt lgkmcnt(6)
    v_mfma_f32_16x16x32_bf16 v[84:87], v[36:39], v[160:163], v[84:87]
    buffer_load_dwordx4 v[108:111], v12, s[24:27], s54 offen offset:128 sc1
    v_mfma_f32_16x16x32_bf16 v[88:91], v[36:39], v[164:167], v[88:91]
    ds_read_b128 v[36:39], v7 offset:11264
    s_waitcnt lgkmcnt(6)
    v_mfma_f32_16x16x32_bf16 v[92:95], v[40:43], v[160:163], v[92:95]
    buffer_load_dwordx4 v[112:115], v12, s[24:27], s54 offen offset:144 sc1
    v_mfma_f32_16x16x32_bf16 v[96:99], v[40:43], v[164:167], v[96:99]
    ds_read_b128 v[40:43], v7 offset:12288
    s_waitcnt vmcnt(20) lgkmcnt(6)
    v_mfma_f32_16x16x32_bf16 v[44:47], v[16:19], v[168:171], v[44:47]
    s_add_u32 s37, s37, 4096
    buffer_load_dwordx4 v[160:163], v2, s[24:27], s37 offen offset:0 sc1
    v_mfma_f32_16x16x32_bf16 v[48:51], v[16:19], v[172:175], v[48:51]
    ds_read_b128 v[16:19], v7 offset:13312
    s_waitcnt lgkmcnt(6)
    v_mfma_f32_16x16x32_bf16 v[52:55], v[20:23], v[168:171], v[52:55]
    s_add_u32 s38, s38, 4096
    buffer_load_dwordx4 v[164:167], v2, s[24:27], s38 offen offset:0 sc1
    v_mfma_f32_16x16x32_bf16 v[56:59], v[20:23], v[172:175], v[56:59]
    ds_read_b128 v[20:23], v7 offset:14336
    s_waitcnt lgkmcnt(6)
    v_mfma_f32_16x16x32_bf16 v[60:63], v[24:27], v[168:171], v[60:63]
    buffer_load_dwordx4 v[116:119], v12, s[24:27], s54 offen offset:256 sc1
    v_mfma_f32_16x16x32_bf16 v[64:67], v[24:27], v[172:175], v[64:67]
    ds_read_b128 v[24:27], v7 offset:15360
    s_waitcnt lgkmcnt(6)
    v_mfma_f32_16x16x32_bf16 v[68:71], v[28:31], v[168:171], v[68:71]
    buffer_load_dwordx4 v[120:123], v12, s[24:27], s54 offen offset:272 sc1
    v_mfma_f32_16x16x32_bf16 v[72:75], v[28:31], v[172:175], v[72:75]
    ds_read_b128 v[28:31], v7 offset:16384
    s_waitcnt lgkmcnt(6)
    v_mfma_f32_16x16x32_bf16 v[76:79], v[32:35], v[168:171], v[76:79]
    buffer_load_dwordx4 v[124:127], v13, s[24:27], s55 offen sc1
    v_mfma_f32_16x16x32_bf16 v[80:83], v[32:35], v[172:175], v[80:83]
    ds_read_b128 v[32:35], v7 offset:17408
    s_waitcnt lgkmcnt(6)
    v_mfma_f32_16x16x32_bf16 v[84:87], v[36:39], v[168:171], v[84:87]
    s_mov_b64 exec, 1
    buffer_store_dwordx2 v[150:151], off, s[24:27], s83 offset:128 sc1
    s_mov_b64 exec, -1
    v_mfma_f32_16x16x32_bf16 v[88:91], v[36:39], v[172:175], v[88:91]
    ds_read_b128 v[36:39], v7 offset:18432
    s_waitcnt lgkmcnt(6)
    v_mfma_f32_16x16x32_bf16 v[92:95], v[40:43], v[168:171], v[92:95]
    v_mfma_f32_16x16x32_bf16 v[96:99], v[40:43], v[172:175], v[96:99]
    ds_read_b128 v[40:43], v7 offset:19456
    s_waitcnt vmcnt(24) lgkmcnt(6)
    v_mfma_f32_16x16x32_bf16 v[44:47], v[16:19], v[176:179], v[44:47]
    buffer_load_dwordx4 v[168:171], v2, s[24:27], s37 offen offset:1024 sc1
    v_mfma_f32_16x16x32_bf16 v[48:51], v[16:19], v[180:183], v[48:51]
    ds_read_b128 v[16:19], v7 offset:20480
    s_waitcnt lgkmcnt(6)
    v_mfma_f32_16x16x32_bf16 v[52:55], v[20:23], v[176:179], v[52:55]
    buffer_load_dwordx4 v[172:175], v2, s[24:27], s38 offen offset:1024 sc1
    v_mfma_f32_16x16x32_bf16 v[56:59], v[20:23], v[180:183], v[56:59]
    ds_read_b128 v[20:23], v7 offset:21504
    s_waitcnt lgkmcnt(6)
    v_mfma_f32_16x16x32_bf16 v[60:63], v[24:27], v[176:179], v[60:63]
    v_mfma_f32_16x16x32_bf16 v[64:67], v[24:27], v[180:183], v[64:67]
    ds_read_b128 v[24:27], v7 offset:22528
    s_waitcnt lgkmcnt(6)
    v_mfma_f32_16x16x32_bf16 v[68:71], v[28:31], v[176:179], v[68:71]
    v_mfma_f32_16x16x32_bf16 v[72:75], v[28:31], v[180:183], v[72:75]
    ds_read_b128 v[28:31], v7 offset:23552
    s_waitcnt lgkmcnt(6)
    v_mfma_f32_16x16x32_bf16 v[76:79], v[32:35], v[176:179], v[76:79]
    v_mfma_f32_16x16x32_bf16 v[80:83], v[32:35], v[180:183], v[80:83]
    ds_read_b128 v[32:35], v7 offset:24576
    s_waitcnt lgkmcnt(6)
    v_mfma_f32_16x16x32_bf16 v[84:87], v[36:39], v[176:179], v[84:87]
    v_mfma_f32_16x16x32_bf16 v[88:91], v[36:39], v[180:183], v[88:91]
    ds_read_b128 v[36:39], v7 offset:25600
    s_waitcnt lgkmcnt(6)
    v_mfma_f32_16x16x32_bf16 v[92:95], v[40:43], v[176:179], v[92:95]
k_pad5:
    s_cbranch_execz k_pad9
    v_mfma_f32_16x16x32_bf16 v[96:99], v[40:43], v[180:183], v[96:99]
    ds_read_b128 v[40:43], v7 offset:26624
    s_waitcnt vmcnt(24) lgkmcnt(6)
    v_mfma_f32_16x16x32_bf16 v[44:47], v[16:19], v[184:187], v[44:47]
    s_barrier
    v_mfma_f32_16x16x32_bf16 v[48:51], v[16:19], v[188:191], v[48:51]
    ds_read_b128 v[16:19], v7 offset:27648
    s_waitcnt lgkmcnt(6)
    v_mfma_f32_16x16x32_bf16 v[52:55], v[20:23], v[184:187], v[52:55]
    buffer_load_dwordx4 v[176:179], v2, s[24:27], s37 offen offset:2048 sc1
    v_mfma_f32_16x16x32_bf16 v[56:59], v[20:23], v[188:191], v[56:59]
    ds_read_b128 v[20:23], v7 offset:28672
    s_waitcnt lgkmcnt(6)
    v_mfma_f32_16x16x32_bf16 v[60:63], v[24:27], v[184:187], v[60:63]
    buffer_load_dwordx4 v[180:183], v2, s[24:27], s38 offen offset:2048 sc1
    v_mfma_f32_16x16x32_bf16 v[64:67], v[24:27], v[188:191], v[64:67]
    ds_read_b128 v[24:27], v7 offset:29696
    s_waitcnt lgkmcnt(6)
    v_mfma_f32_16x16x32_bf16 v[68:71], v[28:31], v[184:187], v[68:71]
    v_mfma_f32_16x16x32_bf16 v[72:75], v[28:31], v[188:191], v[72:75]
    ds_read_b128 v[28:31], v7 offset:30720
    s_waitcnt lgkmcnt(6)
    v_mfma_f32_16x16x32_bf16 v[76:79], v[32:35], v[184:187], v[76:79]
    v_mfma_f32_16x16x32_bf16 v[80:83], v[32:35], v[188:191], v[80:83]
    ds_read_b128 v[32:35], v7 offset:31744
    s_waitcnt lgkmcnt(6)
    v_mfma_f32_16x16x32_bf16 v[84:87], v[36:39], v[184:187], v[84:87]
    v_mfma_f32_16x16x32_bf16 v[88:91], v[36:39], v[188:191], v[88:91]
    ds_read_b128 v[36:39], v5 offset:0
    s_waitcnt lgkmcnt(6)
    v_mfma_f32_16x16x32_bf16 v[92:95], v[40:43], v[184:187], v[92:95]
    v_mfma_f32_16x16x32_bf16 v[96:99], v[40:43], v[188:191], v[96:99]
    ds_read_b128 v[40:43], v5 offset:1024
    s_waitcnt vmcnt(24) lgkmcnt(6)
    v_mfma_f32_16x16x32_bf16 v[44:47], v[16:19], v[192:195], v[44:47]
    buffer_load_dwordx4 v[184:187], v2, s[24:27], s37 offen offset:3072 sc1
    v_mfma_f32_16x16x32_bf16 v[48:51], v[16:19], v[196:199], v[48:51]
    ds_read_b128 v[16:19], v5 offset:2048
    s_waitcnt lgkmcnt(6)
    v_mfma_f32_16x16x32_bf16 v[52:55], v[20:23], v[192:195], v[52:55]
    buffer_load_dwordx4 v[188:191], v2, s[24:27], s38 offen offset:3072 sc1
    v_mfma_f32_16x16x32_bf16 v[56:59], v[20:23], v[196:199], v[56:59]
    ds_read_b128 v[20:23], v5 offset:3072
    s_waitcnt lgkmcnt(6)
    v_mfma_f32_16x16x32_bf16 v[60:63], v[24:27], v[192:195], v[60:63]
    v_mfma_f32_16x16x32_bf16 v[64:67], v[24:27], v[196:199], v[64:67]
    ds_read_b128 v[24:27], v5 offset:4096
    s_waitcnt lgkmcnt(6)
    v_mfma_f32_16x16x32_bf16 v[68:71], v[28:31], v[192:195], v[68:71]
    v_mfma_f32_16x16x32_bf16 v[72:75], v[28:31], v[196:199], v[72:75]
    ds_read_b128 v[28:31], v5 offset:5120
    s_waitcnt lgkmcnt(6)
    v_mfma_f32_16x16x32_bf16 v[76:79], v[32:35], v[192:195], v[76:79]
    v_mfma_f32_16x16x32_bf16 v[80:83], v[32:35], v[196:199], v[80:83]
    ds_read_b128 v[32:35], v5 offset:6144
    s_waitcnt lgkmcnt(6)
    v_mfma_f32_16x16x32_bf16 v[84:87], v[36:39], v[192:195], v[84:87]
    v_mfma_f32_16x16x32_bf16 v[88:91], v[36:39], v[196:199], v[88:91]
    ds_read_b128 v[36:39], v5 offset:7168
    s_waitcnt lgkmcnt(6)
    v_mfma_f32_16x16x32_bf16 v[92:95], v[40:43], v[192:195], v[92:95]
    v_mfma_f32_16x16x32_bf16 v[96:99], v[40:43], v[196:199], v[96:99]
    ds_read_b128 v[40:43], v5 offset:8192
    s_waitcnt vmcnt(19) lgkmcnt(6)
    v_mfma_f32_16x16x32_bf16 v[44:47], v[16:19], v[200:203], v[44:47]
    s_add_u32 s37, s37, 4096
    buffer_load_dwordx2 v[192:193], v3, s[24:27], s37 offen offset:0 sc1
    v_mfma_f32_16x16x32_bf16 v[48:51], v[16:19], v[204:207], v[48:51]
    ds_read_b128 v[16:19], v5 offset:9216
    s_waitcnt lgkmcnt(6)
    v_mfma_f32_16x16x32_bf16 v[52:55], v[20:23], v[200:203], v[52:55]
    buffer_load_dwordx2 v[194:195], v3, s[24:27], s37 offen offset:128 sc1
    v_mfma_f32_16x16x32_bf16 v[56:59], v[20:23], v[204:207], v[56:59]
    ds_read_b128 v[20:23], v5 offset:10240
    s_waitcnt lgkmcnt(6)
    v_mfma_f32_16x16x32_bf16 v[60:63], v[24:27], v[200:203], v[60:63]
    s_add_u32 s38, s38, 4096
    buffer_load_dwordx2 v[196:197], v3, s[24:27], s38 offen offset:0 sc1
    v_mfma_f32_16x16x32_bf16 v[64:67], v[24:27], v[204:207], v[64:67]
    ds_read_b128 v[24:27], v5 offset:11264
    s_waitcnt lgkmcnt(6)
    v_mfma_f32_16x16x32_bf16 v[68:71], v[28:31], v[200:203], v[68:71]
    buffer_load_dwordx2 v[198:199], v3, s[24:27], s38 offen offset:128 sc1
    v_mfma_f32_16x16x32_bf16 v[72:75], v[28:31], v[204:207], v[72:75]
    ds_read_b128 v[28:31], v5 offset:12288
    s_waitcnt lgkmcnt(6)
    v_mfma_f32_16x16x32_bf16 v[76:79], v[32:35], v[200:203], v[76:79]
    v_mfma_f32_16x16x32_bf16 v[80:83], v[32:35], v[204:207], v[80:83]
    ds_read_b128 v[32:35], v5 offset:13312
    s_waitcnt lgkmcnt(6)
    v_mfma_f32_16x16x32_bf16 v[84:87], v[36:39], v[200:203], v[84:87]
    v_mfma_f32_16x16x32_bf16 v[88:91], v[36:39], v[204:207], v[88:91]
    ds_read_b128 v[36:39], v5 offset:14336
    s_waitcnt lgkmcnt(6)
    v_mfma_f32_16x16x32_bf16 v[92:95], v[40:43], v[200:203], v[92:95]
    v_mfma_f32_16x16x32_bf16 v[96:99], v[40:43], v[204:207], v[96:99]
    ds_read_b128 v[40:43], v5 offset:15360
    s_waitcnt vmcnt(16) lgkmcnt(6)
    v_mfma_f32_16x16x32_bf16 v[44:47], v[16:19], v[152:155], v[44:47]
    buffer_load_dwordx4 v[200:203], v2, s[24:27], s37 offen offset:1024 sc1
    v_mfma_f32_16x16x32_bf16 v[48:51], v[16:19], v[156:159], v[48:51]
    ds_read_b128 v[16:19], v5 offset:16384
    s_waitcnt lgkmcnt(6)
    v_mfma_f32_16x16x32_bf16 v[52:55], v[20:23], v[152:155], v[52:55]
    buffer_load_dwordx4 v[204:207], v2, s[24:27], s38 offen offset:1024 sc1
    v_mfma_f32_16x16x32_bf16 v[56:59], v[20:23], v[156:159], v[56:59]
    ds_read_b128 v[20:23], v5 offset:17408
    s_waitcnt lgkmcnt(6)
    v_mfma_f32_16x16x32_bf16 v[60:63], v[24:27], v[152:155], v[60:63]
    v_mfma_f32_16x16x32_bf16 v[64:67], v[24:27], v[156:159], v[64:67]
    ds_read_b128 v[24:27], v5 offset:18432
    s_waitcnt lgkmcnt(6)
    v_mfma_f32_16x16x32_bf16 v[68:71], v[28:31], v[152:155], v[68:71]
    v_mfma_f32_16x16x32_bf16 v[72:75], v[28:31], v[156:159], v[72:75]
    ds_read_b128 v[28:31], v5 offset:19456
    s_waitcnt lgkmcnt(6)
    v_mfma_f32_16x16x32_bf16 v[76:79], v[32:35], v[152:155], v[76:79]
    v_mfma_f32_16x16x32_bf16 v[80:83], v[32:35], v[156:159], v[80:83]
    ds_read_b128 v[32:35], v5 offset:20480
    s_waitcnt lgkmcnt(6)
    v_mfma_f32_16x16x32_bf16 v[84:87], v[36:39], v[152:155], v[84:87]
    v_mfma_f32_16x16x32_bf16 v[88:91], v[36:39], v[156:159], v[88:91]
    ds_read_b128 v[36:39], v5 offset:21504
    s_waitcnt lgkmcnt(6)
    v_mfma_f32_16x16x32_bf16 v[92:95], v[40:43], v[152:155], v[92:95]
    v_mfma_f32_16x16x32_bf16 v[96:99], v[40:43], v[156:159], v[96:99]
    ds_read_b128 v[40:43], v5 offset:22528
    s_waitcnt vmcnt(12) lgkmcnt(6)
    v_mfma_f32_16x16x32_bf16 v[44:47], v[16:19], v[160:163], v[44:47]
    buffer_load_dwordx4 v[152:155], v2, s[24:27], s37 offen offset:2048 sc1
    v_mfma_f32_16x16x32_bf16 v[48:51], v[16:19], v[164:167], v[48:51]
    ds_read_b128 v[16:19], v5 offset:23552
    s_waitcnt lgkmcnt(6)
    v_mfma_f32_16x16x32_bf16 v[52:55], v[20:23], v[160:163], v[52:55]
    buffer_load_dwordx4 v[156:159], v2, s[24:27], s38 offen offset:2048 sc1
    v_mfma_f32_16x16x32_bf16 v[56:59], v[20:23], v[164:167], v[56:59]
    ds_read_b128 v[20:23], v5 offset:24576
    s_waitcnt lgkmcnt(6)
    v_mfma_f32_16x16x32_bf16 v[60:63], v[24:27], v[160:163], v[60:63]
    v_add_f32 v142, v142, v144
    v_add_f32 v143, v143, v145
    v_mfma_f32_16x16x32_bf16 v[64:67], v[24:27], v[164:167], v[64:67]
    ds_read_b128 v[24:27], v5 offset:25600
    s_waitcnt lgkmcnt(6)
    v_mfma_f32_16x16x32_bf16 v[68:71], v[28:31], v[160:163], v[68:71]
    v_add_f32 v146, v146, v148
    v_add_f32 v147, v147, v149
    v_mfma_f32_16x16x32_bf16 v[72:75], v[28:31], v[164:167], v[72:75]
    ds_read_b128 v[28:31], v5 offset:26624
    s_waitcnt lgkmcnt(6)
    v_mfma_f32_16x16x32_bf16 v[76:79], v[32:35], v[160:163], v[76:79]
    v_mov_b32 v144, v142
    v_mov_b32 v145, v143
    v_mfma_f32_16x16x32_bf16 v[80:83], v[32:35], v[164:167], v[80:83]
    ds_read_b128 v[32:35], v5 offset:27648
    s_waitcnt lgkmcnt(6)
    v_mfma_f32_16x16x32_bf16 v[84:87], v[36:39], v[160:163], v[84:87]
    v_mov_b32 v148, v146
    v_mov_b32 v149, v147
    v_mfma_f32_16x16x32_bf16 v[88:91], v[36:39], v[164:167], v[88:91]
    ds_read_b128 v[36:39], v5 offset:28672
    s_waitcnt lgkmcnt(6)
    v_mfma_f32_16x16x32_bf16 v[92:95], v[40:43], v[160:163], v[92:95]
    v_permlane32_swap_b32 v142, v144
    v_permlane32_swap_b32 v143, v145
    v_mfma_f32_16x16x32_bf16 v[96:99], v[40:43], v[164:167], v[96:99]
    ds_read_b128 v[40:43], v5 offset:29696
    s_waitcnt vmcnt(12) lgkmcnt(6)
    v_mfma_f32_16x16x32_bf16 v[44:47], v[16:19], v[168:171], v[44:47]
    buffer_load_dwordx4 v[160:163], v2, s[24:27], s37 offen offset:3072 sc1
    v_mfma_f32_16x16x32_bf16 v[48:51], v[16:19], v[172:175], v[48:51]
    ds_read_b128 v[16:19], v5 offset:30720
    s_waitcnt lgkmcnt(6)
    v_mfma_f32_16x16x32_bf16 v[52:55], v[20:23], v[168:171], v[52:55]
    buffer_load_dwordx4 v[164:167], v2, s[24:27], s38 offen offset:3072 sc1
    v_mfma_f32_16x16x32_bf16 v[56:59], v[20:23], v[172:175], v[56:59]
    ds_read_b128 v[20:23], v5 offset:31744
    s_waitcnt lgkmcnt(6)
    v_mfma_f32_16x16x32_bf16 v[60:63], v[24:27], v[168:171], v[60:63]
    v_permlane32_swap_b32 v146, v148
    v_permlane32_swap_b32 v147, v149
    v_mfma_f32_16x16x32_bf16 v[64:67], v[24:27], v[172:175], v[64:67]
    ds_read_b128 v[24:27], v5 offset:32768
    s_waitcnt lgkmcnt(6)
    v_mfma_f32_16x16x32_bf16 v[68:71], v[28:31], v[168:171], v[68:71]
    v_add_f32 v142, v142, v144
    v_add_f32 v143, v143, v145
    v_mfma_f32_16x16x32_bf16 v[72:75], v[28:31], v[172:175], v[72:75]
    ds_read_b128 v[28:31], v5 offset:33792
    s_waitcnt lgkmcnt(6)
    v_mfma_f32_16x16x32_bf16 v[76:79], v[32:35], v[168:171], v[76:79]
    v_add_f32 v146, v146, v148
    v_add_f32 v147, v147, v149
    v_mfma_f32_16x16x32_bf16 v[80:83], v[32:35], v[172:175], v[80:83]
    ds_read_b128 v[32:35], v5 offset:34816
    s_waitcnt lgkmcnt(6)
    v_mfma_f32_16x16x32_bf16 v[84:87], v[36:39], v[168:171], v[84:87]
    v_mov_b32 v144, v142
    v_mov_b32 v145, v143
    v_mfma_f32_16x16x32_bf16 v[88:91], v[36:39], v[172:175], v[88:91]
    ds_read_b128 v[36:39], v5 offset:35840
    s_waitcnt lgkmcnt(6)
    v_mfma_f32_16x16x32_bf16 v[92:95], v[40:43], v[168:171], v[92:95]
    v_mov_b32 v148, v146
    v_mov_b32 v149, v147
    v_mfma_f32_16x16x32_bf16 v[96:99], v[40:43], v[172:175], v[96:99]
    ds_read_b128 v[40:43], v5 offset:36864
    s_waitcnt vmcnt(12) lgkmcnt(6)
    v_mfma_f32_16x16x32_bf16 v[44:47], v[16:19], v[176:179], v[44:47]
    s_add_u32 s37, s37, 4096
    buffer_load_dwordx4 v[168:171], v2, s[24:27], s37 offen offset:0 sc1
    v_mfma_f32_16x16x32_bf16 v[48:51], v[16:19], v[180:183], v[48:51]
    ds_read_b128 v[16:19], v5 offset:37888
    s_waitcnt lgkmcnt(6)
    v_mfma_f32_16x16x32_bf16 v[52:55], v[20:23], v[176:179], v[52:55]
    s_add_u32 s38, s38, 4096
    buffer_load_dwordx4 v[172:175], v2, s[24:27], s38 offen offset:0 sc1
    v_mfma_f32_16x16x32_bf16 v[56:59], v[20:23], v[180:183], v[56:59]
    ds_read_b128 v[20:23], v5 offset:38912
    s_waitcnt lgkmcnt(6)
    v_mfma_f32_16x16x32_bf16 v[60:63], v[24:27], v[176:179], v[60:63]
    v_permlane16_swap_b32 v142, v144
    v_permlane16_swap_b32 v143, v145
    v_mfma_f32_16x16x32_bf16 v[64:67], v[24:27], v[180:183], v[64:67]
    ds_read_b128 v[24:27], v5 offset:39936
    s_waitcnt lgkmcnt(6)
    v_mfma_f32_16x16x32_bf16 v[68:71], v[28:31], v[176:179], v[68:71]
    v_permlane16_swap_b32 v146, v148
    v_permlane16_swap_b32 v147, v149
    v_mfma_f32_16x16x32_bf16 v[72:75], v[28:31], v[180:183], v[72:75]
    ds_read_b128 v[28:31], v5 offset:40960
    s_waitcnt lgkmcnt(6)
    v_mfma_f32_16x16x32_bf16 v[76:79], v[32:35], v[176:179], v[76:79]
    v_add_f32 v142, v142, v144
    v_add_f32 v143, v143, v145
    v_mfma_f32_16x16x32_bf16 v[80:83], v[32:35], v[180:183], v[80:83]
    ds_read_b128 v[32:35], v5 offset:41984
    s_waitcnt lgkmcnt(6)
    v_mfma_f32_16x16x32_bf16 v[84:87], v[36:39], v[176:179], v[84:87]
    v_add_f32 v146, v146, v148
    v_add_f32 v147, v147, v149
    v_mfma_f32_16x16x32_bf16 v[88:91], v[36:39], v[180:183], v[88:91]
    ds_read_b128 v[36:39], v5 offset:43008
    s_waitcnt lgkmcnt(6)
    v_mfma_f32_16x16x32_bf16 v[92:95], v[40:43], v[176:179], v[92:95]
    v_add_f32 v144, v142, v143
    v_mfma_f32_16x16x32_bf16 v[96:99], v[40:43], v[180:183], v[96:99]
    ds_read_b128 v[40:43], v5 offset:44032
    s_waitcnt vmcnt(12) lgkmcnt(6)
    v_mfma_f32_16x16x32_bf16 v[44:47], v[16:19], v[184:187], v[44:47]
    buffer_load_dwordx2 v[176:177], v3, s[24:27], s37 offen offset:1024 sc1
    v_mfma_f32_16x16x32_bf16 v[48:51], v[16:19], v[188:191], v[48:51]
    ds_read_b128 v[16:19], v5 offset:45056
    s_waitcnt lgkmcnt(6)
    v_mfma_f32_16x16x32_bf16 v[52:55], v[20:23], v[184:187], v[52:55]
    buffer_load_dwordx2 v[178:179], v3, s[24:27], s37 offen offset:1152 sc1
    v_mfma_f32_16x16x32_bf16 v[56:59], v[20:23], v[188:191], v[56:59]
    ds_read_b128 v[20:23], v5 offset:46080
    s_waitcnt lgkmcnt(6)
    v_mfma_f32_16x16x32_bf16 v[60:63], v[24:27], v[184:187], v[60:63]
    buffer_load_dwordx2 v[180:181], v3, s[24:27], s38 offen offset:1024 sc1
    v_mfma_f32_16x16x32_bf16 v[64:67], v[24:27], v[188:191], v[64:67]
    ds_read_b128 v[24:27], v5 offset:47104
    s_waitcnt lgkmcnt(6)
    v_mfma_f32_16x16x32_bf16 v[68:71], v[28:31], v[184:187], v[68:71]
    buffer_load_dwordx2 v[182:183], v3, s[24:27], s38 offen offset:1152 sc1
    v_mfma_f32_16x16x32_bf16 v[72:75], v[28:31], v[188:191], v[72:75]
    ds_read_b128 v[28:31], v5 offset:48128
    s_waitcnt lgkmcnt(6)
    v_mfma_f32_16x16x32_bf16 v[76:79], v[32:35], v[184:187], v[76:79]
    v_add_f32 v148, v146, v147
    v_mfma_f32_16x16x32_bf16 v[80:83], v[32:35], v[188:191], v[80:83]
    ds_read_b128 v[32:35], v5 offset:49152
    s_waitcnt lgkmcnt(6)
    v_mfma_f32_16x16x32_bf16 v[84:87], v[36:39], v[184:187], v[84:87]
    v_mul_f32 v142, 0xbacccccd, v142
    v_mul_f32 v143, 0x3acccccd, v143
    v_mfma_f32_16x16x32_bf16 v[88:91], v[36:39], v[188:191], v[88:91]
    ds_read_b128 v[36:39], v5 offset:50176
    s_waitcnt lgkmcnt(6)
    v_mfma_f32_16x16x32_bf16 v[92:95], v[40:43], v[184:187], v[92:95]
    v_mul_f32 v146, 0xbacccccd, v146
    v_mul_f32 v147, 0x3acccccd, v147
    v_mfma_f32_16x16x32_bf16 v[96:99], v[40:43], v[188:191], v[96:99]
    ds_read_b128 v[40:43], v5 offset:51200
    s_waitcnt vmcnt(12) lgkmcnt(6)
    v_mfma_f32_16x16x32_bf16 v[44:47], v[16:19], v[192:195], v[44:47]
    buffer_load_dwordx4 v[184:187], v2, s[24:27], s37 offen offset:2048 sc1
    v_mfma_f32_16x16x32_bf16 v[48:51], v[16:19], v[196:199], v[48:51]
    ds_read_b128 v[16:19], v5 offset:52224
    s_waitcnt lgkmcnt(6)
    v_mfma_f32_16x16x32_bf16 v[52:55], v[20:23], v[192:195], v[52:55]
    buffer_load_dwordx4 v[188:191], v2, s[24:27], s38 offen offset:2048 sc1
    v_mfma_f32_16x16x32_bf16 v[56:59], v[20:23], v[196:199], v[56:59]
    ds_read_b128 v[20:23], v5 offset:53248
    s_waitcnt lgkmcnt(6)
    v_mfma_f32_16x16x32_bf16 v[60:63], v[24:27], v[192:195], v[60:63]
    v_fma_f32 v143, -v142, v142, v143
    v_max_f32 v143, 0, v143
    v_mfma_f32_16x16x32_bf16 v[64:67], v[24:27], v[196:199], v[64:67]
    ds_read_b128 v[24:27], v5 offset:54272
    s_waitcnt lgkmcnt(6)
    v_mfma_f32_16x16x32_bf16 v[68:71], v[28:31], v[192:195], v[68:71]
    v_fma_f32 v147, -v146, v146, v147
    v_max_f32 v147, 0, v147
    v_mfma_f32_16x16x32_bf16 v[72:75], v[28:31], v[196:199], v[72:75]
    ds_read_b128 v[28:31], v5 offset:55296
    s_waitcnt lgkmcnt(6)
    v_mfma_f32_16x16x32_bf16 v[76:79], v[32:35], v[192:195], v[76:79]
    v_add_f32 v143, 0x3727c5ac, v143
    v_mfma_f32_16x16x32_bf16 v[80:83], v[32:35], v[196:199], v[80:83]
    ds_read_b128 v[32:35], v5 offset:56320
    s_waitcnt lgkmcnt(6)
    v_mfma_f32_16x16x32_bf16 v[84:87], v[36:39], v[192:195], v[84:87]
    v_add_f32 v147, 0x3727c5ac, v147
    v_mfma_f32_16x16x32_bf16 v[88:91], v[36:39], v[196:199], v[88:91]
    ds_read_b128 v[36:39], v5 offset:57344
    s_waitcnt lgkmcnt(6)
    v_mfma_f32_16x16x32_bf16 v[92:95], v[40:43], v[192:195], v[92:95]
    v_rsq_f32 v143, v143
    v_mfma_f32_16x16x32_bf16 v[96:99], v[40:43], v[196:199], v[96:99]
    ds_read_b128 v[40:43], v5 offset:58368
    s_waitcnt vmcnt(12) lgkmcnt(6)
    v_mfma_f32_16x16x32_bf16 v[44:47], v[16:19], v[200:203], v[44:47]
    buffer_load_dwordx4 v[192:195], v2, s[24:27], s37 offen offset:3072 sc1
    v_mfma_f32_16x16x32_bf16 v[48:51], v[16:19], v[204:207], v[48:51]
    ds_read_b128 v[16:19], v5 offset:59392
    s_waitcnt lgkmcnt(6)
    v_mfma_f32_16x16x32_bf16 v[52:55], v[20:23], v[200:203], v[52:55]
    buffer_load_dwordx4 v[196:199], v2, s[24:27], s38 offen offset:3072 sc1
    v_mfma_f32_16x16x32_bf16 v[56:59], v[20:23], v[204:207], v[56:59]
    ds_read_b128 v[20:23], v5 offset:60416
    s_waitcnt lgkmcnt(6)
    v_mfma_f32_16x16x32_bf16 v[60:63], v[24:27], v[200:203], v[60:63]
    v_rsq_f32 v147, v147
    v_mfma_f32_16x16x32_bf16 v[64:67], v[24:27], v[204:207], v[64:67]
    ds_read_b128 v[24:27], v5 offset:61440
    s_waitcnt lgkmcnt(6)
    v_mfma_f32_16x16x32_bf16 v[68:71], v[28:31], v[200:203], v[68:71]
    v_mul_f32 v143, 0xbfb8aa3b, v143
    v_mul_f32 v142, v142, v143
    v_mfma_f32_16x16x32_bf16 v[72:75], v[28:31], v[204:207], v[72:75]
    ds_read_b128 v[28:31], v5 offset:62464
    s_waitcnt lgkmcnt(6)
    v_mfma_f32_16x16x32_bf16 v[76:79], v[32:35], v[200:203], v[76:79]
    v_mul_f32 v147, 0xbfb8aa3b, v147
    v_mul_f32 v146, v146, v147
    v_mfma_f32_16x16x32_bf16 v[80:83], v[32:35], v[204:207], v[80:83]
    ds_read_b128 v[32:35], v5 offset:63488
    s_waitcnt lgkmcnt(6)
    v_mfma_f32_16x16x32_bf16 v[84:87], v[36:39], v[200:203], v[84:87]
    v_mul_f32 v208, v100, v146
    v_mul_f32 v100, v100, v142
    v_mfma_f32_16x16x32_bf16 v[88:91], v[36:39], v[204:207], v[88:91]
    ds_read_b128 v[36:39], v5 offset:64512
    s_waitcnt lgkmcnt(6)
    v_mfma_f32_16x16x32_bf16 v[92:95], v[40:43], v[200:203], v[92:95]
    v_mul_f32 v209, v101, v146
    v_mul_f32 v101, v101, v142
    v_mfma_f32_16x16x32_bf16 v[96:99], v[40:43], v[204:207], v[96:99]
    ds_read_b128 v[40:43], v6 offset:0
    s_waitcnt vmcnt(12) lgkmcnt(6)
    v_mfma_f32_16x16x32_bf16 v[44:47], v[16:19], v[152:155], v[44:47]
    s_barrier
    v_mfma_f32_16x16x32_bf16 v[48:51], v[16:19], v[156:159], v[48:51]
    ds_read_b128 v[16:19], v6 offset:1024
    s_waitcnt lgkmcnt(6)
    v_mfma_f32_16x16x32_bf16 v[52:55], v[20:23], v[152:155], v[52:55]
    v_mul_f32 v210, v102, v146
    v_mul_f32 v102, v102, v142
    v_mfma_f32_16x16x32_bf16 v[56:59], v[20:23], v[156:159], v[56:59]
    ds_read_b128 v[20:23], v6 offset:2048
    s_waitcnt lgkmcnt(6)
    v_mfma_f32_16x16x32_bf16 v[60:63], v[24:27], v[152:155], v[60:63]
    v_mul_f32 v211, v103, v146
    v_mul_f32 v103, v103, v142
    v_mfma_f32_16x16x32_bf16 v[64:67], v[24:27], v[156:159], v[64:67]
    ds_read_b128 v[24:27], v6 offset:3072
    s_waitcnt lgkmcnt(6)
    v_mfma_f32_16x16x32_bf16 v[68:71], v[28:31], v[152:155], v[68:71]
    v_mul_f32 v212, v104, v146
    v_mul_f32 v104, v104, v142
    v_mfma_f32_16x16x32_bf16 v[72:75], v[28:31], v[156:159], v[72:75]
    ds_read_b128 v[28:31], v6 offset:4096
    s_waitcnt lgkmcnt(6)
    v_mfma_f32_16x16x32_bf16 v[76:79], v[32:35], v[152:155], v[76:79]
    v_mul_f32 v213, v105, v146
    v_mul_f32 v105, v105, v142
    v_mfma_f32_16x16x32_bf16 v[80:83], v[32:35], v[156:159], v[80:83]
    ds_read_b128 v[32:35], v6 offset:5120
    s_waitcnt lgkmcnt(6)
    v_mfma_f32_16x16x32_bf16 v[84:87], v[36:39], v[152:155], v[84:87]
    v_mul_f32 v214, v106, v146
    v_mul_f32 v106, v106, v142
    v_mfma_f32_16x16x32_bf16 v[88:91], v[36:39], v[156:159], v[88:91]
    ds_read_b128 v[36:39], v6 offset:6144
    s_waitcnt lgkmcnt(6)
    v_mfma_f32_16x16x32_bf16 v[92:95], v[40:43], v[152:155], v[92:95]
    v_mul_f32 v215, v107, v146
    v_mul_f32 v107, v107, v142
    v_mfma_f32_16x16x32_bf16 v[96:99], v[40:43], v[156:159], v[96:99]
    ds_read_b128 v[40:43], v6 offset:7168
    s_waitcnt vmcnt(10) lgkmcnt(6)
    v_mfma_f32_16x16x32_bf16 v[44:47], v[16:19], v[160:163], v[44:47]
    v_mul_f32 v216, v108, v146
    v_mul_f32 v108, v108, v142
    v_mfma_f32_16x16x32_bf16 v[48:51], v[16:19], v[164:167], v[48:51]
    ds_read_b128 v[16:19], v6 offset:8192
    s_waitcnt lgkmcnt(6)
    v_mfma_f32_16x16x32_bf16 v[52:55], v[20:23], v[160:163], v[52:55]
    v_mul_f32 v217, v109, v146
    v_mul_f32 v109, v109, v142
    v_mfma_f32_16x16x32_bf16 v[56:59], v[20:23], v[164:167], v[56:59]
    ds_read_b128 v[20:23], v6 offset:9216
    s_waitcnt lgkmcnt(6)
    v_mfma_f32_16x16x32_bf16 v[60:63], v[24:27], v[160:163], v[60:63]
    v_mul_f32 v218, v110, v146
    v_mul_f32 v110, v110, v142
    v_mfma_f32_16x16x32_bf16 v[64:67], v[24:27], v[164:167], v[64:67]
    ds_read_b128 v[24:27], v6 offset:10240
    s_waitcnt lgkmcnt(6)
    v_mfma_f32_16x16x32_bf16 v[68:71], v[28:31], v[160:163], v[68:71]
    v_mul_f32 v219, v111, v146
    v_mul_f32 v111, v111, v142
    v_mfma_f32_16x16x32_bf16 v[72:75], v[28:31], v[164:167], v[72:75]
    ds_read_b128 v[28:31], v6 offset:11264
    s_waitcnt lgkmcnt(6)
    v_mfma_f32_16x16x32_bf16 v[76:79], v[32:35], v[160:163], v[76:79]
    v_mul_f32 v220, v112, v146
    v_mul_f32 v112, v112, v142
    v_mfma_f32_16x16x32_bf16 v[80:83], v[32:35], v[164:167], v[80:83]
    ds_read_b128 v[32:35], v6 offset:12288
    s_waitcnt lgkmcnt(6)
    v_mfma_f32_16x16x32_bf16 v[84:87], v[36:39], v[160:163], v[84:87]
    v_mul_f32 v221, v113, v146
    v_mul_f32 v113, v113, v142
    v_mfma_f32_16x16x32_bf16 v[88:91], v[36:39], v[164:167], v[88:91]
    ds_read_b128 v[36:39], v6 offset:13312
    s_waitcnt lgkmcnt(6)
    v_mfma_f32_16x16x32_bf16 v[92:95], v[40:43], v[160:163], v[92:95]
    v_mul_f32 v222, v114, v146
    v_mul_f32 v114, v114, v142
    v_mfma_f32_16x16x32_bf16 v[96:99], v[40:43], v[164:167], v[96:99]
    ds_read_b128 v[40:43], v6 offset:14336
    s_waitcnt vmcnt(8) lgkmcnt(6)
    v_mfma_f32_16x16x32_bf16 v[44:47], v[16:19], v[168:171], v[44:47]
    v_mul_f32 v223, v115, v146
    v_mul_f32 v115, v115, v142
    v_mfma_f32_16x16x32_bf16 v[48:51], v[16:19], v[172:175], v[48:51]
    ds_read_b128 v[16:19], v6 offset:15360
    s_waitcnt lgkmcnt(6)
    v_mfma_f32_16x16x32_bf16 v[52:55], v[20:23], v[168:171], v[52:55]
    v_mul_f32 v224, v116, v146
    v_mul_f32 v116, v116, v142
    v_mfma_f32_16x16x32_bf16 v[56:59], v[20:23], v[172:175], v[56:59]
    ds_read_b128 v[20:23], v6 offset:16384
    s_waitcnt lgkmcnt(6)
    v_mfma_f32_16x16x32_bf16 v[60:63], v[24:27], v[168:171], v[60:63]
    v_mul_f32 v225, v117, v146
    v_mul_f32 v117, v117, v142
    v_mfma_f32_16x16x32_bf16 v[64:67], v[24:27], v[172:175], v[64:67]
    ds_read_b128 v[24:27], v6 offset:17408
    s_waitcnt lgkmcnt(6)
    v_mfma_f32_16x16x32_bf16 v[68:71], v[28:31], v[168:171], v[68:71]
    v_mul_f32 v226, v118, v146
    v_mul_f32 v118, v118, v142
    v_mfma_f32_16x16x32_bf16 v[72:75], v[28:31], v[172:175], v[72:75]
    ds_read_b128 v[28:31], v6 offset:18432
    s_waitcnt lgkmcnt(6)
    v_mfma_f32_16x16x32_bf16 v[76:79], v[32:35], v[168:171], v[76:79]
    v_mul_f32 v227, v119, v146
    v_mul_f32 v119, v119, v142
    v_mfma_f32_16x16x32_bf16 v[80:83], v[32:35], v[172:175], v[80:83]
    ds_read_b128 v[32:35], v6 offset:19456
    s_waitcnt lgkmcnt(6)
    v_mfma_f32_16x16x32_bf16 v[84:87], v[36:39], v[168:171], v[84:87]
    v_mul_f32 v228, v120, v146
    v_mul_f32 v120, v120, v142
    v_mfma_f32_16x16x32_bf16 v[88:91], v[36:39], v[172:175], v[88:91]
    ds_read_b128 v[36:39], v6 offset:20480
    s_waitcnt lgkmcnt(6)
    v_mfma_f32_16x16x32_bf16 v[92:95], v[40:43], v[168:171], v[92:95]
    v_mul_f32 v229, v121, v146
    v_mul_f32 v121, v121, v142
    v_mfma_f32_16x16x32_bf16 v[96:99], v[40:43], v[172:175], v[96:99]
    ds_read_b128 v[40:43], v6 offset:21504
    s_waitcnt vmcnt(4) lgkmcnt(6)
    v_mfma_f32_16x16x32_bf16 v[44:47], v[16:19], v[176:179], v[44:47]
    v_mul_f32 v230, v122, v146
    v_mul_f32 v122, v122, v142
    v_mfma_f32_16x16x32_bf16 v[48:51], v[16:19], v[180:183], v[48:51]
    ds_read_b128 v[16:19], v6 offset:22528
    s_waitcnt lgkmcnt(6)
    v_mfma_f32_16x16x32_bf16 v[52:55], v[20:23], v[176:179], v[52:55]
    v_mul_f32 v231, v123, v146
    v_mul_f32 v123, v123, v142
    v_mfma_f32_16x16x32_bf16 v[56:59], v[20:23], v[180:183], v[56:59]
    ds_read_b128 v[20:23], v6 offset:23552
    s_waitcnt lgkmcnt(6)
    v_mfma_f32_16x16x32_bf16 v[60:63], v[24:27], v[176:179], v[60:63]
    v_mul_f32 v232, v124, v146
    v_mul_f32 v124, v124, v142
    v_mfma_f32_16x16x32_bf16 v[64:67], v[24:27], v[180:183], v[64:67]
    ds_read_b128 v[24:27], v6 offset:24576
    s_waitcnt lgkmcnt(6)
    v_mfma_f32_16x16x32_bf16 v[68:71], v[28:31], v[176:179], v[68:71]
    v_mul_f32 v233, v125, v146
    v_mul_f32 v125, v125, v142
    v_mfma_f32_16x16x32_bf16 v[72:75], v[28:31], v[180:183], v[72:75]
    ds_read_b128 v[28:31], v6 offset:25600
    s_waitcnt lgkmcnt(6)
    v_mfma_f32_16x16x32_bf16 v[76:79], v[32:35], v[176:179], v[76:79]
    v_mul_f32 v234, v126, v146
    v_mul_f32 v126, v126, v142
    v_mfma_f32_16x16x32_bf16 v[80:83], v[32:35], v[180:183], v[80:83]
    ds_read_b128 v[32:35], v6 offset:26624
    s_waitcnt lgkmcnt(6)
    v_mfma_f32_16x16x32_bf16 v[84:87], v[36:39], v[176:179], v[84:87]
    v_mul_f32 v235, v127, v146
    v_mul_f32 v127, v127, v142
    v_mfma_f32_16x16x32_bf16 v[88:91], v[36:39], v[180:183], v[88:91]
    ds_read_b128 v[36:39], v6 offset:27648
    s_waitcnt lgkmcnt(6)
    v_mfma_f32_16x16x32_bf16 v[92:95], v[40:43], v[176:179], v[92:95]
    v_mfma_f32_16x16x32_bf16 v[96:99], v[40:43], v[180:183], v[96:99]
    ds_read_b128 v[40:43], v6 offset:28672
    s_waitcnt vmcnt(2) lgkmcnt(6)
    v_mfma_f32_16x16x32_bf16 v[44:47], v[16:19], v[184:187], v[44:47]
    v_mfma_f32_16x16x32_bf16 v[48:51], v[16:19], v[188:191], v[48:51]
    ds_read_b128 v[16:19], v6 offset:29696
    s_waitcnt lgkmcnt(6)
    v_mfma_f32_16x16x32_bf16 v[52:55], v[20:23], v[184:187], v[52:55]
    v_mfma_f32_16x16x32_bf16 v[56:59], v[20:23], v[188:191], v[56:59]
    ds_read_b128 v[20:23], v6 offset:30720
    s_waitcnt lgkmcnt(6)
    v_mfma_f32_16x16x32_bf16 v[60:63], v[24:27], v[184:187], v[60:63]
    v_mfma_f32_16x16x32_bf16 v[64:67], v[24:27], v[188:191], v[64:67]
    ds_read_b128 v[24:27], v6 offset:31744
    s_waitcnt lgkmcnt(6)
    v_mfma_f32_16x16x32_bf16 v[68:71], v[28:31], v[184:187], v[68:71]
    v_mfma_f32_16x16x32_bf16 v[72:75], v[28:31], v[188:191], v[72:75]
    ds_read_b128 v[28:31], v6 offset:32768
    s_waitcnt lgkmcnt(6)
    v_mfma_f32_16x16x32_bf16 v[76:79], v[32:35], v[184:187], v[76:79]
    v_mfma_f32_16x16x32_bf16 v[80:83], v[32:35], v[188:191], v[80:83]
    ds_read_b128 v[32:35], v6 offset:33792
    s_waitcnt lgkmcnt(6)
    v_mfma_f32_16x16x32_bf16 v[84:87], v[36:39], v[184:187], v[84:87]
    v_mfma_f32_16x16x32_bf16 v[88:91], v[36:39], v[188:191], v[88:91]
    ds_read_b128 v[36:39], v6 offset:34816
    s_waitcnt lgkmcnt(6)
    v_mfma_f32_16x16x32_bf16 v[92:95], v[40:43], v[184:187], v[92:95]
    v_mfma_f32_16x16x32_bf16 v[96:99], v[40:43], v[188:191], v[96:99]
    ds_read_b128 v[40:43], v6 offset:35840
    s_waitcnt vmcnt(0) lgkmcnt(6)
    v_mfma_f32_16x16x32_bf16 v[44:47], v[16:19], v[192:195], v[44:47]
    v_mfma_f32_16x16x32_bf16 v[48:51], v[16:19], v[196:199], v[48:51]
    s_waitcnt lgkmcnt(5)
    v_mfma_f32_16x16x32_bf16 v[52:55], v[20:23], v[192:195], v[52:55]
    v_mfma_f32_16x16x32_bf16 v[56:59], v[20:23], v[196:199], v[56:59]
    s_waitcnt lgkmcnt(4)
    v_mfma_f32_16x16x32_bf16 v[60:63], v[24:27], v[192:195], v[60:63]
    v_mfma_f32_16x16x32_bf16 v[64:67], v[24:27], v[196:199], v[64:67]
    s_waitcnt lgkmcnt(3)
    v_mfma_f32_16x16x32_bf16 v[68:71], v[28:31], v[192:195], v[68:71]
    v_mfma_f32_16x16x32_bf16 v[72:75], v[28:31], v[196:199], v[72:75]
    v_cmp_u_f32 vcc, v44, v48
    s_nop 0
    s_cbranch_vccnz k_r4_7
    s_waitcnt lgkmcnt(2)
    v_mfma_f32_16x16x32_bf16 v[76:79], v[32:35], v[192:195], v[76:79]
    v_mfma_f32_16x16x32_bf16 v[80:83], v[32:35], v[196:199], v[80:83]
    s_waitcnt lgkmcnt(1)
    v_mfma_f32_16x16x32_bf16 v[84:87], v[36:39], v[192:195], v[84:87]
    v_mfma_f32_16x16x32_bf16 v[88:91], v[36:39], v[196:199], v[88:91]
    s_waitcnt lgkmcnt(0)
    v_mfma_f32_16x16x32_bf16 v[92:95], v[40:43], v[192:195], v[92:95]
    v_mfma_f32_16x16x32_bf16 v[96:99], v[40:43], v[196:199], v[96:99]
    v_cmp_u_f32 vcc, v144, v148
    s_nop 0
    s_cbranch_vccnz k_r4_7
k_r4_7_ret:
    s_mov_b32 s54, s93
    s_add_u32 s56, s93, 55296
    s_add_u32 s57, s94, 55296
    v_mov_b32 v14, 0xbfb8aa3b
    v_mov_b32 v15, 0xbfb8aa3b
    v_pk_fma_f32 v[44:45], v[44:45], v[142:143], v[100:101] op_sel:[0,1,0] op_sel_hi:[1,1,1]
    v_pk_fma_f32 v[46:47], v[46:47], v[142:143], v[102:103] op_sel:[0,1,0] op_sel_hi:[1,1,1]
    v_pk_fma_f32 v[52:53], v[52:53], v[142:143], v[104:105] op_sel:[0,1,0] op_sel_hi:[1,1,1]
    v_pk_fma_f32 v[54:55], v[54:55], v[142:143], v[106:107] op_sel:[0,1,0] op_sel_hi:[1,1,1]
    v_exp_f32 v16, v44
    v_exp_f32 v17, v45
    v_exp_f32 v18, v46
    v_exp_f32 v19, v47
    v_exp_f32 v20, v52
    v_exp_f32 v21, v53
    v_exp_f32 v22, v54
    v_exp_f32 v23, v55
    v_pk_fma_f32 v[16:17], v[16:17], v[14:15], v[14:15]
    v_pk_fma_f32 v[18:19], v[18:19], v[14:15], v[14:15]
    v_pk_fma_f32 v[20:21], v[20:21], v[14:15], v[14:15]
    v_pk_fma_f32 v[22:23], v[22:23], v[14:15], v[14:15]
    v_rcp_f32 v16, v16
    v_rcp_f32 v17, v17
    v_rcp_f32 v18, v18
    v_rcp_f32 v19, v19
    v_rcp_f32 v20, v20
    v_rcp_f32 v21, v21
    v_rcp_f32 v22, v22
    v_rcp_f32 v23, v23
    v_pk_mul_f32 v[44:45], v[44:45], v[16:17]
    v_pk_mul_f32 v[46:47], v[46:47], v[18:19]
    v_pk_mul_f32 v[52:53], v[52:53], v[20:21]
    v_pk_mul_f32 v[54:55], v[54:55], v[22:23]
    v_cvt_pk_bf16_f32 v24, v44, v45
    v_cvt_pk_bf16_f32 v25, v46, v47
    v_cvt_pk_bf16_f32 v26, v52, v53
    v_cvt_pk_bf16_f32 v27, v54, v55
    buffer_store_dwordx4 v[24:27], v2, s[24:27], s54 offen sc1
    s_add_u32 s54, s54, 8192
    s_lshl_b32 s53, s64, 1
    s_add_u32 s53, s53, s63
    s_mul_i32 s55, s63, 27648
    s_add_u32 s55, s55, 13107200
    s_mul_i32 s37, s53, 55296
    s_add_u32 s37, s37, s55
    s_mul_i32 s73, s53, 2048
    s_add_u32 s73, s73, 26722304
    s_xor_b32 s53, s53, 1
    s_mul_i32 s38, s53, 55296
    s_add_u32 s38, s38, s55
    v_pk_fma_f32 v[48:49], v[48:49], v[146:147], v[208:209] op_sel:[0,1,0] op_sel_hi:[1,1,1]
    v_pk_fma_f32 v[50:51], v[50:51], v[146:147], v[210:211] op_sel:[0,1,0] op_sel_hi:[1,1,1]
    v_pk_fma_f32 v[56:57], v[56:57], v[146:147], v[212:213] op_sel:[0,1,0] op_sel_hi:[1,1,1]
k_pad6:
    s_cbranch_execz k_pad10
    v_pk_fma_f32 v[58:59], v[58:59], v[146:147], v[214:215] op_sel:[0,1,0] op_sel_hi:[1,1,1]
    v_exp_f32 v28, v48
    v_exp_f32 v29, v49
    v_exp_f32 v30, v50
    v_exp_f32 v31, v51
    v_exp_f32 v32, v56
    v_exp_f32 v33, v57
    v_exp_f32 v34, v58
    v_exp_f32 v35, v59
    v_pk_fma_f32 v[28:29], v[28:29], v[14:15], v[14:15]
    v_pk_fma_f32 v[30:31], v[30:31], v[14:15], v[14:15]
    v_pk_fma_f32 v[32:33], v[32:33], v[14:15], v[14:15]
    v_pk_fma_f32 v[34:35], v[34:35], v[14:15], v[14:15]
    v_rcp_f32 v28, v28
    v_rcp_f32 v29, v29
    v_rcp_f32 v30, v30
    v_rcp_f32 v31, v31
    v_rcp_f32 v32, v32
    v_rcp_f32 v33, v33
    v_rcp_f32 v34, v34
    v_rcp_f32 v35, v35
    v_pk_mul_f32 v[48:49], v[48:49], v[28:29]
    v_pk_mul_f32 v[50:51], v[50:51], v[30:31]
    v_pk_mul_f32 v[56:57], v[56:57], v[32:33]
    v_pk_mul_f32 v[58:59], v[58:59], v[34:35]
    v_cvt_pk_bf16_f32 v36, v48, v49
    v_cvt_pk_bf16_f32 v37, v50, v51
    v_cvt_pk_bf16_f32 v38, v56, v57
    v_cvt_pk_bf16_f32 v39, v58, v59
    buffer_store_dwordx4 v[36:39], v2, s[24:27], s56 offen sc1
    s_add_u32 s56, s56, 8192
    s_and_b32 s72, s84, 0xfffff800
    s_mov_b64 exec, 3
    buffer_atomic_add v254, v10, s[24:27], s72 offen sc1
    s_mov_b64 exec, -1
    v_pk_fma_f32 v[60:61], v[60:61], v[142:143], v[108:109] op_sel:[0,1,0] op_sel_hi:[1,1,1]
    v_pk_fma_f32 v[62:63], v[62:63], v[142:143], v[110:111] op_sel:[0,1,0] op_sel_hi:[1,1,1]
    v_pk_fma_f32 v[68:69], v[68:69], v[142:143], v[112:113] op_sel:[0,1,0] op_sel_hi:[1,1,1]
    v_pk_fma_f32 v[70:71], v[70:71], v[142:143], v[114:115] op_sel:[0,1,0] op_sel_hi:[1,1,1]
    v_exp_f32 v16, v60
    v_exp_f32 v17, v61
    v_exp_f32 v18, v62
    v_exp_f32 v19, v63
    v_exp_f32 v20, v68
    v_exp_f32 v21, v69
    v_exp_f32 v22, v70
    v_exp_f32 v23, v71
    v_pk_fma_f32 v[16:17], v[16:17], v[14:15], v[14:15]
    v_pk_fma_f32 v[18:19], v[18:19], v[14:15], v[14:15]
    v_pk_fma_f32 v[20:21], v[20:21], v[14:15], v[14:15]
    v_pk_fma_f32 v[22:23], v[22:23], v[14:15], v[14:15]
    v_rcp_f32 v16, v16
    v_rcp_f32 v17, v17
    v_rcp_f32 v18, v18
    v_rcp_f32 v19, v19
    v_rcp_f32 v20, v20
    v_rcp_f32 v21, v21
    v_rcp_f32 v22, v22
    v_rcp_f32 v23, v23
    v_pk_mul_f32 v[60:61], v[60:61], v[16:17]
    v_pk_mul_f32 v[62:63], v[62:63], v[18:19]
    v_pk_mul_f32 v[68:69], v[68:69], v[20:21]
    v_pk_mul_f32 v[70:71], v[70:71], v[22:23]
    v_cvt_pk_bf16_f32 v24, v60, v61
    v_cvt_pk_bf16_f32 v25, v62, v63
    v_cvt_pk_bf16_f32 v26, v68, v69
    v_cvt_pk_bf16_f32 v27, v70, v71
    buffer_store_dwordx4 v[24:27], v2, s[24:27], s54 offen sc1
    s_add_u32 s54, s54, 8192
    s_barrier
    v_pk_fma_f32 v[64:65], v[64:65], v[146:147], v[216:217] op_sel:[0,1,0] op_sel_hi:[1,1,1]
    v_pk_fma_f32 v[66:67], v[66:67], v[146:147], v[218:219] op_sel:[0,1,0] op_sel_hi:[1,1,1]
    v_pk_fma_f32 v[72:73], v[72:73], v[146:147], v[220:221] op_sel:[0,1,0] op_sel_hi:[1,1,1]
    v_pk_fma_f32 v[74:75], v[74:75], v[146:147], v[222:223] op_sel:[0,1,0] op_sel_hi:[1,1,1]
    v_exp_f32 v28, v64
    v_exp_f32 v29, v65
    v_exp_f32 v30, v66
    v_exp_f32 v31, v67
    v_exp_f32 v32, v72
    v_exp_f32 v33, v73
    v_exp_f32 v34, v74
    v_exp_f32 v35, v75
    v_pk_fma_f32 v[28:29], v[28:29], v[14:15], v[14:15]
    v_pk_fma_f32 v[30:31], v[30:31], v[14:15], v[14:15]
    v_pk_fma_f32 v[32:33], v[32:33], v[14:15], v[14:15]
    v_pk_fma_f32 v[34:35], v[34:35], v[14:15], v[14:15]
    v_rcp_f32 v28, v28
    v_rcp_f32 v29, v29
    v_rcp_f32 v30, v30
    v_rcp_f32 v31, v31
    v_rcp_f32 v32, v32
    v_rcp_f32 v33, v33
    v_rcp_f32 v34, v34
    v_rcp_f32 v35, v35
    v_pk_mul_f32 v[64:65], v[64:65], v[28:29]
    v_pk_mul_f32 v[66:67], v[66:67], v[30:31]
    v_pk_mul_f32 v[72:73], v[72:73], v[32:33]
    v_pk_mul_f32 v[74:75], v[74:75], v[34:35]
    v_cvt_pk_bf16_f32 v36, v64, v65
    v_cvt_pk_bf16_f32 v37, v66, v67
    v_cvt_pk_bf16_f32 v38, v72, v73
    v_cvt_pk_bf16_f32 v39, v74, v75
    buffer_store_dwordx4 v[36:39], v2, s[24:27], s56 offen sc1
    s_add_u32 s56, s56, 8192
    v_pk_fma_f32 v[76:77], v[76:77], v[142:143], v[116:117] op_sel:[0,1,0] op_sel_hi:[1,1,1]
    v_pk_fma_f32 v[78:79], v[78:79], v[142:143], v[118:119] op_sel:[0,1,0] op_sel_hi:[1,1,1]
    v_pk_fma_f32 v[84:85], v[84:85], v[142:143], v[120:121] op_sel:[0,1,0] op_sel_hi:[1,1,1]
    v_pk_fma_f32 v[86:87], v[86:87], v[142:143], v[122:123] op_sel:[0,1,0] op_sel_hi:[1,1,1]
    v_exp_f32 v16, v76
    v_exp_f32 v17, v77
    v_exp_f32 v18, v78
    v_exp_f32 v19, v79
    v_exp_f32 v20, v84
    v_exp_f32 v21, v85
    v_exp_f32 v22, v86
    v_exp_f32 v23, v87
    v_pk_fma_f32 v[16:17], v[16:17], v[14:15], v[14:15]
    v_pk_fma_f32 v[18:19], v[18:19], v[14:15], v[14:15]
    v_pk_fma_f32 v[20:21], v[20:21], v[14:15], v[14:15]
    v_pk_fma_f32 v[22:23], v[22:23], v[14:15], v[14:15]
    v_rcp_f32 v16, v16
    v_rcp_f32 v17, v17
    v_rcp_f32 v18, v18
    v_rcp_f32 v19, v19
    v_rcp_f32 v20, v20
    v_rcp_f32 v21, v21
    v_rcp_f32 v22, v22
    v_rcp_f32 v23, v23
    v_pk_mul_f32 v[76:77], v[76:77], v[16:17]
    v_pk_mul_f32 v[78:79], v[78:79], v[18:19]
    v_pk_mul_f32 v[84:85], v[84:85], v[20:21]
    v_pk_mul_f32 v[86:87], v[86:87], v[22:23]
    v_cvt_pk_bf16_f32 v24, v76, v77
    v_cvt_pk_bf16_f32 v25, v78, v79
    v_cvt_pk_bf16_f32 v26, v84, v85
    v_cvt_pk_bf16_f32 v27, v86, v87
    buffer_store_dwordx4 v[24:27], v2, s[24:27], s54 offen sc1
    s_add_u32 s54, s54, 8192
    s_and_b32 s74, s61, 1
    s_mul_i32 s74, s74, 256
    s_add_u32 s74, s74, s73
    s_mov_b32 s71, 0
    v_mov_b32 v252, 0
    s_mov_b64 exec, 1
    buffer_atomic_add v252, off, s[24:27], s74 sc0 sc1
    s_mov_b64 exec, -1
    v_pk_fma_f32 v[80:81], v[80:81], v[146:147], v[224:225] op_sel:[0,1,0] op_sel_hi:[1,1,1]
    v_pk_fma_f32 v[82:83], v[82:83], v[146:147], v[226:227] op_sel:[0,1,0] op_sel_hi:[1,1,1]
    v_pk_fma_f32 v[88:89], v[88:89], v[146:147], v[228:229] op_sel:[0,1,0] op_sel_hi:[1,1,1]
    v_pk_fma_f32 v[90:91], v[90:91], v[146:147], v[230:231] op_sel:[0,1,0] op_sel_hi:[1,1,1]
    v_exp_f32 v28, v80
    v_exp_f32 v29, v81
    v_exp_f32 v30, v82
    v_exp_f32 v31, v83
    v_exp_f32 v32, v88
    v_exp_f32 v33, v89
    v_exp_f32 v34, v90
    v_exp_f32 v35, v91
    v_pk_fma_f32 v[28:29], v[28:29], v[14:15], v[14:15]
    v_pk_fma_f32 v[30:31], v[30:31], v[14:15], v[14:15]
    v_pk_fma_f32 v[32:33], v[32:33], v[14:15], v[14:15]
    v_pk_fma_f32 v[34:35], v[34:35], v[14:15], v[14:15]
    v_rcp_f32 v28, v28
    v_rcp_f32 v29, v29
    v_rcp_f32 v30, v30
    v_rcp_f32 v31, v31
    v_rcp_f32 v32, v32
    v_rcp_f32 v33, v33
    v_rcp_f32 v34, v34
    v_rcp_f32 v35, v35
    v_pk_mul_f32 v[80:81], v[80:81], v[28:29]
    v_pk_mul_f32 v[82:83], v[82:83], v[30:31]
    v_pk_mul_f32 v[88:89], v[88:89], v[32:33]
    v_pk_mul_f32 v[90:91], v[90:91], v[34:35]
    v_cvt_pk_bf16_f32 v36, v80, v81
    v_cvt_pk_bf16_f32 v37, v82, v83
    v_cvt_pk_bf16_f32 v38, v88, v89
    v_cvt_pk_bf16_f32 v39, v90, v91
    buffer_store_dwordx4 v[36:39], v2, s[24:27], s56 offen sc1
    s_add_u32 s56, s56, 8192
    v_pk_fma_f32 v[92:93], v[92:93], v[142:143], v[124:125] op_sel:[0,1,0] op_sel_hi:[1,1,1]
    v_pk_fma_f32 v[94:95], v[94:95], v[142:143], v[126:127] op_sel:[0,1,0] op_sel_hi:[1,1,1]
    v_exp_f32 v16, v92
    v_exp_f32 v17, v93
    v_exp_f32 v18, v94
    v_exp_f32 v19, v95
    s_nop 0
    v_pk_fma_f32 v[16:17], v[16:17], v[14:15], v[14:15]
    v_pk_fma_f32 v[18:19], v[18:19], v[14:15], v[14:15]
    v_rcp_f32 v16, v16
    v_rcp_f32 v17, v17
    v_rcp_f32 v18, v18
    v_rcp_f32 v19, v19
    s_nop 0
    v_pk_mul_f32 v[92:93], v[92:93], v[16:17]
    v_pk_mul_f32 v[94:95], v[94:95], v[18:19]
    v_cvt_pk_bf16_f32 v24, v92, v93
    v_cvt_pk_bf16_f32 v25, v94, v95
    buffer_store_dwordx2 v[24:25], v4, s[24:27], s94 offen sc1
    v_pk_fma_f32 v[96:97], v[96:97], v[146:147], v[232:233] op_sel:[0,1,0] op_sel_hi:[1,1,1]
    v_pk_fma_f32 v[98:99], v[98:99], v[146:147], v[234:235] op_sel:[0,1,0] op_sel_hi:[1,1,1]
    v_exp_f32 v28, v96
    v_exp_f32 v29, v97
    v_exp_f32 v30, v98
    v_exp_f32 v31, v99
    s_nop 0
    v_pk_fma_f32 v[28:29], v[28:29], v[14:15], v[14:15]
    v_pk_fma_f32 v[30:31], v[30:31], v[14:15], v[14:15]
    v_rcp_f32 v28, v28
    v_rcp_f32 v29, v29
    v_rcp_f32 v30, v30
    v_rcp_f32 v31, v31
    s_nop 0
    v_pk_mul_f32 v[96:97], v[96:97], v[28:29]
    v_pk_mul_f32 v[98:99], v[98:99], v[30:31]
    v_cvt_pk_bf16_f32 v36, v96, v97
    v_cvt_pk_bf16_f32 v37, v98, v99
    buffer_store_dwordx2 v[36:37], v4, s[24:27], s57 offen sc1
    s_waitcnt vmcnt(3)
    s_branch k_f4_7_c1
k_f4_7_c0:
    v_mov_b32 v252, 0
    s_mov_b64 exec, 1
    buffer_atomic_add v252, off, s[24:27], s74 sc0 sc1
    s_mov_b64 exec, -1
    s_waitcnt vmcnt(0)
k_f4_7_c1:
    v_readfirstlane_b32 s53, v252
    s_add_u32 s71, s71, 1
    s_cmp_gt_u32 s71, 131072
    s_cbranch_scc1 k_f4_7_c2
    s_cmp_lt_u32 s53, 8
    s_cbranch_scc1 k_f4_7_c0
k_f4_7_c2:
    s_branch k_p5
k_six:
k_pad7:
    s_cbranch_execz k_pad11
    ds_read_b128 v[16:19], v6 offset:57344
    ds_read_b128 v[20:23], v6 offset:58368
    ds_read_b128 v[24:27], v6 offset:59392
    ds_read_b128 v[28:31], v6 offset:60416
    ds_read_b128 v[32:35], v6 offset:61440
    ds_read_b128 v[36:39], v6 offset:62464
    s_and_b32 s74, s76, 1
    s_mul_i32 s74, s74, 256
    s_add_u32 s74, s74, s73
    s_mov_b32 s71, 0
    v_mov_b32 v252, 0
    s_mov_b64 exec, 1
    buffer_atomic_add v252, off, s[24:27], s74 sc0 sc1
    s_mov_b64 exec, -1
    ds_write_b128 v14, v[152:155] offset:0
    ds_write_b128 v14, v[156:159] offset:4096
    ds_write_b128 v14, v[160:163] offset:8192
    ds_write_b128 v14, v[164:167] offset:12288
    ds_write_b128 v14, v[168:171] offset:16384
    ds_write_b128 v14, v[172:175] offset:20480
    ds_write_b128 v14, v[176:179] offset:24576
    ds_write_b128 v14, v[180:183] offset:28672
    ds_write_b128 v14, v[184:187] offset:32768
    ds_write_b128 v14, v[188:191] offset:36864
    ds_write_b128 v14, v[192:195] offset:40960
    ds_write_b128 v14, v[196:199] offset:45056
    ds_write_b128 v14, v[200:203] offset:49152
    ds_write_b128 v14, v[204:207] offset:53248
    ds_write_b128 v14, v[208:211] offset:57344
    ds_write_b128 v14, v[212:215] offset:61440
    s_waitcnt vmcnt(0)
    s_branch k_f3_6_c1
k_f3_6_c0:
    v_mov_b32 v252, 0
    s_mov_b64 exec, 1
    buffer_atomic_add v252, off, s[24:27], s74 sc0 sc1
    s_mov_b64 exec, -1
    s_waitcnt vmcnt(0)
k_f3_6_c1:
    v_readfirstlane_b32 s53, v252
    s_add_u32 s71, s71, 1
    s_cmp_gt_u32 s71, 131072
    s_cbranch_scc1 k_f3_6_c2
    s_cmp_lt_u32 s53, 16
    s_cbranch_scc1 k_f3_6_c0
k_f3_6_c2:
    s_waitcnt lgkmcnt(0)
    buffer_load_dwordx4 v[152:155], v2, s[24:27], s37 offen offset:0 sc1
    buffer_load_dwordx4 v[156:159], v2, s[24:27], s38 offen offset:0 sc1
    buffer_load_dwordx4 v[160:163], v2, s[24:27], s37 offen offset:1024 sc1
    buffer_load_dwordx4 v[164:167], v2, s[24:27], s38 offen offset:1024 sc1
    buffer_load_dwordx2 v[168:169], v3, s[24:27], s37 offen offset:2048 sc1
    buffer_load_dwordx2 v[170:171], v3, s[24:27], s37 offen offset:2176 sc1
    buffer_load_dwordx2 v[172:173], v3, s[24:27], s38 offen offset:2048 sc1
    buffer_load_dwordx2 v[174:175], v3, s[24:27], s38 offen offset:2176 sc1
    buffer_load_dwordx4 v[176:179], v2, s[24:27], s37 offen offset:3072 sc1
    buffer_load_dwordx4 v[180:183], v2, s[24:27], s38 offen offset:3072 sc1
    ds_write_b128 v15, v[216:219] offset:0
    ds_write_b128 v15, v[220:223] offset:4096
    ds_write_b128 v15, v[224:227] offset:8192
    ds_write_b128 v15, v[228:231] offset:12288
    ds_write_b128 v15, v[232:235] offset:16384
    ds_write_b128 v15, v[236:239] offset:20480
    ds_write_b128 v15, v[240:243] offset:24576
    ds_write_b128 v15, v[244:247] offset:28672
    ds_write_b128 v15, v[248:251] offset:32768
    s_waitcnt lgkmcnt(0)
    s_add_u32 s37, s37, 4096
    buffer_load_dwordx4 v[184:187], v2, s[24:27], s37 offen offset:0 sc1
    s_add_u32 s38, s38, 4096
    buffer_load_dwordx4 v[188:191], v2, s[24:27], s38 offen offset:0 sc1
    buffer_load_dwordx4 v[192:195], v2, s[24:27], s37 offen offset:1024 sc1
    buffer_load_dwordx4 v[196:199], v2, s[24:27], s38 offen offset:1024 sc1
    s_waitcnt vmcnt(12) lgkmcnt(5)
    v_mfma_f32_16x16x32_bf16 v[44:47], v[16:19], v[152:155], 0
    buffer_load_dwordx4 v[200:203], v2, s[24:27], s37 offen offset:2048 sc1
    v_mfma_f32_16x16x32_bf16 v[48:51], v[16:19], v[156:159], 0
    ds_read_b128 v[16:19], v6 offset:63488
    s_waitcnt lgkmcnt(5)
    v_mfma_f32_16x16x32_bf16 v[52:55], v[20:23], v[152:155], 0
    buffer_load_dwordx4 v[204:207], v2, s[24:27], s38 offen offset:2048 sc1
    v_mfma_f32_16x16x32_bf16 v[56:59], v[20:23], v[156:159], 0
    ds_read_b128 v[20:23], v6 offset:64512
    s_waitcnt lgkmcnt(5)
    v_mfma_f32_16x16x32_bf16 v[60:63], v[24:27], v[152:155], 0
    buffer_load_dwordx2 v[142:143], v3, s[24:27], s58 offen offset:0 sc1
    v_mfma_f32_16x16x32_bf16 v[64:67], v[24:27], v[156:159], 0
    ds_read_b128 v[24:27], v7 offset:0
    s_waitcnt lgkmcnt(5)
    v_mfma_f32_16x16x32_bf16 v[68:71], v[28:31], v[152:155], 0
    buffer_load_dwordx2 v[144:145], v3, s[24:27], s58 offen offset:128 sc1
    v_mfma_f32_16x16x32_bf16 v[72:75], v[28:31], v[156:159], 0
    ds_read_b128 v[28:31], v7 offset:1024
    s_waitcnt lgkmcnt(5)
    v_mfma_f32_16x16x32_bf16 v[76:79], v[32:35], v[152:155], 0
    buffer_load_dwordx2 v[146:147], v3, s[24:27], s58 offen offset:1024 sc1
    v_mfma_f32_16x16x32_bf16 v[80:83], v[32:35], v[156:159], 0
    ds_read_b128 v[32:35], v7 offset:2048
    s_waitcnt lgkmcnt(5)
    v_mfma_f32_16x16x32_bf16 v[84:87], v[36:39], v[152:155], 0
    buffer_load_dwordx2 v[148:149], v3, s[24:27], s58 offen offset:1152 sc1
    v_mfma_f32_16x16x32_bf16 v[88:91], v[36:39], v[156:159], 0
    ds_read_b128 v[36:39], v7 offset:3072
    s_waitcnt vmcnt(16) lgkmcnt(5)
    v_mfma_f32_16x16x32_bf16 v[44:47], v[16:19], v[160:163], v[44:47]
    buffer_load_dwordx2 v[152:153], v3, s[24:27], s37 offen offset:3072 sc1
    v_mfma_f32_16x16x32_bf16 v[48:51], v[16:19], v[164:167], v[48:51]
    ds_read_b128 v[16:19], v7 offset:4096
    s_waitcnt lgkmcnt(5)
    v_mfma_f32_16x16x32_bf16 v[52:55], v[20:23], v[160:163], v[52:55]
    buffer_load_dwordx2 v[154:155], v3, s[24:27], s37 offen offset:3200 sc1
    v_mfma_f32_16x16x32_bf16 v[56:59], v[20:23], v[164:167], v[56:59]
    ds_read_b128 v[20:23], v7 offset:5120
    s_waitcnt lgkmcnt(5)
    v_mfma_f32_16x16x32_bf16 v[60:63], v[24:27], v[160:163], v[60:63]
    buffer_load_dwordx2 v[156:157], v3, s[24:27], s38 offen offset:3072 sc1
    v_mfma_f32_16x16x32_bf16 v[64:67], v[24:27], v[164:167], v[64:67]
    ds_read_b128 v[24:27], v7 offset:6144
    s_waitcnt lgkmcnt(5)
    v_mfma_f32_16x16x32_bf16 v[68:71], v[28:31], v[160:163], v[68:71]
    buffer_load_dwordx2 v[158:159], v3, s[24:27], s38 offen offset:3200 sc1
    v_mfma_f32_16x16x32_bf16 v[72:75], v[28:31], v[164:167], v[72:75]
    ds_read_b128 v[28:31], v7 offset:7168
    s_waitcnt lgkmcnt(5)
    v_mfma_f32_16x16x32_bf16 v[76:79], v[32:35], v[160:163], v[76:79]
    buffer_load_dwordx4 v[100:103], v12, s[24:27], s54 offen offset:0 sc1
    v_mfma_f32_16x16x32_bf16 v[80:83], v[32:35], v[164:167], v[80:83]
    ds_read_b128 v[32:35], v7 offset:8192
    s_waitcnt lgkmcnt(5)
    v_mfma_f32_16x16x32_bf16 v[84:87], v[36:39], v[160:163], v[84:87]
    buffer_load_dwordx4 v[104:107], v12, s[24:27], s54 offen offset:16 sc1
    v_mfma_f32_16x16x32_bf16 v[88:91], v[36:39], v[164:167], v[88:91]
    ds_read_b128 v[36:39], v7 offset:9216
    s_waitcnt vmcnt(18) lgkmcnt(5)
    v_mfma_f32_16x16x32_bf16 v[44:47], v[16:19], v[168:171], v[44:47]
    s_add_u32 s37, s37, 4096
    buffer_load_dwordx4 v[160:163], v2, s[24:27], s37 offen offset:0 sc1
    v_mfma_f32_16x16x32_bf16 v[48:51], v[16:19], v[172:175], v[48:51]
    ds_read_b128 v[16:19], v7 offset:10240
    s_waitcnt lgkmcnt(5)
    v_mfma_f32_16x16x32_bf16 v[52:55], v[20:23], v[168:171], v[52:55]
    s_add_u32 s38, s38, 4096
    buffer_load_dwordx4 v[164:167], v2, s[24:27], s38 offen offset:0 sc1
    v_mfma_f32_16x16x32_bf16 v[56:59], v[20:23], v[172:175], v[56:59]
    ds_read_b128 v[20:23], v7 offset:11264
    s_waitcnt lgkmcnt(5)
    v_mfma_f32_16x16x32_bf16 v[60:63], v[24:27], v[168:171], v[60:63]
    buffer_load_dwordx4 v[108:111], v12, s[24:27], s54 offen offset:128 sc1
    v_mfma_f32_16x16x32_bf16 v[64:67], v[24:27], v[172:175], v[64:67]
    ds_read_b128 v[24:27], v7 offset:12288
    s_waitcnt lgkmcnt(5)
    v_mfma_f32_16x16x32_bf16 v[68:71], v[28:31], v[168:171], v[68:71]
    buffer_load_dwordx4 v[112:115], v12, s[24:27], s54 offen offset:144 sc1
    v_mfma_f32_16x16x32_bf16 v[72:75], v[28:31], v[172:175], v[72:75]
    ds_read_b128 v[28:31], v7 offset:13312
    s_waitcnt lgkmcnt(5)
    v_mfma_f32_16x16x32_bf16 v[76:79], v[32:35], v[168:171], v[76:79]
    buffer_load_dwordx4 v[116:119], v12, s[24:27], s54 offen offset:256 sc1
    v_mfma_f32_16x16x32_bf16 v[80:83], v[32:35], v[172:175], v[80:83]
    ds_read_b128 v[32:35], v7 offset:14336
    s_waitcnt lgkmcnt(5)
    v_mfma_f32_16x16x32_bf16 v[84:87], v[36:39], v[168:171], v[84:87]
    buffer_load_dwordx4 v[120:123], v12, s[24:27], s54 offen offset:272 sc1
    v_mfma_f32_16x16x32_bf16 v[88:91], v[36:39], v[172:175], v[88:91]
    ds_read_b128 v[36:39], v7 offset:15360
    s_waitcnt vmcnt(22) lgkmcnt(5)
    v_mfma_f32_16x16x32_bf16 v[44:47], v[16:19], v[176:179], v[44:47]
    buffer_load_dwordx4 v[168:171], v2, s[24:27], s37 offen offset:1024 sc1
    v_mfma_f32_16x16x32_bf16 v[48:51], v[16:19], v[180:183], v[48:51]
    ds_read_b128 v[16:19], v7 offset:16384
    s_waitcnt lgkmcnt(5)
    v_mfma_f32_16x16x32_bf16 v[52:55], v[20:23], v[176:179], v[52:55]
    buffer_load_dwordx4 v[172:175], v2, s[24:27], s38 offen offset:1024 sc1
    v_mfma_f32_16x16x32_bf16 v[56:59], v[20:23], v[180:183], v[56:59]
    ds_read_b128 v[20:23], v7 offset:17408
    s_waitcnt lgkmcnt(5)
    v_mfma_f32_16x16x32_bf16 v[60:63], v[24:27], v[176:179], v[60:63]
    s_mov_b64 exec, 1
    buffer_store_dwordx2 v[150:151], off, s[24:27], s83 offset:128 sc1
    s_mov_b64 exec, -1
    v_mfma_f32_16x16x32_bf16 v[64:67], v[24:27], v[180:183], v[64:67]
    ds_read_b128 v[24:27], v7 offset:18432
    s_waitcnt lgkmcnt(5)
    v_mfma_f32_16x16x32_bf16 v[68:71], v[28:31], v[176:179], v[68:71]
    v_mfma_f32_16x16x32_bf16 v[72:75], v[28:31], v[180:183], v[72:75]
    ds_read_b128 v[28:31], v7 offset:19456
    s_waitcnt lgkmcnt(5)
    v_mfma_f32_16x16x32_bf16 v[76:79], v[32:35], v[176:179], v[76:79]
    v_mfma_f32_16x16x32_bf16 v[80:83], v[32:35], v[180:183], v[80:83]
    ds_read_b128 v[32:35], v7 offset:20480
    s_waitcnt lgkmcnt(5)
    v_mfma_f32_16x16x32_bf16 v[84:87], v[36:39], v[176:179], v[84:87]
    v_mfma_f32_16x16x32_bf16 v[88:91], v[36:39], v[180:183], v[88:91]
    ds_read_b128 v[36:39], v7 offset:21504
    s_waitcnt vmcnt(23) lgkmcnt(5)
    v_mfma_f32_16x16x32_bf16 v[44:47], v[16:19], v[184:187], v[44:47]
    s_barrier
    v_mfma_f32_16x16x32_bf16 v[48:51], v[16:19], v[188:191], v[48:51]
    ds_read_b128 v[16:19], v7 offset:22528
    s_waitcnt lgkmcnt(5)
    v_mfma_f32_16x16x32_bf16 v[52:55], v[20:23], v[184:187], v[52:55]
    buffer_load_dwordx4 v[176:179], v2, s[24:27], s37 offen offset:2048 sc1
    v_mfma_f32_16x16x32_bf16 v[56:59], v[20:23], v[188:191], v[56:59]
    ds_read_b128 v[20:23], v7 offset:23552
    s_waitcnt lgkmcnt(5)
    v_mfma_f32_16x16x32_bf16 v[60:63], v[24:27], v[184:187], v[60:63]
    buffer_load_dwordx4 v[180:183], v2, s[24:27], s38 offen offset:2048 sc1
    v_mfma_f32_16x16x32_bf16 v[64:67], v[24:27], v[188:191], v[64:67]
    ds_read_b128 v[24:27], v7 offset:24576
    s_waitcnt lgkmcnt(5)
    v_mfma_f32_16x16x32_bf16 v[68:71], v[28:31], v[184:187], v[68:71]
    v_mfma_f32_16x16x32_bf16 v[72:75], v[28:31], v[188:191], v[72:75]
    ds_read_b128 v[28:31], v7 offset:25600
    s_waitcnt lgkmcnt(5)
    v_mfma_f32_16x16x32_bf16 v[76:79], v[32:35], v[184:187], v[76:79]
    v_mfma_f32_16x16x32_bf16 v[80:83], v[32:35], v[188:191], v[80:83]
    ds_read_b128 v[32:35], v7 offset:26624
    s_waitcnt lgkmcnt(5)
    v_mfma_f32_16x16x32_bf16 v[84:87], v[36:39], v[184:187], v[84:87]
    v_mfma_f32_16x16x32_bf16 v[88:91], v[36:39], v[188:191], v[88:91]
    ds_read_b128 v[36:39], v7 offset:27648
    s_waitcnt vmcnt(23) lgkmcnt(5)
    v_mfma_f32_16x16x32_bf16 v[44:47], v[16:19], v[192:195], v[44:47]
    buffer_load_dwordx4 v[184:187], v2, s[24:27], s37 offen offset:3072 sc1
    v_mfma_f32_16x16x32_bf16 v[48:51], v[16:19], v[196:199], v[48:51]
    ds_read_b128 v[16:19], v7 offset:28672
    s_waitcnt lgkmcnt(5)
    v_mfma_f32_16x16x32_bf16 v[52:55], v[20:23], v[192:195], v[52:55]
    buffer_load_dwordx4 v[188:191], v2, s[24:27], s38 offen offset:3072 sc1
    v_mfma_f32_16x16x32_bf16 v[56:59], v[20:23], v[196:199], v[56:59]
    ds_read_b128 v[20:23], v7 offset:29696
    s_waitcnt lgkmcnt(5)
    v_mfma_f32_16x16x32_bf16 v[60:63], v[24:27], v[192:195], v[60:63]
    v_mfma_f32_16x16x32_bf16 v[64:67], v[24:27], v[196:199], v[64:67]
    ds_read_b128 v[24:27], v7 offset:30720
    s_waitcnt lgkmcnt(5)
    v_mfma_f32_16x16x32_bf16 v[68:71], v[28:31], v[192:195], v[68:71]
    v_mfma_f32_16x16x32_bf16 v[72:75], v[28:31], v[196:199], v[72:75]
    ds_read_b128 v[28:31], v7 offset:31744
    s_waitcnt lgkmcnt(5)
    v_mfma_f32_16x16x32_bf16 v[76:79], v[32:35], v[192:195], v[76:79]
    v_mfma_f32_16x16x32_bf16 v[80:83], v[32:35], v[196:199], v[80:83]
    ds_read_b128 v[32:35], v5 offset:0
    s_waitcnt lgkmcnt(5)
    v_mfma_f32_16x16x32_bf16 v[84:87], v[36:39], v[192:195], v[84:87]
    v_mfma_f32_16x16x32_bf16 v[88:91], v[36:39], v[196:199], v[88:91]
    ds_read_b128 v[36:39], v5 offset:1024
    s_waitcnt vmcnt(19) lgkmcnt(5)
    v_mfma_f32_16x16x32_bf16 v[44:47], v[16:19], v[200:203], v[44:47]
    s_add_u32 s37, s37, 4096
    buffer_load_dwordx2 v[192:193], v3, s[24:27], s37 offen offset:0 sc1
    v_mfma_f32_16x16x32_bf16 v[48:51], v[16:19], v[204:207], v[48:51]
    ds_read_b128 v[16:19], v5 offset:2048
    s_waitcnt lgkmcnt(5)
    v_mfma_f32_16x16x32_bf16 v[52:55], v[20:23], v[200:203], v[52:55]
    buffer_load_dwordx2 v[194:195], v3, s[24:27], s37 offen offset:128 sc1
    v_mfma_f32_16x16x32_bf16 v[56:59], v[20:23], v[204:207], v[56:59]
    ds_read_b128 v[20:23], v5 offset:3072
    s_waitcnt lgkmcnt(5)
    v_mfma_f32_16x16x32_bf16 v[60:63], v[24:27], v[200:203], v[60:63]
    s_add_u32 s38, s38, 4096
    buffer_load_dwordx2 v[196:197], v3, s[24:27], s38 offen offset:0 sc1
    v_mfma_f32_16x16x32_bf16 v[64:67], v[24:27], v[204:207], v[64:67]
    ds_read_b128 v[24:27], v5 offset:4096
    s_waitcnt lgkmcnt(5)
    v_mfma_f32_16x16x32_bf16 v[68:71], v[28:31], v[200:203], v[68:71]
    buffer_load_dwordx2 v[198:199], v3, s[24:27], s38 offen offset:128 sc1
    v_mfma_f32_16x16x32_bf16 v[72:75], v[28:31], v[204:207], v[72:75]
    ds_read_b128 v[28:31], v5 offset:5120
    s_waitcnt lgkmcnt(5)
    v_mfma_f32_16x16x32_bf16 v[76:79], v[32:35], v[200:203], v[76:79]
    v_mfma_f32_16x16x32_bf16 v[80:83], v[32:35], v[204:207], v[80:83]
    ds_read_b128 v[32:35], v5 offset:6144
    s_waitcnt lgkmcnt(5)
    v_mfma_f32_16x16x32_bf16 v[84:87], v[36:39], v[200:203], v[84:87]
    v_mfma_f32_16x16x32_bf16 v[88:91], v[36:39], v[204:207], v[88:91]
    ds_read_b128 v[36:39], v5 offset:7168
    s_waitcnt vmcnt(17) lgkmcnt(5)
    v_mfma_f32_16x16x32_bf16 v[44:47], v[16:19], v[152:155], v[44:47]
    buffer_load_dwordx4 v[200:203], v2, s[24:27], s37 offen offset:1024 sc1
    v_mfma_f32_16x16x32_bf16 v[48:51], v[16:19], v[156:159], v[48:51]
    ds_read_b128 v[16:19], v5 offset:8192
    s_waitcnt lgkmcnt(5)
    v_mfma_f32_16x16x32_bf16 v[52:55], v[20:23], v[152:155], v[52:55]
    buffer_load_dwordx4 v[204:207], v2, s[24:27], s38 offen offset:1024 sc1
    v_mfma_f32_16x16x32_bf16 v[56:59], v[20:23], v[156:159], v[56:59]
    ds_read_b128 v[20:23], v5 offset:9216
    s_waitcnt lgkmcnt(5)
    v_mfma_f32_16x16x32_bf16 v[60:63], v[24:27], v[152:155], v[60:63]
    v_mfma_f32_16x16x32_bf16 v[64:67], v[24:27], v[156:159], v[64:67]
    ds_read_b128 v[24:27], v5 offset:10240
    s_waitcnt lgkmcnt(5)
    v_mfma_f32_16x16x32_bf16 v[68:71], v[28:31], v[152:155], v[68:71]
    v_mfma_f32_16x16x32_bf16 v[72:75], v[28:31], v[156:159], v[72:75]
    ds_read_b128 v[28:31], v5 offset:11264
    s_waitcnt lgkmcnt(5)
    v_mfma_f32_16x16x32_bf16 v[76:79], v[32:35], v[152:155], v[76:79]
    v_mfma_f32_16x16x32_bf16 v[80:83], v[32:35], v[156:159], v[80:83]
    ds_read_b128 v[32:35], v5 offset:12288
    s_waitcnt lgkmcnt(5)
    v_mfma_f32_16x16x32_bf16 v[84:87], v[36:39], v[152:155], v[84:87]
    v_mfma_f32_16x16x32_bf16 v[88:91], v[36:39], v[156:159], v[88:91]
    ds_read_b128 v[36:39], v5 offset:13312
    s_waitcnt vmcnt(13) lgkmcnt(5)
    v_mfma_f32_16x16x32_bf16 v[44:47], v[16:19], v[160:163], v[44:47]
    buffer_load_dwordx4 v[152:155], v2, s[24:27], s37 offen offset:2048 sc1
    v_mfma_f32_16x16x32_bf16 v[48:51], v[16:19], v[164:167], v[48:51]
    ds_read_b128 v[16:19], v5 offset:14336
    s_waitcnt lgkmcnt(5)
    v_mfma_f32_16x16x32_bf16 v[52:55], v[20:23], v[160:163], v[52:55]
    buffer_load_dwordx4 v[156:159], v2, s[24:27], s38 offen offset:2048 sc1
    v_mfma_f32_16x16x32_bf16 v[56:59], v[20:23], v[164:167], v[56:59]
    ds_read_b128 v[20:23], v5 offset:15360
    s_waitcnt lgkmcnt(5)
    v_mfma_f32_16x16x32_bf16 v[60:63], v[24:27], v[160:163], v[60:63]
    v_mfma_f32_16x16x32_bf16 v[64:67], v[24:27], v[164:167], v[64:67]
    ds_read_b128 v[24:27], v5 offset:16384
    s_waitcnt lgkmcnt(5)
    v_mfma_f32_16x16x32_bf16 v[68:71], v[28:31], v[160:163], v[68:71]
    v_mfma_f32_16x16x32_bf16 v[72:75], v[28:31], v[164:167], v[72:75]
    ds_read_b128 v[28:31], v5 offset:17408
    s_waitcnt lgkmcnt(5)
    v_mfma_f32_16x16x32_bf16 v[76:79], v[32:35], v[160:163], v[76:79]
    v_mfma_f32_16x16x32_bf16 v[80:83], v[32:35], v[164:167], v[80:83]
    ds_read_b128 v[32:35], v5 offset:18432
    s_waitcnt lgkmcnt(5)
    v_mfma_f32_16x16x32_bf16 v[84:87], v[36:39], v[160:163], v[84:87]
    v_mfma_f32_16x16x32_bf16 v[88:91], v[36:39], v[164:167], v[88:91]
    ds_read_b128 v[36:39], v5 offset:19456
    s_waitcnt vmcnt(12) lgkmcnt(5)
    v_mfma_f32_16x16x32_bf16 v[44:47], v[16:19], v[168:171], v[44:47]
    buffer_load_dwordx4 v[160:163], v2, s[24:27], s37 offen offset:3072 sc1
    v_mfma_f32_16x16x32_bf16 v[48:51], v[16:19], v[172:175], v[48:51]
    ds_read_b128 v[16:19], v5 offset:20480
    s_waitcnt lgkmcnt(5)
    v_mfma_f32_16x16x32_bf16 v[52:55], v[20:23], v[168:171], v[52:55]
    buffer_load_dwordx4 v[164:167], v2, s[24:27], s38 offen offset:3072 sc1
    v_mfma_f32_16x16x32_bf16 v[56:59], v[20:23], v[172:175], v[56:59]
    ds_read_b128 v[20:23], v5 offset:21504
    s_waitcnt lgkmcnt(5)
    v_mfma_f32_16x16x32_bf16 v[60:63], v[24:27], v[168:171], v[60:63]
    v_add_f32 v142, v142, v144
    v_add_f32 v143, v143, v145
    v_mfma_f32_16x16x32_bf16 v[64:67], v[24:27], v[172:175], v[64:67]
    ds_read_b128 v[24:27], v5 offset:22528
    s_waitcnt lgkmcnt(5)
    v_mfma_f32_16x16x32_bf16 v[68:71], v[28:31], v[168:171], v[68:71]
    v_add_f32 v146, v146, v148
    v_add_f32 v147, v147, v149
    v_mfma_f32_16x16x32_bf16 v[72:75], v[28:31], v[172:175], v[72:75]
    ds_read_b128 v[28:31], v5 offset:23552
    s_waitcnt lgkmcnt(5)
    v_mfma_f32_16x16x32_bf16 v[76:79], v[32:35], v[168:171], v[76:79]
    v_mov_b32 v144, v142
    v_mov_b32 v145, v143
    v_mfma_f32_16x16x32_bf16 v[80:83], v[32:35], v[172:175], v[80:83]
    ds_read_b128 v[32:35], v5 offset:24576
    s_waitcnt lgkmcnt(5)
    v_mfma_f32_16x16x32_bf16 v[84:87], v[36:39], v[168:171], v[84:87]
    v_mov_b32 v148, v146
    v_mov_b32 v149, v147
    v_mfma_f32_16x16x32_bf16 v[88:91], v[36:39], v[172:175], v[88:91]
    ds_read_b128 v[36:39], v5 offset:25600
    s_waitcnt vmcnt(12) lgkmcnt(5)
    v_mfma_f32_16x16x32_bf16 v[44:47], v[16:19], v[176:179], v[44:47]
    s_add_u32 s37, s37, 4096
    buffer_load_dwordx4 v[168:171], v2, s[24:27], s37 offen offset:0 sc1
    v_mfma_f32_16x16x32_bf16 v[48:51], v[16:19], v[180:183], v[48:51]
    ds_read_b128 v[16:19], v5 offset:26624
    s_waitcnt lgkmcnt(5)
    v_mfma_f32_16x16x32_bf16 v[52:55], v[20:23], v[176:179], v[52:55]
    s_add_u32 s38, s38, 4096
    buffer_load_dwordx4 v[172:175], v2, s[24:27], s38 offen offset:0 sc1
    v_mfma_f32_16x16x32_bf16 v[56:59], v[20:23], v[180:183], v[56:59]
    ds_read_b128 v[20:23], v5 offset:27648
    s_waitcnt lgkmcnt(5)
    v_mfma_f32_16x16x32_bf16 v[60:63], v[24:27], v[176:179], v[60:63]
    v_permlane32_swap_b32 v142, v144
    v_permlane32_swap_b32 v143, v145
    v_mfma_f32_16x16x32_bf16 v[64:67], v[24:27], v[180:183], v[64:67]
    ds_read_b128 v[24:27], v5 offset:28672
    s_waitcnt lgkmcnt(5)
    v_mfma_f32_16x16x32_bf16 v[68:71], v[28:31], v[176:179], v[68:71]
    v_permlane32_swap_b32 v146, v148
    v_permlane32_swap_b32 v147, v149
    v_mfma_f32_16x16x32_bf16 v[72:75], v[28:31], v[180:183], v[72:75]
k_pad8:
    s_cbranch_execz k_pad12
    ds_read_b128 v[28:31], v5 offset:29696
    s_waitcnt lgkmcnt(5)
    v_mfma_f32_16x16x32_bf16 v[76:79], v[32:35], v[176:179], v[76:79]
    v_add_f32 v142, v142, v144
    v_add_f32 v143, v143, v145
    v_mfma_f32_16x16x32_bf16 v[80:83], v[32:35], v[180:183], v[80:83]
    ds_read_b128 v[32:35], v5 offset:30720
    s_waitcnt lgkmcnt(5)
    v_mfma_f32_16x16x32_bf16 v[84:87], v[36:39], v[176:179], v[84:87]
    v_add_f32 v146, v146, v148
    v_add_f32 v147, v147, v149
    v_mfma_f32_16x16x32_bf16 v[88:91], v[36:39], v[180:183], v[88:91]
    ds_read_b128 v[36:39], v5 offset:31744
    s_waitcnt vmcnt(12) lgkmcnt(5)
    v_mfma_f32_16x16x32_bf16 v[44:47], v[16:19], v[184:187], v[44:47]
    buffer_load_dwordx2 v[176:177], v3, s[24:27], s37 offen offset:1024 sc1
    v_mfma_f32_16x16x32_bf16 v[48:51], v[16:19], v[188:191], v[48:51]
    ds_read_b128 v[16:19], v5 offset:32768
    s_waitcnt lgkmcnt(5)
    v_mfma_f32_16x16x32_bf16 v[52:55], v[20:23], v[184:187], v[52:55]
    buffer_load_dwordx2 v[178:179], v3, s[24:27], s37 offen offset:1152 sc1
    v_mfma_f32_16x16x32_bf16 v[56:59], v[20:23], v[188:191], v[56:59]
    ds_read_b128 v[20:23], v5 offset:33792
    s_waitcnt lgkmcnt(5)
    v_mfma_f32_16x16x32_bf16 v[60:63], v[24:27], v[184:187], v[60:63]
    buffer_load_dwordx2 v[180:181], v3, s[24:27], s38 offen offset:1024 sc1
    v_mfma_f32_16x16x32_bf16 v[64:67], v[24:27], v[188:191], v[64:67]
    ds_read_b128 v[24:27], v5 offset:34816
    s_waitcnt lgkmcnt(5)
    v_mfma_f32_16x16x32_bf16 v[68:71], v[28:31], v[184:187], v[68:71]
    buffer_load_dwordx2 v[182:183], v3, s[24:27], s38 offen offset:1152 sc1
    v_mfma_f32_16x16x32_bf16 v[72:75], v[28:31], v[188:191], v[72:75]
    ds_read_b128 v[28:31], v5 offset:35840
    s_waitcnt lgkmcnt(5)
    v_mfma_f32_16x16x32_bf16 v[76:79], v[32:35], v[184:187], v[76:79]
    v_mov_b32 v144, v142
    v_mov_b32 v145, v143
    v_mfma_f32_16x16x32_bf16 v[80:83], v[32:35], v[188:191], v[80:83]
    ds_read_b128 v[32:35], v5 offset:36864
    s_waitcnt lgkmcnt(5)
    v_mfma_f32_16x16x32_bf16 v[84:87], v[36:39], v[184:187], v[84:87]
    v_mov_b32 v148, v146
    v_mov_b32 v149, v147
    v_mfma_f32_16x16x32_bf16 v[88:91], v[36:39], v[188:191], v[88:91]
    ds_read_b128 v[36:39], v5 offset:37888
    s_waitcnt vmcnt(12) lgkmcnt(5)
    v_mfma_f32_16x16x32_bf16 v[44:47], v[16:19], v[192:195], v[44:47]
    buffer_load_dwordx4 v[184:187], v2, s[24:27], s37 offen offset:2048 sc1
    v_mfma_f32_16x16x32_bf16 v[48:51], v[16:19], v[196:199], v[48:51]
    ds_read_b128 v[16:19], v5 offset:38912
    s_waitcnt lgkmcnt(5)
    v_mfma_f32_16x16x32_bf16 v[52:55], v[20:23], v[192:195], v[52:55]
    buffer_load_dwordx4 v[188:191], v2, s[24:27], s38 offen offset:2048 sc1
    v_mfma_f32_16x16x32_bf16 v[56:59], v[20:23], v[196:199], v[56:59]
    ds_read_b128 v[20:23], v5 offset:39936
    s_waitcnt lgkmcnt(5)
    v_mfma_f32_16x16x32_bf16 v[60:63], v[24:27], v[192:195], v[60:63]
    v_permlane16_swap_b32 v142, v144
    v_permlane16_swap_b32 v143, v145
    v_mfma_f32_16x16x32_bf16 v[64:67], v[24:27], v[196:199], v[64:67]
    ds_read_b128 v[24:27], v5 offset:40960
    s_waitcnt lgkmcnt(5)
    v_mfma_f32_16x16x32_bf16 v[68:71], v[28:31], v[192:195], v[68:71]
    v_permlane16_swap_b32 v146, v148
    v_permlane16_swap_b32 v147, v149
    v_mfma_f32_16x16x32_bf16 v[72:75], v[28:31], v[196:199], v[72:75]
    ds_read_b128 v[28:31], v5 offset:41984
    s_waitcnt lgkmcnt(5)
    v_mfma_f32_16x16x32_bf16 v[76:79], v[32:35], v[192:195], v[76:79]
    v_add_f32 v142, v142, v144
    v_add_f32 v143, v143, v145
    v_mfma_f32_16x16x32_bf16 v[80:83], v[32:35], v[196:199], v[80:83]
    ds_read_b128 v[32:35], v5 offset:43008
    s_waitcnt lgkmcnt(5)
    v_mfma_f32_16x16x32_bf16 v[84:87], v[36:39], v[192:195], v[84:87]
    v_add_f32 v146, v146, v148
    v_add_f32 v147, v147, v149
    v_mfma_f32_16x16x32_bf16 v[88:91], v[36:39], v[196:199], v[88:91]
    ds_read_b128 v[36:39], v5 offset:44032
    s_waitcnt vmcnt(12) lgkmcnt(5)
    v_mfma_f32_16x16x32_bf16 v[44:47], v[16:19], v[200:203], v[44:47]
    buffer_load_dwordx4 v[192:195], v2, s[24:27], s37 offen offset:3072 sc1
    v_mfma_f32_16x16x32_bf16 v[48:51], v[16:19], v[204:207], v[48:51]
    ds_read_b128 v[16:19], v5 offset:45056
    s_waitcnt lgkmcnt(5)
    v_mfma_f32_16x16x32_bf16 v[52:55], v[20:23], v[200:203], v[52:55]
    buffer_load_dwordx4 v[196:199], v2, s[24:27], s38 offen offset:3072 sc1
    v_mfma_f32_16x16x32_bf16 v[56:59], v[20:23], v[204:207], v[56:59]
    ds_read_b128 v[20:23], v5 offset:46080
    s_waitcnt lgkmcnt(5)
    v_mfma_f32_16x16x32_bf16 v[60:63], v[24:27], v[200:203], v[60:63]
    v_add_f32 v144, v142, v143
    v_mfma_f32_16x16x32_bf16 v[64:67], v[24:27], v[204:207], v[64:67]
    ds_read_b128 v[24:27], v5 offset:47104
    s_waitcnt lgkmcnt(5)
    v_mfma_f32_16x16x32_bf16 v[68:71], v[28:31], v[200:203], v[68:71]
    v_add_f32 v148, v146, v147
    v_mfma_f32_16x16x32_bf16 v[72:75], v[28:31], v[204:207], v[72:75]
    ds_read_b128 v[28:31], v5 offset:48128
    s_waitcnt lgkmcnt(5)
    v_mfma_f32_16x16x32_bf16 v[76:79], v[32:35], v[200:203], v[76:79]
    v_mul_f32 v142, 0xbacccccd, v142
    v_mul_f32 v143, 0x3acccccd, v143
    v_mfma_f32_16x16x32_bf16 v[80:83], v[32:35], v[204:207], v[80:83]
    ds_read_b128 v[32:35], v5 offset:49152
    s_waitcnt lgkmcnt(5)
    v_mfma_f32_16x16x32_bf16 v[84:87], v[36:39], v[200:203], v[84:87]
    v_mul_f32 v146, 0xbacccccd, v146
    v_mul_f32 v147, 0x3acccccd, v147
    v_mfma_f32_16x16x32_bf16 v[88:91], v[36:39], v[204:207], v[88:91]
    ds_read_b128 v[36:39], v5 offset:50176
    s_waitcnt vmcnt(12) lgkmcnt(5)
    v_mfma_f32_16x16x32_bf16 v[44:47], v[16:19], v[152:155], v[44:47]
    s_barrier
    v_mfma_f32_16x16x32_bf16 v[48:51], v[16:19], v[156:159], v[48:51]
    ds_read_b128 v[16:19], v5 offset:51200
    s_waitcnt lgkmcnt(5)
    v_mfma_f32_16x16x32_bf16 v[52:55], v[20:23], v[152:155], v[52:55]
    v_fma_f32 v143, -v142, v142, v143
    v_max_f32 v143, 0, v143
    v_mfma_f32_16x16x32_bf16 v[56:59], v[20:23], v[156:159], v[56:59]
    ds_read_b128 v[20:23], v5 offset:52224
    s_waitcnt lgkmcnt(5)
    v_mfma_f32_16x16x32_bf16 v[60:63], v[24:27], v[152:155], v[60:63]
    v_fma_f32 v147, -v146, v146, v147
    v_max_f32 v147, 0, v147
    v_mfma_f32_16x16x32_bf16 v[64:67], v[24:27], v[156:159], v[64:67]
    ds_read_b128 v[24:27], v5 offset:53248
    s_waitcnt lgkmcnt(5)
    v_mfma_f32_16x16x32_bf16 v[68:71], v[28:31], v[152:155], v[68:71]
    v_add_f32 v143, 0x3727c5ac, v143
    v_mfma_f32_16x16x32_bf16 v[72:75], v[28:31], v[156:159], v[72:75]
    ds_read_b128 v[28:31], v5 offset:54272
    s_waitcnt lgkmcnt(5)
    v_mfma_f32_16x16x32_bf16 v[76:79], v[32:35], v[152:155], v[76:79]
    v_add_f32 v147, 0x3727c5ac, v147
    v_mfma_f32_16x16x32_bf16 v[80:83], v[32:35], v[156:159], v[80:83]
    ds_read_b128 v[32:35], v5 offset:55296
    s_waitcnt lgkmcnt(5)
    v_mfma_f32_16x16x32_bf16 v[84:87], v[36:39], v[152:155], v[84:87]
    v_rsq_f32 v143, v143
    v_mfma_f32_16x16x32_bf16 v[88:91], v[36:39], v[156:159], v[88:91]
    ds_read_b128 v[36:39], v5 offset:56320
    s_waitcnt vmcnt(10) lgkmcnt(5)
    v_mfma_f32_16x16x32_bf16 v[44:47], v[16:19], v[160:163], v[44:47]
    v_rsq_f32 v147, v147
    v_mfma_f32_16x16x32_bf16 v[48:51], v[16:19], v[164:167], v[48:51]
    ds_read_b128 v[16:19], v5 offset:57344
    s_waitcnt lgkmcnt(5)
    v_mfma_f32_16x16x32_bf16 v[52:55], v[20:23], v[160:163], v[52:55]
    v_mul_f32 v143, 0xbfb8aa3b, v143
    v_mul_f32 v142, v142, v143
    v_mfma_f32_16x16x32_bf16 v[56:59], v[20:23], v[164:167], v[56:59]
    ds_read_b128 v[20:23], v5 offset:58368
    s_waitcnt lgkmcnt(5)
    v_mfma_f32_16x16x32_bf16 v[60:63], v[24:27], v[160:163], v[60:63]
    v_mul_f32 v147, 0xbfb8aa3b, v147
    v_mul_f32 v146, v146, v147
    v_mfma_f32_16x16x32_bf16 v[64:67], v[24:27], v[164:167], v[64:67]
    ds_read_b128 v[24:27], v5 offset:59392
    s_waitcnt lgkmcnt(5)
    v_mfma_f32_16x16x32_bf16 v[68:71], v[28:31], v[160:163], v[68:71]
    v_mul_f32 v208, v100, v146
    v_mul_f32 v100, v100, v142
    v_mfma_f32_16x16x32_bf16 v[72:75], v[28:31], v[164:167], v[72:75]
    ds_read_b128 v[28:31], v5 offset:60416
    s_waitcnt lgkmcnt(5)
    v_mfma_f32_16x16x32_bf16 v[76:79], v[32:35], v[160:163], v[76:79]
    v_mul_f32 v209, v101, v146
    v_mul_f32 v101, v101, v142
    v_mfma_f32_16x16x32_bf16 v[80:83], v[32:35], v[164:167], v[80:83]
    ds_read_b128 v[32:35], v5 offset:61440
    s_waitcnt lgkmcnt(5)
    v_mfma_f32_16x16x32_bf16 v[84:87], v[36:39], v[160:163], v[84:87]
    v_mul_f32 v210, v102, v146
    v_mul_f32 v102, v102, v142
    v_mfma_f32_16x16x32_bf16 v[88:91], v[36:39], v[164:167], v[88:91]
    ds_read_b128 v[36:39], v5 offset:62464
    s_waitcnt vmcnt(8) lgkmcnt(5)
    v_mfma_f32_16x16x32_bf16 v[44:47], v[16:19], v[168:171], v[44:47]
    v_mul_f32 v211, v103, v146
    v_mul_f32 v103, v103, v142
    v_mfma_f32_16x16x32_bf16 v[48:51], v[16:19], v[172:175], v[48:51]
    ds_read_b128 v[16:19], v5 offset:63488
    s_waitcnt lgkmcnt(5)
    v_mfma_f32_16x16x32_bf16 v[52:55], v[20:23], v[168:171], v[52:55]
    v_mul_f32 v212, v104, v146
    v_mul_f32 v104, v104, v142
    v_mfma_f32_16x16x32_bf16 v[56:59], v[20:23], v[172:175], v[56:59]
    ds_read_b128 v[20:23], v5 offset:64512
    s_waitcnt lgkmcnt(5)
    v_mfma_f32_16x16x32_bf16 v[60:63], v[24:27], v[168:171], v[60:63]
    v_mul_f32 v213, v105, v146
    v_mul_f32 v105, v105, v142
    v_mfma_f32_16x16x32_bf16 v[64:67], v[24:27], v[172:175], v[64:67]
    ds_read_b128 v[24:27], v6 offset:0
    s_waitcnt lgkmcnt(5)
    v_mfma_f32_16x16x32_bf16 v[68:71], v[28:31], v[168:171], v[68:71]
    v_mul_f32 v214, v106, v146
    v_mul_f32 v106, v106, v142
    v_mfma_f32_16x16x32_bf16 v[72:75], v[28:31], v[172:175], v[72:75]
    ds_read_b128 v[28:31], v6 offset:1024
    s_waitcnt lgkmcnt(5)
    v_mfma_f32_16x16x32_bf16 v[76:79], v[32:35], v[168:171], v[76:79]
    v_mul_f32 v215, v107, v146
    v_mul_f32 v107, v107, v142
    v_mfma_f32_16x16x32_bf16 v[80:83], v[32:35], v[172:175], v[80:83]
    ds_read_b128 v[32:35], v6 offset:2048
    s_waitcnt lgkmcnt(5)
    v_mfma_f32_16x16x32_bf16 v[84:87], v[36:39], v[168:171], v[84:87]
    v_mul_f32 v216, v108, v146
    v_mul_f32 v108, v108, v142
    v_mfma_f32_16x16x32_bf16 v[88:91], v[36:39], v[172:175], v[88:91]
    ds_read_b128 v[36:39], v6 offset:3072
    s_waitcnt vmcnt(4) lgkmcnt(5)
    v_mfma_f32_16x16x32_bf16 v[44:47], v[16:19], v[176:179], v[44:47]
    v_mul_f32 v217, v109, v146
    v_mul_f32 v109, v109, v142
    v_mfma_f32_16x16x32_bf16 v[48:51], v[16:19], v[180:183], v[48:51]
    ds_read_b128 v[16:19], v6 offset:4096
    s_waitcnt lgkmcnt(5)
    v_mfma_f32_16x16x32_bf16 v[52:55], v[20:23], v[176:179], v[52:55]
    v_mul_f32 v218, v110, v146
    v_mul_f32 v110, v110, v142
    v_mfma_f32_16x16x32_bf16 v[56:59], v[20:23], v[180:183], v[56:59]
    ds_read_b128 v[20:23], v6 offset:5120
    s_waitcnt lgkmcnt(5)
    v_mfma_f32_16x16x32_bf16 v[60:63], v[24:27], v[176:179], v[60:63]
    v_mul_f32 v219, v111, v146
    v_mul_f32 v111, v111, v142
    v_mfma_f32_16x16x32_bf16 v[64:67], v[24:27], v[180:183], v[64:67]
    ds_read_b128 v[24:27], v6 offset:6144
    s_waitcnt lgkmcnt(5)
    v_mfma_f32_16x16x32_bf16 v[68:71], v[28:31], v[176:179], v[68:71]
    v_mul_f32 v220, v112, v146
    v_mul_f32 v112, v112, v142
    v_mfma_f32_16x16x32_bf16 v[72:75], v[28:31], v[180:183], v[72:75]
    ds_read_b128 v[28:31], v6 offset:7168
    s_waitcnt lgkmcnt(5)
    v_mfma_f32_16x16x32_bf16 v[76:79], v[32:35], v[176:179], v[76:79]
    v_mul_f32 v221, v113, v146
    v_mul_f32 v113, v113, v142
    v_mfma_f32_16x16x32_bf16 v[80:83], v[32:35], v[180:183], v[80:83]
    ds_read_b128 v[32:35], v6 offset:8192
    s_waitcnt lgkmcnt(5)
    v_mfma_f32_16x16x32_bf16 v[84:87], v[36:39], v[176:179], v[84:87]
    v_mul_f32 v222, v114, v146
    v_mul_f32 v114, v114, v142
    v_mfma_f32_16x16x32_bf16 v[88:91], v[36:39], v[180:183], v[88:91]
    ds_read_b128 v[36:39], v6 offset:9216
    s_waitcnt vmcnt(2) lgkmcnt(5)
    v_mfma_f32_16x16x32_bf16 v[44:47], v[16:19], v[184:187], v[44:47]
    v_mul_f32 v223, v115, v146
    v_mul_f32 v115, v115, v142
    v_mfma_f32_16x16x32_bf16 v[48:51], v[16:19], v[188:191], v[48:51]
    ds_read_b128 v[16:19], v6 offset:10240
    s_waitcnt lgkmcnt(5)
    v_mfma_f32_16x16x32_bf16 v[52:55], v[20:23], v[184:187], v[52:55]
    v_mul_f32 v224, v116, v146
    v_mul_f32 v116, v116, v142
    v_mfma_f32_16x16x32_bf16 v[56:59], v[20:23], v[188:191], v[56:59]
    ds_read_b128 v[20:23], v6 offset:11264
    s_waitcnt lgkmcnt(5)
    v_mfma_f32_16x16x32_bf16 v[60:63], v[24:27], v[184:187], v[60:63]
    v_mul_f32 v225, v117, v146
    v_mul_f32 v117, v117, v142
    v_mfma_f32_16x16x32_bf16 v[64:67], v[24:27], v[188:191], v[64:67]
    ds_read_b128 v[24:27], v6 offset:12288
    s_waitcnt lgkmcnt(5)
    v_mfma_f32_16x16x32_bf16 v[68:71], v[28:31], v[184:187], v[68:71]
    v_mul_f32 v226, v118, v146
    v_mul_f32 v118, v118, v142
    v_mfma_f32_16x16x32_bf16 v[72:75], v[28:31], v[188:191], v[72:75]
    ds_read_b128 v[28:31], v6 offset:13312
    s_waitcnt lgkmcnt(5)
    v_mfma_f32_16x16x32_bf16 v[76:79], v[32:35], v[184:187], v[76:79]
    v_mul_f32 v227, v119, v146
    v_mul_f32 v119, v119, v142
    v_mfma_f32_16x16x32_bf16 v[80:83], v[32:35], v[188:191], v[80:83]
    ds_read_b128 v[32:35], v6 offset:14336
    s_waitcnt lgkmcnt(5)
    v_mfma_f32_16x16x32_bf16 v[84:87], v[36:39], v[184:187], v[84:87]
    v_mul_f32 v228, v120, v146
    v_mul_f32 v120, v120, v142
    v_mfma_f32_16x16x32_bf16 v[88:91], v[36:39], v[188:191], v[88:91]
    ds_read_b128 v[36:39], v6 offset:15360
    s_waitcnt vmcnt(0) lgkmcnt(5)
    v_mfma_f32_16x16x32_bf16 v[44:47], v[16:19], v[192:195], v[44:47]
    v_mul_f32 v229, v121, v146
    v_mul_f32 v121, v121, v142
    v_mfma_f32_16x16x32_bf16 v[48:51], v[16:19], v[196:199], v[48:51]
    s_waitcnt lgkmcnt(4)
    v_mfma_f32_16x16x32_bf16 v[52:55], v[20:23], v[192:195], v[52:55]
    v_mul_f32 v230, v122, v146
    v_mul_f32 v122, v122, v142
    v_mfma_f32_16x16x32_bf16 v[56:59], v[20:23], v[196:199], v[56:59]
    s_waitcnt lgkmcnt(3)
    v_mfma_f32_16x16x32_bf16 v[60:63], v[24:27], v[192:195], v[60:63]
    v_mul_f32 v231, v123, v146
    v_mul_f32 v123, v123, v142
    v_mfma_f32_16x16x32_bf16 v[64:67], v[24:27], v[196:199], v[64:67]
    s_waitcnt lgkmcnt(2)
    v_mfma_f32_16x16x32_bf16 v[68:71], v[28:31], v[192:195], v[68:71]
    v_mfma_f32_16x16x32_bf16 v[72:75], v[28:31], v[196:199], v[72:75]
    v_cmp_u_f32 vcc, v44, v48
    s_nop 0
    s_cbranch_vccnz k_r4_6
    s_waitcnt lgkmcnt(1)
    v_mfma_f32_16x16x32_bf16 v[76:79], v[32:35], v[192:195], v[76:79]
    v_mfma_f32_16x16x32_bf16 v[80:83], v[32:35], v[196:199], v[80:83]
    s_waitcnt lgkmcnt(0)
    v_mfma_f32_16x16x32_bf16 v[84:87], v[36:39], v[192:195], v[84:87]
    v_mfma_f32_16x16x32_bf16 v[88:91], v[36:39], v[196:199], v[88:91]
    v_cmp_u_f32 vcc, v144, v148
    s_nop 0
    s_cbranch_vccnz k_r4_6
k_r4_6_ret:
    s_mov_b32 s54, s93
    s_add_u32 s56, s93, 55296
    s_add_u32 s57, s94, 55296
    v_mov_b32 v14, 0xbfb8aa3b
    v_mov_b32 v15, 0xbfb8aa3b
    v_pk_fma_f32 v[44:45], v[44:45], v[142:143], v[100:101] op_sel:[0,1,0] op_sel_hi:[1,1,1]
    v_pk_fma_f32 v[46:47], v[46:47], v[142:143], v[102:103] op_sel:[0,1,0] op_sel_hi:[1,1,1]
    v_pk_fma_f32 v[52:53], v[52:53], v[142:143], v[104:105] op_sel:[0,1,0] op_sel_hi:[1,1,1]
    v_pk_fma_f32 v[54:55], v[54:55], v[142:143], v[106:107] op_sel:[0,1,0] op_sel_hi:[1,1,1]
    v_exp_f32 v16, v44
    v_exp_f32 v17, v45
    v_exp_f32 v18, v46
    v_exp_f32 v19, v47
    v_exp_f32 v20, v52
    v_exp_f32 v21, v53
    v_exp_f32 v22, v54
    v_exp_f32 v23, v55
    v_pk_fma_f32 v[16:17], v[16:17], v[14:15], v[14:15]
    v_pk_fma_f32 v[18:19], v[18:19], v[14:15], v[14:15]
    v_pk_fma_f32 v[20:21], v[20:21], v[14:15], v[14:15]
    v_pk_fma_f32 v[22:23], v[22:23], v[14:15], v[14:15]
    v_rcp_f32 v16, v16
    v_rcp_f32 v17, v17
    v_rcp_f32 v18, v18
    v_rcp_f32 v19, v19
    v_rcp_f32 v20, v20
    v_rcp_f32 v21, v21
    v_rcp_f32 v22, v22
    v_rcp_f32 v23, v23
    v_pk_mul_f32 v[44:45], v[44:45], v[16:17]
    v_pk_mul_f32 v[46:47], v[46:47], v[18:19]
    v_pk_mul_f32 v[52:53], v[52:53], v[20:21]
    v_pk_mul_f32 v[54:55], v[54:55], v[22:23]
    v_cvt_pk_bf16_f32 v24, v44, v45
    v_cvt_pk_bf16_f32 v25, v46, v47
    v_cvt_pk_bf16_f32 v26, v52, v53
    v_cvt_pk_bf16_f32 v27, v54, v55
    buffer_store_dwordx4 v[24:27], v2, s[24:27], s54 offen sc1
    s_add_u32 s54, s54, 8192
    s_lshl_b32 s53, s64, 1
    s_add_u32 s53, s53, s63
    s_mul_i32 s55, s63, 27648
    s_add_u32 s55, s55, 13107200
    s_mul_i32 s37, s53, 55296
    s_add_u32 s37, s37, s55
    s_mul_i32 s73, s53, 2048
    s_add_u32 s73, s73, 26722304
    s_xor_b32 s53, s53, 1
    s_mul_i32 s38, s53, 55296
    s_add_u32 s38, s38, s55
    v_pk_fma_f32 v[48:49], v[48:49], v[146:147], v[208:209] op_sel:[0,1,0] op_sel_hi:[1,1,1]
    v_pk_fma_f32 v[50:51], v[50:51], v[146:147], v[210:211] op_sel:[0,1,0] op_sel_hi:[1,1,1]
    v_pk_fma_f32 v[56:57], v[56:57], v[146:147], v[212:213] op_sel:[0,1,0] op_sel_hi:[1,1,1]
    v_pk_fma_f32 v[58:59], v[58:59], v[146:147], v[214:215] op_sel:[0,1,0] op_sel_hi:[1,1,1]
    v_exp_f32 v28, v48
    v_exp_f32 v29, v49
    v_exp_f32 v30, v50
    v_exp_f32 v31, v51
    v_exp_f32 v32, v56
    v_exp_f32 v33, v57
    v_exp_f32 v34, v58
    v_exp_f32 v35, v59
    v_pk_fma_f32 v[28:29], v[28:29], v[14:15], v[14:15]
    v_pk_fma_f32 v[30:31], v[30:31], v[14:15], v[14:15]
    v_pk_fma_f32 v[32:33], v[32:33], v[14:15], v[14:15]
    v_pk_fma_f32 v[34:35], v[34:35], v[14:15], v[14:15]
    v_rcp_f32 v28, v28
    v_rcp_f32 v29, v29
    v_rcp_f32 v30, v30
    v_rcp_f32 v31, v31
    v_rcp_f32 v32, v32
    v_rcp_f32 v33, v33
    v_rcp_f32 v34, v34
    v_rcp_f32 v35, v35
    v_pk_mul_f32 v[48:49], v[48:49], v[28:29]
    v_pk_mul_f32 v[50:51], v[50:51], v[30:31]
    v_pk_mul_f32 v[56:57], v[56:57], v[32:33]
    v_pk_mul_f32 v[58:59], v[58:59], v[34:35]
    v_cvt_pk_bf16_f32 v36, v48, v49
    v_cvt_pk_bf16_f32 v37, v50, v51
    v_cvt_pk_bf16_f32 v38, v56, v57
    v_cvt_pk_bf16_f32 v39, v58, v59
    buffer_store_dwordx4 v[36:39], v2, s[24:27], s56 offen sc1
    s_add_u32 s56, s56, 8192
    s_and_b32 s72, s84, 0xfffff800
    s_mov_b64 exec, 3
    buffer_atomic_add v254, v10, s[24:27], s72 offen sc1
    s_mov_b64 exec, -1
    v_pk_fma_f32 v[60:61], v[60:61], v[142:143], v[108:109] op_sel:[0,1,0] op_sel_hi:[1,1,1]
    v_pk_fma_f32 v[62:63], v[62:63], v[142:143], v[110:111] op_sel:[0,1,0] op_sel_hi:[1,1,1]
    v_pk_fma_f32 v[68:69], v[68:69], v[142:143], v[112:113] op_sel:[0,1,0] op_sel_hi:[1,1,1]
    v_pk_fma_f32 v[70:71], v[70:71], v[142:143], v[114:115] op_sel:[0,1,0] op_sel_hi:[1,1,1]
    v_exp_f32 v16, v60
    v_exp_f32 v17, v61
    v_exp_f32 v18, v62
    v_exp_f32 v19, v63
    v_exp_f32 v20, v68
    v_exp_f32 v21, v69
    v_exp_f32 v22, v70
    v_exp_f32 v23, v71
    v_pk_fma_f32 v[16:17], v[16:17], v[14:15], v[14:15]
    v_pk_fma_f32 v[18:19], v[18:19], v[14:15], v[14:15]
    v_pk_fma_f32 v[20:21], v[20:21], v[14:15], v[14:15]
    v_pk_fma_f32 v[22:23], v[22:23], v[14:15], v[14:15]
    v_rcp_f32 v16, v16
    v_rcp_f32 v17, v17
    v_rcp_f32 v18, v18
    v_rcp_f32 v19, v19
    v_rcp_f32 v20, v20
    v_rcp_f32 v21, v21
    v_rcp_f32 v22, v22
    v_rcp_f32 v23, v23
    v_pk_mul_f32 v[60:61], v[60:61], v[16:17]
    v_pk_mul_f32 v[62:63], v[62:63], v[18:19]
    v_pk_mul_f32 v[68:69], v[68:69], v[20:21]
    v_pk_mul_f32 v[70:71], v[70:71], v[22:23]
    v_cvt_pk_bf16_f32 v24, v60, v61
    v_cvt_pk_bf16_f32 v25, v62, v63
    v_cvt_pk_bf16_f32 v26, v68, v69
    v_cvt_pk_bf16_f32 v27, v70, v71
    buffer_store_dwordx4 v[24:27], v2, s[24:27], s54 offen sc1
    s_add_u32 s54, s54, 8192
    s_barrier
    v_pk_fma_f32 v[64:65], v[64:65], v[146:147], v[216:217] op_sel:[0,1,0] op_sel_hi:[1,1,1]
    v_pk_fma_f32 v[66:67], v[66:67], v[146:147], v[218:219] op_sel:[0,1,0] op_sel_hi:[1,1,1]
    v_pk_fma_f32 v[72:73], v[72:73], v[146:147], v[220:221] op_sel:[0,1,0] op_sel_hi:[1,1,1]
    v_pk_fma_f32 v[74:75], v[74:75], v[146:147], v[222:223] op_sel:[0,1,0] op_sel_hi:[1,1,1]
    v_exp_f32 v28, v64
    v_exp_f32 v29, v65
    v_exp_f32 v30, v66
    v_exp_f32 v31, v67
    v_exp_f32 v32, v72
    v_exp_f32 v33, v73
    v_exp_f32 v34, v74
    v_exp_f32 v35, v75
    v_pk_fma_f32 v[28:29], v[28:29], v[14:15], v[14:15]
    v_pk_fma_f32 v[30:31], v[30:31], v[14:15], v[14:15]
    v_pk_fma_f32 v[32:33], v[32:33], v[14:15], v[14:15]
    v_pk_fma_f32 v[34:35], v[34:35], v[14:15], v[14:15]
    v_rcp_f32 v28, v28
    v_rcp_f32 v29, v29
    v_rcp_f32 v30, v30
    v_rcp_f32 v31, v31
    v_rcp_f32 v32, v32
    v_rcp_f32 v33, v33
    v_rcp_f32 v34, v34
    v_rcp_f32 v35, v35
    v_pk_mul_f32 v[64:65], v[64:65], v[28:29]
    v_pk_mul_f32 v[66:67], v[66:67], v[30:31]
    v_pk_mul_f32 v[72:73], v[72:73], v[32:33]
    v_pk_mul_f32 v[74:75], v[74:75], v[34:35]
    v_cvt_pk_bf16_f32 v36, v64, v65
    v_cvt_pk_bf16_f32 v37, v66, v67
    v_cvt_pk_bf16_f32 v38, v72, v73
    v_cvt_pk_bf16_f32 v39, v74, v75
    buffer_store_dwordx4 v[36:39], v2, s[24:27], s56 offen sc1
    s_add_u32 s56, s56, 8192
    v_pk_fma_f32 v[76:77], v[76:77], v[142:143], v[116:117] op_sel:[0,1,0] op_sel_hi:[1,1,1]
    v_pk_fma_f32 v[78:79], v[78:79], v[142:143], v[118:119] op_sel:[0,1,0] op_sel_hi:[1,1,1]
    v_pk_fma_f32 v[84:85], v[84:85], v[142:143], v[120:121] op_sel:[0,1,0] op_sel_hi:[1,1,1]
    v_pk_fma_f32 v[86:87], v[86:87], v[142:143], v[122:123] op_sel:[0,1,0] op_sel_hi:[1,1,1]
    v_exp_f32 v16, v76
    v_exp_f32 v17, v77
    v_exp_f32 v18, v78
    v_exp_f32 v19, v79
    v_exp_f32 v20, v84
    v_exp_f32 v21, v85
    v_exp_f32 v22, v86
    v_exp_f32 v23, v87
    v_pk_fma_f32 v[16:17], v[16:17], v[14:15], v[14:15]
    v_pk_fma_f32 v[18:19], v[18:19], v[14:15], v[14:15]
    v_pk_fma_f32 v[20:21], v[20:21], v[14:15], v[14:15]
    v_pk_fma_f32 v[22:23], v[22:23], v[14:15], v[14:15]
    v_rcp_f32 v16, v16
    v_rcp_f32 v17, v17
    v_rcp_f32 v18, v18
    v_rcp_f32 v19, v19
    v_rcp_f32 v20, v20
    v_rcp_f32 v21, v21
    v_rcp_f32 v22, v22
    v_rcp_f32 v23, v23
    v_pk_mul_f32 v[76:77], v[76:77], v[16:17]
    v_pk_mul_f32 v[78:79], v[78:79], v[18:19]
    v_pk_mul_f32 v[84:85], v[84:85], v[20:21]
    v_pk_mul_f32 v[86:87], v[86:87], v[22:23]
    v_cvt_pk_bf16_f32 v24, v76, v77
    v_cvt_pk_bf16_f32 v25, v78, v79
    v_cvt_pk_bf16_f32 v26, v84, v85
    v_cvt_pk_bf16_f32 v27, v86, v87
    buffer_store_dwordx4 v[24:27], v2, s[24:27], s54 offen sc1
    s_add_u32 s54, s54, 8192
    s_and_b32 s74, s61, 1
    s_mul_i32 s74, s74, 256
    s_add_u32 s74, s74, s73
    s_mov_b32 s71, 0
    v_mov_b32 v252, 0
    s_mov_b64 exec, 1
    buffer_atomic_add v252, off, s[24:27], s74 sc0 sc1
    s_mov_b64 exec, -1
    v_pk_fma_f32 v[80:81], v[80:81], v[146:147], v[224:225] op_sel:[0,1,0] op_sel_hi:[1,1,1]
    v_pk_fma_f32 v[82:83], v[82:83], v[146:147], v[226:227] op_sel:[0,1,0] op_sel_hi:[1,1,1]
    v_pk_fma_f32 v[88:89], v[88:89], v[146:147], v[228:229] op_sel:[0,1,0] op_sel_hi:[1,1,1]
    v_pk_fma_f32 v[90:91], v[90:91], v[146:147], v[230:231] op_sel:[0,1,0] op_sel_hi:[1,1,1]
    v_exp_f32 v28, v80
    v_exp_f32 v29, v81
    v_exp_f32 v30, v82
    v_exp_f32 v31, v83
    v_exp_f32 v32, v88
    v_exp_f32 v33, v89
    v_exp_f32 v34, v90
    v_exp_f32 v35, v91
    v_pk_fma_f32 v[28:29], v[28:29], v[14:15], v[14:15]
    v_pk_fma_f32 v[30:31], v[30:31], v[14:15], v[14:15]
    v_pk_fma_f32 v[32:33], v[32:33], v[14:15], v[14:15]
    v_pk_fma_f32 v[34:35], v[34:35], v[14:15], v[14:15]
    v_rcp_f32 v28, v28
    v_rcp_f32 v29, v29
    v_rcp_f32 v30, v30
    v_rcp_f32 v31, v31
    v_rcp_f32 v32, v32
    v_rcp_f32 v33, v33
    v_rcp_f32 v34, v34
    v_rcp_f32 v35, v35
    v_pk_mul_f32 v[80:81], v[80:81], v[28:29]
    v_pk_mul_f32 v[82:83], v[82:83], v[30:31]
    v_pk_mul_f32 v[88:89], v[88:89], v[32:33]
    v_pk_mul_f32 v[90:91], v[90:91], v[34:35]
    v_cvt_pk_bf16_f32 v36, v80, v81
    v_cvt_pk_bf16_f32 v37, v82, v83
    v_cvt_pk_bf16_f32 v38, v88, v89
    v_cvt_pk_bf16_f32 v39, v90, v91
    buffer_store_dwordx4 v[36:39], v2, s[24:27], s56 offen sc1
    s_add_u32 s56, s56, 8192
    s_waitcnt vmcnt(1)
    s_branch k_f4_6_c1
k_f4_6_c0:
    v_mov_b32 v252, 0
    s_mov_b64 exec, 1
    buffer_atomic_add v252, off, s[24:27], s74 sc0 sc1
    s_mov_b64 exec, -1
    s_waitcnt vmcnt(0)
k_f4_6_c1:
    v_readfirstlane_b32 s53, v252
    s_add_u32 s71, s71, 1
    s_cmp_gt_u32 s71, 131072
    s_cbranch_scc1 k_f4_6_c2
    s_cmp_lt_u32 s53, 8
    s_cbranch_scc1 k_f4_6_c0
k_f4_6_c2:
k_p5:
k_pad9:
    s_cbranch_execz k_walked2_0
    buffer_load_dwordx4 v[152:155], v2, s[24:27], s37 offen offset:0 sc1
    buffer_load_dwordx4 v[156:159], v2, s[24:27], s38 offen offset:0 sc1
    buffer_load_dwordx4 v[160:163], v2, s[24:27], s37 offen offset:1024 sc1
    buffer_load_dwordx4 v[164:167], v2, s[24:27], s38 offen offset:1024 sc1
    buffer_load_dwordx4 v[168:171], v2, s[24:27], s37 offen offset:2048 sc1
    buffer_load_dwordx4 v[172:175], v2, s[24:27], s38 offen offset:2048 sc1
    buffer_load_dwordx4 v[176:179], v2, s[24:27], s37 offen offset:3072 sc1
    buffer_load_dwordx4 v[180:183], v2, s[24:27], s38 offen offset:3072 sc1
    s_mul_i32 s53, s63, 10240
    v_add_u32 v5, s53, v2
    v_add_u32 v6, 0x10000, v5
    v_add_u32 v7, 0x20000, v5
    v_lshlrev_b32 v44, 16, v132
    v_and_b32 v45, 0xffff0000, v132
    v_lshlrev_b32 v46, 16, v133
    v_and_b32 v47, 0xffff0000, v133
    v_mov_b32 v48, 0
    v_mov_b32 v49, 0
    v_mov_b32 v50, 0
    v_mov_b32 v51, 0
    v_lshlrev_b32 v52, 16, v134
    v_and_b32 v53, 0xffff0000, v134
    v_lshlrev_b32 v54, 16, v135
    v_and_b32 v55, 0xffff0000, v135
    v_mov_b32 v56, 0
    v_mov_b32 v57, 0
    v_mov_b32 v58, 0
    v_mov_b32 v59, 0
    v_lshlrev_b32 v60, 16, v136
    v_and_b32 v61, 0xffff0000, v136
    v_lshlrev_b32 v62, 16, v137
    v_and_b32 v63, 0xffff0000, v137
    v_mov_b32 v64, 0
    v_mov_b32 v65, 0
    v_mov_b32 v66, 0
    v_mov_b32 v67, 0
    v_lshlrev_b32 v68, 16, v138
    v_and_b32 v69, 0xffff0000, v138
    v_lshlrev_b32 v70, 16, v139
    v_and_b32 v71, 0xffff0000, v139
    v_mov_b32 v72, 0
    v_mov_b32 v73, 0
    v_mov_b32 v74, 0
    v_mov_b32 v75, 0
    v_lshlrev_b32 v76, 16, v140
    v_and_b32 v77, 0xffff0000, v140
    v_lshlrev_b32 v78, 16, v141
    v_and_b32 v79, 0xffff0000, v141
    v_mov_b32 v80, 0
    v_mov_b32 v81, 0
    v_mov_b32 v82, 0
    v_mov_b32 v83, 0
    s_mul_i32 s53, s36, 10752
    s_add_u32 s53, s53, 61440
    s_and_b32 s54, s61, 1
    s_lshl_b32 s55, s54, 6
    s_add_u32 s55, s55, s53
    s_xor_b32 s54, s54, 1
    s_lshl_b32 s56, s54, 8
    s_add_u32 s56, s56, s53
    s_lshl_b32 s53, s63, 4
    v_add_u32 v84, s53, v8
    v_xor_b32 v86, 16, v84
    v_mul_u32_u24 v84, 336, v84
    v_lshl_add_u32 v85, v9, 4, v84
    v_add_u32 v85, s56, v85
    v_lshl_add_u32 v84, v9, 5, v84
    v_add_u32 v84, s55, v84
    v_mul_u32_u24 v86, 336, v86
    v_lshl_add_u32 v87, v9, 4, v86
    v_add_u32 v87, s56, v87
    v_lshl_add_u32 v86, v9, 5, v86
    v_add_u32 v86, s55, v86
    s_mov_b32 s28, s16
    s_mov_b32 s29, s17
    s_mov_b32 s30, 2621440
    s_mul_i32 s59, s60, 81920
    s_mul_i32 s54, s61, 160
    s_add_u32 s59, s59, s54
    v_add_u32 v100, 0, v0
    v_mul_u32_u24 v101, 6554, v100
    v_lshrrev_b32 v101, 16, v101
    v_mul_u32_u24 v102, 16, v101
    v_lshl_add_u32 v102, v100, 5, v102
    v_add_u32 v102, 61440, v102
    v_mul_u32_u24 v103, 1120, v101
    v_lshl_add_u32 v103, v100, 4, v103
    v_add_u32 v104, 128, v0
    v_mul_u32_u24 v105, 6554, v104
    v_lshrrev_b32 v105, 16, v105
    v_mul_u32_u24 v106, 16, v105
    v_lshl_add_u32 v106, v104, 5, v106
    v_add_u32 v106, 61440, v106
    v_mul_u32_u24 v107, 1120, v105
    v_lshl_add_u32 v107, v104, 4, v107
    s_barrier
    ds_read_b128 v[16:19], v6 offset:36864
    ds_read_b128 v[20:23], v6 offset:37888
    ds_read_b128 v[24:27], v6 offset:38912
    ds_read_b128 v[28:31], v6 offset:39936
    ds_read_b128 v[32:35], v6 offset:40960
    s_add_u32 s37, s37, 4096
    buffer_load_dwordx4 v[184:187], v2, s[24:27], s37 offen offset:0 sc1
    s_add_u32 s38, s38, 4096
    buffer_load_dwordx4 v[188:191], v2, s[24:27], s38 offen offset:0 sc1
    buffer_load_dwordx4 v[192:195], v2, s[24:27], s37 offen offset:1024 sc1
    buffer_load_dwordx4 v[196:199], v2, s[24:27], s38 offen offset:1024 sc1
    s_waitcnt vmcnt(10) lgkmcnt(4)
    v_mfma_f32_16x16x32_bf16 v[44:47], v[16:19], v[152:155], v[44:47]
k_pad10:
    s_cbranch_execz k_walked2_0
    buffer_load_dwordx4 v[200:203], v2, s[24:27], s37 offen offset:2048 sc1
    v_mfma_f32_16x16x32_bf16 v[48:51], v[16:19], v[156:159], v[48:51]
    ds_read_b128 v[16:19], v6 offset:41984
    s_waitcnt lgkmcnt(4)
    v_mfma_f32_16x16x32_bf16 v[52:55], v[20:23], v[152:155], v[52:55]
    buffer_load_dwordx4 v[204:207], v2, s[24:27], s38 offen offset:2048 sc1
    v_mfma_f32_16x16x32_bf16 v[56:59], v[20:23], v[156:159], v[56:59]
    ds_read_b128 v[20:23], v6 offset:43008
    s_waitcnt lgkmcnt(4)
    v_mfma_f32_16x16x32_bf16 v[60:63], v[24:27], v[152:155], v[60:63]
    s_mov_b64 exec, 1
    buffer_store_dwordx2 v[150:151], off, s[24:27], s84 offset:128 sc1
    s_mov_b64 exec, -1
    v_mfma_f32_16x16x32_bf16 v[64:67], v[24:27], v[156:159], v[64:67]
    ds_read_b128 v[24:27], v6 offset:44032
    s_waitcnt lgkmcnt(4)
    v_mfma_f32_16x16x32_bf16 v[68:71], v[28:31], v[152:155], v[68:71]
    v_mfma_f32_16x16x32_bf16 v[72:75], v[28:31], v[156:159], v[72:75]
    ds_read_b128 v[28:31], v6 offset:45056
    s_waitcnt lgkmcnt(4)
    v_mfma_f32_16x16x32_bf16 v[76:79], v[32:35], v[152:155], v[76:79]
    v_mfma_f32_16x16x32_bf16 v[80:83], v[32:35], v[156:159], v[80:83]
    ds_read_b128 v[32:35], v6 offset:46080
    s_waitcnt vmcnt(11) lgkmcnt(4)
    v_mfma_f32_16x16x32_bf16 v[44:47], v[16:19], v[160:163], v[44:47]
    buffer_load_dwordx4 v[208:211], v2, s[24:27], s37 offen offset:3072 sc1
    v_mfma_f32_16x16x32_bf16 v[48:51], v[16:19], v[164:167], v[48:51]
    ds_read_b128 v[16:19], v6 offset:57344
    s_waitcnt lgkmcnt(4)
    v_mfma_f32_16x16x32_bf16 v[52:55], v[20:23], v[160:163], v[52:55]
    buffer_load_dwordx4 v[212:215], v2, s[24:27], s38 offen offset:3072 sc1
    v_mfma_f32_16x16x32_bf16 v[56:59], v[20:23], v[164:167], v[56:59]
    ds_read_b128 v[20:23], v6 offset:58368
    s_waitcnt lgkmcnt(4)
    v_mfma_f32_16x16x32_bf16 v[60:63], v[24:27], v[160:163], v[60:63]
    v_mfma_f32_16x16x32_bf16 v[64:67], v[24:27], v[164:167], v[64:67]
    ds_read_b128 v[24:27], v6 offset:59392
    s_waitcnt lgkmcnt(4)
    v_mfma_f32_16x16x32_bf16 v[68:71], v[28:31], v[160:163], v[68:71]
    v_mfma_f32_16x16x32_bf16 v[72:75], v[28:31], v[164:167], v[72:75]
    ds_read_b128 v[28:31], v6 offset:60416
    s_waitcnt lgkmcnt(4)
    v_mfma_f32_16x16x32_bf16 v[76:79], v[32:35], v[160:163], v[76:79]
    v_mfma_f32_16x16x32_bf16 v[80:83], v[32:35], v[164:167], v[80:83]
    ds_read_b128 v[32:35], v6 offset:61440
    s_waitcnt vmcnt(11) lgkmcnt(4)
    v_mfma_f32_16x16x32_bf16 v[44:47], v[16:19], v[168:171], v[44:47]
    s_add_u32 s37, s37, 4096
    buffer_load_dwordx4 v[216:219], v2, s[24:27], s37 offen offset:0 sc1
    v_mfma_f32_16x16x32_bf16 v[48:51], v[16:19], v[172:175], v[48:51]
    ds_read_b128 v[16:19], v6 offset:62464
    s_waitcnt lgkmcnt(4)
    v_mfma_f32_16x16x32_bf16 v[52:55], v[20:23], v[168:171], v[52:55]
    s_add_u32 s38, s38, 4096
    buffer_load_dwordx4 v[220:223], v2, s[24:27], s38 offen offset:0 sc1
    v_mfma_f32_16x16x32_bf16 v[56:59], v[20:23], v[172:175], v[56:59]
    ds_read_b128 v[20:23], v6 offset:63488
    s_waitcnt lgkmcnt(4)
    v_mfma_f32_16x16x32_bf16 v[60:63], v[24:27], v[168:171], v[60:63]
    v_mfma_f32_16x16x32_bf16 v[64:67], v[24:27], v[172:175], v[64:67]
    ds_read_b128 v[24:27], v6 offset:64512
    s_waitcnt lgkmcnt(4)
    v_mfma_f32_16x16x32_bf16 v[68:71], v[28:31], v[168:171], v[68:71]
    v_mfma_f32_16x16x32_bf16 v[72:75], v[28:31], v[172:175], v[72:75]
    ds_read_b128 v[28:31], v7 offset:0
    s_waitcnt lgkmcnt(4)
    v_mfma_f32_16x16x32_bf16 v[76:79], v[32:35], v[168:171], v[76:79]
    v_mfma_f32_16x16x32_bf16 v[80:83], v[32:35], v[172:175], v[80:83]
    ds_read_b128 v[32:35], v7 offset:1024
    s_waitcnt vmcnt(11) lgkmcnt(4)
    v_mfma_f32_16x16x32_bf16 v[44:47], v[16:19], v[176:179], v[44:47]
    buffer_load_dwordx4 v[224:227], v2, s[24:27], s37 offen offset:1024 sc1
    v_mfma_f32_16x16x32_bf16 v[48:51], v[16:19], v[180:183], v[48:51]
    ds_read_b128 v[16:19], v7 offset:12288
    s_waitcnt lgkmcnt(4)
    v_mfma_f32_16x16x32_bf16 v[52:55], v[20:23], v[176:179], v[52:55]
    buffer_load_dwordx4 v[228:231], v2, s[24:27], s38 offen offset:1024 sc1
    v_mfma_f32_16x16x32_bf16 v[56:59], v[20:23], v[180:183], v[56:59]
    ds_read_b128 v[20:23], v7 offset:13312
    s_waitcnt lgkmcnt(4)
    v_mfma_f32_16x16x32_bf16 v[60:63], v[24:27], v[176:179], v[60:63]
    v_mfma_f32_16x16x32_bf16 v[64:67], v[24:27], v[180:183], v[64:67]
    ds_read_b128 v[24:27], v7 offset:14336
    s_waitcnt lgkmcnt(4)
    v_mfma_f32_16x16x32_bf16 v[68:71], v[28:31], v[176:179], v[68:71]
    v_mfma_f32_16x16x32_bf16 v[72:75], v[28:31], v[180:183], v[72:75]
    ds_read_b128 v[28:31], v7 offset:15360
    s_waitcnt lgkmcnt(4)
    v_mfma_f32_16x16x32_bf16 v[76:79], v[32:35], v[176:179], v[76:79]
    v_mfma_f32_16x16x32_bf16 v[80:83], v[32:35], v[180:183], v[80:83]
    ds_read_b128 v[32:35], v7 offset:16384
    s_waitcnt vmcnt(11) lgkmcnt(4)
    v_mfma_f32_16x16x32_bf16 v[44:47], v[16:19], v[184:187], v[44:47]
    s_barrier
    v_mfma_f32_16x16x32_bf16 v[48:51], v[16:19], v[188:191], v[48:51]
    ds_read_b128 v[16:19], v7 offset:17408
    s_waitcnt lgkmcnt(4)
    v_mfma_f32_16x16x32_bf16 v[52:55], v[20:23], v[184:187], v[52:55]
    buffer_load_dwordx4 v[232:235], v2, s[24:27], s37 offen offset:2048 sc1
    v_mfma_f32_16x16x32_bf16 v[56:59], v[20:23], v[188:191], v[56:59]
    ds_read_b128 v[20:23], v7 offset:18432
    s_waitcnt lgkmcnt(4)
    v_mfma_f32_16x16x32_bf16 v[60:63], v[24:27], v[184:187], v[60:63]
    buffer_load_dwordx4 v[236:239], v2, s[24:27], s38 offen offset:2048 sc1
    v_mfma_f32_16x16x32_bf16 v[64:67], v[24:27], v[188:191], v[64:67]
    ds_read_b128 v[24:27], v7 offset:19456
    s_waitcnt lgkmcnt(4)
    v_mfma_f32_16x16x32_bf16 v[68:71], v[28:31], v[184:187], v[68:71]
    v_mfma_f32_16x16x32_bf16 v[72:75], v[28:31], v[188:191], v[72:75]
    ds_read_b128 v[28:31], v7 offset:20480
    s_waitcnt lgkmcnt(4)
    v_mfma_f32_16x16x32_bf16 v[76:79], v[32:35], v[184:187], v[76:79]
    v_mfma_f32_16x16x32_bf16 v[80:83], v[32:35], v[188:191], v[80:83]
    ds_read_b128 v[32:35], v7 offset:21504
    s_waitcnt vmcnt(11) lgkmcnt(4)
    v_mfma_f32_16x16x32_bf16 v[44:47], v[16:19], v[192:195], v[44:47]
    buffer_load_dwordx4 v[240:243], v2, s[24:27], s37 offen offset:3072 sc1
    v_mfma_f32_16x16x32_bf16 v[48:51], v[16:19], v[196:199], v[48:51]
    ds_read_b128 v[16:19], v5 offset:0
    s_waitcnt lgkmcnt(4)
    v_mfma_f32_16x16x32_bf16 v[52:55], v[20:23], v[192:195], v[52:55]
    buffer_load_dwordx4 v[244:247], v2, s[24:27], s38 offen offset:3072 sc1
    v_mfma_f32_16x16x32_bf16 v[56:59], v[20:23], v[196:199], v[56:59]
    ds_read_b128 v[20:23], v5 offset:1024
    s_waitcnt lgkmcnt(4)
    v_mfma_f32_16x16x32_bf16 v[60:63], v[24:27], v[192:195], v[60:63]
    v_mfma_f32_16x16x32_bf16 v[64:67], v[24:27], v[196:199], v[64:67]
    ds_read_b128 v[24:27], v5 offset:2048
    s_waitcnt lgkmcnt(4)
    v_mfma_f32_16x16x32_bf16 v[68:71], v[28:31], v[192:195], v[68:71]
    v_mfma_f32_16x16x32_bf16 v[72:75], v[28:31], v[196:199], v[72:75]
    ds_read_b128 v[28:31], v5 offset:3072
    s_waitcnt lgkmcnt(4)
    v_mfma_f32_16x16x32_bf16 v[76:79], v[32:35], v[192:195], v[76:79]
    v_mfma_f32_16x16x32_bf16 v[80:83], v[32:35], v[196:199], v[80:83]
    ds_read_b128 v[32:35], v5 offset:4096
    s_waitcnt vmcnt(10) lgkmcnt(4)
    v_mfma_f32_16x16x32_bf16 v[44:47], v[16:19], v[200:203], v[44:47]
    s_add_u32 s37, s37, 4096
    buffer_load_dwordx4 v[152:155], v2, s[24:27], s37 offen offset:0 sc1
    v_mfma_f32_16x16x32_bf16 v[48:51], v[16:19], v[204:207], v[48:51]
    ds_read_b128 v[16:19], v5 offset:5120
    s_waitcnt lgkmcnt(4)
    v_mfma_f32_16x16x32_bf16 v[52:55], v[20:23], v[200:203], v[52:55]
    s_add_u32 s38, s38, 4096
    buffer_load_dwordx4 v[156:159], v2, s[24:27], s38 offen offset:0 sc1
    v_mfma_f32_16x16x32_bf16 v[56:59], v[20:23], v[204:207], v[56:59]
    ds_read_b128 v[20:23], v5 offset:6144
    s_waitcnt lgkmcnt(4)
    v_mfma_f32_16x16x32_bf16 v[60:63], v[24:27], v[200:203], v[60:63]
    v_mfma_f32_16x16x32_bf16 v[64:67], v[24:27], v[204:207], v[64:67]
    ds_read_b128 v[24:27], v5 offset:7168
    s_waitcnt lgkmcnt(4)
    v_mfma_f32_16x16x32_bf16 v[68:71], v[28:31], v[200:203], v[68:71]
    v_mfma_f32_16x16x32_bf16 v[72:75], v[28:31], v[204:207], v[72:75]
    ds_read_b128 v[28:31], v5 offset:8192
    s_waitcnt lgkmcnt(4)
    v_mfma_f32_16x16x32_bf16 v[76:79], v[32:35], v[200:203], v[76:79]
    v_mfma_f32_16x16x32_bf16 v[80:83], v[32:35], v[204:207], v[80:83]
    ds_read_b128 v[32:35], v5 offset:9216
    s_waitcnt vmcnt(10) lgkmcnt(4)
    v_mfma_f32_16x16x32_bf16 v[44:47], v[16:19], v[208:211], v[44:47]
    buffer_load_dwordx4 v[160:163], v2, s[24:27], s37 offen offset:1024 sc1
    v_mfma_f32_16x16x32_bf16 v[48:51], v[16:19], v[212:215], v[48:51]
    ds_read_b128 v[16:19], v5 offset:20480
    s_waitcnt lgkmcnt(4)
    v_mfma_f32_16x16x32_bf16 v[52:55], v[20:23], v[208:211], v[52:55]
    buffer_load_dwordx4 v[164:167], v2, s[24:27], s38 offen offset:1024 sc1
    v_mfma_f32_16x16x32_bf16 v[56:59], v[20:23], v[212:215], v[56:59]
    ds_read_b128 v[20:23], v5 offset:21504
    s_waitcnt lgkmcnt(4)
    v_mfma_f32_16x16x32_bf16 v[60:63], v[24:27], v[208:211], v[60:63]
    v_mfma_f32_16x16x32_bf16 v[64:67], v[24:27], v[212:215], v[64:67]
    ds_read_b128 v[24:27], v5 offset:22528
    s_waitcnt lgkmcnt(4)
    v_mfma_f32_16x16x32_bf16 v[68:71], v[28:31], v[208:211], v[68:71]
    v_mfma_f32_16x16x32_bf16 v[72:75], v[28:31], v[212:215], v[72:75]
    ds_read_b128 v[28:31], v5 offset:23552
    s_waitcnt lgkmcnt(4)
    v_mfma_f32_16x16x32_bf16 v[76:79], v[32:35], v[208:211], v[76:79]
    v_mfma_f32_16x16x32_bf16 v[80:83], v[32:35], v[212:215], v[80:83]
    ds_read_b128 v[32:35], v5 offset:24576
    s_waitcnt vmcnt(10) lgkmcnt(4)
    v_mfma_f32_16x16x32_bf16 v[44:47], v[16:19], v[216:219], v[44:47]
    buffer_load_dwordx4 v[168:171], v2, s[24:27], s37 offen offset:2048 sc1
    v_mfma_f32_16x16x32_bf16 v[48:51], v[16:19], v[220:223], v[48:51]
    ds_read_b128 v[16:19], v5 offset:25600
    s_waitcnt lgkmcnt(4)
    v_mfma_f32_16x16x32_bf16 v[52:55], v[20:23], v[216:219], v[52:55]
    buffer_load_dwordx4 v[172:175], v2, s[24:27], s38 offen offset:2048 sc1
    v_mfma_f32_16x16x32_bf16 v[56:59], v[20:23], v[220:223], v[56:59]
    ds_read_b128 v[20:23], v5 offset:26624
    s_waitcnt lgkmcnt(4)
    v_mfma_f32_16x16x32_bf16 v[60:63], v[24:27], v[216:219], v[60:63]
    v_mfma_f32_16x16x32_bf16 v[64:67], v[24:27], v[220:223], v[64:67]
    ds_read_b128 v[24:27], v5 offset:27648
    s_waitcnt lgkmcnt(4)
    v_mfma_f32_16x16x32_bf16 v[68:71], v[28:31], v[216:219], v[68:71]
    v_mfma_f32_16x16x32_bf16 v[72:75], v[28:31], v[220:223], v[72:75]
    ds_read_b128 v[28:31], v5 offset:28672
    s_waitcnt lgkmcnt(4)
    v_mfma_f32_16x16x32_bf16 v[76:79], v[32:35], v[216:219], v[76:79]
    v_mfma_f32_16x16x32_bf16 v[80:83], v[32:35], v[220:223], v[80:83]
    ds_read_b128 v[32:35], v5 offset:29696
    s_waitcnt vmcnt(10) lgkmcnt(4)
    v_mfma_f32_16x16x32_bf16 v[44:47], v[16:19], v[224:227], v[44:47]
    buffer_load_dwordx4 v[176:179], v2, s[24:27], s37 offen offset:3072 sc1
    v_mfma_f32_16x16x32_bf16 v[48:51], v[16:19], v[228:231], v[48:51]
    ds_read_b128 v[16:19], v5 offset:40960
    s_waitcnt lgkmcnt(4)
    v_mfma_f32_16x16x32_bf16 v[52:55], v[20:23], v[224:227], v[52:55]
    buffer_load_dwordx4 v[180:183], v2, s[24:27], s38 offen offset:3072 sc1
    v_mfma_f32_16x16x32_bf16 v[56:59], v[20:23], v[228:231], v[56:59]
    ds_read_b128 v[20:23], v5 offset:41984
    s_waitcnt lgkmcnt(4)
    v_mfma_f32_16x16x32_bf16 v[60:63], v[24:27], v[224:227], v[60:63]
    v_mfma_f32_16x16x32_bf16 v[64:67], v[24:27], v[228:231], v[64:67]
    ds_read_b128 v[24:27], v5 offset:43008
    s_waitcnt lgkmcnt(4)
    v_mfma_f32_16x16x32_bf16 v[68:71], v[28:31], v[224:227], v[68:71]
    v_mfma_f32_16x16x32_bf16 v[72:75], v[28:31], v[228:231], v[72:75]
    ds_read_b128 v[28:31], v5 offset:44032
    s_waitcnt lgkmcnt(4)
    v_mfma_f32_16x16x32_bf16 v[76:79], v[32:35], v[224:227], v[76:79]
    v_mfma_f32_16x16x32_bf16 v[80:83], v[32:35], v[228:231], v[80:83]
    ds_read_b128 v[32:35], v5 offset:45056
    s_waitcnt vmcnt(10) lgkmcnt(4)
    v_mfma_f32_16x16x32_bf16 v[44:47], v[16:19], v[232:235], v[44:47]
    s_add_u32 s37, s37, 4096
    buffer_load_dwordx4 v[184:187], v2, s[24:27], s37 offen offset:0 sc1
    v_mfma_f32_16x16x32_bf16 v[48:51], v[16:19], v[236:239], v[48:51]
    ds_read_b128 v[16:19], v5 offset:46080
    s_waitcnt lgkmcnt(4)
    v_mfma_f32_16x16x32_bf16 v[52:55], v[20:23], v[232:235], v[52:55]
    s_add_u32 s38, s38, 4096
    buffer_load_dwordx4 v[188:191], v2, s[24:27], s38 offen offset:0 sc1
    v_mfma_f32_16x16x32_bf16 v[56:59], v[20:23], v[236:239], v[56:59]
    ds_read_b128 v[20:23], v5 offset:47104
    s_waitcnt lgkmcnt(4)
    v_mfma_f32_16x16x32_bf16 v[60:63], v[24:27], v[232:235], v[60:63]
    v_mfma_f32_16x16x32_bf16 v[64:67], v[24:27], v[236:239], v[64:67]
    ds_read_b128 v[24:27], v5 offset:48128
    s_waitcnt lgkmcnt(4)
    v_mfma_f32_16x16x32_bf16 v[68:71], v[28:31], v[232:235], v[68:71]
    v_mfma_f32_16x16x32_bf16 v[72:75], v[28:31], v[236:239], v[72:75]
    ds_read_b128 v[28:31], v5 offset:49152
    s_waitcnt lgkmcnt(4)
    v_mfma_f32_16x16x32_bf16 v[76:79], v[32:35], v[232:235], v[76:79]
    v_mfma_f32_16x16x32_bf16 v[80:83], v[32:35], v[236:239], v[80:83]
    ds_read_b128 v[32:35], v5 offset:50176
    s_waitcnt vmcnt(10) lgkmcnt(4)
    v_mfma_f32_16x16x32_bf16 v[44:47], v[16:19], v[240:243], v[44:47]
    s_barrier
    v_mfma_f32_16x16x32_bf16 v[48:51], v[16:19], v[244:247], v[48:51]
    ds_read_b128 v[16:19], v5 offset:61440
    s_waitcnt lgkmcnt(4)
    v_mfma_f32_16x16x32_bf16 v[52:55], v[20:23], v[240:243], v[52:55]
    buffer_load_dwordx4 v[192:195], v2, s[24:27], s37 offen offset:1024 sc1
    v_mfma_f32_16x16x32_bf16 v[56:59], v[20:23], v[244:247], v[56:59]
    ds_read_b128 v[20:23], v5 offset:62464
    s_waitcnt lgkmcnt(4)
    v_mfma_f32_16x16x32_bf16 v[60:63], v[24:27], v[240:243], v[60:63]
    buffer_load_dwordx4 v[196:199], v2, s[24:27], s38 offen offset:1024 sc1
    v_mfma_f32_16x16x32_bf16 v[64:67], v[24:27], v[244:247], v[64:67]
    ds_read_b128 v[24:27], v5 offset:63488
    s_waitcnt lgkmcnt(4)
    v_mfma_f32_16x16x32_bf16 v[68:71], v[28:31], v[240:243], v[68:71]
    v_mfma_f32_16x16x32_bf16 v[72:75], v[28:31], v[244:247], v[72:75]
    ds_read_b128 v[28:31], v5 offset:64512
    s_waitcnt lgkmcnt(4)
    v_mfma_f32_16x16x32_bf16 v[76:79], v[32:35], v[240:243], v[76:79]
    v_mfma_f32_16x16x32_bf16 v[80:83], v[32:35], v[244:247], v[80:83]
    ds_read_b128 v[32:35], v6 offset:0
    s_waitcnt vmcnt(10) lgkmcnt(4)
    v_mfma_f32_16x16x32_bf16 v[44:47], v[16:19], v[152:155], v[44:47]
    buffer_load_dwordx4 v[200:203], v2, s[24:27], s37 offen offset:2048 sc1
    v_mfma_f32_16x16x32_bf16 v[48:51], v[16:19], v[156:159], v[48:51]
    ds_read_b128 v[16:19], v6 offset:1024
    s_waitcnt lgkmcnt(4)
    v_mfma_f32_16x16x32_bf16 v[52:55], v[20:23], v[152:155], v[52:55]
    buffer_load_dwordx4 v[204:207], v2, s[24:27], s38 offen offset:2048 sc1
    v_mfma_f32_16x16x32_bf16 v[56:59], v[20:23], v[156:159], v[56:59]
    ds_read_b128 v[20:23], v6 offset:2048
    s_waitcnt lgkmcnt(4)
    v_mfma_f32_16x16x32_bf16 v[60:63], v[24:27], v[152:155], v[60:63]
    v_mfma_f32_16x16x32_bf16 v[64:67], v[24:27], v[156:159], v[64:67]
    ds_read_b128 v[24:27], v6 offset:3072
    s_waitcnt lgkmcnt(4)
    v_mfma_f32_16x16x32_bf16 v[68:71], v[28:31], v[152:155], v[68:71]
    v_mfma_f32_16x16x32_bf16 v[72:75], v[28:31], v[156:159], v[72:75]
    ds_read_b128 v[28:31], v6 offset:4096
    s_waitcnt lgkmcnt(4)
    v_mfma_f32_16x16x32_bf16 v[76:79], v[32:35], v[152:155], v[76:79]
    v_mfma_f32_16x16x32_bf16 v[80:83], v[32:35], v[156:159], v[80:83]
    ds_read_b128 v[32:35], v6 offset:5120
    s_waitcnt vmcnt(10) lgkmcnt(4)
    v_mfma_f32_16x16x32_bf16 v[44:47], v[16:19], v[160:163], v[44:47]
    buffer_load_dwordx4 v[208:211], v2, s[24:27], s37 offen offset:3072 sc1
    v_mfma_f32_16x16x32_bf16 v[48:51], v[16:19], v[164:167], v[48:51]
    ds_read_b128 v[16:19], v6 offset:16384
    s_waitcnt lgkmcnt(4)
    v_mfma_f32_16x16x32_bf16 v[52:55], v[20:23], v[160:163], v[52:55]
    buffer_load_dwordx4 v[212:215], v2, s[24:27], s38 offen offset:3072 sc1
    v_mfma_f32_16x16x32_bf16 v[56:59], v[20:23], v[164:167], v[56:59]
    ds_read_b128 v[20:23], v6 offset:17408
    s_waitcnt lgkmcnt(4)
    v_mfma_f32_16x16x32_bf16 v[60:63], v[24:27], v[160:163], v[60:63]
    v_mfma_f32_16x16x32_bf16 v[64:67], v[24:27], v[164:167], v[64:67]
    ds_read_b128 v[24:27], v6 offset:18432
    s_waitcnt lgkmcnt(4)
    v_mfma_f32_16x16x32_bf16 v[68:71], v[28:31], v[160:163], v[68:71]
    v_mfma_f32_16x16x32_bf16 v[72:75], v[28:31], v[164:167], v[72:75]
    ds_read_b128 v[28:31], v6 offset:19456
    s_waitcnt lgkmcnt(4)
    v_mfma_f32_16x16x32_bf16 v[76:79], v[32:35], v[160:163], v[76:79]
    v_mfma_f32_16x16x32_bf16 v[80:83], v[32:35], v[164:167], v[80:83]
    ds_read_b128 v[32:35], v6 offset:20480
    s_waitcnt vmcnt(10) lgkmcnt(4)
    v_mfma_f32_16x16x32_bf16 v[44:47], v[16:19], v[168:171], v[44:47]
    s_add_u32 s37, s37, 4096
    buffer_load_dwordx4 v[216:219], v2, s[24:27], s37 offen offset:0 sc1
    v_mfma_f32_16x16x32_bf16 v[48:51], v[16:19], v[172:175], v[48:51]
    ds_read_b128 v[16:19], v6 offset:21504
    s_waitcnt lgkmcnt(4)
    v_mfma_f32_16x16x32_bf16 v[52:55], v[20:23], v[168:171], v[52:55]
    s_add_u32 s38, s38, 4096
    buffer_load_dwordx4 v[220:223], v2, s[24:27], s38 offen offset:0 sc1
    v_mfma_f32_16x16x32_bf16 v[56:59], v[20:23], v[172:175], v[56:59]
    ds_read_b128 v[20:23], v6 offset:22528
    s_waitcnt lgkmcnt(4)
    v_mfma_f32_16x16x32_bf16 v[60:63], v[24:27], v[168:171], v[60:63]
    v_mfma_f32_16x16x32_bf16 v[64:67], v[24:27], v[172:175], v[64:67]
    ds_read_b128 v[24:27], v6 offset:23552
    s_waitcnt lgkmcnt(4)
    v_mfma_f32_16x16x32_bf16 v[68:71], v[28:31], v[168:171], v[68:71]
    v_mfma_f32_16x16x32_bf16 v[72:75], v[28:31], v[172:175], v[72:75]
    ds_read_b128 v[28:31], v6 offset:24576
    s_waitcnt lgkmcnt(4)
    v_mfma_f32_16x16x32_bf16 v[76:79], v[32:35], v[168:171], v[76:79]
    v_mfma_f32_16x16x32_bf16 v[80:83], v[32:35], v[172:175], v[80:83]
    ds_read_b128 v[32:35], v6 offset:25600
    s_waitcnt vmcnt(10) lgkmcnt(4)
    v_mfma_f32_16x16x32_bf16 v[44:47], v[16:19], v[176:179], v[44:47]
    buffer_load_dwordx4 v[224:227], v2, s[24:27], s37 offen offset:1024 sc1
    v_mfma_f32_16x16x32_bf16 v[48:51], v[16:19], v[180:183], v[48:51]
    ds_read_b128 v[16:19], v6 offset:36864
    s_waitcnt lgkmcnt(4)
    v_mfma_f32_16x16x32_bf16 v[52:55], v[20:23], v[176:179], v[52:55]
    buffer_load_dwordx4 v[228:231], v2, s[24:27], s38 offen offset:1024 sc1
    v_mfma_f32_16x16x32_bf16 v[56:59], v[20:23], v[180:183], v[56:59]
    ds_read_b128 v[20:23], v6 offset:37888
    s_waitcnt lgkmcnt(4)
    v_mfma_f32_16x16x32_bf16 v[60:63], v[24:27], v[176:179], v[60:63]
    v_mfma_f32_16x16x32_bf16 v[64:67], v[24:27], v[180:183], v[64:67]
    ds_read_b128 v[24:27], v6 offset:38912
    s_waitcnt lgkmcnt(4)
    v_mfma_f32_16x16x32_bf16 v[68:71], v[28:31], v[176:179], v[68:71]
    v_mfma_f32_16x16x32_bf16 v[72:75], v[28:31], v[180:183], v[72:75]
    ds_read_b128 v[28:31], v6 offset:39936
    s_waitcnt lgkmcnt(4)
    v_mfma_f32_16x16x32_bf16 v[76:79], v[32:35], v[176:179], v[76:79]
    v_mfma_f32_16x16x32_bf16 v[80:83], v[32:35], v[180:183], v[80:83]
    ds_read_b128 v[32:35], v6 offset:40960
    s_waitcnt vmcnt(10) lgkmcnt(4)
    v_mfma_f32_16x16x32_bf16 v[44:47], v[16:19], v[184:187], v[44:47]
    buffer_load_dwordx4 v[232:235], v2, s[24:27], s37 offen offset:2048 sc1
    v_mfma_f32_16x16x32_bf16 v[48:51], v[16:19], v[188:191], v[48:51]
    ds_read_b128 v[16:19], v6 offset:41984
    s_waitcnt lgkmcnt(4)
    v_mfma_f32_16x16x32_bf16 v[52:55], v[20:23], v[184:187], v[52:55]
    buffer_load_dwordx4 v[236:239], v2, s[24:27], s38 offen offset:2048 sc1
    v_mfma_f32_16x16x32_bf16 v[56:59], v[20:23], v[188:191], v[56:59]
    ds_read_b128 v[20:23], v6 offset:43008
    s_waitcnt lgkmcnt(4)
    v_mfma_f32_16x16x32_bf16 v[60:63], v[24:27], v[184:187], v[60:63]
    v_mfma_f32_16x16x32_bf16 v[64:67], v[24:27], v[188:191], v[64:67]
    ds_read_b128 v[24:27], v6 offset:44032
    s_waitcnt lgkmcnt(4)
    v_mfma_f32_16x16x32_bf16 v[68:71], v[28:31], v[184:187], v[68:71]
    v_mfma_f32_16x16x32_bf16 v[72:75], v[28:31], v[188:191], v[72:75]
    ds_read_b128 v[28:31], v6 offset:45056
    s_waitcnt lgkmcnt(4)
    v_mfma_f32_16x16x32_bf16 v[76:79], v[32:35], v[184:187], v[76:79]
    v_mfma_f32_16x16x32_bf16 v[80:83], v[32:35], v[188:191], v[80:83]
    ds_read_b128 v[32:35], v6 offset:46080
    s_waitcnt vmcnt(10) lgkmcnt(4)
    v_mfma_f32_16x16x32_bf16 v[44:47], v[16:19], v[192:195], v[44:47]
    s_barrier
    v_mfma_f32_16x16x32_bf16 v[48:51], v[16:19], v[196:199], v[48:51]
    ds_read_b128 v[16:19], v6 offset:57344
    s_waitcnt lgkmcnt(4)
    v_mfma_f32_16x16x32_bf16 v[52:55], v[20:23], v[192:195], v[52:55]
    buffer_load_dwordx4 v[240:243], v2, s[24:27], s37 offen offset:3072 sc1
    v_mfma_f32_16x16x32_bf16 v[56:59], v[20:23], v[196:199], v[56:59]
    ds_read_b128 v[20:23], v6 offset:58368
    s_waitcnt lgkmcnt(4)
    v_mfma_f32_16x16x32_bf16 v[60:63], v[24:27], v[192:195], v[60:63]
    buffer_load_dwordx4 v[244:247], v2, s[24:27], s38 offen offset:3072 sc1
    v_mfma_f32_16x16x32_bf16 v[64:67], v[24:27], v[196:199], v[64:67]
    ds_read_b128 v[24:27], v6 offset:59392
    s_waitcnt lgkmcnt(4)
    v_mfma_f32_16x16x32_bf16 v[68:71], v[28:31], v[192:195], v[68:71]
    v_mfma_f32_16x16x32_bf16 v[72:75], v[28:31], v[196:199], v[72:75]
    ds_read_b128 v[28:31], v6 offset:60416
    s_waitcnt lgkmcnt(4)
    v_mfma_f32_16x16x32_bf16 v[76:79], v[32:35], v[192:195], v[76:79]
    v_mfma_f32_16x16x32_bf16 v[80:83], v[32:35], v[196:199], v[80:83]
    ds_read_b128 v[32:35], v6 offset:61440
    s_waitcnt vmcnt(10) lgkmcnt(4)
    v_mfma_f32_16x16x32_bf16 v[44:47], v[16:19], v[200:203], v[44:47]
    s_add_u32 s37, s37, 4096
    buffer_load_dwordx2 v[152:153], v3, s[24:27], s37 offen offset:0 sc1
    v_mfma_f32_16x16x32_bf16 v[48:51], v[16:19], v[204:207], v[48:51]
    ds_read_b128 v[16:19], v6 offset:62464
    s_waitcnt lgkmcnt(4)
    v_mfma_f32_16x16x32_bf16 v[52:55], v[20:23], v[200:203], v[52:55]
    buffer_load_dwordx2 v[154:155], v3, s[24:27], s37 offen offset:128 sc1
    v_mfma_f32_16x16x32_bf16 v[56:59], v[20:23], v[204:207], v[56:59]
    ds_read_b128 v[20:23], v6 offset:63488
    s_waitcnt lgkmcnt(4)
    v_mfma_f32_16x16x32_bf16 v[60:63], v[24:27], v[200:203], v[60:63]
    s_add_u32 s38, s38, 4096
    buffer_load_dwordx2 v[156:157], v3, s[24:27], s38 offen offset:0 sc1
    v_mfma_f32_16x16x32_bf16 v[64:67], v[24:27], v[204:207], v[64:67]
    ds_read_b128 v[24:27], v6 offset:64512
    s_waitcnt lgkmcnt(4)
    v_mfma_f32_16x16x32_bf16 v[68:71], v[28:31], v[200:203], v[68:71]
    buffer_load_dwordx2 v[158:159], v3, s[24:27], s38 offen offset:128 sc1
    v_mfma_f32_16x16x32_bf16 v[72:75], v[28:31], v[204:207], v[72:75]
    ds_read_b128 v[28:31], v7 offset:0
    s_waitcnt lgkmcnt(4)
    v_mfma_f32_16x16x32_bf16 v[76:79], v[32:35], v[200:203], v[76:79]
    v_mfma_f32_16x16x32_bf16 v[80:83], v[32:35], v[204:207], v[80:83]
    ds_read_b128 v[32:35], v7 offset:1024
    s_waitcnt vmcnt(12) lgkmcnt(4)
    v_mfma_f32_16x16x32_bf16 v[44:47], v[16:19], v[208:211], v[44:47]
    buffer_load_dwordx2 v[160:161], v3, s[24:27], s37 offen offset:1024 sc1
    v_mfma_f32_16x16x32_bf16 v[48:51], v[16:19], v[212:215], v[48:51]
    ds_read_b128 v[16:19], v7 offset:12288
    s_waitcnt lgkmcnt(4)
    v_mfma_f32_16x16x32_bf16 v[52:55], v[20:23], v[208:211], v[52:55]
    buffer_load_dwordx2 v[162:163], v3, s[24:27], s37 offen offset:1152 sc1
    v_mfma_f32_16x16x32_bf16 v[56:59], v[20:23], v[212:215], v[56:59]
    ds_read_b128 v[20:23], v7 offset:13312
    s_waitcnt lgkmcnt(4)
    v_mfma_f32_16x16x32_bf16 v[60:63], v[24:27], v[208:211], v[60:63]
    buffer_load_dwordx2 v[164:165], v3, s[24:27], s38 offen offset:1024 sc1
    v_mfma_f32_16x16x32_bf16 v[64:67], v[24:27], v[212:215], v[64:67]
    ds_read_b128 v[24:27], v7 offset:14336
    s_waitcnt lgkmcnt(4)
    v_mfma_f32_16x16x32_bf16 v[68:71], v[28:31], v[208:211], v[68:71]
    buffer_load_dwordx2 v[166:167], v3, s[24:27], s38 offen offset:1152 sc1
    v_mfma_f32_16x16x32_bf16 v[72:75], v[28:31], v[212:215], v[72:75]
    ds_read_b128 v[28:31], v7 offset:15360
    s_waitcnt lgkmcnt(4)
    v_mfma_f32_16x16x32_bf16 v[76:79], v[32:35], v[208:211], v[76:79]
    v_mfma_f32_16x16x32_bf16 v[80:83], v[32:35], v[212:215], v[80:83]
    ds_read_b128 v[32:35], v7 offset:16384
    s_waitcnt vmcnt(14) lgkmcnt(4)
    v_mfma_f32_16x16x32_bf16 v[44:47], v[16:19], v[216:219], v[44:47]
    buffer_load_dwordx2 v[168:169], v3, s[24:27], s37 offen offset:2048 sc1
    v_mfma_f32_16x16x32_bf16 v[48:51], v[16:19], v[220:223], v[48:51]
    ds_read_b128 v[16:19], v7 offset:17408
    s_waitcnt lgkmcnt(4)
    v_mfma_f32_16x16x32_bf16 v[52:55], v[20:23], v[216:219], v[52:55]
    buffer_load_dwordx2 v[170:171], v3, s[24:27], s37 offen offset:2176 sc1
    v_mfma_f32_16x16x32_bf16 v[56:59], v[20:23], v[220:223], v[56:59]
    ds_read_b128 v[20:23], v7 offset:18432
    s_waitcnt lgkmcnt(4)
    v_mfma_f32_16x16x32_bf16 v[60:63], v[24:27], v[216:219], v[60:63]
    buffer_load_dwordx2 v[172:173], v3, s[24:27], s38 offen offset:2048 sc1
    v_mfma_f32_16x16x32_bf16 v[64:67], v[24:27], v[220:223], v[64:67]
    ds_read_b128 v[24:27], v7 offset:19456
    s_waitcnt lgkmcnt(4)
    v_mfma_f32_16x16x32_bf16 v[68:71], v[28:31], v[216:219], v[68:71]
    buffer_load_dwordx2 v[174:175], v3, s[24:27], s38 offen offset:2176 sc1
    v_mfma_f32_16x16x32_bf16 v[72:75], v[28:31], v[220:223], v[72:75]
    ds_read_b128 v[28:31], v7 offset:20480
    s_waitcnt lgkmcnt(4)
    v_mfma_f32_16x16x32_bf16 v[76:79], v[32:35], v[216:219], v[76:79]
    v_mfma_f32_16x16x32_bf16 v[80:83], v[32:35], v[220:223], v[80:83]
    ds_read_b128 v[32:35], v7 offset:21504
    s_waitcnt vmcnt(16) lgkmcnt(4)
    v_mfma_f32_16x16x32_bf16 v[44:47], v[16:19], v[224:227], v[44:47]
    v_mfma_f32_16x16x32_bf16 v[48:51], v[16:19], v[228:231], v[48:51]
    ds_read_b128 v[16:19], v5 offset:0
    s_waitcnt lgkmcnt(4)
    v_mfma_f32_16x16x32_bf16 v[52:55], v[20:23], v[224:227], v[52:55]
    v_mfma_f32_16x16x32_bf16 v[56:59], v[20:23], v[228:231], v[56:59]
    ds_read_b128 v[20:23], v5 offset:1024
    s_waitcnt lgkmcnt(4)
    v_mfma_f32_16x16x32_bf16 v[60:63], v[24:27], v[224:227], v[60:63]
    v_mfma_f32_16x16x32_bf16 v[64:67], v[24:27], v[228:231], v[64:67]
    ds_read_b128 v[24:27], v5 offset:2048
    s_waitcnt lgkmcnt(4)
    v_mfma_f32_16x16x32_bf16 v[68:71], v[28:31], v[224:227], v[68:71]
    v_mfma_f32_16x16x32_bf16 v[72:75], v[28:31], v[228:231], v[72:75]
    ds_read_b128 v[28:31], v5 offset:3072
    s_waitcnt lgkmcnt(4)
    v_mfma_f32_16x16x32_bf16 v[76:79], v[32:35], v[224:227], v[76:79]
    v_mfma_f32_16x16x32_bf16 v[80:83], v[32:35], v[228:231], v[80:83]
    ds_read_b128 v[32:35], v5 offset:4096
    s_waitcnt vmcnt(14) lgkmcnt(4)
    v_mfma_f32_16x16x32_bf16 v[44:47], v[16:19], v[232:235], v[44:47]
    v_mfma_f32_16x16x32_bf16 v[48:51], v[16:19], v[236:239], v[48:51]
    ds_read_b128 v[16:19], v5 offset:5120
    s_waitcnt lgkmcnt(4)
    v_mfma_f32_16x16x32_bf16 v[52:55], v[20:23], v[232:235], v[52:55]
    v_mfma_f32_16x16x32_bf16 v[56:59], v[20:23], v[236:239], v[56:59]
    ds_read_b128 v[20:23], v5 offset:6144
    s_waitcnt lgkmcnt(4)
    v_mfma_f32_16x16x32_bf16 v[60:63], v[24:27], v[232:235], v[60:63]
    v_mfma_f32_16x16x32_bf16 v[64:67], v[24:27], v[236:239], v[64:67]
    ds_read_b128 v[24:27], v5 offset:7168
    s_waitcnt lgkmcnt(4)
    v_mfma_f32_16x16x32_bf16 v[68:71], v[28:31], v[232:235], v[68:71]
    v_mfma_f32_16x16x32_bf16 v[72:75], v[28:31], v[236:239], v[72:75]
    ds_read_b128 v[28:31], v5 offset:8192
    s_waitcnt lgkmcnt(4)
    v_mfma_f32_16x16x32_bf16 v[76:79], v[32:35], v[232:235], v[76:79]
    v_mfma_f32_16x16x32_bf16 v[80:83], v[32:35], v[236:239], v[80:83]
    ds_read_b128 v[32:35], v5 offset:9216
    s_waitcnt vmcnt(12) lgkmcnt(4)
    v_mfma_f32_16x16x32_bf16 v[44:47], v[16:19], v[240:243], v[44:47]
    s_barrier
    v_mfma_f32_16x16x32_bf16 v[48:51], v[16:19], v[244:247], v[48:51]
    ds_read_b128 v[16:19], v5 offset:20480
    s_waitcnt lgkmcnt(4)
    v_mfma_f32_16x16x32_bf16 v[52:55], v[20:23], v[240:243], v[52:55]
    v_mfma_f32_16x16x32_bf16 v[56:59], v[20:23], v[244:247], v[56:59]
    ds_read_b128 v[20:23], v5 offset:21504
    s_waitcnt lgkmcnt(4)
    v_mfma_f32_16x16x32_bf16 v[60:63], v[24:27], v[240:243], v[60:63]
    v_mfma_f32_16x16x32_bf16 v[64:67], v[24:27], v[244:247], v[64:67]
    ds_read_b128 v[24:27], v5 offset:22528
    s_waitcnt lgkmcnt(4)
    v_mfma_f32_16x16x32_bf16 v[68:71], v[28:31], v[240:243], v[68:71]
    v_mfma_f32_16x16x32_bf16 v[72:75], v[28:31], v[244:247], v[72:75]
    ds_read_b128 v[28:31], v5 offset:23552
    s_waitcnt lgkmcnt(4)
    v_mfma_f32_16x16x32_bf16 v[76:79], v[32:35], v[240:243], v[76:79]
    v_mfma_f32_16x16x32_bf16 v[80:83], v[32:35], v[244:247], v[80:83]
    ds_read_b128 v[32:35], v5 offset:24576
    s_waitcnt vmcnt(8) lgkmcnt(4)
    v_mfma_f32_16x16x32_bf16 v[44:47], v[16:19], v[152:155], v[44:47]
    v_mfma_f32_16x16x32_bf16 v[48:51], v[16:19], v[156:159], v[48:51]
    ds_read_b128 v[16:19], v5 offset:25600
    s_waitcnt lgkmcnt(4)
    v_mfma_f32_16x16x32_bf16 v[52:55], v[20:23], v[152:155], v[52:55]
    v_mfma_f32_16x16x32_bf16 v[56:59], v[20:23], v[156:159], v[56:59]
    ds_read_b128 v[20:23], v5 offset:26624
    s_waitcnt lgkmcnt(4)
    v_mfma_f32_16x16x32_bf16 v[60:63], v[24:27], v[152:155], v[60:63]
    v_mfma_f32_16x16x32_bf16 v[64:67], v[24:27], v[156:159], v[64:67]
    ds_read_b128 v[24:27], v5 offset:27648
    s_waitcnt lgkmcnt(4)
    v_mfma_f32_16x16x32_bf16 v[68:71], v[28:31], v[152:155], v[68:71]
    v_mfma_f32_16x16x32_bf16 v[72:75], v[28:31], v[156:159], v[72:75]
    ds_read_b128 v[28:31], v5 offset:28672
    s_waitcnt lgkmcnt(4)
    v_mfma_f32_16x16x32_bf16 v[76:79], v[32:35], v[152:155], v[76:79]
    v_mfma_f32_16x16x32_bf16 v[80:83], v[32:35], v[156:159], v[80:83]
    ds_read_b128 v[32:35], v5 offset:29696
    s_waitcnt vmcnt(4) lgkmcnt(4)
    v_mfma_f32_16x16x32_bf16 v[44:47], v[16:19], v[160:163], v[44:47]
    v_mfma_f32_16x16x32_bf16 v[48:51], v[16:19], v[164:167], v[48:51]
    ds_read_b128 v[16:19], v5 offset:40960
    s_waitcnt lgkmcnt(4)
    v_mfma_f32_16x16x32_bf16 v[52:55], v[20:23], v[160:163], v[52:55]
    v_mfma_f32_16x16x32_bf16 v[56:59], v[20:23], v[164:167], v[56:59]
    ds_read_b128 v[20:23], v5 offset:41984
    s_waitcnt lgkmcnt(4)
    v_mfma_f32_16x16x32_bf16 v[60:63], v[24:27], v[160:163], v[60:63]
    v_mfma_f32_16x16x32_bf16 v[64:67], v[24:27], v[164:167], v[64:67]
k_pad11:
    s_cbranch_execz k_walked2_0
    ds_read_b128 v[24:27], v5 offset:43008
    s_waitcnt lgkmcnt(4)
    v_mfma_f32_16x16x32_bf16 v[68:71], v[28:31], v[160:163], v[68:71]
    v_mfma_f32_16x16x32_bf16 v[72:75], v[28:31], v[164:167], v[72:75]
    ds_read_b128 v[28:31], v5 offset:44032
    s_waitcnt lgkmcnt(4)
    v_mfma_f32_16x16x32_bf16 v[76:79], v[32:35], v[160:163], v[76:79]
    v_mfma_f32_16x16x32_bf16 v[80:83], v[32:35], v[164:167], v[80:83]
    ds_read_b128 v[32:35], v5 offset:45056
    s_waitcnt vmcnt(0) lgkmcnt(4)
    v_mfma_f32_16x16x32_bf16 v[44:47], v[16:19], v[168:171], v[44:47]
    v_mfma_f32_16x16x32_bf16 v[48:51], v[16:19], v[172:175], v[48:51]
    s_waitcnt lgkmcnt(3)
    v_mfma_f32_16x16x32_bf16 v[52:55], v[20:23], v[168:171], v[52:55]
    v_mfma_f32_16x16x32_bf16 v[56:59], v[20:23], v[172:175], v[56:59]
    s_waitcnt lgkmcnt(2)
    v_mfma_f32_16x16x32_bf16 v[60:63], v[24:27], v[168:171], v[60:63]
    v_mfma_f32_16x16x32_bf16 v[64:67], v[24:27], v[172:175], v[64:67]
    s_waitcnt lgkmcnt(1)
    v_mfma_f32_16x16x32_bf16 v[68:71], v[28:31], v[168:171], v[68:71]
    v_mfma_f32_16x16x32_bf16 v[72:75], v[28:31], v[172:175], v[72:75]
    v_cmp_u_f32 vcc, v44, v48
    s_nop 0
    s_cbranch_vccnz k_r5
    ds_write_b128 v84, v[44:47] offset:0
    ds_write_b128 v86, v[48:51] offset:0
    s_waitcnt lgkmcnt(0)
    v_mfma_f32_16x16x32_bf16 v[76:79], v[32:35], v[168:171], v[76:79]
    v_mfma_f32_16x16x32_bf16 v[80:83], v[32:35], v[172:175], v[80:83]
    ds_write_b128 v84, v[52:55] offset:16
    ds_write_b128 v86, v[56:59] offset:16
    ds_write_b128 v84, v[60:63] offset:128
    ds_write_b128 v86, v[64:67] offset:128
    ds_write_b128 v84, v[68:71] offset:144
    ds_write_b128 v86, v[72:75] offset:144
    s_nop 2
    ds_write_b128 v85, v[76:79]
    ds_write_b128 v87, v[80:83]
k_r5_ret:
    s_branch k_fin5
k_ld:
k_pad12:
    s_cbranch_execz k_walked2_0
    s_mul_i32 s50, s96, 5120
    v_add_u32 v5, s50, v2
    v_add_u32 v6, 0x10000, v5
    v_add_u32 v7, 0x20000, v5
    s_mul_i32 s53, s62, 3072
    s_sub_u32 s49, s85, s53
    s_sub_u32 s51, s50, s53
    v_subrev_u32 v11, s53, v5
    s_lshl_b32 s53, s96, 10
    s_add_u32 s53, s53, 122880
    v_add_u32 v14, s53, v2
    s_waitcnt vmcnt(3)
    s_barrier
    ds_write_b128 v14, v[152:155] offset:0
    ds_write_b128 v14, v[156:159] offset:4096
    ds_write_b128 v14, v[160:163] offset:8192
    ds_write_b128 v14, v[164:167] offset:12288
    ds_write_b128 v14, v[168:171] offset:16384
    ds_write_b128 v14, v[172:175] offset:20480
    ds_write_b128 v14, v[176:179] offset:24576
    ds_write_b128 v14, v[180:183] offset:28672
    ds_write_b128 v14, v[184:187] offset:32768
    ds_write_b128 v14, v[188:191] offset:36864
    s_waitcnt vmcnt(0) lgkmcnt(0)
    s_mov_b64 exec, 1
    buffer_store_dwordx2 v[150:151], off, s[24:27], s82 offset:128 sc1
    s_mov_b64 exec, -1
    s_barrier
    s_add_u32 s53, s85, 51200
    s_add_u32 s54, s53, 4096
    buffer_load_dwordx4 v[16:19], v2, s[24:27], s53 offen offset:0 sc1
    buffer_load_dwordx4 v[20:23], v2, s[24:27], s53 offen offset:1024 sc1
    buffer_load_dwordx4 v[24:27], v2, s[24:27], s53 offen offset:2048 sc1
    buffer_load_dwordx4 v[28:31], v2, s[24:27], s53 offen offset:3072 sc1
    buffer_load_dwordx4 v[32:35], v2, s[24:27], s54 offen offset:0 sc1
    s_add_u32 s53, s85, 61440
    s_add_u32 s54, s53, 4096
    buffer_load_dwordx4 v[36:39], v2, s[24:27], s53 offen offset:0 sc1
    buffer_load_dwordx4 v[40:43], v2, s[24:27], s53 offen offset:1024 sc1
    buffer_load_dwordx4 v[44:47], v2, s[24:27], s53 offen offset:2048 sc1
    buffer_load_dwordx4 v[48:51], v2, s[24:27], s53 offen offset:3072 sc1
    buffer_load_dwordx4 v[52:55], v2, s[24:27], s54 offen offset:0 sc1
    s_add_u32 s53, s85, 71680
    s_add_u32 s54, s53, 4096
    buffer_load_dwordx4 v[56:59], v2, s[24:27], s53 offen offset:0 sc1
    buffer_load_dwordx4 v[60:63], v2, s[24:27], s53 offen offset:1024 sc1
    buffer_load_dwordx4 v[64:67], v2, s[24:27], s53 offen offset:2048 sc1
    buffer_load_dwordx4 v[68:71], v2, s[24:27], s53 offen offset:3072 sc1
    buffer_load_dwordx4 v[72:75], v2, s[24:27], s54 offen offset:0 sc1
    s_add_u32 s53, s85, 81920
    s_add_u32 s54, s53, 4096
    buffer_load_dwordx4 v[76:79], v2, s[24:27], s53 offen offset:0 sc1
    buffer_load_dwordx4 v[80:83], v2, s[24:27], s53 offen offset:1024 sc1
    buffer_load_dwordx4 v[84:87], v2, s[24:27], s53 offen offset:2048 sc1
    buffer_load_dwordx4 v[88:91], v2, s[24:27], s53 offen offset:3072 sc1
    buffer_load_dwordx4 v[92:95], v2, s[24:27], s54 offen offset:0 sc1
    s_barrier
    s_barrier
    s_add_u32 s53, s85, 92160
    s_add_u32 s54, s53, 4096
    buffer_load_dwordx4 v[96:99], v2, s[24:27], s53 offen offset:0 sc1
    buffer_load_dwordx4 v[100:103], v2, s[24:27], s53 offen offset:1024 sc1
    buffer_load_dwordx4 v[104:107], v2, s[24:27], s53 offen offset:2048 sc1
    buffer_load_dwordx4 v[108:111], v2, s[24:27], s53 offen offset:3072 sc1
    buffer_load_dwordx4 v[112:115], v2, s[24:27], s54 offen offset:0 sc1
    s_add_u32 s53, s85, 102400
    s_add_u32 s54, s53, 4096
    buffer_load_dwordx4 v[116:119], v2, s[24:27], s53 offen offset:0 sc1
    buffer_load_dwordx4 v[120:123], v2, s[24:27], s53 offen offset:1024 sc1
    buffer_load_dwordx4 v[124:127], v2, s[24:27], s53 offen offset:2048 sc1
    buffer_load_dwordx4 v[128:131], v2, s[24:27], s53 offen offset:3072 sc1
    buffer_load_dwordx4 v[132:135], v2, s[24:27], s54 offen offset:0 sc1
    ds_write_b128 v6, v[192:195] offset:36864
    ds_write_b128 v6, v[196:199] offset:37888
    ds_write_b128 v6, v[200:203] offset:38912
    ds_write_b128 v6, v[204:207] offset:39936
    ds_write_b128 v6, v[208:211] offset:40960
    s_barrier
    s_barrier
    s_add_u32 m0, s50, 122880
    s_add_u32 s53, s85, 10240
    buffer_load_dwordx4 v2, s[24:27], s53 offen offset:0 sc1 lds
    buffer_load_dwordx4 v2, s[24:27], s53 offen offset:1024 sc1 lds
    buffer_load_dwordx4 v2, s[24:27], s53 offen offset:2048 sc1 lds
    buffer_load_dwordx4 v2, s[24:27], s53 offen offset:3072 sc1 lds
    s_add_u32 m0, m0, 4096
    s_add_u32 s53, s53, 4096
    buffer_load_dwordx4 v2, s[24:27], s53 offen offset:0 sc1 lds
    s_add_u32 m0, s50, 143360
    s_add_u32 s53, s85, 20480
    buffer_load_dwordx4 v2, s[24:27], s53 offen offset:0 sc1 lds
    buffer_load_dwordx4 v2, s[24:27], s53 offen offset:1024 sc1 lds
    buffer_load_dwordx4 v2, s[24:27], s53 offen offset:2048 sc1 lds
    buffer_load_dwordx4 v2, s[24:27], s53 offen offset:3072 sc1 lds
    s_add_u32 m0, m0, 4096
    s_add_u32 s53, s53, 4096
    buffer_load_dwordx4 v2, s[24:27], s53 offen offset:0 sc1 lds
    s_add_u32 m0, s50, 0
    s_add_u32 s53, s85, 30720
    buffer_load_dwordx4 v2, s[24:27], s53 offen offset:0 sc1 lds
    buffer_load_dwordx4 v2, s[24:27], s53 offen offset:1024 sc1 lds
    buffer_load_dwordx4 v2, s[24:27], s53 offen offset:2048 sc1 lds
    buffer_load_dwordx4 v2, s[24:27], s53 offen offset:3072 sc1 lds
    s_add_u32 m0, m0, 4096
    s_add_u32 s53, s53, 4096
    buffer_load_dwordx4 v2, s[24:27], s53 offen offset:0 sc1 lds
    s_add_u32 m0, s50, 20480
    s_add_u32 s53, s85, 40960
    buffer_load_dwordx4 v2, s[24:27], s53 offen offset:0 sc1 lds
    buffer_load_dwordx4 v2, s[24:27], s53 offen offset:1024 sc1 lds
    buffer_load_dwordx4 v2, s[24:27], s53 offen offset:2048 sc1 lds
    buffer_load_dwordx4 v2, s[24:27], s53 offen offset:3072 sc1 lds
    s_add_u32 m0, m0, 4096
    s_add_u32 s53, s53, 4096
    buffer_load_dwordx4 v2, s[24:27], s53 offen offset:0 sc1 lds
    s_add_u32 s53, s49, 133120
    s_add_u32 s54, s53, 4096
    buffer_load_dwordx4 v[136:139], v2, s[24:27], s53 offen offset:0 sc1
    buffer_load_dwordx4 v[140:143], v2, s[24:27], s53 offen offset:1024 sc1
    buffer_load_dwordx4 v[144:147], v2, s[24:27], s53 offen offset:2048 sc1
    s_barrier
    s_waitcnt vmcnt(23)
    ds_write_b128 v5, v[16:19] offset:40960
    ds_write_b128 v5, v[20:23] offset:41984
    ds_write_b128 v5, v[24:27] offset:43008
    ds_write_b128 v5, v[28:31] offset:44032
    ds_write_b128 v5, v[32:35] offset:45056
    ds_write_b128 v5, v[36:39] offset:61440
    ds_write_b128 v5, v[40:43] offset:62464
    ds_write_b128 v5, v[44:47] offset:63488
    ds_write_b128 v5, v[48:51] offset:64512
    ds_write_b128 v6, v[52:55] offset:0
    ds_write_b128 v6, v[56:59] offset:16384
    ds_write_b128 v6, v[60:63] offset:17408
    ds_write_b128 v6, v[64:67] offset:18432
    ds_write_b128 v6, v[68:71] offset:19456
    ds_write_b128 v6, v[72:75] offset:20480
    s_waitcnt vmcnt(0) lgkmcnt(0)
    s_barrier
    s_waitcnt lgkmcnt(0)
    s_barrier
    ds_write_b128 v6, v[76:79] offset:36864
    ds_write_b128 v6, v[80:83] offset:37888
    ds_write_b128 v6, v[84:87] offset:38912
    ds_write_b128 v6, v[88:91] offset:39936
    ds_write_b128 v6, v[92:95] offset:40960
    ds_write_b128 v6, v[96:99] offset:57344
    ds_write_b128 v6, v[100:103] offset:58368
    ds_write_b128 v6, v[104:107] offset:59392
    ds_write_b128 v6, v[108:111] offset:60416
    ds_write_b128 v6, v[112:115] offset:61440
    s_waitcnt lgkmcnt(0)
    s_barrier
    ds_write_b128 v7, v[116:119] offset:12288
    ds_write_b128 v7, v[120:123] offset:13312
    ds_write_b128 v7, v[124:127] offset:14336
    ds_write_b128 v7, v[128:131] offset:15360
    ds_write_b128 v7, v[132:135] offset:16384
    ds_write_b128 v5, v[212:215] offset:0
    ds_write_b128 v5, v[216:219] offset:1024
    ds_write_b128 v5, v[220:223] offset:2048
    ds_write_b128 v5, v[224:227] offset:3072
    ds_write_b128 v5, v[228:231] offset:4096
    s_waitcnt lgkmcnt(0)
    s_barrier
    ds_write_b128 v5, v[232:235] offset:20480
    ds_write_b128 v5, v[236:239] offset:21504
    ds_write_b128 v5, v[240:243] offset:22528
    ds_write_b128 v5, v[244:247] offset:23552
    ds_write_b128 v5, v[248:251] offset:24576
    ds_write_b128 v11, v[136:139] offset:40960
    ds_write_b128 v11, v[140:143] offset:41984
    ds_write_b128 v11, v[144:147] offset:43008
    s_waitcnt lgkmcnt(0)
    s_barrier
    s_mov_b32 s28, s16
    s_mov_b32 s29, s17
    s_mov_b32 s30, 2621440
    s_mul_i32 s59, s60, 81920
    s_mul_i32 s54, s61, 160
    s_add_u32 s59, s59, s54
    v_add_u32 v100, 0, v0
    v_mul_u32_u24 v101, 6554, v100
    v_lshrrev_b32 v101, 16, v101
    v_mul_u32_u24 v102, 16, v101
    v_lshl_add_u32 v102, v100, 5, v102
    v_add_u32 v102, 61440, v102
    v_mul_u32_u24 v103, 1120, v101
    v_lshl_add_u32 v103, v100, 4, v103
    v_add_u32 v104, 128, v0
    v_mul_u32_u24 v105, 6554, v104
    v_lshrrev_b32 v105, 16, v105
    v_mul_u32_u24 v106, 16, v105
    v_lshl_add_u32 v106, v104, 5, v106
    v_add_u32 v106, 61440, v106
    v_mul_u32_u24 v107, 1120, v105
    v_lshl_add_u32 v107, v104, 4, v107
k_fin5:
    s_waitcnt lgkmcnt(0)
    s_barrier
    ds_read_b128 v[152:155], v102 offset:0
    ds_read_b128 v[156:159], v102 offset:16
    ds_read_b128 v[160:163], v102 offset:21504
    ds_read_b128 v[164:167], v102 offset:21520
    s_cmp_lt_u32 s36, 6
    s_cbranch_scc1 k_r2
    ds_read_b128 v[168:171], v106 offset:0
    ds_read_b128 v[172:175], v106 offset:16
    ds_read_b128 v[176:179], v106 offset:21504
    ds_read_b128 v[180:183], v106 offset:21520
k_r2:
    s_waitcnt lgkmcnt(0)
    v_pk_add_f32 v[152:153], v[152:153], v[160:161]
    v_pk_add_f32 v[154:155], v[154:155], v[162:163]
    v_pk_add_f32 v[156:157], v[156:157], v[164:165]
    v_pk_add_f32 v[158:159], v[158:159], v[166:167]
    v_cvt_pk_bf16_f32 v160, v152, v153
    v_cvt_pk_bf16_f32 v161, v154, v155
    v_cvt_pk_bf16_f32 v162, v156, v157
    v_cvt_pk_bf16_f32 v163, v158, v159
    buffer_store_dwordx4 v[160:163], v103, s[28:31], s59 offen
    s_cmp_lt_u32 s36, 6
    s_cbranch_scc1 k_end
    v_pk_add_f32 v[168:169], v[168:169], v[176:177]
    v_pk_add_f32 v[170:171], v[170:171], v[178:179]
    v_pk_add_f32 v[172:173], v[172:173], v[180:181]
    v_pk_add_f32 v[174:175], v[174:175], v[182:183]
    v_cvt_pk_bf16_f32 v176, v168, v169
    v_cvt_pk_bf16_f32 v177, v170, v171
    v_cvt_pk_bf16_f32 v178, v172, v173
    v_cvt_pk_bf16_f32 v179, v174, v175
    buffer_store_dwordx4 v[176:179], v107, s[28:31], s59 offen
k_end:
    s_endpgm
k_slow:
    v_subrev_u32 v122, 107520, v122
    v_subrev_u32 v123, 107520, v123
    v_subrev_u32 v124, 107520, v124
    v_mov_b32 v126, 0xff800000
    s_mov_b32 s52, 0
    s_mul_i32 s53, s37, 163840
k_slow1:
    buffer_load_dwordx2 v[98:99], v123, s[24:27], s53 offen offset:2048 sc1
    buffer_load_dwordx4 v[90:93], v122, s[24:27], s53 offen sc1
    buffer_load_dwordx4 v[94:97], v122, s[24:27], s53 offen offset:1024 sc1
    s_add_u32 s54, s53, 2560
    s_mov_b64 exec, s[50:51]
    buffer_load_dwordx4 v[100:103], v124, s[24:27], s54 offen offset:0 sc1
    buffer_load_dwordx4 v[104:107], v124, s[24:27], s54 offen offset:640 sc1
    buffer_load_dwordx4 v[108:111], v124, s[24:27], s54 offen offset:1280 sc1
    buffer_load_dwordx4 v[112:115], v124, s[24:27], s54 offen offset:1920 sc1
    s_mov_b64 exec, -1
    s_waitcnt vmcnt(0)
    v_mfma_f32_32x32x4_2b_bf16 v[2:33], v[98:99], v[120:121], 0
    s_nop 15
    s_nop 1
    v_mfma_f32_32x32x16_bf16 v[2:17], v[90:93], v[116:119], v[2:17]
    v_mfma_f32_32x32x16_bf16 v[18:33], v[94:97], v[116:119], v[18:33]
    s_nop 11
    v_max3_f32 v126, v2, v3, v126
    v_max3_f32 v126, v4, v5, v126
    v_max3_f32 v126, v6, v7, v126
    v_max3_f32 v126, v8, v9, v126
    v_max3_f32 v126, v10, v11, v126
    v_max3_f32 v126, v12, v13, v126
    v_max3_f32 v126, v14, v15, v126
    v_max3_f32 v126, v16, v17, v126
    v_max3_f32 v126, v18, v19, v126
    v_max3_f32 v126, v20, v21, v126
    v_max3_f32 v126, v22, v23, v126
    v_max3_f32 v126, v24, v25, v126
    v_max3_f32 v126, v26, v27, v126
    v_max3_f32 v126, v28, v29, v126
    v_max3_f32 v126, v30, v31, v126
    v_max3_f32 v126, v32, v33, v126
    s_add_u32 s53, s53, 5120
    s_add_u32 s52, s52, 1
    s_cmp_lt_u32 s52, 32
    s_cbranch_scc1 k_slow1
    v_mov_b32 v127, v126
    s_nop 1
    v_permlane32_swap_b32 v126, v127
    v_max_f32 v126, v126, v127
    v_sub_f32 v34, 0, v126
    v_sub_f32 v35, 0, v126
    v_sub_f32 v36, 0, v126
    v_sub_f32 v37, 0, v126
    v_sub_f32 v38, 0, v126
    v_sub_f32 v39, 0, v126
    v_sub_f32 v40, 0, v126
    v_sub_f32 v41, 0, v126
    v_sub_f32 v42, 0, v126
    v_sub_f32 v43, 0, v126
    v_sub_f32 v44, 0, v126
    v_sub_f32 v45, 0, v126
    v_sub_f32 v46, 0, v126
    v_sub_f32 v47, 0, v126
    v_sub_f32 v48, 0, v126
    v_sub_f32 v49, 0, v126
    v_sub_f32 v50, 0, v126
    v_sub_f32 v51, 0, v126
    v_sub_f32 v52, 0, v126
    v_sub_f32 v53, 0, v126
    v_sub_f32 v54, 0, v126
    v_sub_f32 v55, 0, v126
    v_sub_f32 v56, 0, v126
    v_sub_f32 v57, 0, v126
    v_sub_f32 v58, 0, v126
    v_sub_f32 v59, 0, v126
    v_sub_f32 v60, 0, v126
    v_sub_f32 v61, 0, v126
    v_sub_f32 v62, 0, v126
    v_sub_f32 v63, 0, v126
    v_sub_f32 v64, 0, v126
    v_sub_f32 v65, 0, v126
    v_mov_b32 v66, 0
    v_mov_b32 v67, 0
    v_mov_b32 v68, 0
    v_mov_b32 v69, 0
    v_mov_b32 v70, 0
    v_mov_b32 v71, 0
    v_mov_b32 v72, 0
    v_mov_b32 v73, 0
    v_mov_b32 v74, 0
    v_mov_b32 v75, 0
    v_mov_b32 v76, 0
    v_mov_b32 v77, 0
    v_mov_b32 v78, 0
    v_mov_b32 v79, 0
    v_mov_b32 v80, 0
    v_mov_b32 v81, 0
    s_mov_b32 s52, 0
    s_mul_i32 s53, s37, 163840
k_slow2:
    buffer_load_dwordx2 v[98:99], v123, s[24:27], s53 offen offset:2048 sc1
    buffer_load_dwordx4 v[90:93], v122, s[24:27], s53 offen sc1
    buffer_load_dwordx4 v[94:97], v122, s[24:27], s53 offen offset:1024 sc1
    s_add_u32 s54, s53, 2560
    s_mov_b64 exec, s[50:51]
    buffer_load_dwordx4 v[100:103], v124, s[24:27], s54 offen offset:0 sc1
    buffer_load_dwordx4 v[104:107], v124, s[24:27], s54 offen offset:640 sc1
    buffer_load_dwordx4 v[108:111], v124, s[24:27], s54 offen offset:1280 sc1
    buffer_load_dwordx4 v[112:115], v124, s[24:27], s54 offen offset:1920 sc1
    s_mov_b64 exec, -1
    s_waitcnt vmcnt(0)
    v_mfma_f32_32x32x4_2b_bf16 v[2:33], v[98:99], v[120:121], v[34:65]
    s_nop 15
    s_nop 1
    v_mfma_f32_32x32x16_bf16 v[2:17], v[90:93], v[116:119], v[2:17]
    v_mfma_f32_32x32x16_bf16 v[18:33], v[94:97], v[116:119], v[18:33]
    s_nop 11
    v_exp_f32 v2, v2
    v_exp_f32 v3, v3
    v_exp_f32 v4, v4
    v_exp_f32 v5, v5
    v_exp_f32 v6, v6
    v_exp_f32 v7, v7
    v_exp_f32 v8, v8
    v_exp_f32 v9, v9
    v_exp_f32 v10, v10
    v_exp_f32 v11, v11
    v_exp_f32 v12, v12
    v_exp_f32 v13, v13
    v_exp_f32 v14, v14
    v_exp_f32 v15, v15
    v_exp_f32 v16, v16
    v_exp_f32 v17, v17
    v_exp_f32 v18, v18
    v_exp_f32 v19, v19
    v_exp_f32 v20, v20
    v_exp_f32 v21, v21
    v_exp_f32 v22, v22
    v_exp_f32 v23, v23
    v_exp_f32 v24, v24
    v_exp_f32 v25, v25
    v_exp_f32 v26, v26
    v_exp_f32 v27, v27
    v_exp_f32 v28, v28
    v_exp_f32 v29, v29
    v_exp_f32 v30, v30
    v_exp_f32 v31, v31
    v_exp_f32 v32, v32
    v_exp_f32 v33, v33
    v_cvt_pk_bf16_f32 v82, v2, v3
    v_cvt_pk_bf16_f32 v83, v4, v5
    v_cvt_pk_bf16_f32 v84, v6, v7
    v_cvt_pk_bf16_f32 v85, v8, v9
    s_nop 1
    v_mfma_f32_32x32x16_bf16 v[66:81], v[100:103], v[82:85], v[66:81]
    v_cvt_pk_bf16_f32 v86, v10, v11
    v_cvt_pk_bf16_f32 v87, v12, v13
    v_cvt_pk_bf16_f32 v88, v14, v15
    v_cvt_pk_bf16_f32 v89, v16, v17
    s_nop 1
    v_mfma_f32_32x32x16_bf16 v[66:81], v[104:107], v[86:89], v[66:81]
    v_cvt_pk_bf16_f32 v82, v18, v19
    v_cvt_pk_bf16_f32 v83, v20, v21
    v_cvt_pk_bf16_f32 v84, v22, v23
    v_cvt_pk_bf16_f32 v85, v24, v25
    s_nop 1
    v_mfma_f32_32x32x16_bf16 v[66:81], v[108:111], v[82:85], v[66:81]
    v_cvt_pk_bf16_f32 v86, v26, v27
    v_cvt_pk_bf16_f32 v87, v28, v29
    v_cvt_pk_bf16_f32 v88, v30, v31
    v_cvt_pk_bf16_f32 v89, v32, v33
    s_nop 1
    v_mfma_f32_32x32x16_bf16 v[66:81], v[112:115], v[86:89], v[66:81]
    s_add_u32 s53, s53, 5120
    s_add_u32 s52, s52, 1
    s_cmp_lt_u32 s52, 32
    s_cbranch_scc1 k_slow2
    s_nop 11
    v_rcp_f32 v126, v78
    s_branch k_out
k_r3:
    s_add_u32 s72, s73, 128
    s_waitcnt vmcnt(0) lgkmcnt(0)
    s_mov_b32 s71, 0
    s_mov_b64 exec, 0xffff
k_r3_p0:
    buffer_load_dwordx2 v[76:77], v10, s[24:27], s72 offen sc1
k_r3_p2:
    s_add_u32 s71, s71, 1
    s_cmp_gt_u32 s71, 131072
    s_waitcnt vmcnt(0)
k_r3_p3:
    v_cmpx_ne_u64 vcc, s[22:23], v[76:77]
    s_cbranch_scc1 k_r3_p1
    s_cbranch_execnz k_r3_p0
k_r3_p1:
    s_mov_b64 exec, -1
    s_nop 3
    s_sub_u32 s37, s37, 8192
    s_sub_u32 s38, s38, 8192
    s_mov_b32 s39, 0
    s_lshl_b32 s40, s61, 1
    s_add_u32 s40, s40, s63
    s_mul_i32 s40, s40, 51200
    s_add_u32 s40, s40, 20316160
    s_nop 7
    v_lshlrev_b32 v36, 16, v132
    v_and_b32 v37, 0xffff0000, v132
    v_lshlrev_b32 v38, 16, v133
    v_and_b32 v39, 0xffff0000, v133
    v_mov_b32 v40, 0
    v_mov_b32 v41, 0
    v_mov_b32 v42, 0
    v_mov_b32 v43, 0
    v_lshlrev_b32 v44, 16, v134
    v_and_b32 v45, 0xffff0000, v134
    v_lshlrev_b32 v46, 16, v135
    v_and_b32 v47, 0xffff0000, v135
    v_mov_b32 v48, 0
    v_mov_b32 v49, 0
    v_mov_b32 v50, 0
    v_mov_b32 v51, 0
    v_lshlrev_b32 v52, 16, v136
    v_and_b32 v53, 0xffff0000, v136
    v_lshlrev_b32 v54, 16, v137
    v_and_b32 v55, 0xffff0000, v137
    v_mov_b32 v56, 0
    v_mov_b32 v57, 0
    v_mov_b32 v58, 0
    v_mov_b32 v59, 0
    v_lshlrev_b32 v60, 16, v138
    v_and_b32 v61, 0xffff0000, v138
    v_lshlrev_b32 v62, 16, v139
    v_and_b32 v63, 0xffff0000, v139
    v_mov_b32 v64, 0
    v_mov_b32 v65, 0
    v_mov_b32 v66, 0
    v_mov_b32 v67, 0
    v_lshlrev_b32 v68, 16, v140
    v_and_b32 v69, 0xffff0000, v140
    v_lshlrev_b32 v70, 16, v141
    v_and_b32 v71, 0xffff0000, v141
    v_mov_b32 v72, 0
    v_mov_b32 v73, 0
    v_mov_b32 v74, 0
    v_mov_b32 v75, 0
k_r3_l:
    s_lshr_b32 s41, 0x300, s39
    s_bitcmp1_b32 s41, 0
    s_cselect_b64 vcc, -1, 0
    s_cselect_b32 s41, 0x80, 8
    v_cndmask_b32 v84, v2, v3, vcc
    v_add_u32 v85, s41, v84
    s_add_u32 s41, s40, 4096
    buffer_load_dwordx2 v[76:77], v84, s[24:27], s37 offen sc1
    buffer_load_dwordx2 v[78:79], v85, s[24:27], s37 offen sc1
    buffer_load_dwordx2 v[80:81], v84, s[24:27], s38 offen sc1
    buffer_load_dwordx2 v[82:83], v85, s[24:27], s38 offen sc1
    buffer_load_dwordx4 v[16:19], v2, s[24:27], s40 offen offset:0 sc1
    buffer_load_dwordx4 v[20:23], v2, s[24:27], s40 offen offset:1024 sc1
    buffer_load_dwordx4 v[24:27], v2, s[24:27], s40 offen offset:2048 sc1
    buffer_load_dwordx4 v[28:31], v2, s[24:27], s40 offen offset:3072 sc1
    buffer_load_dwordx4 v[32:35], v2, s[24:27], s41 offen offset:0 sc1
    s_waitcnt vmcnt(0)
    v_mfma_f32_16x16x32_bf16 v[36:39], v[16:19], v[76:79], v[36:39]
    v_mfma_f32_16x16x32_bf16 v[40:43], v[16:19], v[80:83], v[40:43]
    v_mfma_f32_16x16x32_bf16 v[44:47], v[20:23], v[76:79], v[44:47]
    v_mfma_f32_16x16x32_bf16 v[48:51], v[20:23], v[80:83], v[48:51]
    v_mfma_f32_16x16x32_bf16 v[52:55], v[24:27], v[76:79], v[52:55]
    v_mfma_f32_16x16x32_bf16 v[56:59], v[24:27], v[80:83], v[56:59]
    v_mfma_f32_16x16x32_bf16 v[60:63], v[28:31], v[76:79], v[60:63]
    v_mfma_f32_16x16x32_bf16 v[64:67], v[28:31], v[80:83], v[64:67]
    v_mfma_f32_16x16x32_bf16 v[68:71], v[32:35], v[76:79], v[68:71]
    v_mfma_f32_16x16x32_bf16 v[72:75], v[32:35], v[80:83], v[72:75]
    s_add_u32 s37, s37, 1024
    s_add_u32 s38, s38, 1024
    s_add_u32 s40, s40, 5120
    s_add_u32 s39, s39, 1
    s_cmp_lt_u32 s39, 10
    s_cbranch_scc1 k_r3_l
    s_nop 7
    s_nop 1
    ds_write_b128 v12, v[40:43] offset:0
    s_nop 1
    ds_write_b128 v12, v[48:51] offset:1024
    s_nop 1
    ds_write_b128 v12, v[56:59] offset:2048
    s_nop 1
    ds_write_b128 v12, v[64:67] offset:3072
    s_nop 1
    ds_write_b128 v12, v[72:75] offset:4096
    s_branch k_r3_ret
k_r4_7:
    s_add_u32 s72, s73, 128
    s_waitcnt vmcnt(0) lgkmcnt(0)
    s_mov_b32 s71, 0
    s_mov_b64 exec, 0xffff
k_r4_7_p0:
    buffer_load_dwordx2 v[152:153], v10, s[24:27], s72 offen sc1
k_r4_7_p2:
    s_add_u32 s71, s71, 1
    s_cmp_gt_u32 s71, 131072
    s_waitcnt vmcnt(0)
k_r4_7_p3:
    v_cmpx_ne_u64 vcc, s[22:23], v[152:153]
    s_cbranch_scc1 k_r4_7_p1
    s_cbranch_execnz k_r4_7_p0
k_r4_7_p1:
    s_mov_b64 exec, -1
    s_nop 3
    s_sub_u32 s37, s37, 16384
    s_sub_u32 s38, s38, 16384
    s_mov_b32 s39, 0
    s_mul_i32 s40, s79, 20480
    s_add_u32 s40, s40, 21135360
    s_nop 7
    buffer_load_dwordx2 v[142:143], v3, s[24:27], s58 offen offset:0 sc1
    buffer_load_dwordx2 v[144:145], v3, s[24:27], s58 offen offset:128 sc1
    buffer_load_dwordx2 v[146:147], v3, s[24:27], s58 offen offset:1024 sc1
    buffer_load_dwordx2 v[148:149], v3, s[24:27], s58 offen offset:1152 sc1
    buffer_load_dwordx4 v[100:103], v12, s[24:27], s54 offen offset:0 sc1
    buffer_load_dwordx4 v[104:107], v12, s[24:27], s54 offen offset:16 sc1
    buffer_load_dwordx4 v[108:111], v12, s[24:27], s54 offen offset:128 sc1
    buffer_load_dwordx4 v[112:115], v12, s[24:27], s54 offen offset:144 sc1
    buffer_load_dwordx4 v[116:119], v12, s[24:27], s54 offen offset:256 sc1
    buffer_load_dwordx4 v[120:123], v12, s[24:27], s54 offen offset:272 sc1
    buffer_load_dwordx4 v[124:127], v13, s[24:27], s55 offen sc1
    v_mov_b32 v44, 0
    v_mov_b32 v45, 0
    v_mov_b32 v46, 0
    v_mov_b32 v47, 0
    v_mov_b32 v48, 0
    v_mov_b32 v49, 0
    v_mov_b32 v50, 0
    v_mov_b32 v51, 0
    v_mov_b32 v52, 0
    v_mov_b32 v53, 0
    v_mov_b32 v54, 0
    v_mov_b32 v55, 0
    v_mov_b32 v56, 0
    v_mov_b32 v57, 0
    v_mov_b32 v58, 0
    v_mov_b32 v59, 0
    v_mov_b32 v60, 0
    v_mov_b32 v61, 0
    v_mov_b32 v62, 0
    v_mov_b32 v63, 0
    v_mov_b32 v64, 0
    v_mov_b32 v65, 0
    v_mov_b32 v66, 0
    v_mov_b32 v67, 0
    v_mov_b32 v68, 0
    v_mov_b32 v69, 0
    v_mov_b32 v70, 0
    v_mov_b32 v71, 0
    v_mov_b32 v72, 0
    v_mov_b32 v73, 0
    v_mov_b32 v74, 0
    v_mov_b32 v75, 0
    v_mov_b32 v76, 0
    v_mov_b32 v77, 0
    v_mov_b32 v78, 0
    v_mov_b32 v79, 0
    v_mov_b32 v80, 0
    v_mov_b32 v81, 0
    v_mov_b32 v82, 0
    v_mov_b32 v83, 0
    v_mov_b32 v84, 0
    v_mov_b32 v85, 0
    v_mov_b32 v86, 0
    v_mov_b32 v87, 0
    v_mov_b32 v88, 0
    v_mov_b32 v89, 0
    v_mov_b32 v90, 0
    v_mov_b32 v91, 0
    v_mov_b32 v92, 0
    v_mov_b32 v93, 0
    v_mov_b32 v94, 0
    v_mov_b32 v95, 0
    v_mov_b32 v96, 0
    v_mov_b32 v97, 0
    v_mov_b32 v98, 0
    v_mov_b32 v99, 0
    s_waitcnt vmcnt(0)
    v_add_f32 v142, v142, v144
    v_add_f32 v143, v143, v145
    s_nop 1
    v_add_f32 v146, v146, v148
    v_add_f32 v147, v147, v149
    s_nop 1
    v_mov_b32 v144, v142
    v_mov_b32 v145, v143
    s_nop 1
    v_mov_b32 v148, v146
    v_mov_b32 v149, v147
    s_nop 1
    v_permlane32_swap_b32 v142, v144
    v_permlane32_swap_b32 v143, v145
    s_nop 1
    v_permlane32_swap_b32 v146, v148
    v_permlane32_swap_b32 v147, v149
    s_nop 1
    v_add_f32 v142, v142, v144
    v_add_f32 v143, v143, v145
    s_nop 1
    v_add_f32 v146, v146, v148
    v_add_f32 v147, v147, v149
    s_nop 1
    v_mov_b32 v144, v142
    v_mov_b32 v145, v143
    s_nop 1
    v_mov_b32 v148, v146
    v_mov_b32 v149, v147
    s_nop 1
    v_permlane16_swap_b32 v142, v144
    v_permlane16_swap_b32 v143, v145
    s_nop 1
    v_permlane16_swap_b32 v146, v148
    v_permlane16_swap_b32 v147, v149
    s_nop 1
    v_add_f32 v142, v142, v144
    v_add_f32 v143, v143, v145
    s_nop 1
    v_add_f32 v146, v146, v148
    v_add_f32 v147, v147, v149
    s_nop 1
    v_add_f32 v144, v142, v143
    s_nop 1
    v_add_f32 v148, v146, v147
    s_nop 1
    v_mul_f32 v142, 0xbacccccd, v142
    v_mul_f32 v143, 0x3acccccd, v143
    s_nop 1
    v_mul_f32 v146, 0xbacccccd, v146
    v_mul_f32 v147, 0x3acccccd, v147
    s_nop 1
    v_fma_f32 v143, -v142, v142, v143
    v_max_f32 v143, 0, v143
    s_nop 1
    v_fma_f32 v147, -v146, v146, v147
    v_max_f32 v147, 0, v147
    s_nop 1
    v_add_f32 v143, 0x3727c5ac, v143
    s_nop 1
    v_add_f32 v147, 0x3727c5ac, v147
    s_nop 1
    v_rsq_f32 v143, v143
    s_nop 1
    v_rsq_f32 v147, v147
    s_nop 1
    v_mul_f32 v143, 0xbfb8aa3b, v143
    v_mul_f32 v142, v142, v143
    s_nop 1
    v_mul_f32 v147, 0xbfb8aa3b, v147
    v_mul_f32 v146, v146, v147
    s_nop 1
    v_mul_f32 v208, v100, v146
    v_mul_f32 v100, v100, v142
    s_nop 1
    v_mul_f32 v209, v101, v146
    v_mul_f32 v101, v101, v142
    s_nop 1
    v_mul_f32 v210, v102, v146
    v_mul_f32 v102, v102, v142
    s_nop 1
    v_mul_f32 v211, v103, v146
    v_mul_f32 v103, v103, v142
    s_nop 1
    v_mul_f32 v212, v104, v146
    v_mul_f32 v104, v104, v142
    s_nop 1
    v_mul_f32 v213, v105, v146
    v_mul_f32 v105, v105, v142
    s_nop 1
    v_mul_f32 v214, v106, v146
    v_mul_f32 v106, v106, v142
    s_nop 1
    v_mul_f32 v215, v107, v146
    v_mul_f32 v107, v107, v142
    s_nop 1
    v_mul_f32 v216, v108, v146
    v_mul_f32 v108, v108, v142
    s_nop 1
    v_mul_f32 v217, v109, v146
    v_mul_f32 v109, v109, v142
    s_nop 1
    v_mul_f32 v218, v110, v146
    v_mul_f32 v110, v110, v142
    s_nop 1
    v_mul_f32 v219, v111, v146
    v_mul_f32 v111, v111, v142
    s_nop 1
    v_mul_f32 v220, v112, v146
    v_mul_f32 v112, v112, v142
    s_nop 1
    v_mul_f32 v221, v113, v146
    v_mul_f32 v113, v113, v142
    s_nop 1
    v_mul_f32 v222, v114, v146
    v_mul_f32 v114, v114, v142
    s_nop 1
    v_mul_f32 v223, v115, v146
    v_mul_f32 v115, v115, v142
    s_nop 1
    v_mul_f32 v224, v116, v146
    v_mul_f32 v116, v116, v142
    s_nop 1
    v_mul_f32 v225, v117, v146
    v_mul_f32 v117, v117, v142
    s_nop 1
    v_mul_f32 v226, v118, v146
    v_mul_f32 v118, v118, v142
    s_nop 1
    v_mul_f32 v227, v119, v146
    v_mul_f32 v119, v119, v142
    s_nop 1
    v_mul_f32 v228, v120, v146
    v_mul_f32 v120, v120, v142
    s_nop 1
    v_mul_f32 v229, v121, v146
    v_mul_f32 v121, v121, v142
    s_nop 1
    v_mul_f32 v230, v122, v146
    v_mul_f32 v122, v122, v142
    s_nop 1
    v_mul_f32 v231, v123, v146
    v_mul_f32 v123, v123, v142
    s_nop 1
    v_mul_f32 v232, v124, v146
    v_mul_f32 v124, v124, v142
    s_nop 1
    v_mul_f32 v233, v125, v146
    v_mul_f32 v125, v125, v142
    s_nop 1
    v_mul_f32 v234, v126, v146
    v_mul_f32 v126, v126, v142
    s_nop 1
    v_mul_f32 v235, v127, v146
    v_mul_f32 v127, v127, v142
    s_nop 1
k_r4_7_l:
    s_lshr_b32 s41, 0x21084, s39
    s_bitcmp1_b32 s41, 0
    s_cselect_b64 vcc, -1, 0
    s_cselect_b32 s41, 0x80, 8
    v_cndmask_b32 v160, v2, v3, vcc
    v_add_u32 v161, s41, v160
    s_add_u32 s41, s40, 4096
    buffer_load_dwordx2 v[152:153], v160, s[24:27], s37 offen sc1
    buffer_load_dwordx2 v[154:155], v161, s[24:27], s37 offen sc1
    buffer_load_dwordx2 v[156:157], v160, s[24:27], s38 offen sc1
    buffer_load_dwordx2 v[158:159], v161, s[24:27], s38 offen sc1
    buffer_load_dwordx4 v[16:19], v2, s[24:27], s40 offen offset:0 sc1
    buffer_load_dwordx4 v[20:23], v2, s[24:27], s40 offen offset:1024 sc1
    buffer_load_dwordx4 v[24:27], v2, s[24:27], s40 offen offset:2048 sc1
    buffer_load_dwordx4 v[28:31], v2, s[24:27], s40 offen offset:3072 sc1
    buffer_load_dwordx4 v[32:35], v2, s[24:27], s41 offen offset:0 sc1
    buffer_load_dwordx4 v[36:39], v2, s[24:27], s41 offen offset:1024 sc1
    buffer_load_dwordx4 v[40:43], v2, s[24:27], s41 offen offset:2048 sc1
    s_waitcnt vmcnt(0)
    v_mfma_f32_16x16x32_bf16 v[44:47], v[16:19], v[152:155], v[44:47]
    v_mfma_f32_16x16x32_bf16 v[48:51], v[16:19], v[156:159], v[48:51]
    v_mfma_f32_16x16x32_bf16 v[52:55], v[20:23], v[152:155], v[52:55]
    v_mfma_f32_16x16x32_bf16 v[56:59], v[20:23], v[156:159], v[56:59]
    v_mfma_f32_16x16x32_bf16 v[60:63], v[24:27], v[152:155], v[60:63]
    v_mfma_f32_16x16x32_bf16 v[64:67], v[24:27], v[156:159], v[64:67]
    v_mfma_f32_16x16x32_bf16 v[68:71], v[28:31], v[152:155], v[68:71]
    v_mfma_f32_16x16x32_bf16 v[72:75], v[28:31], v[156:159], v[72:75]
    v_mfma_f32_16x16x32_bf16 v[76:79], v[32:35], v[152:155], v[76:79]
    v_mfma_f32_16x16x32_bf16 v[80:83], v[32:35], v[156:159], v[80:83]
    v_mfma_f32_16x16x32_bf16 v[84:87], v[36:39], v[152:155], v[84:87]
    v_mfma_f32_16x16x32_bf16 v[88:91], v[36:39], v[156:159], v[88:91]
    v_mfma_f32_16x16x32_bf16 v[92:95], v[40:43], v[152:155], v[92:95]
    v_mfma_f32_16x16x32_bf16 v[96:99], v[40:43], v[156:159], v[96:99]
    s_add_u32 s37, s37, 1024
    s_add_u32 s38, s38, 1024
    s_add_u32 s40, s40, 7168
    s_add_u32 s39, s39, 1
    s_cmp_lt_u32 s39, 20
    s_cbranch_scc1 k_r4_7_l
    s_nop 7
    s_branch k_r4_7_ret
k_r4_6:
    s_add_u32 s72, s73, 128
    s_waitcnt vmcnt(0) lgkmcnt(0)
    s_mov_b32 s71, 0
    s_mov_b64 exec, 0xffff
k_r4_6_p0:
    buffer_load_dwordx2 v[152:153], v10, s[24:27], s72 offen sc1
k_r4_6_p2:
    s_add_u32 s71, s71, 1
    s_cmp_gt_u32 s71, 131072
    s_waitcnt vmcnt(0)
k_r4_6_p3:
    v_cmpx_ne_u64 vcc, s[22:23], v[152:153]
    s_cbranch_scc1 k_r4_6_p1
    s_cbranch_execnz k_r4_6_p0
k_r4_6_p1:
    s_mov_b64 exec, -1
    s_nop 3
    s_sub_u32 s37, s37, 16384
    s_sub_u32 s38, s38, 16384
    s_mov_b32 s39, 0
    s_mul_i32 s40, s79, 20480
    s_add_u32 s40, s40, 21135360
    s_nop 7
    buffer_load_dwordx2 v[142:143], v3, s[24:27], s58 offen offset:0 sc1
    buffer_load_dwordx2 v[144:145], v3, s[24:27], s58 offen offset:128 sc1
    buffer_load_dwordx2 v[146:147], v3, s[24:27], s58 offen offset:1024 sc1
    buffer_load_dwordx2 v[148:149], v3, s[24:27], s58 offen offset:1152 sc1
    buffer_load_dwordx4 v[100:103], v12, s[24:27], s54 offen offset:0 sc1
    buffer_load_dwordx4 v[104:107], v12, s[24:27], s54 offen offset:16 sc1
    buffer_load_dwordx4 v[108:111], v12, s[24:27], s54 offen offset:128 sc1
    buffer_load_dwordx4 v[112:115], v12, s[24:27], s54 offen offset:144 sc1
    buffer_load_dwordx4 v[116:119], v12, s[24:27], s54 offen offset:256 sc1
    buffer_load_dwordx4 v[120:123], v12, s[24:27], s54 offen offset:272 sc1
    v_mov_b32 v44, 0
    v_mov_b32 v45, 0
    v_mov_b32 v46, 0
    v_mov_b32 v47, 0
    v_mov_b32 v48, 0
    v_mov_b32 v49, 0
    v_mov_b32 v50, 0
    v_mov_b32 v51, 0
    v_mov_b32 v52, 0
    v_mov_b32 v53, 0
    v_mov_b32 v54, 0
    v_mov_b32 v55, 0
    v_mov_b32 v56, 0
    v_mov_b32 v57, 0
    v_mov_b32 v58, 0
    v_mov_b32 v59, 0
    v_mov_b32 v60, 0
    v_mov_b32 v61, 0
    v_mov_b32 v62, 0
    v_mov_b32 v63, 0
    v_mov_b32 v64, 0
    v_mov_b32 v65, 0
    v_mov_b32 v66, 0
    v_mov_b32 v67, 0
    v_mov_b32 v68, 0
    v_mov_b32 v69, 0
    v_mov_b32 v70, 0
    v_mov_b32 v71, 0
    v_mov_b32 v72, 0
    v_mov_b32 v73, 0
    v_mov_b32 v74, 0
    v_mov_b32 v75, 0
    v_mov_b32 v76, 0
    v_mov_b32 v77, 0
    v_mov_b32 v78, 0
    v_mov_b32 v79, 0
    v_mov_b32 v80, 0
    v_mov_b32 v81, 0
    v_mov_b32 v82, 0
    v_mov_b32 v83, 0
    v_mov_b32 v84, 0
    v_mov_b32 v85, 0
    v_mov_b32 v86, 0
    v_mov_b32 v87, 0
    v_mov_b32 v88, 0
    v_mov_b32 v89, 0
    v_mov_b32 v90, 0
    v_mov_b32 v91, 0
    s_waitcnt vmcnt(0)
    v_add_f32 v142, v142, v144
    v_add_f32 v143, v143, v145
    s_nop 1
    v_add_f32 v146, v146, v148
    v_add_f32 v147, v147, v149
    s_nop 1
    v_mov_b32 v144, v142
    v_mov_b32 v145, v143
    s_nop 1
    v_mov_b32 v148, v146
    v_mov_b32 v149, v147
    s_nop 1
    v_permlane32_swap_b32 v142, v144
    v_permlane32_swap_b32 v143, v145
    s_nop 1
    v_permlane32_swap_b32 v146, v148
    v_permlane32_swap_b32 v147, v149
    s_nop 1
    v_add_f32 v142, v142, v144
    v_add_f32 v143, v143, v145
    s_nop 1
    v_add_f32 v146, v146, v148
    v_add_f32 v147, v147, v149
    s_nop 1
    v_mov_b32 v144, v142
    v_mov_b32 v145, v143
    s_nop 1
    v_mov_b32 v148, v146
    v_mov_b32 v149, v147
    s_nop 1
    v_permlane16_swap_b32 v142, v144
    v_permlane16_swap_b32 v143, v145
    s_nop 1
    v_permlane16_swap_b32 v146, v148
    v_permlane16_swap_b32 v147, v149
    s_nop 1
    v_add_f32 v142, v142, v144
    v_add_f32 v143, v143, v145
    s_nop 1
    v_add_f32 v146, v146, v148
    v_add_f32 v147, v147, v149
    s_nop 1
    v_add_f32 v144, v142, v143
    s_nop 1
    v_add_f32 v148, v146, v147
    s_nop 1
    v_mul_f32 v142, 0xbacccccd, v142
    v_mul_f32 v143, 0x3acccccd, v143
    s_nop 1
    v_mul_f32 v146, 0xbacccccd, v146
    v_mul_f32 v147, 0x3acccccd, v147
    s_nop 1
    v_fma_f32 v143, -v142, v142, v143
    v_max_f32 v143, 0, v143
    s_nop 1
    v_fma_f32 v147, -v146, v146, v147
    v_max_f32 v147, 0, v147
    s_nop 1
    v_add_f32 v143, 0x3727c5ac, v143
    s_nop 1
    v_add_f32 v147, 0x3727c5ac, v147
    s_nop 1
    v_rsq_f32 v143, v143
    s_nop 1
    v_rsq_f32 v147, v147
    s_nop 1
    v_mul_f32 v143, 0xbfb8aa3b, v143
    v_mul_f32 v142, v142, v143
    s_nop 1
    v_mul_f32 v147, 0xbfb8aa3b, v147
    v_mul_f32 v146, v146, v147
    s_nop 1
    v_mul_f32 v208, v100, v146
    v_mul_f32 v100, v100, v142
    s_nop 1
    v_mul_f32 v209, v101, v146
    v_mul_f32 v101, v101, v142
    s_nop 1
    v_mul_f32 v210, v102, v146
    v_mul_f32 v102, v102, v142
    s_nop 1
    v_mul_f32 v211, v103, v146
    v_mul_f32 v103, v103, v142
    s_nop 1
    v_mul_f32 v212, v104, v146
    v_mul_f32 v104, v104, v142
    s_nop 1
    v_mul_f32 v213, v105, v146
    v_mul_f32 v105, v105, v142
    s_nop 1
    v_mul_f32 v214, v106, v146
    v_mul_f32 v106, v106, v142
    s_nop 1
    v_mul_f32 v215, v107, v146
    v_mul_f32 v107, v107, v142
    s_nop 1
    v_mul_f32 v216, v108, v146
    v_mul_f32 v108, v108, v142
    s_nop 1
    v_mul_f32 v217, v109, v146
    v_mul_f32 v109, v109, v142
    s_nop 1
    v_mul_f32 v218, v110, v146
    v_mul_f32 v110, v110, v142
    s_nop 1
    v_mul_f32 v219, v111, v146
    v_mul_f32 v111, v111, v142
    s_nop 1
    v_mul_f32 v220, v112, v146
    v_mul_f32 v112, v112, v142
    s_nop 1
    v_mul_f32 v221, v113, v146
    v_mul_f32 v113, v113, v142
    s_nop 1
    v_mul_f32 v222, v114, v146
    v_mul_f32 v114, v114, v142
    s_nop 1
    v_mul_f32 v223, v115, v146
    v_mul_f32 v115, v115, v142
    s_nop 1
    v_mul_f32 v224, v116, v146
    v_mul_f32 v116, v116, v142
    s_nop 1
    v_mul_f32 v225, v117, v146
    v_mul_f32 v117, v117, v142
    s_nop 1
    v_mul_f32 v226, v118, v146
    v_mul_f32 v118, v118, v142
    s_nop 1
    v_mul_f32 v227, v119, v146
    v_mul_f32 v119, v119, v142
    s_nop 1
    v_mul_f32 v228, v120, v146
    v_mul_f32 v120, v120, v142
    s_nop 1
    v_mul_f32 v229, v121, v146
    v_mul_f32 v121, v121, v142
    s_nop 1
    v_mul_f32 v230, v122, v146
    v_mul_f32 v122, v122, v142
    s_nop 1
    v_mul_f32 v231, v123, v146
    v_mul_f32 v123, v123, v142
    s_nop 1
k_r4_6_l:
    s_lshr_b32 s41, 0x21084, s39
    s_bitcmp1_b32 s41, 0
    s_cselect_b64 vcc, -1, 0
    s_cselect_b32 s41, 0x80, 8
    v_cndmask_b32 v160, v2, v3, vcc
    v_add_u32 v161, s41, v160
    s_add_u32 s41, s40, 4096
    buffer_load_dwordx2 v[152:153], v160, s[24:27], s37 offen sc1
    buffer_load_dwordx2 v[154:155], v161, s[24:27], s37 offen sc1
    buffer_load_dwordx2 v[156:157], v160, s[24:27], s38 offen sc1
    buffer_load_dwordx2 v[158:159], v161, s[24:27], s38 offen sc1
    buffer_load_dwordx4 v[16:19], v2, s[24:27], s40 offen offset:0 sc1
    buffer_load_dwordx4 v[20:23], v2, s[24:27], s40 offen offset:1024 sc1
    buffer_load_dwordx4 v[24:27], v2, s[24:27], s40 offen offset:2048 sc1
    buffer_load_dwordx4 v[28:31], v2, s[24:27], s40 offen offset:3072 sc1
    buffer_load_dwordx4 v[32:35], v2, s[24:27], s41 offen offset:0 sc1
    buffer_load_dwordx4 v[36:39], v2, s[24:27], s41 offen offset:1024 sc1
    s_waitcnt vmcnt(0)
    v_mfma_f32_16x16x32_bf16 v[44:47], v[16:19], v[152:155], v[44:47]
    v_mfma_f32_16x16x32_bf16 v[48:51], v[16:19], v[156:159], v[48:51]
    v_mfma_f32_16x16x32_bf16 v[52:55], v[20:23], v[152:155], v[52:55]
    v_mfma_f32_16x16x32_bf16 v[56:59], v[20:23], v[156:159], v[56:59]
    v_mfma_f32_16x16x32_bf16 v[60:63], v[24:27], v[152:155], v[60:63]
    v_mfma_f32_16x16x32_bf16 v[64:67], v[24:27], v[156:159], v[64:67]
    v_mfma_f32_16x16x32_bf16 v[68:71], v[28:31], v[152:155], v[68:71]
    v_mfma_f32_16x16x32_bf16 v[72:75], v[28:31], v[156:159], v[72:75]
    v_mfma_f32_16x16x32_bf16 v[76:79], v[32:35], v[152:155], v[76:79]
    v_mfma_f32_16x16x32_bf16 v[80:83], v[32:35], v[156:159], v[80:83]
    v_mfma_f32_16x16x32_bf16 v[84:87], v[36:39], v[152:155], v[84:87]
    v_mfma_f32_16x16x32_bf16 v[88:91], v[36:39], v[156:159], v[88:91]
    s_add_u32 s37, s37, 1024
    s_add_u32 s38, s38, 1024
    s_add_u32 s40, s40, 6144
    s_add_u32 s39, s39, 1
    s_cmp_lt_u32 s39, 20
    s_cbranch_scc1 k_r4_6_l
    s_nop 7
    s_branch k_r4_6_ret
k_r5:
    s_add_u32 s72, s73, 128
    s_waitcnt vmcnt(0) lgkmcnt(0)
    s_mov_b32 s71, 0
    s_mov_b64 exec, 0xff
k_r5_p0:
    buffer_load_dwordx2 v[152:153], v10, s[24:27], s72 offen sc1
k_r5_p2:
    s_add_u32 s71, s71, 1
    s_cmp_gt_u32 s71, 131072
    s_waitcnt vmcnt(0)
k_r5_p3:
    v_cmpx_ne_u64 vcc, s[22:23], v[152:153]
    s_cbranch_scc1 k_r5_p1
    s_cbranch_execnz k_r5_p0
k_r5_p1:
    s_mov_b64 exec, -1
    s_nop 3
    s_sub_u32 s37, s37, 24576
    s_sub_u32 s38, s38, 24576
    s_mov_b32 s39, 0
    s_lshl_b32 s40, s61, 1
    s_add_u32 s40, s40, s63
    s_mul_i32 s40, s40, 138240
    s_add_u32 s40, s40, 23347200
    s_nop 7
    v_lshlrev_b32 v44, 16, v132
    v_and_b32 v45, 0xffff0000, v132
    v_lshlrev_b32 v46, 16, v133
    v_and_b32 v47, 0xffff0000, v133
    v_mov_b32 v48, 0
    v_mov_b32 v49, 0
    v_mov_b32 v50, 0
    v_mov_b32 v51, 0
    v_lshlrev_b32 v52, 16, v134
    v_and_b32 v53, 0xffff0000, v134
    v_lshlrev_b32 v54, 16, v135
    v_and_b32 v55, 0xffff0000, v135
    v_mov_b32 v56, 0
    v_mov_b32 v57, 0
    v_mov_b32 v58, 0
    v_mov_b32 v59, 0
    v_lshlrev_b32 v60, 16, v136
    v_and_b32 v61, 0xffff0000, v136
    v_lshlrev_b32 v62, 16, v137
    v_and_b32 v63, 0xffff0000, v137
    v_mov_b32 v64, 0
    v_mov_b32 v65, 0
    v_mov_b32 v66, 0
    v_mov_b32 v67, 0
    v_lshlrev_b32 v68, 16, v138
    v_and_b32 v69, 0xffff0000, v138
    v_lshlrev_b32 v70, 16, v139
    v_and_b32 v71, 0xffff0000, v139
    v_mov_b32 v72, 0
    v_mov_b32 v73, 0
    v_mov_b32 v74, 0
    v_mov_b32 v75, 0
    v_lshlrev_b32 v76, 16, v140
    v_and_b32 v77, 0xffff0000, v140
    v_lshlrev_b32 v78, 16, v141
    v_and_b32 v79, 0xffff0000, v141
    v_mov_b32 v80, 0
    v_mov_b32 v81, 0
    v_mov_b32 v82, 0
    v_mov_b32 v83, 0
k_r5_l:
    s_lshr_b32 s41, 0x7000000, s39
    s_bitcmp1_b32 s41, 0
    s_cselect_b64 vcc, -1, 0
    s_cselect_b32 s41, 0x80, 8
    v_cndmask_b32 v160, v2, v3, vcc
    v_add_u32 v161, s41, v160
    s_add_u32 s41, s40, 4096
    buffer_load_dwordx2 v[152:153], v160, s[24:27], s37 offen sc1
    buffer_load_dwordx2 v[154:155], v161, s[24:27], s37 offen sc1
    buffer_load_dwordx2 v[156:157], v160, s[24:27], s38 offen sc1
    buffer_load_dwordx2 v[158:159], v161, s[24:27], s38 offen sc1
    buffer_load_dwordx4 v[16:19], v2, s[24:27], s40 offen offset:0 sc1
    buffer_load_dwordx4 v[20:23], v2, s[24:27], s40 offen offset:1024 sc1
    buffer_load_dwordx4 v[24:27], v2, s[24:27], s40 offen offset:2048 sc1
    buffer_load_dwordx4 v[28:31], v2, s[24:27], s40 offen offset:3072 sc1
    buffer_load_dwordx4 v[32:35], v2, s[24:27], s41 offen offset:0 sc1
    s_waitcnt vmcnt(0)
    v_mfma_f32_16x16x32_bf16 v[44:47], v[16:19], v[152:155], v[44:47]
    v_mfma_f32_16x16x32_bf16 v[48:51], v[16:19], v[156:159], v[48:51]
    v_mfma_f32_16x16x32_bf16 v[52:55], v[20:23], v[152:155], v[52:55]
    v_mfma_f32_16x16x32_bf16 v[56:59], v[20:23], v[156:159], v[56:59]
    v_mfma_f32_16x16x32_bf16 v[60:63], v[24:27], v[152:155], v[60:63]
    v_mfma_f32_16x16x32_bf16 v[64:67], v[24:27], v[156:159], v[64:67]
    v_mfma_f32_16x16x32_bf16 v[68:71], v[28:31], v[152:155], v[68:71]
    v_mfma_f32_16x16x32_bf16 v[72:75], v[28:31], v[156:159], v[72:75]
    v_mfma_f32_16x16x32_bf16 v[76:79], v[32:35], v[152:155], v[76:79]
    v_mfma_f32_16x16x32_bf16 v[80:83], v[32:35], v[156:159], v[80:83]
    s_add_u32 s37, s37, 1024
    s_add_u32 s38, s38, 1024
    s_add_u32 s40, s40, 5120
    s_add_u32 s39, s39, 1
    s_cmp_lt_u32 s39, 27
    s_cbranch_scc1 k_r5_l
    s_nop 7
    ds_write_b128 v84, v[44:47] offset:0
    ds_write_b128 v86, v[48:51] offset:0
    ds_write_b128 v84, v[52:55] offset:16
    ds_write_b128 v86, v[56:59] offset:16
    ds_write_b128 v84, v[60:63] offset:128
    ds_write_b128 v86, v[64:67] offset:128
    ds_write_b128 v84, v[68:71] offset:144
    ds_write_b128 v86, v[72:75] offset:144
    ds_write_b128 v85, v[76:79]
    ds_write_b128 v87, v[80:83]
    s_branch k_r5_ret
.p2align 7
k_tab2:
.long 0x0,0x80,0x100,0x180,0x200,0x0,0x0,0x0
.long 0x1360000,0x1360400,0x1360800,0x1360c00,0x1361001,0x137a001,0x1379000,0x1379400
.long 0x1379800,0x1379c00,0x1392000,0x1392400,0x1392800,0x1392c00,0x1393001,0x13ac001
.long 0x13ab000,0x13ab400,0x13ab800,0x13abc00,0x0,0x0,0x0,0x0
.long 0x280,0x300,0x380,0x400,0x480,0x0,0x0,0x0
.long 0x13c4000,0x13c4400,0x13c4800,0x13c4c00,0x13c5001,0x13de001,0x13dd000,0x13dd400
.long 0x13dd800,0x13ddc00,0x13f6000,0x13f6400,0x13f6800,0x13f6c00,0x13f7001,0x1410001
.long 0x140f000,0x140f400,0x140f800,0x140fc00,0x0,0x0,0x0,0x0
.long 0xc800,0xc880,0xc900,0xc980,0xca00,0x0,0x0,0x0
.long 0x1361400,0x1361800,0x1361c00,0x1362000,0x1362401,0x137b401,0x137a400,0x137a800
.long 0x137ac00,0x137b000,0x1393400,0x1393800,0x1393c00,0x1394000,0x1394401,0x13ad401
.long 0x13ac400,0x13ac800,0x13acc00,0x13ad000,0x0,0x0,0x0,0x0
.long 0xca80,0xcb00,0xcb80,0xcc00,0xcc80,0x0,0x0,0x0
.long 0x13c5400,0x13c5800,0x13c5c00,0x13c6000,0x13c6401,0x13df401,0x13de400,0x13de800
.long 0x13dec00,0x13df000,0x13f7400,0x13f7800,0x13f7c00,0x13f8000,0x13f8401,0x1411401
.long 0x1410400,0x1410800,0x1410c00,0x1411000,0x0,0x0,0x0,0x0
.long 0x19000,0x19080,0x19100,0x19180,0x19200,0x0,0x0,0x0
.long 0x1362800,0x1362c00,0x1363000,0x1363400,0x1363801,0x137c801,0x137b800,0x137bc00
.long 0x137c000,0x137c400,0x1394800,0x1394c00,0x1395000,0x1395400,0x1395801,0x13ae801
.long 0x13ad800,0x13adc00,0x13ae000,0x13ae400,0x0,0x0,0x0,0x0
.long 0x19280,0x19300,0x19380,0x19400,0x19480,0x0,0x0,0x0
.long 0x13c6800,0x13c6c00,0x13c7000,0x13c7400,0x13c7801,0x13e0801,0x13df800,0x13dfc00
.long 0x13e0000,0x13e0400,0x13f8800,0x13f8c00,0x13f9000,0x13f9400,0x13f9801,0x1412801
.long 0x1411800,0x1411c00,0x1412000,0x1412400,0x0,0x0,0x0,0x0
.long 0x25800,0x25880,0x25900,0x25980,0x25a00,0x0,0x0,0x0
.long 0x1363c00,0x1364000,0x1364400,0x1364800,0x1364c01,0x137dc01,0x137cc00,0x137d000
.long 0x137d400,0x137d800,0x1395c00,0x1396000,0x1396400,0x1396800,0x1396c01,0x13afc01
.long 0x13aec00,0x13af000,0x13af400,0x13af800,0x0,0x0,0x0,0x0
.long 0x25a80,0x25b00,0x25b80,0x25c00,0x25c80,0x0,0x0,0x0
.long 0x13c7c00,0x13c8000,0x13c8400,0x13c8800,0x13c8c01,0x13e1c01,0x13e0c00,0x13e1000
.long 0x13e1400,0x13e1800,0x13f9c00,0x13fa000,0x13fa400,0x13fa800,0x13fac01,0x1413c01
.long 0x1412c00,0x1413000,0x1413400,0x1413800,0x0,0x0,0x0,0x0
.long 0x32000,0x32080,0x32100,0x32180,0x32200,0x0,0x0,0x0
.long 0x1365000,0x1365400,0x1365800,0x1365c00,0x1366001,0x137f001,0x137e000,0x137e400
.long 0x137e800,0x137ec00,0x1397000,0x1397400,0x1397800,0x1397c00,0x1398001,0x13b1001
.long 0x13b0000,0x13b0400,0x13b0800,0x13b0c00,0x0,0x0,0x0,0x0
.long 0x32280,0x32300,0x32380,0x32400,0x32480,0x0,0x0,0x0
.long 0x13c9000,0x13c9400,0x13c9800,0x13c9c00,0x13ca001,0x13e3001,0x13e2000,0x13e2400
.long 0x13e2800,0x13e2c00,0x13fb000,0x13fb400,0x13fb800,0x13fbc00,0x13fc001,0x1415001
.long 0x1414000,0x1414400,0x1414800,0x1414c00,0x0,0x0,0x0,0x0
.long 0x3e800,0x3e880,0x3e900,0x3e980,0x3ea00,0x0,0x0,0x0
.long 0x1366400,0x1366800,0x1366c00,0x1367000,0x1367401,0x1380401,0x137f400,0x137f800
.long 0x137fc00,0x1380000,0x1398400,0x1398800,0x1398c00,0x1399000,0x1399401,0x13b2401
.long 0x13b1400,0x13b1800,0x13b1c00,0x13b2000,0x0,0x0,0x0,0x0
.long 0x3ea80,0x3eb00,0x3eb80,0x3ec00,0x3ec80,0x0,0x0,0x0
.long 0x13ca400,0x13ca800,0x13cac00,0x13cb000,0x13cb401,0x13e4401,0x13e3400,0x13e3800
.long 0x13e3c00,0x13e4000,0x13fc400,0x13fc800,0x13fcc00,0x13fd000,0x13fd401,0x1416401
.long 0x1415400,0x1415800,0x1415c00,0x1416000,0x0,0x0,0x0,0x0
.long 0x4b000,0x4b080,0x4b100,0x4b180,0x4b200,0x0,0x0,0x0
.long 0x1367800,0x1367c00,0x1368000,0x1368400,0x1368801,0x1381801,0x1380800,0x1380c00
.long 0x1381000,0x1381400,0x1399800,0x1399c00,0x139a000,0x139a400,0x139a801,0x13b3801
.long 0x13b2800,0x13b2c00,0x13b3000,0x13b3400,0x0,0x0,0x0,0x0
.long 0x4b280,0x4b300,0x4b380,0x4b400,0x4b480,0x0,0x0,0x0
.long 0x13cb800,0x13cbc00,0x13cc000,0x13cc400,0x13cc801,0x13e5801,0x13e4800,0x13e4c00
.long 0x13e5000,0x13e5400,0x13fd800,0x13fdc00,0x13fe000,0x13fe400,0x13fe801,0x1417801
.long 0x1416800,0x1416c00,0x1417000,0x1417400,0x0,0x0,0x0,0x0
.long 0x57800,0x57880,0x57900,0x57980,0x57a00,0x0,0x0,0x0
.long 0x1368c00,0x1369000,0x1369400,0x1369800,0x1369c01,0x1382c01,0x1381c00,0x1382000
.long 0x1382400,0x1382800,0x139ac00,0x139b000,0x139b400,0x139b800,0x139bc01,0x13b4c01
.long 0x13b3c00,0x13b4000,0x13b4400,0x13b4800,0x0,0x0,0x0,0x0
.long 0x57a80,0x57b00,0x57b80,0x57c00,0x57c80,0x0,0x0,0x0
.long 0x13ccc00,0x13cd000,0x13cd400,0x13cd800,0x13cdc01,0x13e6c01,0x13e5c00,0x13e6000
.long 0x13e6400,0x13e6800,0x13fec00,0x13ff000,0x13ff400,0x13ff800,0x13ffc01,0x1418c01
.long 0x1417c00,0x1418000,0x1418400,0x1418800,0x0,0x0,0x0,0x0
.long 0x5000,0x5080,0x5100,0x5180,0x5200,0x0,0x0,0x0
.long 0x136a000,0x136a400,0x136a800,0x136ac00,0x136b001,0x1384001,0x1383000,0x1383400
.long 0x1383800,0x1383c00,0x139c000,0x139c400,0x139c800,0x139cc00,0x139d001,0x13b6001
.long 0x13b5000,0x13b5400,0x13b5800,0x13b5c00,0x0,0x0,0x0,0x0
.long 0x5280,0x5300,0x5380,0x5400,0x5480,0x0,0x0,0x0
.long 0x13ce000,0x13ce400,0x13ce800,0x13cec00,0x13cf001,0x13e8001,0x13e7000,0x13e7400
.long 0x13e7800,0x13e7c00,0x1400000,0x1400400,0x1400800,0x1400c00,0x1401001,0x141a001
.long 0x1419000,0x1419400,0x1419800,0x1419c00,0x0,0x0,0x0,0x0
.long 0x37000,0x37080,0x37100,0x37180,0x37200,0x0,0x0,0x0
.long 0x136b400,0x136b800,0x136bc00,0x136c000,0x136c401,0x1385401,0x1384400,0x1384800
.long 0x1384c00,0x1385000,0x139d400,0x139d800,0x139dc00,0x139e000,0x139e401,0x13b7401
.long 0x13b6400,0x13b6800,0x13b6c00,0x13b7000,0x0,0x0,0x0,0x0
.long 0x37280,0x37300,0x37380,0x37400,0x37480,0x0,0x0,0x0
.long 0x13cf400,0x13cf800,0x13cfc00,0x13d0000,0x13d0401,0x13e9401,0x13e8400,0x13e8800
.long 0x13e8c00,0x13e9000,0x1401400,0x1401800,0x1401c00,0x1402000,0x1402401,0x141b401
.long 0x141a400,0x141a800,0x141ac00,0x141b000,0x0,0x0,0x0,0x0
.long 0x64000,0x64080,0x64100,0x64180,0x64200,0x0,0x0,0x0
.long 0x136c800,0x136cc00,0x136d000,0x136d400,0x136d801,0x1386801,0x1385800,0x1385c00
.long 0x1386000,0x1386400,0x139e800,0x139ec00,0x139f000,0x139f400,0x139f801,0x13b8801
.long 0x13b7800,0x13b7c00,0x13b8000,0x13b8400,0x0,0x0,0x0,0x0
.long 0x64280,0x64300,0x64380,0x64400,0x64480,0x0,0x0,0x0
.long 0x13d0800,0x13d0c00,0x13d1000,0x13d1400,0x13d1801,0x13ea801,0x13e9800,0x13e9c00
.long 0x13ea000,0x13ea400,0x1402800,0x1402c00,0x1403000,0x1403400,0x1403801,0x141c801
.long 0x141b800,0x141bc00,0x141c000,0x141c400,0x0,0x0,0x0,0x0
.long 0x70800,0x70880,0x70900,0x70980,0x70a00,0x0,0x0,0x0
.long 0x136dc00,0x136e000,0x136e400,0x136e800,0x136ec01,0x1387c01,0x1386c00,0x1387000
.long 0x1387400,0x1387800,0x139fc00,0x13a0000,0x13a0400,0x13a0800,0x13a0c01,0x13b9c01
.long 0x13b8c00,0x13b9000,0x13b9400,0x13b9800,0x0,0x0,0x0,0x0
.long 0x70a80,0x70b00,0x70b80,0x70c00,0x70c80,0x0,0x0,0x0
.long 0x13d1c00,0x13d2000,0x13d2400,0x13d2800,0x13d2c01,0x13ebc01,0x13eac00,0x13eb000
.long 0x13eb400,0x13eb800,0x1403c00,0x1404000,0x1404400,0x1404800,0x1404c01,0x141dc01
.long 0x141cc00,0x141d000,0x141d400,0x141d800,0x0,0x0,0x0,0x0
.long 0x7d000,0x7d080,0x7d100,0x7d180,0x7d200,0x0,0x0,0x0
.long 0x136f000,0x136f400,0x136f800,0x136fc00,0x1370001,0x1389001,0x1388000,0x1388400
.long 0x1388800,0x1388c00,0x13a1000,0x13a1400,0x13a1800,0x13a1c00,0x13a2001,0x13bb001
.long 0x13ba000,0x13ba400,0x13ba800,0x13bac00,0x0,0x0,0x0,0x0
.long 0x7d280,0x7d300,0x7d380,0x7d400,0x7d480,0x0,0x0,0x0
.long 0x13d3000,0x13d3400,0x13d3800,0x13d3c00,0x13d4001,0x13ed001,0x13ec000,0x13ec400
.long 0x13ec800,0x13ecc00,0x1405000,0x1405400,0x1405800,0x1405c00,0x1406001,0x141f001
.long 0x141e000,0x141e400,0x141e800,0x141ec00,0x0,0x0,0x0,0x0
.long 0x89800,0x89880,0x89900,0x89980,0x89a00,0x0,0x0,0x0
.long 0x1370400,0x1370800,0x1370c00,0x1371000,0x1371401,0x138a401,0x1389400,0x1389800
.long 0x1389c00,0x138a000,0x13a2400,0x13a2800,0x13a2c00,0x13a3000,0x13a3401,0x13bc401
.long 0x13bb400,0x13bb800,0x13bbc00,0x13bc000,0x0,0x0,0x0,0x0
.long 0x89a80,0x89b00,0x89b80,0x89c00,0x89c80,0x0,0x0,0x0
.long 0x13d4400,0x13d4800,0x13d4c00,0x13d5000,0x13d5401,0x13ee401,0x13ed400,0x13ed800
.long 0x13edc00,0x13ee000,0x1406400,0x1406800,0x1406c00,0x1407000,0x1407401,0x1420401
.long 0x141f400,0x141f800,0x141fc00,0x1420000,0x0,0x0,0x0,0x0
.long 0x96000,0x96080,0x96100,0x96180,0x96200,0x0,0x0,0x0
.long 0x1371800,0x1371c00,0x1372000,0x1372400,0x1372801,0x138b801,0x138a800,0x138ac00
.long 0x138b000,0x138b400,0x13a3800,0x13a3c00,0x13a4000,0x13a4400,0x13a4801,0x13bd801
.long 0x13bc800,0x13bcc00,0x13bd000,0x13bd400,0x0,0x0,0x0,0x0
.long 0x96280,0x96300,0x96380,0x96400,0x96480,0x0,0x0,0x0
.long 0x13d5800,0x13d5c00,0x13d6000,0x13d6400,0x13d6801,0x13ef801,0x13ee800,0x13eec00
.long 0x13ef000,0x13ef400,0x1407800,0x1407c00,0x1408000,0x1408400,0x1408801,0x1421801
.long 0x1420800,0x1420c00,0x1421000,0x1421400,0x0,0x0,0x0,0x0
.long 0xa2800,0xa2880,0xa2900,0xa2980,0xa2a00,0x0,0x0,0x0
.long 0x1372c00,0x1373000,0x1373400,0x1373800,0x1373c01,0x138cc01,0x138bc00,0x138c000
.long 0x138c400,0x138c800,0x13a4c00,0x13a5000,0x13a5400,0x13a5800,0x13a5c01,0x13bec01
.long 0x13bdc00,0x13be000,0x13be400,0x13be800,0x0,0x0,0x0,0x0
.long 0xa2a80,0xa2b00,0xa2b80,0xa2c00,0xa2c80,0x0,0x0,0x0
.long 0x13d6c00,0x13d7000,0x13d7400,0x13d7800,0x13d7c01,0x13f0c01,0x13efc00,0x13f0000
.long 0x13f0400,0x13f0800,0x1408c00,0x1409000,0x1409400,0x1409800,0x1409c01,0x1422c01
.long 0x1421c00,0x1422000,0x1422400,0x1422800,0x0,0x0,0x0,0x0
.long 0xaf000,0xaf080,0xaf100,0xaf180,0xaf200,0x0,0x0,0x0
.long 0x1374000,0x1374400,0x1374800,0x1374c00,0x1375001,0x138e001,0x138d000,0x138d400
.long 0x138d800,0x138dc00,0x13a6000,0x13a6400,0x13a6800,0x13a6c00,0x13a7001,0x13c0001
.long 0x13bf000,0x13bf400,0x13bf800,0x13bfc00,0x0,0x0,0x0,0x0
.long 0xaf280,0xaf300,0xaf380,0xaf400,0xaf480,0x0,0x0,0x0
.long 0x13d8000,0x13d8400,0x13d8800,0x13d8c00,0x13d9001,0x13f2001,0x13f1000,0x13f1400
.long 0x13f1800,0x13f1c00,0x140a000,0x140a400,0x140a800,0x140ac00,0x140b001,0x1424001
.long 0x1423000,0x1423400,0x1423800,0x1423c00,0x0,0x0,0x0,0x0
.long 0xbb800,0xbb880,0xbb900,0xbb980,0xbba00,0x0,0x0,0x0
.long 0x1375400,0x1375800,0x1375c00,0x1376000,0x1376401,0x138f401,0x138e400,0x138e800
.long 0x138ec00,0x138f000,0x13a7400,0x13a7800,0x13a7c00,0x13a8000,0x13a8401,0x13c1401
.long 0x13c0400,0x13c0800,0x13c0c00,0x13c1000,0x0,0x0,0x0,0x0
.long 0xbba80,0xbbb00,0xbbb80,0xbbc00,0xbbc80,0x0,0x0,0x0
.long 0x13d9400,0x13d9800,0x13d9c00,0x13da000,0x13da401,0x13f3401,0x13f2400,0x13f2800
.long 0x13f2c00,0x13f3000,0x140b400,0x140b800,0x140bc00,0x140c000,0x140c401,0x1425401
.long 0x1424400,0x1424800,0x1424c00,0x1425000,0x0,0x0,0x0,0x0
.long 0x69000,0x69080,0x69100,0x69180,0x69200,0x0,0x0,0x0
.long 0x1376800,0x1376c00,0x1377000,0x1377400,0x1377801,0x1390801,0x138f800,0x138fc00
.long 0x1390000,0x1390400,0x13a8800,0x13a8c00,0x13a9000,0x13a9400,0x13a9801,0x13c2801
.long 0x13c1800,0x13c1c00,0x13c2000,0x13c2400,0x0,0x0,0x0,0x0
.long 0x69280,0x69300,0x69380,0x69400,0x69480,0x0,0x0,0x0
.long 0x13da800,0x13dac00,0x13db000,0x13db400,0x13db801,0x13f4801,0x13f3800,0x13f3c00
.long 0x13f4000,0x13f4400,0x140c800,0x140cc00,0x140d000,0x140d400,0x140d801,0x1426801
.long 0x1425800,0x1425c00,0x1426000,0x1426400,0x0,0x0,0x0,0x0
.long 0x9b000,0x9b080,0x9b100,0x9b180,0x9b200,0x0,0x0,0x0
.long 0x1377c00,0x1378000,0x1378400,0x1378800,0x1378c01,0x1391c01,0x1390c00,0x1391000
.long 0x1391400,0x1391800,0x13a9c00,0x13aa000,0x13aa400,0x13aa800,0x13aac01,0x13c3c01
.long 0x13c2c00,0x13c3000,0x13c3400,0x13c3800,0x0,0x0,0x0,0x0
.long 0x9b280,0x9b300,0x9b380,0x9b400,0x9b480,0x0,0x0,0x0
.long 0x13dbc00,0x13dc000,0x13dc400,0x13dc800,0x13dcc01,0x13f5c01,0x13f4c00,0x13f5000
.long 0x13f5400,0x13f5800,0x140dc00,0x140e000,0x140e400,0x140e800,0x140ec01,0x1427c01
.long 0x1426c00,0x1427000,0x1427400,0x1427800,0x0,0x0,0x0,0x0
.long 0x0,0x80,0x100,0x180,0x200,0x0,0x0,0x0
.long 0x1428000,0x1428400,0x1428800,0x1428c00,0x1429000,0x1429400,0x1429801,0x144c801
.long 0x144b000,0x144b400,0x144b800,0x144bc00,0x144c000,0x144c400,0x146e000,0x146e400
.long 0x146e800,0x146ec00,0x146f000,0x146f400,0x0,0x0,0x0,0x0
.long 0x280,0x300,0x380,0x400,0x480,0x0,0x0,0x0
.long 0x146f801,0x1492801,0x1491000,0x1491400,0x1491800,0x1491c00,0x1492000,0x1492400
.long 0x14b4000,0x14b4400,0x14b4800,0x14b4c00,0x14b5000,0x14b5400,0x14b5801,0x14d8801
.long 0x14d7000,0x14d7400,0x14d7800,0x14d7c00,0x0,0x0,0x0,0x0
.long 0x500,0x580,0x600,0x680,0x700,0x0,0x0,0x0
.long 0x14d8000,0x14d8400,0x14fa000,0x14fa400,0x14fa800,0x14fac00,0x14fb000,0x14fb400
.long 0x1518000,0x1518400,0x1518800,0x1518c00,0x1519000,0x1519400,0x1536000,0x1536400
.long 0x1536800,0x1536c00,0x1537000,0x1537400,0x0,0x0,0x0,0x0
.long 0x780,0x800,0x880,0x900,0x980,0x0,0x0,0x0
.long 0x1537801,0x155a801,0x1559000,0x1559400,0x1559800,0x1559c00,0x155a000,0x155a400
.long 0x157c000,0x157c400,0x157c800,0x157cc00,0x157d000,0x157d400,0x157d801,0x15a0801
.long 0x159f000,0x159f400,0x159f800,0x159fc00,0x0,0x0,0x0,0x0
.long 0xa00,0xa80,0xb00,0xb80,0xc00,0x0,0x0,0x0
.long 0x15a0000,0x15a0400,0x15c2000,0x15c2400,0x15c2800,0x15c2c00,0x15c3000,0x15c3400
.long 0x15c3801,0x15e6801,0x15e5000,0x15e5400,0x15e5800,0x15e5c00,0x15e6000,0x15e6400
.long 0x1608000,0x1608400,0x1608800,0x1608c00,0x0,0x0,0x0,0x0
.long 0xc80,0xd00,0x1b000,0x1b080,0x1b100,0x0,0x0,0x0
.long 0x1609000,0x1609400,0x1626000,0x1626400,0x1626800,0x1626c00,0x1627000,0x1627400
.long 0x1429c00,0x142a000,0x142a400,0x142a800,0x142ac00,0x142b000,0x142b401,0x144e401
.long 0x144cc00,0x144d000,0x144d400,0x144d800,0x0,0x0,0x0,0x0
.long 0x1b180,0x1b200,0x1b280,0x1b300,0x1b380,0x0,0x0,0x0
.long 0x144dc00,0x144e000,0x146fc00,0x1470000,0x1470400,0x1470800,0x1470c00,0x1471000
.long 0x1471401,0x1494401,0x1492c00,0x1493000,0x1493400,0x1493800,0x1493c00,0x1494000
.long 0x14b5c00,0x14b6000,0x14b6400,0x14b6800,0x0,0x0,0x0,0x0
.long 0x1b400,0x1b480,0x1b500,0x1b580,0x1b600,0x0,0x0,0x0
.long 0x14b6c00,0x14b7000,0x14b7401,0x14da401,0x14d8c00,0x14d9000,0x14d9400,0x14d9800
.long 0x14d9c00,0x14da000,0x14fb800,0x14fbc00,0x14fc000,0x14fc400,0x14fc800,0x14fcc00
.long 0x1519800,0x1519c00,0x151a000,0x151a400,0x0,0x0,0x0,0x0
.long 0x1b680,0x1b700,0x1b780,0x1b800,0x1b880,0x0,0x0,0x0
.long 0x151a800,0x151ac00,0x1537c00,0x1538000,0x1538400,0x1538800,0x1538c00,0x1539000
.long 0x1539401,0x155c401,0x155ac00,0x155b000,0x155b400,0x155b800,0x155bc00,0x155c000
.long 0x157dc00,0x157e000,0x157e400,0x157e800,0x0,0x0,0x0,0x0
.long 0x1b900,0x1b980,0x1ba00,0x1ba80,0x1bb00,0x0,0x0,0x0
.long 0x157ec00,0x157f000,0x157f401,0x15a2401,0x15a0c00,0x15a1000,0x15a1400,0x15a1800
.long 0x15a1c00,0x15a2000,0x15c3c00,0x15c4000,0x15c4400,0x15c4800,0x15c4c00,0x15c5000
.long 0x15c5401,0x15e8401,0x15e6c00,0x15e7000,0x0,0x0,0x0,0x0
.long 0x1bb80,0x1bc00,0x1bc80,0x1bd00,0x36000,0x0,0x0,0x0
.long 0x15e7400,0x15e7800,0x15e7c00,0x15e8000,0x1609800,0x1609c00,0x160a000,0x160a400
.long 0x160a800,0x160ac00,0x1627800,0x1627c00,0x1628000,0x1628400,0x1628800,0x1628c00
.long 0x142b800,0x142bc00,0x142c000,0x142c400,0x0,0x0,0x0,0x0
.long 0x36080,0x36100,0x36180,0x36200,0x36280,0x0,0x0,0x0
.long 0x142c800,0x142cc00,0x142d001,0x1450001,0x144e800,0x144ec00,0x144f000,0x144f400
.long 0x144f800,0x144fc00,0x1471800,0x1471c00,0x1472000,0x1472400,0x1472800,0x1472c00
.long 0x1473001,0x1496001,0x1494800,0x1494c00,0x0,0x0,0x0,0x0
.long 0x36300,0x36380,0x36400,0x36480,0x36500,0x0,0x0,0x0
.long 0x1495000,0x1495400,0x1495800,0x1495c00,0x14b7800,0x14b7c00,0x14b8000,0x14b8400
.long 0x14b8800,0x14b8c00,0x14b9001,0x14dc001,0x14da800,0x14dac00,0x14db000,0x14db400
.long 0x14db800,0x14dbc00,0x14fd000,0x14fd400,0x0,0x0,0x0,0x0
.long 0x36580,0x36600,0x36680,0x36700,0x36780,0x0,0x0,0x0
.long 0x14fd800,0x14fdc00,0x14fe000,0x14fe400,0x151b000,0x151b400,0x151b800,0x151bc00
.long 0x151c000,0x151c400,0x1539800,0x1539c00,0x153a000,0x153a400,0x153a800,0x153ac00
.long 0x153b001,0x155e001,0x155c800,0x155cc00,0x0,0x0,0x0,0x0
.long 0x36800,0x36880,0x36900,0x36980,0x36a00,0x0,0x0,0x0
.long 0x155d000,0x155d400,0x155d800,0x155dc00,0x157f800,0x157fc00,0x1580000,0x1580400
.long 0x1580800,0x1580c00,0x1581001,0x15a4001,0x15a2800,0x15a2c00,0x15a3000,0x15a3400
.long 0x15a3800,0x15a3c00,0x15c5800,0x15c5c00,0x0,0x0,0x0,0x0
.long 0x36a80,0x36b00,0x36b80,0x36c00,0x36c80,0x0,0x0,0x0
.long 0x15c6000,0x15c6400,0x15c6800,0x15c6c00,0x15c7001,0x15ea001,0x15e8800,0x15e8c00
.long 0x15e9000,0x15e9400,0x15e9800,0x15e9c00,0x160b000,0x160b400,0x160b800,0x160bc00
.long 0x160c000,0x160c400,0x1629000,0x1629400,0x0,0x0,0x0,0x0
.long 0x36d00,0x51000,0x51080,0x51100,0x51180,0x0,0x0,0x0
.long 0x1629800,0x1629c00,0x162a000,0x162a400,0x142d400,0x142d800,0x142dc00,0x142e000
.long 0x142e400,0x142e800,0x142ec01,0x1451c01,0x1450400,0x1450800,0x1450c00,0x1451000
.long 0x1451400,0x1451800,0x1473400,0x1473800,0x0,0x0,0x0,0x0
.long 0x51200,0x51280,0x51300,0x51380,0x51400,0x0,0x0,0x0
.long 0x1473c00,0x1474000,0x1474400,0x1474800,0x1474c01,0x1497c01,0x1496400,0x1496800
.long 0x1496c00,0x1497000,0x1497400,0x1497800,0x14b9400,0x14b9800,0x14b9c00,0x14ba000
.long 0x14ba400,0x14ba800,0x14bac01,0x14ddc01,0x0,0x0,0x0,0x0
.long 0x51480,0x51500,0x51580,0x51600,0x51680,0x0,0x0,0x0
.long 0x14dc400,0x14dc800,0x14dcc00,0x14dd000,0x14dd400,0x14dd800,0x14fe800,0x14fec00
.long 0x14ff000,0x14ff400,0x14ff800,0x14ffc00,0x151c800,0x151cc00,0x151d000,0x151d400
.long 0x151d800,0x151dc00,0x153b400,0x153b800,0x0,0x0,0x0,0x0
.long 0x51700,0x51780,0x51800,0x51880,0x51900,0x0,0x0,0x0
.long 0x153bc00,0x153c000,0x153c400,0x153c800,0x153cc01,0x155fc01,0x155e400,0x155e800
.long 0x155ec00,0x155f000,0x155f400,0x155f800,0x1581400,0x1581800,0x1581c00,0x1582000
.long 0x1582400,0x1582800,0x1582c01,0x15a5c01,0x0,0x0,0x0,0x0
.long 0x51980,0x51a00,0x51a80,0x51b00,0x51b80,0x0,0x0,0x0
.long 0x15a4400,0x15a4800,0x15a4c00,0x15a5000,0x15a5400,0x15a5800,0x15c7400,0x15c7800
.long 0x15c7c00,0x15c8000,0x15c8400,0x15c8800,0x15c8c01,0x15ebc01,0x15ea400,0x15ea800
.long 0x15eac00,0x15eb000,0x15eb400,0x15eb800,0x0,0x0,0x0,0x0
.long 0x51c00,0x51c80,0x51d00,0x6c000,0x6c080,0x0,0x0,0x0
.long 0x160c800,0x160cc00,0x160d000,0x160d400,0x160d800,0x160dc00,0x162a800,0x162ac00
.long 0x162b000,0x162b400,0x162b800,0x162bc00,0x142f000,0x142f400,0x142f800,0x142fc00
.long 0x1430000,0x1430400,0x1430801,0x1453801,0x0,0x0,0x0,0x0
.long 0x6c100,0x6c180,0x6c200,0x6c280,0x6c300,0x0,0x0,0x0
.long 0x1452000,0x1452400,0x1452800,0x1452c00,0x1453000,0x1453400,0x1475000,0x1475400
.long 0x1475800,0x1475c00,0x1476000,0x1476400,0x1476801,0x1499801,0x1498000,0x1498400
.long 0x1498800,0x1498c00,0x1499000,0x1499400,0x0,0x0,0x0,0x0
.long 0x6c380,0x6c400,0x6c480,0x6c500,0x6c580,0x0,0x0,0x0
.long 0x14bb000,0x14bb400,0x14bb800,0x14bbc00,0x14bc000,0x14bc400,0x14bc801,0x14df801
.long 0x14de000,0x14de400,0x14de800,0x14dec00,0x14df000,0x14df400,0x1500000,0x1500400
.long 0x1500800,0x1500c00,0x1501000,0x1501400,0x0,0x0,0x0,0x0
.long 0x6c600,0x6c680,0x6c700,0x6c780,0x6c800,0x0,0x0,0x0
.long 0x151e000,0x151e400,0x151e800,0x151ec00,0x151f000,0x151f400,0x153d000,0x153d400
.long 0x153d800,0x153dc00,0x153e000,0x153e400,0x153e801,0x1561801,0x1560000,0x1560400
.long 0x1560800,0x1560c00,0x1561000,0x1561400,0x0,0x0,0x0,0x0
.long 0x6c880,0x6c900,0x6c980,0x6ca00,0x6ca80,0x0,0x0,0x0
.long 0x1583000,0x1583400,0x1583800,0x1583c00,0x1584000,0x1584400,0x1584801,0x15a7801
.long 0x15a6000,0x15a6400,0x15a6800,0x15a6c00,0x15a7000,0x15a7400,0x15c9000,0x15c9400
.long 0x15c9800,0x15c9c00,0x15ca000,0x15ca400,0x0,0x0,0x0,0x0
.long 0x6cb00,0x6cb80,0x6cc00,0x6cc80,0x6cd00,0x0,0x0,0x0
.long 0x15ca801,0x15ed801,0x15ec000,0x15ec400,0x15ec800,0x15ecc00,0x15ed000,0x15ed400
.long 0x160e000,0x160e400,0x160e800,0x160ec00,0x160f000,0x160f400,0x162c000,0x162c400
.long 0x162c800,0x162cc00,0x162d000,0x162d400,0x0,0x0,0x0,0x0
.long 0x87000,0x87080,0x87100,0x87180,0x87200,0x0,0x0,0x0
.long 0x1430c00,0x1431000,0x1431400,0x1431800,0x1431c00,0x1432000,0x1432401,0x1455401
.long 0x1453c00,0x1454000,0x1454400,0x1454800,0x1454c00,0x1455000,0x1476c00,0x1477000
.long 0x1477400,0x1477800,0x1477c00,0x1478000,0x0,0x0,0x0,0x0
.long 0x87280,0x87300,0x87380,0x87400,0x87480,0x0,0x0,0x0
.long 0x1478401,0x149b401,0x1499c00,0x149a000,0x149a400,0x149a800,0x149ac00,0x149b000
.long 0x14bcc00,0x14bd000,0x14bd400,0x14bd800,0x14bdc00,0x14be000,0x14be401,0x14e1401
.long 0x14dfc00,0x14e0000,0x14e0400,0x14e0800,0x0,0x0,0x0,0x0
.long 0x87500,0x87580,0x87600,0x87680,0x87700,0x0,0x0,0x0
.long 0x14e0c00,0x14e1000,0x1501800,0x1501c00,0x1502000,0x1502400,0x1502800,0x1502c00
.long 0x151f800,0x151fc00,0x1520000,0x1520400,0x1520800,0x1520c00,0x153ec00,0x153f000
.long 0x153f400,0x153f800,0x153fc00,0x1540000,0x0,0x0,0x0,0x0
.long 0x87780,0x87800,0x87880,0x87900,0x87980,0x0,0x0,0x0
.long 0x1540401,0x1563401,0x1561c00,0x1562000,0x1562400,0x1562800,0x1562c00,0x1563000
.long 0x1584c00,0x1585000,0x1585400,0x1585800,0x1585c00,0x1586000,0x1586401,0x15a9401
.long 0x15a7c00,0x15a8000,0x15a8400,0x15a8800,0x0,0x0,0x0,0x0
.long 0x87a00,0x87a80,0x87b00,0x87b80,0x87c00,0x0,0x0,0x0
.long 0x15a8c00,0x15a9000,0x15cac00,0x15cb000,0x15cb400,0x15cb800,0x15cbc00,0x15cc000
.long 0x15cc401,0x15ef401,0x15edc00,0x15ee000,0x15ee400,0x15ee800,0x15eec00,0x15ef000
.long 0x160f800,0x160fc00,0x1610000,0x1610400,0x0,0x0,0x0,0x0
.long 0x87c80,0x87d00,0xa2000,0xa2080,0xa2100,0x0,0x0,0x0
.long 0x1610800,0x1610c00,0x162d800,0x162dc00,0x162e000,0x162e400,0x162e800,0x162ec00
.long 0x1432800,0x1432c00,0x1433000,0x1433400,0x1433800,0x1433c00,0x1434001,0x1457001
.long 0x1455800,0x1455c00,0x1456000,0x1456400,0x0,0x0,0x0,0x0
.long 0xa2180,0xa2200,0xa2280,0xa2300,0xa2380,0x0,0x0,0x0
.long 0x1456800,0x1456c00,0x1478800,0x1478c00,0x1479000,0x1479400,0x1479800,0x1479c00
.long 0x147a001,0x149d001,0x149b800,0x149bc00,0x149c000,0x149c400,0x149c800,0x149cc00
.long 0x14be800,0x14bec00,0x14bf000,0x14bf400,0x0,0x0,0x0,0x0
.long 0xa2400,0xa2480,0xa2500,0xa2580,0xa2600,0x0,0x0,0x0
.long 0x14bf800,0x14bfc00,0x14c0001,0x14e3001,0x14e1800,0x14e1c00,0x14e2000,0x14e2400
.long 0x14e2800,0x14e2c00,0x1503000,0x1503400,0x1503800,0x1503c00,0x1504000,0x1504400
.long 0x1521000,0x1521400,0x1521800,0x1521c00,0x0,0x0,0x0,0x0
.long 0xa2680,0xa2700,0xa2780,0xa2800,0xa2880,0x0,0x0,0x0
.long 0x1522000,0x1522400,0x1540800,0x1540c00,0x1541000,0x1541400,0x1541800,0x1541c00
.long 0x1542001,0x1565001,0x1563800,0x1563c00,0x1564000,0x1564400,0x1564800,0x1564c00
.long 0x1586800,0x1586c00,0x1587000,0x1587400,0x0,0x0,0x0,0x0
.long 0xa2900,0xa2980,0xa2a00,0xa2a80,0xa2b00,0x0,0x0,0x0
.long 0x1587800,0x1587c00,0x1588001,0x15ab001,0x15a9800,0x15a9c00,0x15aa000,0x15aa400
.long 0x15aa800,0x15aac00,0x15cc800,0x15ccc00,0x15cd000,0x15cd400,0x15cd800,0x15cdc00
.long 0x15ce001,0x15f1001,0x15ef800,0x15efc00,0x0,0x0,0x0,0x0
.long 0xa2b80,0xa2c00,0xa2c80,0xa2d00,0xbd000,0x0,0x0,0x0
.long 0x15f0000,0x15f0400,0x15f0800,0x15f0c00,0x1611000,0x1611400,0x1611800,0x1611c00
.long 0x1612000,0x1612400,0x162f000,0x162f400,0x162f800,0x162fc00,0x1630000,0x1630400
.long 0x1434400,0x1434800,0x1434c00,0x1435000,0x0,0x0,0x0,0x0
.long 0xbd080,0xbd100,0xbd180,0xbd200,0xbd280,0x0,0x0,0x0
.long 0x1435400,0x1435800,0x1435c01,0x1458c01,0x1457400,0x1457800,0x1457c00,0x1458000
.long 0x1458400,0x1458800,0x147a400,0x147a800,0x147ac00,0x147b000,0x147b400,0x147b800
.long 0x147bc01,0x149ec01,0x149d400,0x149d800,0x0,0x0,0x0,0x0
.long 0xbd300,0xbd380,0xbd400,0xbd480,0xbd500,0x0,0x0,0x0
.long 0x149dc00,0x149e000,0x149e400,0x149e800,0x14c0400,0x14c0800,0x14c0c00,0x14c1000
.long 0x14c1400,0x14c1800,0x14c1c01,0x14e4c01,0x14e3400,0x14e3800,0x14e3c00,0x14e4000
.long 0x14e4400,0x14e4800,0x1504800,0x1504c00,0x0,0x0,0x0,0x0
.long 0xbd580,0xbd600,0xbd680,0xbd700,0xbd780,0x0,0x0,0x0
.long 0x1505000,0x1505400,0x1505800,0x1505c00,0x1522800,0x1522c00,0x1523000,0x1523400
.long 0x1523800,0x1523c00,0x1542400,0x1542800,0x1542c00,0x1543000,0x1543400,0x1543800
.long 0x1543c01,0x1566c01,0x1565400,0x1565800,0x0,0x0,0x0,0x0
.long 0xbd800,0xbd880,0xbd900,0xbd980,0xbda00,0x0,0x0,0x0
.long 0x1565c00,0x1566000,0x1566400,0x1566800,0x1588400,0x1588800,0x1588c00,0x1589000
.long 0x1589400,0x1589800,0x1589c01,0x15acc01,0x15ab400,0x15ab800,0x15abc00,0x15ac000
.long 0x15ac400,0x15ac800,0x15ce400,0x15ce800,0x0,0x0,0x0,0x0
.long 0xbda80,0xbdb00,0xbdb80,0xbdc00,0xbdc80,0x0,0x0,0x0
.long 0x15cec00,0x15cf000,0x15cf400,0x15cf800,0x15cfc01,0x15f2c01,0x15f1400,0x15f1800
.long 0x15f1c00,0x15f2000,0x15f2400,0x15f2800,0x1612800,0x1612c00,0x1613000,0x1613400
.long 0x1613800,0x1613c00,0x1630800,0x1630c00,0x0,0x0,0x0,0x0
.long 0xbdd00,0xd8000,0xd8080,0xd8100,0xd8180,0x0,0x0,0x0
.long 0x1631000,0x1631400,0x1631800,0x1631c00,0x1436000,0x1436400,0x1436800,0x1436c00
.long 0x1437000,0x1437400,0x1437801,0x145a801,0x1459000,0x1459400,0x1459800,0x1459c00
.long 0x145a000,0x145a400,0x147c000,0x147c400,0x0,0x0,0x0,0x0
.long 0xd8200,0xd8280,0xd8300,0xd8380,0xd8400,0x0,0x0,0x0
.long 0x147c800,0x147cc00,0x147d000,0x147d400,0x147d801,0x14a0801,0x149f000,0x149f400
.long 0x149f800,0x149fc00,0x14a0000,0x14a0400,0x14c2000,0x14c2400,0x14c2800,0x14c2c00
.long 0x14c3000,0x14c3400,0x14c3801,0x14e6801,0x0,0x0,0x0,0x0
.long 0xd8480,0xd8500,0xd8580,0xd8600,0xd8680,0x0,0x0,0x0
.long 0x14e5000,0x14e5400,0x14e5800,0x14e5c00,0x14e6000,0x14e6400,0x1506000,0x1506400
.long 0x1506800,0x1506c00,0x1507000,0x1507400,0x1524000,0x1524400,0x1524800,0x1524c00
.long 0x1525000,0x1525400,0x1544000,0x1544400,0x0,0x0,0x0,0x0
.long 0xd8700,0xd8780,0xd8800,0xd8880,0xd8900,0x0,0x0,0x0
.long 0x1544800,0x1544c00,0x1545000,0x1545400,0x1545801,0x1568801,0x1567000,0x1567400
.long 0x1567800,0x1567c00,0x1568000,0x1568400,0x158a000,0x158a400,0x158a800,0x158ac00
.long 0x158b000,0x158b400,0x158b801,0x15ae801,0x0,0x0,0x0,0x0
.long 0xd8980,0xd8a00,0xd8a80,0xd8b00,0xd8b80,0x0,0x0,0x0
.long 0x15ad000,0x15ad400,0x15ad800,0x15adc00,0x15ae000,0x15ae400,0x15d0000,0x15d0400
.long 0x15d0800,0x15d0c00,0x15d1000,0x15d1400,0x15d1801,0x15f4801,0x15f3000,0x15f3400
.long 0x15f3800,0x15f3c00,0x15f4000,0x15f4400,0x0,0x0,0x0,0x0
.long 0xd8c00,0xd8c80,0xd8d00,0xf3000,0xf3080,0x0,0x0,0x0
.long 0x1614000,0x1614400,0x1614800,0x1614c00,0x1615000,0x1615400,0x1632000,0x1632400
.long 0x1632800,0x1632c00,0x1633000,0x1633400,0x1437c00,0x1438000,0x1438400,0x1438800
.long 0x1438c00,0x1439000,0x1439401,0x145c401,0x0,0x0,0x0,0x0
.long 0xf3100,0xf3180,0xf3200,0xf3280,0xf3300,0x0,0x0,0x0
.long 0x145ac00,0x145b000,0x145b400,0x145b800,0x145bc00,0x145c000,0x147dc00,0x147e000
.long 0x147e400,0x147e800,0x147ec00,0x147f000,0x147f401,0x14a2401,0x14a0c00,0x14a1000
.long 0x14a1400,0x14a1800,0x14a1c00,0x14a2000,0x0,0x0,0x0,0x0
.long 0xf3380,0xf3400,0xf3480,0xf3500,0xf3580,0x0,0x0,0x0
.long 0x14c3c00,0x14c4000,0x14c4400,0x14c4800,0x14c4c00,0x14c5000,0x14c5401,0x14e8401
.long 0x14e6c00,0x14e7000,0x14e7400,0x14e7800,0x14e7c00,0x14e8000,0x1507800,0x1507c00
.long 0x1508000,0x1508400,0x1508800,0x1508c00,0x0,0x0,0x0,0x0
.long 0xf3600,0xf3680,0xf3700,0xf3780,0xf3800,0x0,0x0,0x0
.long 0x1525800,0x1525c00,0x1526000,0x1526400,0x1526800,0x1526c00,0x1545c00,0x1546000
.long 0x1546400,0x1546800,0x1546c00,0x1547000,0x1547401,0x156a401,0x1568c00,0x1569000
.long 0x1569400,0x1569800,0x1569c00,0x156a000,0x0,0x0,0x0,0x0
.long 0xf3880,0xf3900,0xf3980,0xf3a00,0xf3a80,0x0,0x0,0x0
.long 0x158bc00,0x158c000,0x158c400,0x158c800,0x158cc00,0x158d000,0x158d401,0x15b0401
.long 0x15aec00,0x15af000,0x15af400,0x15af800,0x15afc00,0x15b0000,0x15d1c00,0x15d2000
.long 0x15d2400,0x15d2800,0x15d2c00,0x15d3000,0x0,0x0,0x0,0x0
.long 0xf3b00,0xf3b80,0xf3c00,0xf3c80,0xf3d00,0x0,0x0,0x0
.long 0x15d3401,0x15f6401,0x15f4c00,0x15f5000,0x15f5400,0x15f5800,0x15f5c00,0x15f6000
.long 0x1615800,0x1615c00,0x1616000,0x1616400,0x1616800,0x1616c00,0x1633800,0x1633c00
.long 0x1634000,0x1634400,0x1634800,0x1634c00,0x0,0x0,0x0,0x0
.long 0x10e000,0x10e080,0x10e100,0x10e180,0x10e200,0x0,0x0,0x0
.long 0x1439800,0x1439c00,0x143a000,0x143a400,0x143a800,0x143ac00,0x143b001,0x145e001
.long 0x145c800,0x145cc00,0x145d000,0x145d400,0x145d800,0x145dc00,0x147f800,0x147fc00
.long 0x1480000,0x1480400,0x1480800,0x1480c00,0x0,0x0,0x0,0x0
.long 0x10e280,0x10e300,0x10e380,0x10e400,0x10e480,0x0,0x0,0x0
.long 0x1481001,0x14a4001,0x14a2800,0x14a2c00,0x14a3000,0x14a3400,0x14a3800,0x14a3c00
.long 0x14c5800,0x14c5c00,0x14c6000,0x14c6400,0x14c6800,0x14c6c00,0x14c7001,0x14ea001
.long 0x14e8800,0x14e8c00,0x14e9000,0x14e9400,0x0,0x0,0x0,0x0
.long 0x10e500,0x10e580,0x10e600,0x10e680,0x10e700,0x0,0x0,0x0
.long 0x14e9800,0x14e9c00,0x1509000,0x1509400,0x1509800,0x1509c00,0x150a000,0x150a400
.long 0x1527000,0x1527400,0x1527800,0x1527c00,0x1528000,0x1528400,0x1547800,0x1547c00
.long 0x1548000,0x1548400,0x1548800,0x1548c00,0x0,0x0,0x0,0x0
.long 0x10e780,0x10e800,0x10e880,0x10e900,0x10e980,0x0,0x0,0x0
.long 0x1549001,0x156c001,0x156a800,0x156ac00,0x156b000,0x156b400,0x156b800,0x156bc00
.long 0x158d800,0x158dc00,0x158e000,0x158e400,0x158e800,0x158ec00,0x158f001,0x15b2001
.long 0x15b0800,0x15b0c00,0x15b1000,0x15b1400,0x0,0x0,0x0,0x0
.long 0x10ea00,0x10ea80,0x10eb00,0x10eb80,0x10ec00,0x0,0x0,0x0
.long 0x15b1800,0x15b1c00,0x15d3800,0x15d3c00,0x15d4000,0x15d4400,0x15d4800,0x15d4c00
.long 0x15d5001,0x15f8001,0x15f6800,0x15f6c00,0x15f7000,0x15f7400,0x15f7800,0x15f7c00
.long 0x1617000,0x1617400,0x1617800,0x1617c00,0x0,0x0,0x0,0x0
.long 0x10ec80,0x10ed00,0x129000,0x129080,0x129100,0x0,0x0,0x0
.long 0x1618000,0x1618400,0x1635000,0x1635400,0x1635800,0x1635c00,0x1636000,0x1636400
.long 0x143b400,0x143b800,0x143bc00,0x143c000,0x143c400,0x143c800,0x143cc01,0x145fc01
.long 0x145e400,0x145e800,0x145ec00,0x145f000,0x0,0x0,0x0,0x0
.long 0x129180,0x129200,0x129280,0x129300,0x129380,0x0,0x0,0x0
.long 0x145f400,0x145f800,0x1481400,0x1481800,0x1481c00,0x1482000,0x1482400,0x1482800
.long 0x1482c01,0x14a5c01,0x14a4400,0x14a4800,0x14a4c00,0x14a5000,0x14a5400,0x14a5800
.long 0x14c7400,0x14c7800,0x14c7c00,0x14c8000,0x0,0x0,0x0,0x0
.long 0x129400,0x129480,0x129500,0x129580,0x129600,0x0,0x0,0x0
.long 0x14c8400,0x14c8800,0x14c8c01,0x14ebc01,0x14ea400,0x14ea800,0x14eac00,0x14eb000
.long 0x14eb400,0x14eb800,0x150a800,0x150ac00,0x150b000,0x150b400,0x150b800,0x150bc00
.long 0x1528800,0x1528c00,0x1529000,0x1529400,0x0,0x0,0x0,0x0
.long 0x129680,0x129700,0x129780,0x129800,0x129880,0x0,0x0,0x0
.long 0x1529800,0x1529c00,0x1549400,0x1549800,0x1549c00,0x154a000,0x154a400,0x154a800
.long 0x154ac01,0x156dc01,0x156c400,0x156c800,0x156cc00,0x156d000,0x156d400,0x156d800
.long 0x158f400,0x158f800,0x158fc00,0x1590000,0x0,0x0,0x0,0x0
.long 0x129900,0x129980,0x129a00,0x129a80,0x129b00,0x0,0x0,0x0
.long 0x1590400,0x1590800,0x1590c01,0x15b3c01,0x15b2400,0x15b2800,0x15b2c00,0x15b3000
.long 0x15b3400,0x15b3800,0x15d5400,0x15d5800,0x15d5c00,0x15d6000,0x15d6400,0x15d6800
.long 0x15d6c01,0x15f9c01,0x15f8400,0x15f8800,0x0,0x0,0x0,0x0
.long 0x129b80,0x129c00,0x129c80,0x129d00,0x144000,0x0,0x0,0x0
.long 0x15f8c00,0x15f9000,0x15f9400,0x15f9800,0x1618800,0x1618c00,0x1619000,0x1619400
.long 0x1619800,0x1619c00,0x1636800,0x1636c00,0x1637000,0x1637400,0x1637800,0x1637c00
.long 0x143d000,0x143d400,0x143d800,0x143dc00,0x0,0x0,0x0,0x0
.long 0x144080,0x144100,0x144180,0x144200,0x144280,0x0,0x0,0x0
.long 0x143e000,0x143e400,0x143e801,0x1461801,0x1460000,0x1460400,0x1460800,0x1460c00
.long 0x1461000,0x1461400,0x1483000,0x1483400,0x1483800,0x1483c00,0x1484000,0x1484400
.long 0x1484801,0x14a7801,0x14a6000,0x14a6400,0x0,0x0,0x0,0x0
.long 0x144300,0x144380,0x144400,0x144480,0x144500,0x0,0x0,0x0
.long 0x14a6800,0x14a6c00,0x14a7000,0x14a7400,0x14c9000,0x14c9400,0x14c9800,0x14c9c00
.long 0x14ca000,0x14ca400,0x14ca801,0x14ed801,0x14ec000,0x14ec400,0x14ec800,0x14ecc00
.long 0x14ed000,0x14ed400,0x150c000,0x150c400,0x0,0x0,0x0,0x0
.long 0x144580,0x144600,0x144680,0x144700,0x144780,0x0,0x0,0x0
.long 0x150c800,0x150cc00,0x150d000,0x150d400,0x152a000,0x152a400,0x152a800,0x152ac00
.long 0x152b000,0x152b400,0x154b000,0x154b400,0x154b800,0x154bc00,0x154c000,0x154c400
.long 0x154c801,0x156f801,0x156e000,0x156e400,0x0,0x0,0x0,0x0
.long 0x144800,0x144880,0x144900,0x144980,0x144a00,0x0,0x0,0x0
.long 0x156e800,0x156ec00,0x156f000,0x156f400,0x1591000,0x1591400,0x1591800,0x1591c00
.long 0x1592000,0x1592400,0x1592801,0x15b5801,0x15b4000,0x15b4400,0x15b4800,0x15b4c00
.long 0x15b5000,0x15b5400,0x15d7000,0x15d7400,0x0,0x0,0x0,0x0
.long 0x144a80,0x144b00,0x144b80,0x144c00,0x144c80,0x0,0x0,0x0
.long 0x15d7800,0x15d7c00,0x15d8000,0x15d8400,0x15d8801,0x15fb801,0x15fa000,0x15fa400
.long 0x15fa800,0x15fac00,0x15fb000,0x15fb400,0x161a000,0x161a400,0x161a800,0x161ac00
.long 0x161b000,0x161b400,0x1638000,0x1638400,0x0,0x0,0x0,0x0
.long 0x144d00,0x15f000,0x15f080,0x15f100,0x15f180,0x0,0x0,0x0
.long 0x1638800,0x1638c00,0x1639000,0x1639400,0x143ec00,0x143f000,0x143f400,0x143f800
.long 0x143fc00,0x1440000,0x1440401,0x1463401,0x1461c00,0x1462000,0x1462400,0x1462800
.long 0x1462c00,0x1463000,0x1484c00,0x1485000,0x0,0x0,0x0,0x0
.long 0x15f200,0x15f280,0x15f300,0x15f380,0x15f400,0x0,0x0,0x0
.long 0x1485400,0x1485800,0x1485c00,0x1486000,0x1486401,0x14a9401,0x14a7c00,0x14a8000
.long 0x14a8400,0x14a8800,0x14a8c00,0x14a9000,0x14cac00,0x14cb000,0x14cb400,0x14cb800
.long 0x14cbc00,0x14cc000,0x14cc401,0x14ef401,0x0,0x0,0x0,0x0
.long 0x15f480,0x15f500,0x15f580,0x15f600,0x15f680,0x0,0x0,0x0
.long 0x14edc00,0x14ee000,0x14ee400,0x14ee800,0x14eec00,0x14ef000,0x150d800,0x150dc00
.long 0x150e000,0x150e400,0x150e800,0x150ec00,0x152b800,0x152bc00,0x152c000,0x152c400
.long 0x152c800,0x152cc00,0x154cc00,0x154d000,0x0,0x0,0x0,0x0
.long 0x15f700,0x15f780,0x15f800,0x15f880,0x15f900,0x0,0x0,0x0
.long 0x154d400,0x154d800,0x154dc00,0x154e000,0x154e401,0x1571401,0x156fc00,0x1570000
.long 0x1570400,0x1570800,0x1570c00,0x1571000,0x1592c00,0x1593000,0x1593400,0x1593800
.long 0x1593c00,0x1594000,0x1594401,0x15b7401,0x0,0x0,0x0,0x0
.long 0x15f980,0x15fa00,0x15fa80,0x15fb00,0x15fb80,0x0,0x0,0x0
.long 0x15b5c00,0x15b6000,0x15b6400,0x15b6800,0x15b6c00,0x15b7000,0x15d8c00,0x15d9000
.long 0x15d9400,0x15d9800,0x15d9c00,0x15da000,0x15da401,0x15fd401,0x15fbc00,0x15fc000
.long 0x15fc400,0x15fc800,0x15fcc00,0x15fd000,0x0,0x0,0x0,0x0
.long 0x15fc00,0x15fc80,0x15fd00,0x17a000,0x17a080,0x0,0x0,0x0
.long 0x161b800,0x161bc00,0x161c000,0x161c400,0x161c800,0x161cc00,0x1639800,0x1639c00
.long 0x163a000,0x163a400,0x163a800,0x163ac00,0x1440800,0x1440c00,0x1441000,0x1441400
.long 0x1441800,0x1441c00,0x1442001,0x1465001,0x0,0x0,0x0,0x0
.long 0x17a100,0x17a180,0x17a200,0x17a280,0x17a300,0x0,0x0,0x0
.long 0x1463800,0x1463c00,0x1464000,0x1464400,0x1464800,0x1464c00,0x1486800,0x1486c00
.long 0x1487000,0x1487400,0x1487800,0x1487c00,0x1488001,0x14ab001,0x14a9800,0x14a9c00
.long 0x14aa000,0x14aa400,0x14aa800,0x14aac00,0x0,0x0,0x0,0x0
.long 0x17a380,0x17a400,0x17a480,0x17a500,0x17a580,0x0,0x0,0x0
.long 0x14cc800,0x14ccc00,0x14cd000,0x14cd400,0x14cd800,0x14cdc00,0x14ce001,0x14f1001
.long 0x14ef800,0x14efc00,0x14f0000,0x14f0400,0x14f0800,0x14f0c00,0x150f000,0x150f400
.long 0x150f800,0x150fc00,0x1510000,0x1510400,0x0,0x0,0x0,0x0
.long 0x17a600,0x17a680,0x17a700,0x17a780,0x17a800,0x0,0x0,0x0
.long 0x152d000,0x152d400,0x152d800,0x152dc00,0x152e000,0x152e400,0x154e800,0x154ec00
.long 0x154f000,0x154f400,0x154f800,0x154fc00,0x1550001,0x1573001,0x1571800,0x1571c00
.long 0x1572000,0x1572400,0x1572800,0x1572c00,0x0,0x0,0x0,0x0
.long 0x17a880,0x17a900,0x17a980,0x17aa00,0x17aa80,0x0,0x0,0x0
.long 0x1594800,0x1594c00,0x1595000,0x1595400,0x1595800,0x1595c00,0x1596001,0x15b9001
.long 0x15b7800,0x15b7c00,0x15b8000,0x15b8400,0x15b8800,0x15b8c00,0x15da800,0x15dac00
.long 0x15db000,0x15db400,0x15db800,0x15dbc00,0x0,0x0,0x0,0x0
.long 0x17ab00,0x17ab80,0x17ac00,0x17ac80,0x17ad00,0x0,0x0,0x0
.long 0x15dc001,0x15ff001,0x15fd800,0x15fdc00,0x15fe000,0x15fe400,0x15fe800,0x15fec00
.long 0x161d000,0x161d400,0x161d800,0x161dc00,0x161e000,0x161e400,0x163b000,0x163b400
.long 0x163b800,0x163bc00,0x163c000,0x163c400,0x0,0x0,0x0,0x0
.long 0x195000,0x195080,0x195100,0x195180,0x195200,0x0,0x0,0x0
.long 0x1442400,0x1442800,0x1442c00,0x1443000,0x1443400,0x1443800,0x1443c01,0x1466c01
.long 0x1465400,0x1465800,0x1465c00,0x1466000,0x1466400,0x1466800,0x1488400,0x1488800
.long 0x1488c00,0x1489000,0x1489400,0x1489800,0x0,0x0,0x0,0x0
.long 0x195280,0x195300,0x195380,0x195400,0x195480,0x0,0x0,0x0
.long 0x1489c01,0x14acc01,0x14ab400,0x14ab800,0x14abc00,0x14ac000,0x14ac400,0x14ac800
.long 0x14ce400,0x14ce800,0x14cec00,0x14cf000,0x14cf400,0x14cf800,0x14cfc01,0x14f2c01
.long 0x14f1400,0x14f1800,0x14f1c00,0x14f2000,0x0,0x0,0x0,0x0
.long 0x195500,0x195580,0x195600,0x195680,0x195700,0x0,0x0,0x0
.long 0x14f2400,0x14f2800,0x1510800,0x1510c00,0x1511000,0x1511400,0x1511800,0x1511c00
.long 0x152e800,0x152ec00,0x152f000,0x152f400,0x152f800,0x152fc00,0x1550400,0x1550800
.long 0x1550c00,0x1551000,0x1551400,0x1551800,0x0,0x0,0x0,0x0
.long 0x195780,0x195800,0x195880,0x195900,0x195980,0x0,0x0,0x0
.long 0x1551c01,0x1574c01,0x1573400,0x1573800,0x1573c00,0x1574000,0x1574400,0x1574800
.long 0x1596400,0x1596800,0x1596c00,0x1597000,0x1597400,0x1597800,0x1597c01,0x15bac01
.long 0x15b9400,0x15b9800,0x15b9c00,0x15ba000,0x0,0x0,0x0,0x0
.long 0x195a00,0x195a80,0x195b00,0x195b80,0x195c00,0x0,0x0,0x0
.long 0x15ba400,0x15ba800,0x15dc400,0x15dc800,0x15dcc00,0x15dd000,0x15dd400,0x15dd800
.long 0x15ddc01,0x1600c01,0x15ff400,0x15ff800,0x15ffc00,0x1600000,0x1600400,0x1600800
.long 0x161e800,0x161ec00,0x161f000,0x161f400,0x0,0x0,0x0,0x0
.long 0x195c80,0x195d00,0x1b0000,0x1b0080,0x1b0100,0x0,0x0,0x0
.long 0x161f800,0x161fc00,0x163c800,0x163cc00,0x163d000,0x163d400,0x163d800,0x163dc00
.long 0x1444000,0x1444400,0x1444800,0x1444c00,0x1445000,0x1445400,0x1445801,0x1468801
.long 0x1467000,0x1467400,0x1467800,0x1467c00,0x0,0x0,0x0,0x0
.long 0x1b0180,0x1b0200,0x1b0280,0x1b0300,0x1b0380,0x0,0x0,0x0
.long 0x1468000,0x1468400,0x148a000,0x148a400,0x148a800,0x148ac00,0x148b000,0x148b400
.long 0x148b801,0x14ae801,0x14ad000,0x14ad400,0x14ad800,0x14adc00,0x14ae000,0x14ae400
.long 0x14d0000,0x14d0400,0x14d0800,0x14d0c00,0x0,0x0,0x0,0x0
.long 0x1b0400,0x1b0480,0x1b0500,0x1b0580,0x1b0600,0x0,0x0,0x0
.long 0x14d1000,0x14d1400,0x14d1801,0x14f4801,0x14f3000,0x14f3400,0x14f3800,0x14f3c00
.long 0x14f4000,0x14f4400,0x1512000,0x1512400,0x1512800,0x1512c00,0x1513000,0x1513400
.long 0x1530000,0x1530400,0x1530800,0x1530c00,0x0,0x0,0x0,0x0
.long 0x1b0680,0x1b0700,0x1b0780,0x1b0800,0x1b0880,0x0,0x0,0x0
.long 0x1531000,0x1531400,0x1552000,0x1552400,0x1552800,0x1552c00,0x1553000,0x1553400
.long 0x1553801,0x1576801,0x1575000,0x1575400,0x1575800,0x1575c00,0x1576000,0x1576400
.long 0x1598000,0x1598400,0x1598800,0x1598c00,0x0,0x0,0x0,0x0
.long 0x1b0900,0x1b0980,0x1b0a00,0x1b0a80,0x1b0b00,0x0,0x0,0x0
.long 0x1599000,0x1599400,0x1599801,0x15bc801,0x15bb000,0x15bb400,0x15bb800,0x15bbc00
.long 0x15bc000,0x15bc400,0x15de000,0x15de400,0x15de800,0x15dec00,0x15df000,0x15df400
.long 0x15df801,0x1602801,0x1601000,0x1601400,0x0,0x0,0x0,0x0
.long 0x1b0b80,0x1b0c00,0x1b0c80,0x1b0d00,0x1cb000,0x0,0x0,0x0
.long 0x1601800,0x1601c00,0x1602000,0x1602400,0x1620000,0x1620400,0x1620800,0x1620c00
.long 0x1621000,0x1621400,0x163e000,0x163e400,0x163e800,0x163ec00,0x163f000,0x163f400
.long 0x1445c00,0x1446000,0x1446400,0x1446800,0x0,0x0,0x0,0x0
.long 0x1cb080,0x1cb100,0x1cb180,0x1cb200,0x1cb280,0x0,0x0,0x0
.long 0x1446c00,0x1447000,0x1447401,0x146a401,0x1468c00,0x1469000,0x1469400,0x1469800
.long 0x1469c00,0x146a000,0x148bc00,0x148c000,0x148c400,0x148c800,0x148cc00,0x148d000
.long 0x148d401,0x14b0401,0x14aec00,0x14af000,0x0,0x0,0x0,0x0
.long 0x1cb300,0x1cb380,0x1cb400,0x1cb480,0x1cb500,0x0,0x0,0x0
.long 0x14af400,0x14af800,0x14afc00,0x14b0000,0x14d1c00,0x14d2000,0x14d2400,0x14d2800
.long 0x14d2c00,0x14d3000,0x14d3401,0x14f6401,0x14f4c00,0x14f5000,0x14f5400,0x14f5800
.long 0x14f5c00,0x14f6000,0x1513800,0x1513c00,0x0,0x0,0x0,0x0
.long 0x1cb580,0x1cb600,0x1cb680,0x1cb700,0x1cb780,0x0,0x0,0x0
.long 0x1514000,0x1514400,0x1514800,0x1514c00,0x1531800,0x1531c00,0x1532000,0x1532400
.long 0x1532800,0x1532c00,0x1553c00,0x1554000,0x1554400,0x1554800,0x1554c00,0x1555000
.long 0x1555401,0x1578401,0x1576c00,0x1577000,0x0,0x0,0x0,0x0
.long 0x1cb800,0x1cb880,0x1cb900,0x1cb980,0x1cba00,0x0,0x0,0x0
.long 0x1577400,0x1577800,0x1577c00,0x1578000,0x1599c00,0x159a000,0x159a400,0x159a800
.long 0x159ac00,0x159b000,0x159b401,0x15be401,0x15bcc00,0x15bd000,0x15bd400,0x15bd800
.long 0x15bdc00,0x15be000,0x15dfc00,0x15e0000,0x0,0x0,0x0,0x0
.long 0x1cba80,0x1cbb00,0x1cbb80,0x1cbc00,0x1cbc80,0x0,0x0,0x0
.long 0x15e0400,0x15e0800,0x15e0c00,0x15e1000,0x15e1401,0x1604401,0x1602c00,0x1603000
.long 0x1603400,0x1603800,0x1603c00,0x1604000,0x1621800,0x1621c00,0x1622000,0x1622400
.long 0x1622800,0x1622c00,0x163f800,0x163fc00,0x0,0x0,0x0,0x0
.long 0x1cbd00,0x1e6000,0x1e6080,0x1e6100,0x1e6180,0x0,0x0,0x0
.long 0x1640000,0x1640400,0x1640800,0x1640c00,0x1447800,0x1447c00,0x1448000,0x1448400
.long 0x1448800,0x1448c00,0x1449001,0x146c001,0x146a800,0x146ac00,0x146b000,0x146b400
.long 0x146b800,0x146bc00,0x148d800,0x148dc00,0x0,0x0,0x0,0x0
.long 0x1e6200,0x1e6280,0x1e6300,0x1e6380,0x1e6400,0x0,0x0,0x0
.long 0x148e000,0x148e400,0x148e800,0x148ec00,0x148f001,0x14b2001,0x14b0800,0x14b0c00
.long 0x14b1000,0x14b1400,0x14b1800,0x14b1c00,0x14d3800,0x14d3c00,0x14d4000,0x14d4400
.long 0x14d4800,0x14d4c00,0x14d5001,0x14f8001,0x0,0x0,0x0,0x0
.long 0x1e6480,0x1e6500,0x1e6580,0x1e6600,0x1e6680,0x0,0x0,0x0
.long 0x14f6800,0x14f6c00,0x14f7000,0x14f7400,0x14f7800,0x14f7c00,0x1515000,0x1515400
.long 0x1515800,0x1515c00,0x1516000,0x1516400,0x1533000,0x1533400,0x1533800,0x1533c00
.long 0x1534000,0x1534400,0x1555800,0x1555c00,0x0,0x0,0x0,0x0
.long 0x1e6700,0x1e6780,0x1e6800,0x1e6880,0x1e6900,0x0,0x0,0x0
.long 0x1556000,0x1556400,0x1556800,0x1556c00,0x1557001,0x157a001,0x1578800,0x1578c00
.long 0x1579000,0x1579400,0x1579800,0x1579c00,0x159b800,0x159bc00,0x159c000,0x159c400
.long 0x159c800,0x159cc00,0x159d001,0x15c0001,0x0,0x0,0x0,0x0
.long 0x1e6980,0x1e6a00,0x1e6a80,0x1e6b00,0x1e6b80,0x0,0x0,0x0
.long 0x15be800,0x15bec00,0x15bf000,0x15bf400,0x15bf800,0x15bfc00,0x15e1800,0x15e1c00
.long 0x15e2000,0x15e2400,0x15e2800,0x15e2c00,0x15e3001,0x1606001,0x1604800,0x1604c00
.long 0x1605000,0x1605400,0x1605800,0x1605c00,0x0,0x0,0x0,0x0
.long 0x1e6c00,0x1e6c80,0x1e6d00,0x201000,0x201080,0x0,0x0,0x0
.long 0x1623000,0x1623400,0x1623800,0x1623c00,0x1624000,0x1624400,0x1641000,0x1641400
.long 0x1641800,0x1641c00,0x1642000,0x1642400,0x1449400,0x1449800,0x1449c00,0x144a000
.long 0x144a400,0x144a800,0x144ac01,0x146dc01,0x0,0x0,0x0,0x0
.long 0x201100,0x201180,0x201200,0x201280,0x201300,0x0,0x0,0x0
.long 0x146c400,0x146c800,0x146cc00,0x146d000,0x146d400,0x146d800,0x148f400,0x148f800
.long 0x148fc00,0x1490000,0x1490400,0x1490800,0x1490c01,0x14b3c01,0x14b2400,0x14b2800
.long 0x14b2c00,0x14b3000,0x14b3400,0x14b3800,0x0,0x0,0x0,0x0
.long 0x201380,0x201400,0x201480,0x201500,0x201580,0x0,0x0,0x0
.long 0x14d5400,0x14d5800,0x14d5c00,0x14d6000,0x14d6400,0x14d6800,0x14d6c01,0x14f9c01
.long 0x14f8400,0x14f8800,0x14f8c00,0x14f9000,0x14f9400,0x14f9800,0x1516800,0x1516c00
.long 0x1517000,0x1517400,0x1517800,0x1517c00,0x0,0x0,0x0,0x0
.long 0x201600,0x201680,0x201700,0x201780,0x201800,0x0,0x0,0x0
.long 0x1534800,0x1534c00,0x1535000,0x1535400,0x1535800,0x1535c00,0x1557400,0x1557800
.long 0x1557c00,0x1558000,0x1558400,0x1558800,0x1558c01,0x157bc01,0x157a400,0x157a800
.long 0x157ac00,0x157b000,0x157b400,0x157b800,0x0,0x0,0x0,0x0
.long 0x201880,0x201900,0x201980,0x201a00,0x201a80,0x0,0x0,0x0
.long 0x159d400,0x159d800,0x159dc00,0x159e000,0x159e400,0x159e800,0x159ec01,0x15c1c01
.long 0x15c0400,0x15c0800,0x15c0c00,0x15c1000,0x15c1400,0x15c1800,0x15e3400,0x15e3800
.long 0x15e3c00,0x15e4000,0x15e4400,0x15e4800,0x0,0x0,0x0,0x0
.long 0x201b00,0x201b80,0x201c00,0x201c80,0x201d00,0x0,0x0,0x0
.long 0x15e4c01,0x1607c01,0x1606400,0x1606800,0x1606c00,0x1607000,0x1607400,0x1607800
.long 0x1624800,0x1624c00,0x1625000,0x1625400,0x1625800,0x1625c00,0x1642800,0x1642c00
.long 0x1643000,0x1643400,0x1643800,0x1643c00,0x0,0x0,0x0,0x0
.long 0x0,0x80,0x100,0x180,0x200,0x0,0x0,0x0
.long 0x1644000,0x1644400,0x1644800,0x1644c00,0x1645001,0x1688801,0x1687800,0x1687c00
.long 0x1688000,0x1688400,0x16cb000,0x16cb400,0x16cb800,0x16cbc00,0x16cc001,0x170f801
.long 0x170e800,0x170ec00,0x170f000,0x170f400,0x0,0x0,0x0,0x0
.long 0x280,0x300,0x380,0x400,0x480,0x0,0x0,0x0
.long 0x1752000,0x1752400,0x1752800,0x1752c00,0x1753001,0x1796801,0x1795800,0x1795c00
.long 0x1796000,0x1796400,0x17d9000,0x17d9400,0x17d9800,0x17d9c00,0x17da001,0x181d801
.long 0x181c800,0x181cc00,0x181d000,0x181d400,0x0,0x0,0x0,0x0
.long 0x28000,0x28080,0x28100,0x28180,0x28200,0x0,0x0,0x0
.long 0x1645400,0x1645800,0x1645c00,0x1646000,0x1646401,0x1689c01,0x1688c00,0x1689000
.long 0x1689400,0x1689800,0x16cc400,0x16cc800,0x16ccc00,0x16cd000,0x16cd401,0x1710c01
.long 0x170fc00,0x1710000,0x1710400,0x1710800,0x0,0x0,0x0,0x0
.long 0x28280,0x28300,0x28380,0x28400,0x28480,0x0,0x0,0x0
.long 0x1753400,0x1753800,0x1753c00,0x1754000,0x1754401,0x1797c01,0x1796c00,0x1797000
.long 0x1797400,0x1797800,0x17da400,0x17da800,0x17dac00,0x17db000,0x17db401,0x181ec01
.long 0x181dc00,0x181e000,0x181e400,0x181e800,0x0,0x0,0x0,0x0
.long 0x46000,0x46080,0x46100,0x46180,0x46200,0x0,0x0,0x0
.long 0x1646800,0x1646c00,0x1647000,0x1647400,0x1647801,0x168b001,0x168a000,0x168a400
.long 0x168a800,0x168ac00,0x16cd800,0x16cdc00,0x16ce000,0x16ce400,0x16ce801,0x1712001
.long 0x1711000,0x1711400,0x1711800,0x1711c00,0x0,0x0,0x0,0x0
.long 0x46280,0x46300,0x46380,0x46400,0x46480,0x0,0x0,0x0
.long 0x1754800,0x1754c00,0x1755000,0x1755400,0x1755801,0x1799001,0x1798000,0x1798400
.long 0x1798800,0x1798c00,0x17db800,0x17dbc00,0x17dc000,0x17dc400,0x17dc801,0x1820001
.long 0x181f000,0x181f400,0x181f800,0x181fc00,0x0,0x0,0x0,0x0
.long 0x6e000,0x6e080,0x6e100,0x6e180,0x6e200,0x0,0x0,0x0
.long 0x1647c00,0x1648000,0x1648400,0x1648800,0x1648c01,0x168c401,0x168b400,0x168b800
.long 0x168bc00,0x168c000,0x16cec00,0x16cf000,0x16cf400,0x16cf800,0x16cfc01,0x1713401
.long 0x1712400,0x1712800,0x1712c00,0x1713000,0x0,0x0,0x0,0x0
.long 0x6e280,0x6e300,0x6e380,0x6e400,0x6e480,0x0,0x0,0x0
.long 0x1755c00,0x1756000,0x1756400,0x1756800,0x1756c01,0x179a401,0x1799400,0x1799800
.long 0x1799c00,0x179a000,0x17dcc00,0x17dd000,0x17dd400,0x17dd800,0x17ddc01,0x1821401
.long 0x1820400,0x1820800,0x1820c00,0x1821000,0x0,0x0,0x0,0x0
.long 0x8c000,0x8c080,0x8c100,0x8c180,0x8c200,0x0,0x0,0x0
.long 0x1649000,0x1649400,0x1649800,0x1649c00,0x164a001,0x168d801,0x168c800,0x168cc00
.long 0x168d000,0x168d400,0x16d0000,0x16d0400,0x16d0800,0x16d0c00,0x16d1001,0x1714801
.long 0x1713800,0x1713c00,0x1714000,0x1714400,0x0,0x0,0x0,0x0
.long 0x8c280,0x8c300,0x8c380,0x8c400,0x8c480,0x0,0x0,0x0
.long 0x1757000,0x1757400,0x1757800,0x1757c00,0x1758001,0x179b801,0x179a800,0x179ac00
.long 0x179b000,0x179b400,0x17de000,0x17de400,0x17de800,0x17dec00,0x17df001,0x1822801
.long 0x1821800,0x1821c00,0x1822000,0x1822400,0x0,0x0,0x0,0x0
.long 0xb4000,0xb4080,0xb4100,0xb4180,0xb4200,0x0,0x0,0x0
.long 0x164a400,0x164a800,0x164ac00,0x164b000,0x164b401,0x168ec01,0x168dc00,0x168e000
.long 0x168e400,0x168e800,0x16d1400,0x16d1800,0x16d1c00,0x16d2000,0x16d2401,0x1715c01
.long 0x1714c00,0x1715000,0x1715400,0x1715800,0x0,0x0,0x0,0x0
.long 0xb4280,0xb4300,0xb4380,0xb4400,0xb4480,0x0,0x0,0x0
.long 0x1758400,0x1758800,0x1758c00,0x1759000,0x1759401,0x179cc01,0x179bc00,0x179c000
.long 0x179c400,0x179c800,0x17df400,0x17df800,0x17dfc00,0x17e0000,0x17e0401,0x1823c01
.long 0x1822c00,0x1823000,0x1823400,0x1823800,0x0,0x0,0x0,0x0
.long 0xd2000,0xd2080,0xd2100,0xd2180,0xd2200,0x0,0x0,0x0
.long 0x164b800,0x164bc00,0x164c000,0x164c400,0x164c801,0x1690001,0x168f000,0x168f400
.long 0x168f800,0x168fc00,0x16d2800,0x16d2c00,0x16d3000,0x16d3400,0x16d3801,0x1717001
.long 0x1716000,0x1716400,0x1716800,0x1716c00,0x0,0x0,0x0,0x0
.long 0xd2280,0xd2300,0xd2380,0xd2400,0xd2480,0x0,0x0,0x0
.long 0x1759800,0x1759c00,0x175a000,0x175a400,0x175a801,0x179e001,0x179d000,0x179d400
.long 0x179d800,0x179dc00,0x17e0800,0x17e0c00,0x17e1000,0x17e1400,0x17e1801,0x1825001
.long 0x1824000,0x1824400,0x1824800,0x1824c00,0x0,0x0,0x0,0x0
.long 0xf0000,0xf0080,0xf0100,0xf0180,0xf0200,0x0,0x0,0x0
.long 0x164cc00,0x164d000,0x164d400,0x164d800,0x164dc01,0x1691401,0x1690400,0x1690800
.long 0x1690c00,0x1691000,0x16d3c00,0x16d4000,0x16d4400,0x16d4800,0x16d4c01,0x1718401
.long 0x1717400,0x1717800,0x1717c00,0x1718000,0x0,0x0,0x0,0x0
.long 0xf0280,0xf0300,0xf0380,0xf0400,0xf0480,0x0,0x0,0x0
.long 0x175ac00,0x175b000,0x175b400,0x175b800,0x175bc01,0x179f401,0x179e400,0x179e800
.long 0x179ec00,0x179f000,0x17e1c00,0x17e2000,0x17e2400,0x17e2800,0x17e2c01,0x1826401
.long 0x1825400,0x1825800,0x1825c00,0x1826000,0x0,0x0,0x0,0x0
.long 0xa000,0xa080,0xa100,0xa180,0xa200,0x0,0x0,0x0
.long 0x164e000,0x164e400,0x164e800,0x164ec00,0x164f001,0x1692801,0x1691800,0x1691c00
.long 0x1692000,0x1692400,0x16d5000,0x16d5400,0x16d5800,0x16d5c00,0x16d6001,0x1719801
.long 0x1718800,0x1718c00,0x1719000,0x1719400,0x0,0x0,0x0,0x0
.long 0xa280,0xa300,0xa380,0xa400,0xa480,0x0,0x0,0x0
.long 0x175c000,0x175c400,0x175c800,0x175cc00,0x175d001,0x17a0801,0x179f800,0x179fc00
.long 0x17a0000,0x17a0400,0x17e3000,0x17e3400,0x17e3800,0x17e3c00,0x17e4001,0x1827801
.long 0x1826800,0x1826c00,0x1827000,0x1827400,0x0,0x0,0x0,0x0
.long 0x32000,0x32080,0x32100,0x32180,0x32200,0x0,0x0,0x0
.long 0x164f400,0x164f800,0x164fc00,0x1650000,0x1650401,0x1693c01,0x1692c00,0x1693000
.long 0x1693400,0x1693800,0x16d6400,0x16d6800,0x16d6c00,0x16d7000,0x16d7401,0x171ac01
.long 0x1719c00,0x171a000,0x171a400,0x171a800,0x0,0x0,0x0,0x0
.long 0x32280,0x32300,0x32380,0x32400,0x32480,0x0,0x0,0x0
.long 0x175d400,0x175d800,0x175dc00,0x175e000,0x175e401,0x17a1c01,0x17a0c00,0x17a1000
.long 0x17a1400,0x17a1800,0x17e4400,0x17e4800,0x17e4c00,0x17e5000,0x17e5401,0x1828c01
.long 0x1827c00,0x1828000,0x1828400,0x1828800,0x0,0x0,0x0,0x0
.long 0x50000,0x50080,0x50100,0x50180,0x50200,0x0,0x0,0x0
.long 0x1650800,0x1650c00,0x1651000,0x1651400,0x1651801,0x1695001,0x1694000,0x1694400
.long 0x1694800,0x1694c00,0x16d7800,0x16d7c00,0x16d8000,0x16d8400,0x16d8801,0x171c001
.long 0x171b000,0x171b400,0x171b800,0x171bc00,0x0,0x0,0x0,0x0
.long 0x50280,0x50300,0x50380,0x50400,0x50480,0x0,0x0,0x0
.long 0x175e800,0x175ec00,0x175f000,0x175f400,0x175f801,0x17a3001,0x17a2000,0x17a2400
.long 0x17a2800,0x17a2c00,0x17e5800,0x17e5c00,0x17e6000,0x17e6400,0x17e6801,0x182a001
.long 0x1829000,0x1829400,0x1829800,0x1829c00,0x0,0x0,0x0,0x0
.long 0x78000,0x78080,0x78100,0x78180,0x78200,0x0,0x0,0x0
.long 0x1651c00,0x1652000,0x1652400,0x1652800,0x1652c01,0x1696401,0x1695400,0x1695800
.long 0x1695c00,0x1696000,0x16d8c00,0x16d9000,0x16d9400,0x16d9800,0x16d9c01,0x171d401
.long 0x171c400,0x171c800,0x171cc00,0x171d000,0x0,0x0,0x0,0x0
.long 0x78280,0x78300,0x78380,0x78400,0x78480,0x0,0x0,0x0
.long 0x175fc00,0x1760000,0x1760400,0x1760800,0x1760c01,0x17a4401,0x17a3400,0x17a3800
.long 0x17a3c00,0x17a4000,0x17e6c00,0x17e7000,0x17e7400,0x17e7800,0x17e7c01,0x182b401
.long 0x182a400,0x182a800,0x182ac00,0x182b000,0x0,0x0,0x0,0x0
.long 0x96000,0x96080,0x96100,0x96180,0x96200,0x0,0x0,0x0
.long 0x1653000,0x1653400,0x1653800,0x1653c00,0x1654001,0x1697801,0x1696800,0x1696c00
.long 0x1697000,0x1697400,0x16da000,0x16da400,0x16da800,0x16dac00,0x16db001,0x171e801
.long 0x171d800,0x171dc00,0x171e000,0x171e400,0x0,0x0,0x0,0x0
.long 0x96280,0x96300,0x96380,0x96400,0x96480,0x0,0x0,0x0
.long 0x1761000,0x1761400,0x1761800,0x1761c00,0x1762001,0x17a5801,0x17a4800,0x17a4c00
.long 0x17a5000,0x17a5400,0x17e8000,0x17e8400,0x17e8800,0x17e8c00,0x17e9001,0x182c801
.long 0x182b800,0x182bc00,0x182c000,0x182c400,0x0,0x0,0x0,0x0
.long 0xbe000,0xbe080,0xbe100,0xbe180,0xbe200,0x0,0x0,0x0
.long 0x1654400,0x1654800,0x1654c00,0x1655000,0x1655401,0x1698c01,0x1697c00,0x1698000
.long 0x1698400,0x1698800,0x16db400,0x16db800,0x16dbc00,0x16dc000,0x16dc401,0x171fc01
.long 0x171ec00,0x171f000,0x171f400,0x171f800,0x0,0x0,0x0,0x0
.long 0xbe280,0xbe300,0xbe380,0xbe400,0xbe480,0x0,0x0,0x0
.long 0x1762400,0x1762800,0x1762c00,0x1763000,0x1763401,0x17a6c01,0x17a5c00,0x17a6000
.long 0x17a6400,0x17a6800,0x17e9400,0x17e9800,0x17e9c00,0x17ea000,0x17ea401,0x182dc01
.long 0x182cc00,0x182d000,0x182d400,0x182d800,0x0,0x0,0x0,0x0
.long 0xdc000,0xdc080,0xdc100,0xdc180,0xdc200,0x0,0x0,0x0
.long 0x1655800,0x1655c00,0x1656000,0x1656400,0x1656801,0x169a001,0x1699000,0x1699400
.long 0x1699800,0x1699c00,0x16dc800,0x16dcc00,0x16dd000,0x16dd400,0x16dd801,0x1721001
.long 0x1720000,0x1720400,0x1720800,0x1720c00,0x0,0x0,0x0,0x0
.long 0xdc280,0xdc300,0xdc380,0xdc400,0xdc480,0x0,0x0,0x0
.long 0x1763800,0x1763c00,0x1764000,0x1764400,0x1764801,0x17a8001,0x17a7000,0x17a7400
.long 0x17a7800,0x17a7c00,0x17ea800,0x17eac00,0x17eb000,0x17eb400,0x17eb801,0x182f001
.long 0x182e000,0x182e400,0x182e800,0x182ec00,0x0,0x0,0x0,0x0
.long 0xfa000,0xfa080,0xfa100,0xfa180,0xfa200,0x0,0x0,0x0
.long 0x1656c00,0x1657000,0x1657400,0x1657800,0x1657c01,0x169b401,0x169a400,0x169a800
.long 0x169ac00,0x169b000,0x16ddc00,0x16de000,0x16de400,0x16de800,0x16dec01,0x1722401
.long 0x1721400,0x1721800,0x1721c00,0x1722000,0x0,0x0,0x0,0x0
.long 0xfa280,0xfa300,0xfa380,0xfa400,0xfa480,0x0,0x0,0x0
.long 0x1764c00,0x1765000,0x1765400,0x1765800,0x1765c01,0x17a9401,0x17a8400,0x17a8800
.long 0x17a8c00,0x17a9000,0x17ebc00,0x17ec000,0x17ec400,0x17ec800,0x17ecc01,0x1830401
.long 0x182f400,0x182f800,0x182fc00,0x1830000,0x0,0x0,0x0,0x0
.long 0x14000,0x14080,0x14100,0x14180,0x14200,0x0,0x0,0x0
.long 0x1658000,0x1658400,0x1658800,0x1658c00,0x1659001,0x169c801,0x169b800,0x169bc00
.long 0x169c000,0x169c400,0x16df000,0x16df400,0x16df800,0x16dfc00,0x16e0001,0x1723801
.long 0x1722800,0x1722c00,0x1723000,0x1723400,0x0,0x0,0x0,0x0
.long 0x14280,0x14300,0x14380,0x14400,0x14480,0x0,0x0,0x0
.long 0x1766000,0x1766400,0x1766800,0x1766c00,0x1767001,0x17aa801,0x17a9800,0x17a9c00
.long 0x17aa000,0x17aa400,0x17ed000,0x17ed400,0x17ed800,0x17edc00,0x17ee001,0x1831801
.long 0x1830800,0x1830c00,0x1831000,0x1831400,0x0,0x0,0x0,0x0
.long 0x3c000,0x3c080,0x3c100,0x3c180,0x3c200,0x0,0x0,0x0
.long 0x1659400,0x1659800,0x1659c00,0x165a000,0x165a401,0x169dc01,0x169cc00,0x169d000
.long 0x169d400,0x169d800,0x16e0400,0x16e0800,0x16e0c00,0x16e1000,0x16e1401,0x1724c01
.long 0x1723c00,0x1724000,0x1724400,0x1724800,0x0,0x0,0x0,0x0
.long 0x3c280,0x3c300,0x3c380,0x3c400,0x3c480,0x0,0x0,0x0
.long 0x1767400,0x1767800,0x1767c00,0x1768000,0x1768401,0x17abc01,0x17aac00,0x17ab000
.long 0x17ab400,0x17ab800,0x17ee400,0x17ee800,0x17eec00,0x17ef000,0x17ef401,0x1832c01
.long 0x1831c00,0x1832000,0x1832400,0x1832800,0x0,0x0,0x0,0x0
.long 0x5a000,0x5a080,0x5a100,0x5a180,0x5a200,0x0,0x0,0x0
.long 0x165a800,0x165ac00,0x165b000,0x165b400,0x165b801,0x169f001,0x169e000,0x169e400
.long 0x169e800,0x169ec00,0x16e1800,0x16e1c00,0x16e2000,0x16e2400,0x16e2801,0x1726001
.long 0x1725000,0x1725400,0x1725800,0x1725c00,0x0,0x0,0x0,0x0
.long 0x5a280,0x5a300,0x5a380,0x5a400,0x5a480,0x0,0x0,0x0
.long 0x1768800,0x1768c00,0x1769000,0x1769400,0x1769801,0x17ad001,0x17ac000,0x17ac400
.long 0x17ac800,0x17acc00,0x17ef800,0x17efc00,0x17f0000,0x17f0400,0x17f0801,0x1834001
.long 0x1833000,0x1833400,0x1833800,0x1833c00,0x0,0x0,0x0,0x0
.long 0x82000,0x82080,0x82100,0x82180,0x82200,0x0,0x0,0x0
.long 0x165bc00,0x165c000,0x165c400,0x165c800,0x165cc01,0x16a0401,0x169f400,0x169f800
.long 0x169fc00,0x16a0000,0x16e2c00,0x16e3000,0x16e3400,0x16e3800,0x16e3c01,0x1727401
.long 0x1726400,0x1726800,0x1726c00,0x1727000,0x0,0x0,0x0,0x0
.long 0x82280,0x82300,0x82380,0x82400,0x82480,0x0,0x0,0x0
.long 0x1769c00,0x176a000,0x176a400,0x176a800,0x176ac01,0x17ae401,0x17ad400,0x17ad800
.long 0x17adc00,0x17ae000,0x17f0c00,0x17f1000,0x17f1400,0x17f1800,0x17f1c01,0x1835401
.long 0x1834400,0x1834800,0x1834c00,0x1835000,0x0,0x0,0x0,0x0
.long 0xa0000,0xa0080,0xa0100,0xa0180,0xa0200,0x0,0x0,0x0
.long 0x165d000,0x165d400,0x165d800,0x165dc00,0x165e001,0x16a1801,0x16a0800,0x16a0c00
.long 0x16a1000,0x16a1400,0x16e4000,0x16e4400,0x16e4800,0x16e4c00,0x16e5001,0x1728801
.long 0x1727800,0x1727c00,0x1728000,0x1728400,0x0,0x0,0x0,0x0
.long 0xa0280,0xa0300,0xa0380,0xa0400,0xa0480,0x0,0x0,0x0
.long 0x176b000,0x176b400,0x176b800,0x176bc00,0x176c001,0x17af801,0x17ae800,0x17aec00
.long 0x17af000,0x17af400,0x17f2000,0x17f2400,0x17f2800,0x17f2c00,0x17f3001,0x1836801
.long 0x1835800,0x1835c00,0x1836000,0x1836400,0x0,0x0,0x0,0x0
.long 0xc8000,0xc8080,0xc8100,0xc8180,0xc8200,0x0,0x0,0x0
.long 0x165e400,0x165e800,0x165ec00,0x165f000,0x165f401,0x16a2c01,0x16a1c00,0x16a2000
.long 0x16a2400,0x16a2800,0x16e5400,0x16e5800,0x16e5c00,0x16e6000,0x16e6401,0x1729c01
.long 0x1728c00,0x1729000,0x1729400,0x1729800,0x0,0x0,0x0,0x0
.long 0xc8280,0xc8300,0xc8380,0xc8400,0xc8480,0x0,0x0,0x0
.long 0x176c400,0x176c800,0x176cc00,0x176d000,0x176d401,0x17b0c01,0x17afc00,0x17b0000
.long 0x17b0400,0x17b0800,0x17f3400,0x17f3800,0x17f3c00,0x17f4000,0x17f4401,0x1837c01
.long 0x1836c00,0x1837000,0x1837400,0x1837800,0x0,0x0,0x0,0x0
.long 0xe6000,0xe6080,0xe6100,0xe6180,0xe6200,0x0,0x0,0x0
.long 0x165f800,0x165fc00,0x1660000,0x1660400,0x1660801,0x16a4001,0x16a3000,0x16a3400
.long 0x16a3800,0x16a3c00,0x16e6800,0x16e6c00,0x16e7000,0x16e7400,0x16e7801,0x172b001
.long 0x172a000,0x172a400,0x172a800,0x172ac00,0x0,0x0,0x0,0x0
.long 0xe6280,0xe6300,0xe6380,0xe6400,0xe6480,0x0,0x0,0x0
.long 0x176d800,0x176dc00,0x176e000,0x176e400,0x176e801,0x17b2001,0x17b1000,0x17b1400
.long 0x17b1800,0x17b1c00,0x17f4800,0x17f4c00,0x17f5000,0x17f5400,0x17f5801,0x1839001
.long 0x1838000,0x1838400,0x1838800,0x1838c00,0x0,0x0,0x0,0x0
.long 0x104000,0x104080,0x104100,0x104180,0x104200,0x0,0x0,0x0
.long 0x1660c00,0x1661000,0x1661400,0x1661800,0x1661c01,0x16a5401,0x16a4400,0x16a4800
.long 0x16a4c00,0x16a5000,0x16e7c00,0x16e8000,0x16e8400,0x16e8800,0x16e8c01,0x172c401
.long 0x172b400,0x172b800,0x172bc00,0x172c000,0x0,0x0,0x0,0x0
.long 0x104280,0x104300,0x104380,0x104400,0x104480,0x0,0x0,0x0
.long 0x176ec00,0x176f000,0x176f400,0x176f800,0x176fc01,0x17b3401,0x17b2400,0x17b2800
.long 0x17b2c00,0x17b3000,0x17f5c00,0x17f6000,0x17f6400,0x17f6800,0x17f6c01,0x183a401
.long 0x1839400,0x1839800,0x1839c00,0x183a000,0x0,0x0,0x0,0x0
.long 0x1e000,0x1e080,0x1e100,0x1e180,0x1e200,0x0,0x0,0x0
.long 0x1662000,0x1662400,0x1662800,0x1662c00,0x1663001,0x16a6801,0x16a5800,0x16a5c00
.long 0x16a6000,0x16a6400,0x16e9000,0x16e9400,0x16e9800,0x16e9c00,0x16ea001,0x172d801
.long 0x172c800,0x172cc00,0x172d000,0x172d400,0x0,0x0,0x0,0x0
.long 0x1e280,0x1e300,0x1e380,0x1e400,0x1e480,0x0,0x0,0x0
.long 0x1770000,0x1770400,0x1770800,0x1770c00,0x1771001,0x17b4801,0x17b3800,0x17b3c00
.long 0x17b4000,0x17b4400,0x17f7000,0x17f7400,0x17f7800,0x17f7c00,0x17f8001,0x183b801
.long 0x183a800,0x183ac00,0x183b000,0x183b400,0x0,0x0,0x0,0x0
.long 0x64000,0x64080,0x64100,0x64180,0x64200,0x0,0x0,0x0
.long 0x1663400,0x1663800,0x1663c00,0x1664000,0x1664401,0x16a7c01,0x16a6c00,0x16a7000
.long 0x16a7400,0x16a7800,0x16ea400,0x16ea800,0x16eac00,0x16eb000,0x16eb401,0x172ec01
.long 0x172dc00,0x172e000,0x172e400,0x172e800,0x0,0x0,0x0,0x0
.long 0x64280,0x64300,0x64380,0x64400,0x64480,0x0,0x0,0x0
.long 0x1771400,0x1771800,0x1771c00,0x1772000,0x1772401,0x17b5c01,0x17b4c00,0x17b5000
.long 0x17b5400,0x17b5800,0x17f8400,0x17f8800,0x17f8c00,0x17f9000,0x17f9401,0x183cc01
.long 0x183bc00,0x183c000,0x183c400,0x183c800,0x0,0x0,0x0,0x0
.long 0xaa000,0xaa080,0xaa100,0xaa180,0xaa200,0x0,0x0,0x0
.long 0x1664800,0x1664c00,0x1665000,0x1665400,0x1665801,0x16a9001,0x16a8000,0x16a8400
.long 0x16a8800,0x16a8c00,0x16eb800,0x16ebc00,0x16ec000,0x16ec400,0x16ec801,0x1730001
.long 0x172f000,0x172f400,0x172f800,0x172fc00,0x0,0x0,0x0,0x0
.long 0xaa280,0xaa300,0xaa380,0xaa400,0xaa480,0x0,0x0,0x0
.long 0x1772800,0x1772c00,0x1773000,0x1773400,0x1773801,0x17b7001,0x17b6000,0x17b6400
.long 0x17b6800,0x17b6c00,0x17f9800,0x17f9c00,0x17fa000,0x17fa400,0x17fa801,0x183e001
.long 0x183d000,0x183d400,0x183d800,0x183dc00,0x0,0x0,0x0,0x0
.long 0x10e000,0x10e080,0x10e100,0x10e180,0x10e200,0x0,0x0,0x0
.long 0x1665c00,0x1666000,0x1666400,0x1666800,0x1666c01,0x16aa401,0x16a9400,0x16a9800
.long 0x16a9c00,0x16aa000,0x16ecc00,0x16ed000,0x16ed400,0x16ed800,0x16edc01,0x1731401
.long 0x1730400,0x1730800,0x1730c00,0x1731000,0x0,0x0,0x0,0x0
.long 0x10e280,0x10e300,0x10e380,0x10e400,0x10e480,0x0,0x0,0x0
.long 0x1773c00,0x1774000,0x1774400,0x1774800,0x1774c01,0x17b8401,0x17b7400,0x17b7800
.long 0x17b7c00,0x17b8000,0x17fac00,0x17fb000,0x17fb400,0x17fb800,0x17fbc01,0x183f401
.long 0x183e400,0x183e800,0x183ec00,0x183f000,0x0,0x0,0x0,0x0
.long 0x136000,0x136080,0x136100,0x136180,0x136200,0x0,0x0,0x0
.long 0x1667000,0x1667400,0x1667800,0x1667c00,0x1668001,0x16ab801,0x16aa800,0x16aac00
.long 0x16ab000,0x16ab400,0x16ee000,0x16ee400,0x16ee800,0x16eec00,0x16ef001,0x1732801
.long 0x1731800,0x1731c00,0x1732000,0x1732400,0x0,0x0,0x0,0x0
.long 0x136280,0x136300,0x136380,0x136400,0x136480,0x0,0x0,0x0
.long 0x1775000,0x1775400,0x1775800,0x1775c00,0x1776001,0x17b9801,0x17b8800,0x17b8c00
.long 0x17b9000,0x17b9400,0x17fc000,0x17fc400,0x17fc800,0x17fcc00,0x17fd001,0x1840801
.long 0x183f800,0x183fc00,0x1840000,0x1840400,0x0,0x0,0x0,0x0
.long 0x154000,0x154080,0x154100,0x154180,0x154200,0x0,0x0,0x0
.long 0x1668400,0x1668800,0x1668c00,0x1669000,0x1669401,0x16acc01,0x16abc00,0x16ac000
.long 0x16ac400,0x16ac800,0x16ef400,0x16ef800,0x16efc00,0x16f0000,0x16f0401,0x1733c01
.long 0x1732c00,0x1733000,0x1733400,0x1733800,0x0,0x0,0x0,0x0
.long 0x154280,0x154300,0x154380,0x154400,0x154480,0x0,0x0,0x0
.long 0x1776400,0x1776800,0x1776c00,0x1777000,0x1777401,0x17bac01,0x17b9c00,0x17ba000
.long 0x17ba400,0x17ba800,0x17fd400,0x17fd800,0x17fdc00,0x17fe000,0x17fe401,0x1841c01
.long 0x1840c00,0x1841000,0x1841400,0x1841800,0x0,0x0,0x0,0x0
.long 0x17c000,0x17c080,0x17c100,0x17c180,0x17c200,0x0,0x0,0x0
.long 0x1669800,0x1669c00,0x166a000,0x166a400,0x166a801,0x16ae001,0x16ad000,0x16ad400
.long 0x16ad800,0x16adc00,0x16f0800,0x16f0c00,0x16f1000,0x16f1400,0x16f1801,0x1735001
.long 0x1734000,0x1734400,0x1734800,0x1734c00,0x0,0x0,0x0,0x0
.long 0x17c280,0x17c300,0x17c380,0x17c400,0x17c480,0x0,0x0,0x0
.long 0x1777800,0x1777c00,0x1778000,0x1778400,0x1778801,0x17bc001,0x17bb000,0x17bb400
.long 0x17bb800,0x17bbc00,0x17fe800,0x17fec00,0x17ff000,0x17ff400,0x17ff801,0x1843001
.long 0x1842000,0x1842400,0x1842800,0x1842c00,0x0,0x0,0x0,0x0
.long 0x19a000,0x19a080,0x19a100,0x19a180,0x19a200,0x0,0x0,0x0
.long 0x166ac00,0x166b000,0x166b400,0x166b800,0x166bc01,0x16af401,0x16ae400,0x16ae800
.long 0x16aec00,0x16af000,0x16f1c00,0x16f2000,0x16f2400,0x16f2800,0x16f2c01,0x1736401
.long 0x1735400,0x1735800,0x1735c00,0x1736000,0x0,0x0,0x0,0x0
.long 0x19a280,0x19a300,0x19a380,0x19a400,0x19a480,0x0,0x0,0x0
.long 0x1778c00,0x1779000,0x1779400,0x1779800,0x1779c01,0x17bd401,0x17bc400,0x17bc800
.long 0x17bcc00,0x17bd000,0x17ffc00,0x1800000,0x1800400,0x1800800,0x1800c01,0x1844401
.long 0x1843400,0x1843800,0x1843c00,0x1844000,0x0,0x0,0x0,0x0
.long 0x1c2000,0x1c2080,0x1c2100,0x1c2180,0x1c2200,0x0,0x0,0x0
.long 0x166c000,0x166c400,0x166c800,0x166cc00,0x166d001,0x16b0801,0x16af800,0x16afc00
.long 0x16b0000,0x16b0400,0x16f3000,0x16f3400,0x16f3800,0x16f3c00,0x16f4001,0x1737801
.long 0x1736800,0x1736c00,0x1737000,0x1737400,0x0,0x0,0x0,0x0
.long 0x1c2280,0x1c2300,0x1c2380,0x1c2400,0x1c2480,0x0,0x0,0x0
.long 0x177a000,0x177a400,0x177a800,0x177ac00,0x177b001,0x17be801,0x17bd800,0x17bdc00
.long 0x17be000,0x17be400,0x1801000,0x1801400,0x1801800,0x1801c00,0x1802001,0x1845801
.long 0x1844800,0x1844c00,0x1845000,0x1845400,0x0,0x0,0x0,0x0
.long 0x1e0000,0x1e0080,0x1e0100,0x1e0180,0x1e0200,0x0,0x0,0x0
.long 0x166d400,0x166d800,0x166dc00,0x166e000,0x166e401,0x16b1c01,0x16b0c00,0x16b1000
.long 0x16b1400,0x16b1800,0x16f4400,0x16f4800,0x16f4c00,0x16f5000,0x16f5401,0x1738c01
.long 0x1737c00,0x1738000,0x1738400,0x1738800,0x0,0x0,0x0,0x0
.long 0x1e0280,0x1e0300,0x1e0380,0x1e0400,0x1e0480,0x0,0x0,0x0
.long 0x177b400,0x177b800,0x177bc00,0x177c000,0x177c401,0x17bfc01,0x17bec00,0x17bf000
.long 0x17bf400,0x17bf800,0x1802400,0x1802800,0x1802c00,0x1803000,0x1803401,0x1846c01
.long 0x1845c00,0x1846000,0x1846400,0x1846800,0x0,0x0,0x0,0x0
.long 0x1fe000,0x1fe080,0x1fe100,0x1fe180,0x1fe200,0x0,0x0,0x0
.long 0x166e800,0x166ec00,0x166f000,0x166f400,0x166f801,0x16b3001,0x16b2000,0x16b2400
.long 0x16b2800,0x16b2c00,0x16f5800,0x16f5c00,0x16f6000,0x16f6400,0x16f6801,0x173a001
.long 0x1739000,0x1739400,0x1739800,0x1739c00,0x0,0x0,0x0,0x0
.long 0x1fe280,0x1fe300,0x1fe380,0x1fe400,0x1fe480,0x0,0x0,0x0
.long 0x177c800,0x177cc00,0x177d000,0x177d400,0x177d801,0x17c1001,0x17c0000,0x17c0400
.long 0x17c0800,0x17c0c00,0x1803800,0x1803c00,0x1804000,0x1804400,0x1804801,0x1848001
.long 0x1847000,0x1847400,0x1847800,0x1847c00,0x0,0x0,0x0,0x0
.long 0x118000,0x118080,0x118100,0x118180,0x118200,0x0,0x0,0x0
.long 0x166fc00,0x1670000,0x1670400,0x1670800,0x1670c01,0x16b4401,0x16b3400,0x16b3800
.long 0x16b3c00,0x16b4000,0x16f6c00,0x16f7000,0x16f7400,0x16f7800,0x16f7c01,0x173b401
.long 0x173a400,0x173a800,0x173ac00,0x173b000,0x0,0x0,0x0,0x0
.long 0x118280,0x118300,0x118380,0x118400,0x118480,0x0,0x0,0x0
.long 0x177dc00,0x177e000,0x177e400,0x177e800,0x177ec01,0x17c2401,0x17c1400,0x17c1800
.long 0x17c1c00,0x17c2000,0x1804c00,0x1805000,0x1805400,0x1805800,0x1805c01,0x1849401
.long 0x1848400,0x1848800,0x1848c00,0x1849000,0x0,0x0,0x0,0x0
.long 0x140000,0x140080,0x140100,0x140180,0x140200,0x0,0x0,0x0
.long 0x1671000,0x1671400,0x1671800,0x1671c00,0x1672001,0x16b5801,0x16b4800,0x16b4c00
.long 0x16b5000,0x16b5400,0x16f8000,0x16f8400,0x16f8800,0x16f8c00,0x16f9001,0x173c801
.long 0x173b800,0x173bc00,0x173c000,0x173c400,0x0,0x0,0x0,0x0
.long 0x140280,0x140300,0x140380,0x140400,0x140480,0x0,0x0,0x0
.long 0x177f000,0x177f400,0x177f800,0x177fc00,0x1780001,0x17c3801,0x17c2800,0x17c2c00
.long 0x17c3000,0x17c3400,0x1806000,0x1806400,0x1806800,0x1806c00,0x1807001,0x184a801
.long 0x1849800,0x1849c00,0x184a000,0x184a400,0x0,0x0,0x0,0x0
.long 0x15e000,0x15e080,0x15e100,0x15e180,0x15e200,0x0,0x0,0x0
.long 0x1672400,0x1672800,0x1672c00,0x1673000,0x1673401,0x16b6c01,0x16b5c00,0x16b6000
.long 0x16b6400,0x16b6800,0x16f9400,0x16f9800,0x16f9c00,0x16fa000,0x16fa401,0x173dc01
.long 0x173cc00,0x173d000,0x173d400,0x173d800,0x0,0x0,0x0,0x0
.long 0x15e280,0x15e300,0x15e380,0x15e400,0x15e480,0x0,0x0,0x0
.long 0x1780400,0x1780800,0x1780c00,0x1781000,0x1781401,0x17c4c01,0x17c3c00,0x17c4000
.long 0x17c4400,0x17c4800,0x1807400,0x1807800,0x1807c00,0x1808000,0x1808401,0x184bc01
.long 0x184ac00,0x184b000,0x184b400,0x184b800,0x0,0x0,0x0,0x0
.long 0x186000,0x186080,0x186100,0x186180,0x186200,0x0,0x0,0x0
.long 0x1673800,0x1673c00,0x1674000,0x1674400,0x1674801,0x16b8001,0x16b7000,0x16b7400
.long 0x16b7800,0x16b7c00,0x16fa800,0x16fac00,0x16fb000,0x16fb400,0x16fb801,0x173f001
.long 0x173e000,0x173e400,0x173e800,0x173ec00,0x0,0x0,0x0,0x0
.long 0x186280,0x186300,0x186380,0x186400,0x186480,0x0,0x0,0x0
.long 0x1781800,0x1781c00,0x1782000,0x1782400,0x1782801,0x17c6001,0x17c5000,0x17c5400
.long 0x17c5800,0x17c5c00,0x1808800,0x1808c00,0x1809000,0x1809400,0x1809801,0x184d001
.long 0x184c000,0x184c400,0x184c800,0x184cc00,0x0,0x0,0x0,0x0
.long 0x1a4000,0x1a4080,0x1a4100,0x1a4180,0x1a4200,0x0,0x0,0x0
.long 0x1674c00,0x1675000,0x1675400,0x1675800,0x1675c01,0x16b9401,0x16b8400,0x16b8800
.long 0x16b8c00,0x16b9000,0x16fbc00,0x16fc000,0x16fc400,0x16fc800,0x16fcc01,0x1740401
.long 0x173f400,0x173f800,0x173fc00,0x1740000,0x0,0x0,0x0,0x0
.long 0x1a4280,0x1a4300,0x1a4380,0x1a4400,0x1a4480,0x0,0x0,0x0
.long 0x1782c00,0x1783000,0x1783400,0x1783800,0x1783c01,0x17c7401,0x17c6400,0x17c6800
.long 0x17c6c00,0x17c7000,0x1809c00,0x180a000,0x180a400,0x180a800,0x180ac01,0x184e401
.long 0x184d400,0x184d800,0x184dc00,0x184e000,0x0,0x0,0x0,0x0
.long 0x1cc000,0x1cc080,0x1cc100,0x1cc180,0x1cc200,0x0,0x0,0x0
.long 0x1676000,0x1676400,0x1676800,0x1676c00,0x1677001,0x16ba801,0x16b9800,0x16b9c00
.long 0x16ba000,0x16ba400,0x16fd000,0x16fd400,0x16fd800,0x16fdc00,0x16fe001,0x1741801
.long 0x1740800,0x1740c00,0x1741000,0x1741400,0x0,0x0,0x0,0x0
.long 0x1cc280,0x1cc300,0x1cc380,0x1cc400,0x1cc480,0x0,0x0,0x0
.long 0x1784000,0x1784400,0x1784800,0x1784c00,0x1785001,0x17c8801,0x17c7800,0x17c7c00
.long 0x17c8000,0x17c8400,0x180b000,0x180b400,0x180b800,0x180bc00,0x180c001,0x184f801
.long 0x184e800,0x184ec00,0x184f000,0x184f400,0x0,0x0,0x0,0x0
.long 0x1ea000,0x1ea080,0x1ea100,0x1ea180,0x1ea200,0x0,0x0,0x0
.long 0x1677400,0x1677800,0x1677c00,0x1678000,0x1678401,0x16bbc01,0x16bac00,0x16bb000
.long 0x16bb400,0x16bb800,0x16fe400,0x16fe800,0x16fec00,0x16ff000,0x16ff401,0x1742c01
.long 0x1741c00,0x1742000,0x1742400,0x1742800,0x0,0x0,0x0,0x0
.long 0x1ea280,0x1ea300,0x1ea380,0x1ea400,0x1ea480,0x0,0x0,0x0
.long 0x1785400,0x1785800,0x1785c00,0x1786000,0x1786401,0x17c9c01,0x17c8c00,0x17c9000
.long 0x17c9400,0x17c9800,0x180c400,0x180c800,0x180cc00,0x180d000,0x180d401,0x1850c01
.long 0x184fc00,0x1850000,0x1850400,0x1850800,0x0,0x0,0x0,0x0
.long 0x208000,0x208080,0x208100,0x208180,0x208200,0x0,0x0,0x0
.long 0x1678800,0x1678c00,0x1679000,0x1679400,0x1679801,0x16bd001,0x16bc000,0x16bc400
.long 0x16bc800,0x16bcc00,0x16ff800,0x16ffc00,0x1700000,0x1700400,0x1700801,0x1744001
.long 0x1743000,0x1743400,0x1743800,0x1743c00,0x0,0x0,0x0,0x0
.long 0x208280,0x208300,0x208380,0x208400,0x208480,0x0,0x0,0x0
.long 0x1786800,0x1786c00,0x1787000,0x1787400,0x1787801,0x17cb001,0x17ca000,0x17ca400
.long 0x17ca800,0x17cac00,0x180d800,0x180dc00,0x180e000,0x180e400,0x180e801,0x1852001
.long 0x1851000,0x1851400,0x1851800,0x1851c00,0x0,0x0,0x0,0x0
.long 0x122000,0x122080,0x122100,0x122180,0x122200,0x0,0x0,0x0
.long 0x1679c00,0x167a000,0x167a400,0x167a800,0x167ac01,0x16be401,0x16bd400,0x16bd800
.long 0x16bdc00,0x16be000,0x1700c00,0x1701000,0x1701400,0x1701800,0x1701c01,0x1745401
.long 0x1744400,0x1744800,0x1744c00,0x1745000,0x0,0x0,0x0,0x0
.long 0x122280,0x122300,0x122380,0x122400,0x122480,0x0,0x0,0x0
.long 0x1787c00,0x1788000,0x1788400,0x1788800,0x1788c01,0x17cc401,0x17cb400,0x17cb800
.long 0x17cbc00,0x17cc000,0x180ec00,0x180f000,0x180f400,0x180f800,0x180fc01,0x1853401
.long 0x1852400,0x1852800,0x1852c00,0x1853000,0x0,0x0,0x0,0x0
.long 0x14a000,0x14a080,0x14a100,0x14a180,0x14a200,0x0,0x0,0x0
.long 0x167b000,0x167b400,0x167b800,0x167bc00,0x167c001,0x16bf801,0x16be800,0x16bec00
.long 0x16bf000,0x16bf400,0x1702000,0x1702400,0x1702800,0x1702c00,0x1703001,0x1746801
.long 0x1745800,0x1745c00,0x1746000,0x1746400,0x0,0x0,0x0,0x0
.long 0x14a280,0x14a300,0x14a380,0x14a400,0x14a480,0x0,0x0,0x0
.long 0x1789000,0x1789400,0x1789800,0x1789c00,0x178a001,0x17cd801,0x17cc800,0x17ccc00
.long 0x17cd000,0x17cd400,0x1810000,0x1810400,0x1810800,0x1810c00,0x1811001,0x1854801
.long 0x1853800,0x1853c00,0x1854000,0x1854400,0x0,0x0,0x0,0x0
.long 0x168000,0x168080,0x168100,0x168180,0x168200,0x0,0x0,0x0
.long 0x167c400,0x167c800,0x167cc00,0x167d000,0x167d401,0x16c0c01,0x16bfc00,0x16c0000
.long 0x16c0400,0x16c0800,0x1703400,0x1703800,0x1703c00,0x1704000,0x1704401,0x1747c01
.long 0x1746c00,0x1747000,0x1747400,0x1747800,0x0,0x0,0x0,0x0
.long 0x168280,0x168300,0x168380,0x168400,0x168480,0x0,0x0,0x0
.long 0x178a400,0x178a800,0x178ac00,0x178b000,0x178b401,0x17cec01,0x17cdc00,0x17ce000
.long 0x17ce400,0x17ce800,0x1811400,0x1811800,0x1811c00,0x1812000,0x1812401,0x1855c01
.long 0x1854c00,0x1855000,0x1855400,0x1855800,0x0,0x0,0x0,0x0
.long 0x190000,0x190080,0x190100,0x190180,0x190200,0x0,0x0,0x0
.long 0x167d800,0x167dc00,0x167e000,0x167e400,0x167e801,0x16c2001,0x16c1000,0x16c1400
.long 0x16c1800,0x16c1c00,0x1704800,0x1704c00,0x1705000,0x1705400,0x1705801,0x1749001
.long 0x1748000,0x1748400,0x1748800,0x1748c00,0x0,0x0,0x0,0x0
.long 0x190280,0x190300,0x190380,0x190400,0x190480,0x0,0x0,0x0
.long 0x178b800,0x178bc00,0x178c000,0x178c400,0x178c801,0x17d0001,0x17cf000,0x17cf400
.long 0x17cf800,0x17cfc00,0x1812800,0x1812c00,0x1813000,0x1813400,0x1813801,0x1857001
.long 0x1856000,0x1856400,0x1856800,0x1856c00,0x0,0x0,0x0,0x0
.long 0x1ae000,0x1ae080,0x1ae100,0x1ae180,0x1ae200,0x0,0x0,0x0
.long 0x167ec00,0x167f000,0x167f400,0x167f800,0x167fc01,0x16c3401,0x16c2400,0x16c2800
.long 0x16c2c00,0x16c3000,0x1705c00,0x1706000,0x1706400,0x1706800,0x1706c01,0x174a401
.long 0x1749400,0x1749800,0x1749c00,0x174a000,0x0,0x0,0x0,0x0
.long 0x1ae280,0x1ae300,0x1ae380,0x1ae400,0x1ae480,0x0,0x0,0x0
.long 0x178cc00,0x178d000,0x178d400,0x178d800,0x178dc01,0x17d1401,0x17d0400,0x17d0800
.long 0x17d0c00,0x17d1000,0x1813c00,0x1814000,0x1814400,0x1814800,0x1814c01,0x1858401
.long 0x1857400,0x1857800,0x1857c00,0x1858000,0x0,0x0,0x0,0x0
.long 0x1d6000,0x1d6080,0x1d6100,0x1d6180,0x1d6200,0x0,0x0,0x0
.long 0x1680000,0x1680400,0x1680800,0x1680c00,0x1681001,0x16c4801,0x16c3800,0x16c3c00
.long 0x16c4000,0x16c4400,0x1707000,0x1707400,0x1707800,0x1707c00,0x1708001,0x174b801
.long 0x174a800,0x174ac00,0x174b000,0x174b400,0x0,0x0,0x0,0x0
.long 0x1d6280,0x1d6300,0x1d6380,0x1d6400,0x1d6480,0x0,0x0,0x0
.long 0x178e000,0x178e400,0x178e800,0x178ec00,0x178f001,0x17d2801,0x17d1800,0x17d1c00
.long 0x17d2000,0x17d2400,0x1815000,0x1815400,0x1815800,0x1815c00,0x1816001,0x1859801
.long 0x1858800,0x1858c00,0x1859000,0x1859400,0x0,0x0,0x0,0x0
.long 0x1f4000,0x1f4080,0x1f4100,0x1f4180,0x1f4200,0x0,0x0,0x0
.long 0x1681400,0x1681800,0x1681c00,0x1682000,0x1682401,0x16c5c01,0x16c4c00,0x16c5000
.long 0x16c5400,0x16c5800,0x1708400,0x1708800,0x1708c00,0x1709000,0x1709401,0x174cc01
.long 0x174bc00,0x174c000,0x174c400,0x174c800,0x0,0x0,0x0,0x0
.long 0x1f4280,0x1f4300,0x1f4380,0x1f4400,0x1f4480,0x0,0x0,0x0
.long 0x178f400,0x178f800,0x178fc00,0x1790000,0x1790401,0x17d3c01,0x17d2c00,0x17d3000
.long 0x17d3400,0x17d3800,0x1816400,0x1816800,0x1816c00,0x1817000,0x1817401,0x185ac01
.long 0x1859c00,0x185a000,0x185a400,0x185a800,0x0,0x0,0x0,0x0
.long 0x212000,0x212080,0x212100,0x212180,0x212200,0x0,0x0,0x0
.long 0x1682800,0x1682c00,0x1683000,0x1683400,0x1683801,0x16c7001,0x16c6000,0x16c6400
.long 0x16c6800,0x16c6c00,0x1709800,0x1709c00,0x170a000,0x170a400,0x170a801,0x174e001
.long 0x174d000,0x174d400,0x174d800,0x174dc00,0x0,0x0,0x0,0x0
.long 0x212280,0x212300,0x212380,0x212400,0x212480,0x0,0x0,0x0
.long 0x1790800,0x1790c00,0x1791000,0x1791400,0x1791801,0x17d5001,0x17d4000,0x17d4400
.long 0x17d4800,0x17d4c00,0x1817800,0x1817c00,0x1818000,0x1818400,0x1818801,0x185c001
.long 0x185b000,0x185b400,0x185b800,0x185bc00,0x0,0x0,0x0,0x0
.long 0x12c000,0x12c080,0x12c100,0x12c180,0x12c200,0x0,0x0,0x0
.long 0x1683c00,0x1684000,0x1684400,0x1684800,0x1684c01,0x16c8401,0x16c7400,0x16c7800
.long 0x16c7c00,0x16c8000,0x170ac00,0x170b000,0x170b400,0x170b800,0x170bc01,0x174f401
.long 0x174e400,0x174e800,0x174ec00,0x174f000,0x0,0x0,0x0,0x0
.long 0x12c280,0x12c300,0x12c380,0x12c400,0x12c480,0x0,0x0,0x0
.long 0x1791c00,0x1792000,0x1792400,0x1792800,0x1792c01,0x17d6401,0x17d5400,0x17d5800
.long 0x17d5c00,0x17d6000,0x1818c00,0x1819000,0x1819400,0x1819800,0x1819c01,0x185d401
.long 0x185c400,0x185c800,0x185cc00,0x185d000,0x0,0x0,0x0,0x0
.long 0x172000,0x172080,0x172100,0x172180,0x172200,0x0,0x0,0x0
.long 0x1685000,0x1685400,0x1685800,0x1685c00,0x1686001,0x16c9801,0x16c8800,0x16c8c00
.long 0x16c9000,0x16c9400,0x170c000,0x170c400,0x170c800,0x170cc00,0x170d001,0x1750801
.long 0x174f800,0x174fc00,0x1750000,0x1750400,0x0,0x0,0x0,0x0
.long 0x172280,0x172300,0x172380,0x172400,0x172480,0x0,0x0,0x0
.long 0x1793000,0x1793400,0x1793800,0x1793c00,0x1794001,0x17d7801,0x17d6800,0x17d6c00
.long 0x17d7000,0x17d7400,0x181a000,0x181a400,0x181a800,0x181ac00,0x181b001,0x185e801
.long 0x185d800,0x185dc00,0x185e000,0x185e400,0x0,0x0,0x0,0x0
.long 0x1b8000,0x1b8080,0x1b8100,0x1b8180,0x1b8200,0x0,0x0,0x0
.long 0x1686400,0x1686800,0x1686c00,0x1687000,0x1687401,0x16cac01,0x16c9c00,0x16ca000
.long 0x16ca400,0x16ca800,0x170d400,0x170d800,0x170dc00,0x170e000,0x170e401,0x1751c01
.long 0x1750c00,0x1751000,0x1751400,0x1751800,0x0,0x0,0x0,0x0
.long 0x1b8280,0x1b8300,0x1b8380,0x1b8400,0x1b8480,0x0,0x0,0x0
.long 0x1794400,0x1794800,0x1794c00,0x1795000,0x1795401,0x17d8c01,0x17d7c00,0x17d8000
.long 0x17d8400,0x17d8800,0x181b400,0x181b800,0x181bc00,0x181c000,0x181c401,0x185fc01
.long 0x185ec00,0x185f000,0x185f400,0x185f800,0x0,0x0,0x0,0x0
.section .rodata,"a"
.p2align 6
.amdhsa_kernel sequential_preLN__softmax_full_mha__dense_activation_silu__prompt_kernel
  .amdhsa_next_free_vgpr 256
  .amdhsa_next_free_sgpr 98
  .amdhsa_accum_offset 256
  .amdhsa_group_segment_fixed_size 0
  .amdhsa_kernarg_size 72
  .amdhsa_user_sgpr_count 2
  .amdhsa_user_sgpr_kernarg_segment_ptr 1
  .amdhsa_system_sgpr_workgroup_id_x 1
.end_amdhsa_kernel
```
